```python
import torch

def _softmax(x, axis=-1):
    return torch.softmax(x, dim=axis)
def _gelu(x):
    return torch.nn.functional.gelu(x, approximate="tanh")
def _silu(x):
    return torch.nn.functional.silu(x)
def _sigmoid(x):
    return torch.sigmoid(x)
def _layernorm(x, axis=-1, eps=1e-5):
    m = x.mean(dim=axis, keepdim=True)
    v = x.var(dim=axis, keepdim=True, unbiased=False)
    return (x - m) / torch.sqrt(v + eps)
def _scatter_add(tgt, idx, src, axis=0):
    return tgt.clone().index_add_(axis, idx, src)
def _segment_sum(src, seg, n):
    out = torch.zeros((n,) + src.shape[1:], dtype=src.dtype)
    return out.index_add_(0, seg, src)
def _pad(x, pw):
    flat = tuple(v for pair in reversed(pw) for v in pair)
    return torch.nn.functional.pad(x, flat)

kernel_name = 'recurrent_scan__mha_block_cached__glu_gated_swiglu__prompt'

def setup_inputs():

    _w = (lambda a: (lambda t: t.to(torch.bfloat16) if t.is_floating_point() else t)(torch.as_tensor(a)))
    def _A_setup():
        B, Sq, D = 1, 2048, 640
        H, Sk, Dh = 32, 2048, 192
        return {
            "x": _w((lambda *s: torch.randn(*s, dtype=torch.bfloat16) * 0.05)(B, Sq, D)),
            "k_cache": _w((lambda *s: torch.randn(*s, dtype=torch.bfloat16) * 1.6)(B, H, Sk, Dh)),
            "v_cache": _w((lambda *s: torch.randn(*s, dtype=torch.bfloat16) * 1.6)(B, H, Sk, Dh)),
            "wq": _w((lambda *s: torch.randn(*s, dtype=torch.bfloat16) * 1.6)(D, H * Dh) * (D ** -0.5)),
            "wo": _w((lambda *s: torch.randn(*s, dtype=torch.bfloat16) * 1.6)(H * Dh, D) * ((H * Dh) ** -0.5)),
        }
    _A_in = _A_setup()

    def _B_setup():
        B, S, D, F = 1, 2048, 640, 1536
        return {
            "x": _w((lambda *s: torch.randn(*s, dtype=torch.bfloat16) * 0.05)(B, S, D)),
            "w1": _w((lambda *s: torch.randn(*s, dtype=torch.bfloat16) * 0.2)(D, F) * (2.0 / D) ** 0.5),
            "w3": _w((lambda *s: torch.randn(*s, dtype=torch.bfloat16) * 0.2)(D, F) * (2.0 / D) ** 0.5),
            "w2": _w((lambda *s: torch.randn(*s, dtype=torch.bfloat16) * 0.2)(F, D) * (2.0 / F) ** 0.5),
        }
    _B_in = _B_setup()

    return {
        "A_x": _A_in["x"],
        "A_k_cache": _A_in["k_cache"],
        "A_v_cache": _A_in["v_cache"],
        "A_wq": _A_in["wq"],
        "A_wo": _A_in["wo"],
        "B_x": _B_in["x"],
        "B_w1": _B_in["w1"],
        "B_w3": _B_in["w3"],
        "B_w2": _B_in["w2"],
    }

def reference(A_x, A_k_cache, A_v_cache, A_wq, A_wo, B_x, B_w1, B_w3, B_w2):
    def _A_ref(x, k_cache, v_cache, wq, wo):
        B, Sq, D = x.shape
        H, Dh = 32, 192
        q = (lambda x, *d: x.permute(*d))((x @ wq).reshape(B, Sq, H, Dh), 0, 2, 1, 3)
        scores = torch.einsum("bhqd,bhkd->bhqk", q, k_cache) * (Dh ** -0.5)
        p = _softmax(scores, axis=-1)
        o = torch.einsum("bhqk,bhkd->bhqd", p, v_cache)
        return (lambda x, *d: x.permute(*d))(o, 0, 2, 1, 3).reshape(B, Sq, H * Dh) @ wo

    def _B_ref(x, w1, w3, w2):
        gate = torch.einsum("bsd,df->bsf", x, w1)
        up = torch.einsum("bsd,df->bsf", x, w3)
        h = _silu(gate) * up
        out = torch.einsum("bsf,fd->bsd", h, w2)
        return out

    x = A_x
    xn = _layernorm(x, axis=-1)
    s = _A_ref(xn, A_k_cache, A_v_cache, A_wq, A_wo)
    g = _silu(_B_ref(xn, B_w1, B_w3, B_w2))
    return x + s * g
```

```asm
; @launch grid=(256,1,1) block=(256,1,1) lds=163840
.amdgcn_target "amdgcn-amd-amdhsa--gfx950"
.text
.globl recurrent_scan__mha_block_cached__glu_gated_swiglu__prompt_kernel
.p2align 8
.type recurrent_scan__mha_block_cached__glu_gated_swiglu__prompt_kernel,@function
recurrent_scan__mha_block_cached__glu_gated_swiglu__prompt_kernel:
s_cmp_ge_u32 s2, 256
s_cbranch_scc1 L_at_end
s_load_dwordx2 s[68:69], s[0:1], 0
s_load_dwordx2 s[16:17], s[0:1], 24
s_load_dwordx4 s[20:23], s[0:1], 48
s_load_dwordx4 s[4:7], s[0:1], 80
s_load_dwordx4 s[8:11], s[0:1], 8
s_load_dwordx2 s[64:65], s[0:1], 32
s_load_dwordx4 s[80:83], s[0:1], 64
s_and_b32 s36, s2, 7
s_lshl_b32 s36, s36, 2
s_bfe_u32 s37, s2, 0x20003
s_add_u32 s36, s36, s37
s_lshr_b32 s37, s2, 5
v_lshrrev_b32 v1, 6, v0
v_and_b32 v2, 63, v0
v_lshlrev_b32 v57, 4, v2
v_readfirstlane_b32 s38, v1
s_getpc_b64 s[46:47]
L_pc0:
s_lshr_b32 s55, s2, 3
s_lshl_b32 s55, s55, 12
v_lshl_add_u32 v113, v0, 4, s55
v_min_u32 v113, L_code_end-L_pc0-16, v113
global_load_dwordx4 v[120:123], v113, s[46:47]
s_lshl_b32 s55, s37, 8
s_lshl_b32 s56, s36, 3
s_add_u32 s55, s55, s56
v_lshrrev_b32 v110, 5, v0
v_and_b32 v111, 31, v0
v_add_u32 v112, s55, v110
v_mul_u32_u24 v112, 1280, v112
v_lshl_add_u32 v112, v111, 3, v112
s_waitcnt lgkmcnt(0)
s_and_b32 s69, s69, 0xffff
s_mov_b32 s70, 2621440
s_mov_b32 s71, 0x20000
buffer_load_dwordx2 v[64:65], v112, s[68:71], 0 offen offset:0
buffer_load_dwordx2 v[66:67], v112, s[68:71], 0 offen offset:256
buffer_load_dwordx2 v[68:69], v112, s[68:71], 0 offen offset:512
buffer_load_dwordx2 v[70:71], v112, s[68:71], 0 offen offset:768
buffer_load_dwordx2 v[72:73], v112, s[68:71], 0 offen offset:1024
v_mul_u32_u24 v3, 192, v1
v_add_u32 v3, v3, v2
s_mov_b32 s48, 178956971
s_mov_b32 s49, 715827883
s_and_b32 s53, s36, 1
s_lshl_b32 s53, s53, 1
v_add_u32 v60, 0, v3
v_mul_hi_u32 v61, v60, s48
v_mul_u32_u24 v62, 24, v61
v_sub_u32 v62, v60, v62
v_bfe_u32 v63, v61, 1, 3
v_xor_b32 v63, v63, v62
v_mul_u32_u24 v60, 384, v61
v_lshl_add_u32 v4, v63, 4, v60
v_bfe_u32 v63, v61, 1, 2
v_lshlrev_b32 v63, 1, v63
v_xor_b32 v63, v63, v62
v_lshl_add_u32 v7, v63, 4, v60
v_mul_u32_u24 v60, 12288, v61
v_lshl_add_u32 v10, v63, 4, v60
v_add_u32 v60, 0, v2
v_mul_hi_u32 v61, v60, s49
v_mul_u32_u24 v62, 6, v61
v_sub_u32 v62, v60, v62
v_add_u32 v62, s53, v62
v_subrev_u32 v63, 6, v62
v_min_u32 v62, v62, v63
v_and_b32 v63, 1, v1
v_lshl_add_u32 v61, v63, 5, v61
v_mul_u32_u24 v61, 3072, v61
v_lshl_add_u32 v13, v62, 4, v61
v_add_u32 v60, 64, v3
v_mul_hi_u32 v61, v60, s48
v_mul_u32_u24 v62, 24, v61
v_sub_u32 v62, v60, v62
v_bfe_u32 v63, v61, 1, 3
v_xor_b32 v63, v63, v62
v_mul_u32_u24 v60, 384, v61
v_lshl_add_u32 v5, v63, 4, v60
v_bfe_u32 v63, v61, 1, 2
v_lshlrev_b32 v63, 1, v63
v_xor_b32 v63, v63, v62
v_lshl_add_u32 v8, v63, 4, v60
v_mul_u32_u24 v60, 12288, v61
v_lshl_add_u32 v11, v63, 4, v60
v_add_u32 v60, 64, v2
v_mul_hi_u32 v61, v60, s49
v_mul_u32_u24 v62, 6, v61
v_sub_u32 v62, v60, v62
v_add_u32 v62, s53, v62
v_subrev_u32 v63, 6, v62
v_min_u32 v62, v62, v63
v_and_b32 v63, 1, v1
v_lshl_add_u32 v61, v63, 5, v61
v_mul_u32_u24 v61, 3072, v61
v_lshl_add_u32 v14, v62, 4, v61
v_subrev_u32 v5, 1024, v5
v_subrev_u32 v8, 1024, v8
v_subrev_u32 v11, 1024, v11
v_subrev_u32 v14, 1024, v14
v_add_u32 v60, 128, v3
v_mul_hi_u32 v61, v60, s48
v_mul_u32_u24 v62, 24, v61
v_sub_u32 v62, v60, v62
v_bfe_u32 v63, v61, 1, 3
v_xor_b32 v63, v63, v62
v_mul_u32_u24 v60, 384, v61
v_lshl_add_u32 v6, v63, 4, v60
v_bfe_u32 v63, v61, 1, 2
v_lshlrev_b32 v63, 1, v63
v_xor_b32 v63, v63, v62
v_lshl_add_u32 v9, v63, 4, v60
v_mul_u32_u24 v60, 12288, v61
v_lshl_add_u32 v12, v63, 4, v60
v_add_u32 v60, 128, v2
v_mul_hi_u32 v61, v60, s49
v_mul_u32_u24 v62, 6, v61
v_sub_u32 v62, v60, v62
v_add_u32 v62, s53, v62
v_subrev_u32 v63, 6, v62
v_min_u32 v62, v62, v63
v_and_b32 v63, 1, v1
v_lshl_add_u32 v61, v63, 5, v61
v_mul_u32_u24 v61, 3072, v61
v_lshl_add_u32 v15, v62, 4, v61
v_subrev_u32 v6, 2048, v6
v_subrev_u32 v9, 2048, v9
v_subrev_u32 v12, 2048, v12
v_subrev_u32 v15, 2048, v15
s_mov_b32 s55, s4
s_mov_b32 s56, s5
s_mov_b32 s4, s6
s_mov_b32 s5, s7
s_mov_b32 s6, s55
s_mov_b32 s7, s56
s_and_b32 s17, s17, 0xffff
s_mov_b32 s18, 7864320
s_mov_b32 s19, 0x20000
s_cmp_ge_u32 s38, 2
s_cselect_b32 s20, s22, s20
s_cselect_b32 s21, s23, s21
s_and_b32 s21, s21, 0xffff
s_mov_b32 s22, 1966080
s_mov_b32 s23, 0x20000
s_mul_i32 s39, s38, 3072
s_mul_i32 s42, s36, 384
s_mul_i32 s43, s36, 96
s_mov_b32 s40, 0
s_mov_b32 s41, 0
s_mov_b32 s44, 0
s_add_u32 m0, s39, 0
s_nop 0
buffer_load_dwordx4 v10, s[16:19], s42 offen offset:0 lds
buffer_load_dwordx4 v11, s[16:19], s42 offen offset:1024 lds
buffer_load_dwordx4 v12, s[16:19], s42 offen offset:2048 lds
s_add_u32 s42, s42, 393216
s_add_u32 m0, s39, 12288
s_nop 0
buffer_load_dwordx4 v10, s[16:19], s42 offen offset:0 lds
buffer_load_dwordx4 v11, s[16:19], s42 offen offset:1024 lds
buffer_load_dwordx4 v12, s[16:19], s42 offen offset:2048 lds
s_add_u32 s42, s42, 393216
s_add_u32 m0, s39, 24576
s_nop 0
buffer_load_dwordx4 v13, s[20:23], s43 offen offset:0 lds
buffer_load_dwordx4 v14, s[20:23], s43 offen offset:1024 lds
buffer_load_dwordx4 v15, s[20:23], s43 offen offset:2048 lds
s_add_u32 s43, s43, 196608
s_add_u32 s24, s4, 4096
s_addc_u32 s25, s5, 0
s_and_b32 s25, s25, 0xffff
s_mov_b32 s26, 2621440
s_mov_b32 s27, 0x20000
s_add_u32 s60, s4, 62914560
s_addc_u32 s61, s5, 0
s_and_b32 s61, s61, 0xffff
s_mov_b32 s62, 40960
s_mov_b32 s63, 0x20000
s_mul_i32 s58, s2, 160
v_mov_b32 v113, 0
v_min_u32 v114, 39, v2
v_lshlrev_b32 v114, 2, v114
buffer_store_dword v113, v114, s[60:63], s58 offen sc1
v_lshrrev_b32 v114, 3, v111
v_lshlrev_b32 v114, 9, v114
v_and_b32 v115, 3, v111
v_lshl_add_u32 v114, v115, 7, v114
v_lshl_add_u32 v114, v110, 4, v114
v_bfe_u32 v115, v111, 2, 1
v_lshl_add_u32 v114, v115, 3, v114
v_add_u32 v114, 147456, v114
v_lshlrev_b32 v115, 4, v0
v_add_u32 v115, 147456, v115
v_lshrrev_b32 v116, 5, v0
v_lshlrev_b32 v116, 10, v116
v_bfe_u32 v117, v0, 3, 2
v_lshl_add_u32 v116, v117, 8, v116
v_and_b32 v117, 7, v0
v_lshl_add_u32 v116, v117, 4, v116
s_lshl_b32 s55, s37, 4
s_lshr_b32 s56, s36, 1
s_add_u32 s55, s55, s56
s_mul_i32 s55, s55, 20480
s_and_b32 s56, s36, 1
s_lshl_b32 s56, s56, 7
s_add_u32 s55, s55, s56
v_cmp_gt_u32 vcc, 128, v0
v_mov_b32 v117, 0x7ff00000
s_mov_b32 s94, 0xffff0000
v_add_u32 v118, 16384, v116
v_cndmask_b32 v117, v117, v118, vcc
s_waitcnt vmcnt(14)
v_lshlrev_b32 v80, 16, v64
v_and_b32 v81, s94, v64
v_lshlrev_b32 v82, 16, v65
v_and_b32 v83, s94, v65
s_waitcnt vmcnt(13)
v_lshlrev_b32 v84, 16, v66
v_and_b32 v85, s94, v66
v_lshlrev_b32 v86, 16, v67
v_and_b32 v87, s94, v67
s_waitcnt vmcnt(12)
v_lshlrev_b32 v88, 16, v68
v_and_b32 v89, s94, v68
v_lshlrev_b32 v90, 16, v69
v_and_b32 v91, s94, v69
s_waitcnt vmcnt(11)
v_lshlrev_b32 v92, 16, v70
v_and_b32 v93, s94, v70
v_lshlrev_b32 v94, 16, v71
v_and_b32 v95, s94, v71
s_waitcnt vmcnt(10)
v_lshlrev_b32 v96, 16, v72
v_and_b32 v97, s94, v72
v_lshlrev_b32 v98, 16, v73
v_and_b32 v99, s94, v73
v_add_f32 v100, v80, v81
v_add_f32 v101, v82, v83
v_add_f32 v100, v100, v84
v_add_f32 v101, v101, v85
v_add_f32 v100, v100, v86
v_add_f32 v101, v101, v87
v_add_f32 v100, v100, v88
v_add_f32 v101, v101, v89
v_add_f32 v100, v100, v90
v_add_f32 v101, v101, v91
v_add_f32 v100, v100, v92
v_add_f32 v101, v101, v93
v_add_f32 v100, v100, v94
v_add_f32 v101, v101, v95
v_add_f32 v100, v100, v96
v_add_f32 v101, v101, v97
v_add_f32 v100, v100, v98
v_add_f32 v101, v101, v99
v_add_f32 v100, v100, v101
s_nop 1
v_add_f32_dpp v100, v100, v100 row_ror:8 row_mask:0xf bank_mask:0xf
s_nop 1
v_add_f32_dpp v100, v100, v100 row_ror:4 row_mask:0xf bank_mask:0xf
s_nop 1
v_add_f32_dpp v100, v100, v100 row_ror:2 row_mask:0xf bank_mask:0xf
s_nop 1
v_add_f32_dpp v100, v100, v100 row_ror:1 row_mask:0xf bank_mask:0xf
v_mov_b32 v102, v100
v_mov_b32 v103, v100
s_nop 1
v_permlane16_swap_b32 v102, v103
s_nop 1
v_add_f32 v100, v102, v103
v_mul_f32 v100, 0x3acccccd, v100
v_sub_f32 v102, v80, v100
v_sub_f32 v103, v81, v100
v_mul_f32 v101, v102, v102
v_mul_f32 v104, v103, v103
v_sub_f32 v102, v82, v100
v_fmac_f32 v101, v102, v102
v_sub_f32 v103, v83, v100
v_fmac_f32 v104, v103, v103
v_sub_f32 v102, v84, v100
v_fmac_f32 v101, v102, v102
v_sub_f32 v103, v85, v100
v_fmac_f32 v104, v103, v103
v_sub_f32 v102, v86, v100
v_fmac_f32 v101, v102, v102
v_sub_f32 v103, v87, v100
v_fmac_f32 v104, v103, v103
v_sub_f32 v102, v88, v100
v_fmac_f32 v101, v102, v102
v_sub_f32 v103, v89, v100
v_fmac_f32 v104, v103, v103
v_sub_f32 v102, v90, v100
v_fmac_f32 v101, v102, v102
v_sub_f32 v103, v91, v100
v_fmac_f32 v104, v103, v103
v_sub_f32 v102, v92, v100
v_fmac_f32 v101, v102, v102
v_sub_f32 v103, v93, v100
v_fmac_f32 v104, v103, v103
v_sub_f32 v102, v94, v100
v_fmac_f32 v101, v102, v102
v_sub_f32 v103, v95, v100
v_fmac_f32 v104, v103, v103
v_sub_f32 v102, v96, v100
v_fmac_f32 v101, v102, v102
v_sub_f32 v103, v97, v100
v_fmac_f32 v104, v103, v103
v_sub_f32 v102, v98, v100
v_fmac_f32 v101, v102, v102
v_sub_f32 v103, v99, v100
v_fmac_f32 v104, v103, v103
v_add_f32 v101, v101, v104
s_nop 1
v_add_f32_dpp v101, v101, v101 row_ror:8 row_mask:0xf bank_mask:0xf
s_nop 1
v_add_f32_dpp v101, v101, v101 row_ror:4 row_mask:0xf bank_mask:0xf
s_nop 1
v_add_f32_dpp v101, v101, v101 row_ror:2 row_mask:0xf bank_mask:0xf
s_nop 1
v_add_f32_dpp v101, v101, v101 row_ror:1 row_mask:0xf bank_mask:0xf
v_mov_b32 v102, v101
v_mov_b32 v103, v101
s_nop 1
v_permlane16_swap_b32 v102, v103
s_nop 1
v_add_f32 v101, v102, v103
v_mul_f32 v101, 0x3acccccd, v101
v_cvt_pk_bf16_f32 v101, v101, v101
v_lshlrev_b32 v101, 16, v101
v_add_f32 v101, 0x3727c5ac, v101
v_cvt_pk_bf16_f32 v101, v101, v101
v_lshlrev_b32 v101, 16, v101
v_sqrt_f32 v101, v101
s_nop 0
v_cvt_pk_bf16_f32 v101, v101, v101
v_lshlrev_b32 v101, 16, v101
v_rcp_f32 v101, v101
v_cvt_pk_bf16_f32 v100, v100, v100
v_lshlrev_b32 v100, 16, v100
s_mov_b32 s95, 0x3dd53b95
v_sub_f32 v80, v80, v100
v_sub_f32 v81, v81, v100
v_cvt_pk_bf16_f32 v102, v80, v81
v_lshlrev_b32 v80, 16, v102
v_and_b32 v81, s94, v102
v_mul_f32 v80, v80, v101
v_mul_f32 v81, v81, v101
v_cvt_pk_bf16_f32 v102, v80, v81
v_lshlrev_b32 v80, 16, v102
v_and_b32 v81, s94, v102
v_mul_f32 v80, s95, v80
v_mul_f32 v81, s95, v81
v_cvt_pk_bf16_f32 v64, v80, v81
v_sub_f32 v82, v82, v100
v_sub_f32 v83, v83, v100
v_cvt_pk_bf16_f32 v102, v82, v83
v_lshlrev_b32 v82, 16, v102
v_and_b32 v83, s94, v102
v_mul_f32 v82, v82, v101
v_mul_f32 v83, v83, v101
v_cvt_pk_bf16_f32 v102, v82, v83
v_lshlrev_b32 v82, 16, v102
v_and_b32 v83, s94, v102
v_mul_f32 v82, s95, v82
v_mul_f32 v83, s95, v83
v_cvt_pk_bf16_f32 v65, v82, v83
ds_write_b64 v114, v[64:65] offset:0
v_sub_f32 v84, v84, v100
v_sub_f32 v85, v85, v100
v_cvt_pk_bf16_f32 v102, v84, v85
v_lshlrev_b32 v84, 16, v102
v_and_b32 v85, s94, v102
v_mul_f32 v84, v84, v101
v_mul_f32 v85, v85, v101
v_cvt_pk_bf16_f32 v102, v84, v85
v_lshlrev_b32 v84, 16, v102
v_and_b32 v85, s94, v102
v_mul_f32 v84, s95, v84
v_mul_f32 v85, s95, v85
v_cvt_pk_bf16_f32 v66, v84, v85
v_sub_f32 v86, v86, v100
v_sub_f32 v87, v87, v100
v_cvt_pk_bf16_f32 v102, v86, v87
v_lshlrev_b32 v86, 16, v102
v_and_b32 v87, s94, v102
v_mul_f32 v86, v86, v101
v_mul_f32 v87, v87, v101
v_cvt_pk_bf16_f32 v102, v86, v87
v_lshlrev_b32 v86, 16, v102
v_and_b32 v87, s94, v102
v_mul_f32 v86, s95, v86
v_mul_f32 v87, s95, v87
v_cvt_pk_bf16_f32 v67, v86, v87
ds_write_b64 v114, v[66:67] offset:2048
v_sub_f32 v88, v88, v100
v_sub_f32 v89, v89, v100
v_cvt_pk_bf16_f32 v102, v88, v89
v_lshlrev_b32 v88, 16, v102
v_and_b32 v89, s94, v102
v_mul_f32 v88, v88, v101
v_mul_f32 v89, v89, v101
v_cvt_pk_bf16_f32 v102, v88, v89
v_lshlrev_b32 v88, 16, v102
v_and_b32 v89, s94, v102
v_mul_f32 v88, s95, v88
v_mul_f32 v89, s95, v89
v_cvt_pk_bf16_f32 v68, v88, v89
v_sub_f32 v90, v90, v100
v_sub_f32 v91, v91, v100
v_cvt_pk_bf16_f32 v102, v90, v91
v_lshlrev_b32 v90, 16, v102
v_and_b32 v91, s94, v102
v_mul_f32 v90, v90, v101
v_mul_f32 v91, v91, v101
v_cvt_pk_bf16_f32 v102, v90, v91
v_lshlrev_b32 v90, 16, v102
v_and_b32 v91, s94, v102
v_mul_f32 v90, s95, v90
v_mul_f32 v91, s95, v91
v_cvt_pk_bf16_f32 v69, v90, v91
ds_write_b64 v114, v[68:69] offset:4096
v_sub_f32 v92, v92, v100
v_sub_f32 v93, v93, v100
v_cvt_pk_bf16_f32 v102, v92, v93
v_lshlrev_b32 v92, 16, v102
v_and_b32 v93, s94, v102
v_mul_f32 v92, v92, v101
v_mul_f32 v93, v93, v101
v_cvt_pk_bf16_f32 v102, v92, v93
v_lshlrev_b32 v92, 16, v102
v_and_b32 v93, s94, v102
v_mul_f32 v92, s95, v92
v_mul_f32 v93, s95, v93
v_cvt_pk_bf16_f32 v70, v92, v93
v_sub_f32 v94, v94, v100
v_sub_f32 v95, v95, v100
v_cvt_pk_bf16_f32 v102, v94, v95
v_lshlrev_b32 v94, 16, v102
v_and_b32 v95, s94, v102
v_mul_f32 v94, v94, v101
v_mul_f32 v95, v95, v101
v_cvt_pk_bf16_f32 v102, v94, v95
v_lshlrev_b32 v94, 16, v102
v_and_b32 v95, s94, v102
v_mul_f32 v94, s95, v94
v_mul_f32 v95, s95, v95
v_cvt_pk_bf16_f32 v71, v94, v95
ds_write_b64 v114, v[70:71] offset:6144
v_sub_f32 v96, v96, v100
v_sub_f32 v97, v97, v100
v_cvt_pk_bf16_f32 v102, v96, v97
v_lshlrev_b32 v96, 16, v102
v_and_b32 v97, s94, v102
v_mul_f32 v96, v96, v101
v_mul_f32 v97, v97, v101
v_cvt_pk_bf16_f32 v102, v96, v97
v_lshlrev_b32 v96, 16, v102
v_and_b32 v97, s94, v102
v_mul_f32 v96, s95, v96
v_mul_f32 v97, s95, v97
v_cvt_pk_bf16_f32 v72, v96, v97
v_sub_f32 v98, v98, v100
v_sub_f32 v99, v99, v100
v_cvt_pk_bf16_f32 v102, v98, v99
v_lshlrev_b32 v98, 16, v102
v_and_b32 v99, s94, v102
v_mul_f32 v98, v98, v101
v_mul_f32 v99, v99, v101
v_cvt_pk_bf16_f32 v102, v98, v99
v_lshlrev_b32 v98, 16, v102
v_and_b32 v99, s94, v102
v_mul_f32 v98, s95, v98
v_mul_f32 v99, s95, v99
v_cvt_pk_bf16_f32 v73, v98, v99
ds_write_b64 v114, v[72:73] offset:8192
s_waitcnt lgkmcnt(0)
s_barrier
ds_read_b128 v[80:83], v115 offset:0
ds_read_b128 v[84:87], v115 offset:4096
ds_read_b128 v[88:91], v115 offset:8192
s_add_u32 s56, s55, 8192
s_waitcnt lgkmcnt(2)
buffer_store_dwordx4 v[80:83], v116, s[24:27], s55 offen sc1
s_waitcnt lgkmcnt(1)
buffer_store_dwordx4 v[84:87], v116, s[24:27], s56 offen sc1
s_waitcnt lgkmcnt(0)
buffer_store_dwordx4 v[88:91], v117, s[24:27], s55 offen sc1
s_lshl_b32 s93, s37, 5
v_mov_b32 v110, s93
v_mov_b32 v102, 1
s_waitcnt vmcnt(0)
s_barrier
s_cmp_lg_u32 s38, 0
s_cbranch_scc1 L_nosig
s_mov_b64 exec, 1
global_atomic_add v110, v102, s[6:7]
s_mov_b64 exec, -1
L_nosig:
s_add_u32 m0, s39, 36864
s_nop 0
buffer_load_dwordx4 v10, s[16:19], s42 offen offset:0 lds
buffer_load_dwordx4 v11, s[16:19], s42 offen offset:1024 lds
buffer_load_dwordx4 v12, s[16:19], s42 offen offset:2048 lds
s_add_u32 s42, s42, 393216
s_add_u32 m0, s39, 49152
s_nop 0
buffer_load_dwordx4 v10, s[16:19], s42 offen offset:0 lds
buffer_load_dwordx4 v11, s[16:19], s42 offen offset:1024 lds
buffer_load_dwordx4 v12, s[16:19], s42 offen offset:2048 lds
s_add_u32 s42, s42, 393216
s_add_u32 m0, s39, 61440
s_nop 0
buffer_load_dwordx4 v13, s[20:23], s43 offen offset:0 lds
buffer_load_dwordx4 v14, s[20:23], s43 offen offset:1024 lds
buffer_load_dwordx4 v15, s[20:23], s43 offen offset:2048 lds
s_add_u32 s43, s43, 196608
s_add_u32 m0, s39, 73728
s_nop 0
buffer_load_dwordx4 v10, s[16:19], s42 offen offset:0 lds
buffer_load_dwordx4 v11, s[16:19], s42 offen offset:1024 lds
buffer_load_dwordx4 v12, s[16:19], s42 offen offset:2048 lds
s_add_u32 s42, s42, 393216
s_add_u32 m0, s39, 86016
s_nop 0
buffer_load_dwordx4 v10, s[16:19], s42 offen offset:0 lds
buffer_load_dwordx4 v11, s[16:19], s42 offen offset:1024 lds
buffer_load_dwordx4 v12, s[16:19], s42 offen offset:2048 lds
s_add_u32 s42, s42, 393216
s_add_u32 m0, s39, 98304
s_nop 0
buffer_load_dwordx4 v13, s[20:23], s43 offen offset:0 lds
buffer_load_dwordx4 v14, s[20:23], s43 offen offset:1024 lds
buffer_load_dwordx4 v15, s[20:23], s43 offen offset:2048 lds
s_add_u32 s43, s43, 196608
s_mul_i32 s52, s36, 786432
s_add_u32 s12, s10, s52
s_addc_u32 s13, s11, 0
s_and_b32 s13, s13, 0xffff
s_mov_b32 s14, 786432
s_mov_b32 s15, 0x20000
s_add_u32 s8, s8, s52
s_addc_u32 s9, s9, 0
s_and_b32 s9, s9, 0xffff
s_mov_b32 s10, 786432
s_mov_b32 s11, 0x20000
s_add_u32 s28, s4, 4194304
s_addc_u32 s29, s5, 0
s_and_b32 s29, s29, 0xffff
s_mov_b32 s30, 25165824
s_mov_b32 s31, 0x20000
s_add_u32 s32, s4, 29360128
s_addc_u32 s33, s5, 0
s_and_b32 s33, s33, 0xffff
s_mov_b32 s34, 6291456
s_mov_b32 s35, 0x20000
s_add_u32 s76, s4, 37748736
s_addc_u32 s77, s5, 0
s_and_b32 s77, s77, 0xffff
s_mov_b32 s78, 20971520
s_mov_b32 s79, 0x20000
s_mov_b32 s72, s82
s_and_b32 s73, s83, 0xffff
s_mov_b32 s74, 2621440
s_mov_b32 s75, 0x20000
s_and_b32 s81, s81, 0xffff
s_mov_b32 s82, 1966080
s_mov_b32 s83, 0x20000
v_and_b32 v60, 15, v2
v_lshrrev_b32 v61, 4, v2
v_bfe_u32 v62, v2, 1, 3
v_xor_b32 v61, v61, v62
v_mul_u32_u24 v60, 384, v60
v_add_u32 v60, 73728, v60
v_lshl_add_u32 v16, v61, 4, v60
v_xor_b32 v61, 4, v61
v_lshl_add_u32 v17, v61, 4, v60
v_lshrrev_b32 v60, 2, v2
v_and_b32 v61, 3, v2
v_mul_u32_u24 v62, 384, v60
v_lshl_add_u32 v62, v61, 3, v62
v_bfe_u32 v63, v2, 3, 2
v_xor_b32 v20, 0, v63
v_lshl_add_u32 v20, v20, 5, v62
v_xor_b32 v21, 1, v63
v_lshl_add_u32 v21, v21, 5, v62
v_xor_b32 v22, 2, v63
v_lshl_add_u32 v22, v22, 5, v62
v_xor_b32 v23, 3, v63
v_lshl_add_u32 v23, v23, 5, v62
v_mul_u32_u24 v62, 96, v60
v_lshl_add_u32 v62, v61, 3, v62
v_add_u32 v28, 24576, v62
v_add_u32 v29, 98304, v62
v_lshrrev_b32 v44, 2, v2
v_mul_u32_u24 v44, 384, v44
v_and_b32 v45, 3, v2
v_bfe_u32 v46, v2, 3, 2
v_lshlrev_b32 v46, 1, v46
v_xor_b32 v45, v45, v46
v_lshl_add_u32 v47, v45, 4, v44
v_xor_b32 v45, 4, v45
v_lshl_add_u32 v48, v45, 4, v44
s_lshl_b32 s50, s37, 4
s_lshl_b32 s51, s38, 2
s_add_u32 s50, s50, s51
s_mul_i32 s51, s50, 20480
v_add_u32 v53, s51, v57
v_add_u32 v54, 20480, v53
v_add_u32 v55, 40960, v53
v_add_u32 v56, 61440, v53
s_lshl_b32 s59, s37, 2
s_lshr_b32 s55, s36, 3
s_add_u32 s59, s59, s55
s_lshl_b32 s59, s59, 6
s_and_b32 s55, s36, 7
s_lshl_b32 s55, s55, 2
s_add_u32 s59, s59, s55
s_lshl_b32 s45, s37, 2
s_lshr_b32 s55, s36, 3
s_add_u32 s45, s45, s55
s_lshl_b32 s45, s45, 1
s_lshr_b32 s55, s38, 1
s_add_u32 s45, s45, s55
s_lshl_b32 s45, s45, 6
s_and_b32 s55, s36, 7
s_lshl_b32 s55, s55, 1
s_and_b32 s56, s38, 1
s_add_u32 s55, s55, s56
s_lshl_b32 s55, s55, 2
s_add_u32 s45, s45, s55
s_add_u32 s45, s45, 36864
s_bfe_u32 s90, s2, 0x10002
s_lshl_b32 s90, s90, 1
s_and_b32 s55, s2, 1
s_add_u32 s90, s90, s55
s_bfe_u32 s55, s2, 0x10001
s_lshl_b32 s55, s55, 3
s_lshr_b32 s56, s2, 5
s_add_u32 s55, s55, s56
s_bfe_u32 s56, s2, 0x20003
s_and_b32 s65, s65, 0xffff
s_mov_b32 s66, 7864320
s_mov_b32 s67, 0x20000
s_mul_i32 s48, s56, 320
s_mul_i32 s49, s38, 5120
s_mov_b32 s51, 0
s_mov_b32 s52, 0
s_lshl_b32 s57, s55, 3
s_lshl_b32 s58, s38, 1
s_add_u32 s57, s57, s58
s_mul_i32 s3, s57, 196608
s_mul_i32 s100, s57, 49152
s_mul_i32 s58, s90, 12288
s_add_u32 s100, s100, s58
s_and_b32 s84, s90, 1
s_add_u32 s101, s84, s57
s_mul_i32 s101, s101, 20480
s_lshr_b32 s85, s90, 1
s_mul_i32 s92, s85, 160
s_add_u32 s92, s92, s48
s_add_u32 s101, s101, s92
s_mul_i32 s92, s90, 491520
s_add_u32 s92, s92, s48
s_lshr_b32 s87, s55, 1
s_lshl_b32 s87, s87, 2
s_add_u32 s87, s87, s90
s_lshl_b32 s87, s87, 6
s_lshl_b32 s88, s55, 2
s_add_u32 s88, s88, s56
s_lshl_b32 s88, s88, 2
s_add_u32 s88, s88, s38
s_lshl_b32 s88, s88, 6
s_add_u32 s88, s88, 4096
s_lshl_b32 s89, s90, 2
s_add_u32 s89, s89, s88
s_sub_u32 s93, s88, 4096
s_lshr_b32 s93, s93, 6
s_mul_i32 s93, s93, 40960
s_mul_i32 s91, s90, 2560
s_add_u32 s91, s91, s93
s_mul_i32 s58, s90, 10240
s_add_u32 s93, s93, s58
s_add_u32 s84, s90, 1
s_and_b32 s84, s84, 3
s_mul_i32 s84, s84, 2560
s_add_u32 s84, s84, s93
s_add_u32 s85, s90, 2
s_and_b32 s85, s85, 3
s_mul_i32 s85, s85, 2560
s_add_u32 s85, s85, s93
s_add_u32 s86, s90, 3
s_and_b32 s86, s86, 3
s_mul_i32 s86, s86, 2560
s_add_u32 s86, s86, s93
s_cmp_lg_u32 s38, 0
s_cbranch_scc1 L_pd0
s_mov_b32 s93, 0x200000
global_load_dword v63, v110, s[6:7] sc1
s_waitcnt vmcnt(0)
v_cmp_le_u32 vcc, 32, v63
s_nop 1
s_cmp_eq_u64 vcc, -1
s_cbranch_scc1 L_pd0
L_pl0:
s_sleep 1
global_load_dword v63, v110, s[6:7] sc1
s_waitcnt vmcnt(0)
v_cmp_le_u32 vcc, 32, v63
s_sub_u32 s93, s93, 1
s_cmp_eq_u64 vcc, -1
s_cbranch_scc1 L_pd0
s_cmp_lg_u32 s93, 0
s_cbranch_scc1 L_pl0
L_pd0:
s_barrier
v_mov_b32 v58, v47
v_mov_b32 v59, v48
v_add_u32 v60, 73728, v47
v_add_u32 v61, 73728, v48
buffer_load_dwordx4 a[96:99], v53, s[24:27], s44 offen offset:0 sc1
buffer_load_dwordx4 a[100:103], v53, s[24:27], s44 offen offset:1024 sc1
buffer_load_dwordx4 a[104:107], v54, s[24:27], s44 offen offset:0 sc1
buffer_load_dwordx4 a[108:111], v54, s[24:27], s44 offen offset:1024 sc1
buffer_load_dwordx4 a[112:115], v55, s[24:27], s44 offen offset:0 sc1
buffer_load_dwordx4 a[116:119], v55, s[24:27], s44 offen offset:1024 sc1
buffer_load_dwordx4 a[120:123], v56, s[24:27], s44 offen offset:0 sc1
buffer_load_dwordx4 a[124:127], v56, s[24:27], s44 offen offset:1024 sc1
s_add_u32 s44, s44, 2048
buffer_load_dwordx4 a[128:131], v53, s[24:27], s44 offen offset:0 sc1
buffer_load_dwordx4 a[132:135], v53, s[24:27], s44 offen offset:1024 sc1
buffer_load_dwordx4 a[136:139], v54, s[24:27], s44 offen offset:0 sc1
buffer_load_dwordx4 a[140:143], v54, s[24:27], s44 offen offset:1024 sc1
buffer_load_dwordx4 a[144:147], v55, s[24:27], s44 offen offset:0 sc1
buffer_load_dwordx4 a[148:151], v55, s[24:27], s44 offen offset:1024 sc1
buffer_load_dwordx4 a[152:155], v56, s[24:27], s44 offen offset:0 sc1
buffer_load_dwordx4 a[156:159], v56, s[24:27], s44 offen offset:1024 sc1
s_add_u32 s44, s44, 2048
ds_read_b64_tr_b16 a[192:193], v58 offset:0
ds_read_b64_tr_b16 a[194:195], v58 offset:6144
ds_read_b64_tr_b16 a[196:197], v58 offset:12288
ds_read_b64_tr_b16 a[198:199], v58 offset:18432
s_waitcnt lgkmcnt(2)
s_waitcnt vmcnt(15)
v_mfma_f32_16x16x32_bf16 v[64:67], a[192:195], a[96:99], 0
s_waitcnt lgkmcnt(0) vmcnt(14)
ds_read_b64_tr_b16 a[200:201], v58 offset:8
ds_read_b64_tr_b16 a[202:203], v58 offset:6152
v_mfma_f32_16x16x32_bf16 v[64:67], a[196:199], a[100:103], v[64:67]
s_waitcnt vmcnt(13)
ds_read_b64_tr_b16 a[204:205], v58 offset:12296
ds_read_b64_tr_b16 a[206:207], v58 offset:18440
v_mfma_f32_16x16x32_bf16 v[68:71], a[192:195], a[104:107], 0
s_waitcnt vmcnt(12)
s_add_u32 m0, s39, 110592
v_mfma_f32_16x16x32_bf16 v[68:71], a[196:199], a[108:111], v[68:71]
s_waitcnt vmcnt(11)
buffer_load_dwordx4 v10, s[16:19], s42 offen offset:0 lds
v_mfma_f32_16x16x32_bf16 v[72:75], a[192:195], a[112:115], 0
s_waitcnt vmcnt(11)
v_mfma_f32_16x16x32_bf16 v[72:75], a[196:199], a[116:119], v[72:75]
s_waitcnt vmcnt(10)
v_mfma_f32_16x16x32_bf16 v[76:79], a[192:195], a[120:123], 0
s_waitcnt vmcnt(9)
v_mfma_f32_16x16x32_bf16 v[76:79], a[196:199], a[124:127], v[76:79]
s_waitcnt lgkmcnt(2)
v_mfma_f32_16x16x32_bf16 v[80:83], a[200:203], a[96:99], 0
s_waitcnt lgkmcnt(0)
ds_read_b64_tr_b16 a[208:209], v59 offset:0
ds_read_b64_tr_b16 a[210:211], v59 offset:6144
v_mfma_f32_16x16x32_bf16 v[80:83], a[204:207], a[100:103], v[80:83]
ds_read_b64_tr_b16 a[212:213], v59 offset:12288
ds_read_b64_tr_b16 a[214:215], v59 offset:18432
v_mfma_f32_16x16x32_bf16 v[84:87], a[200:203], a[104:107], 0
buffer_load_dwordx4 v11, s[16:19], s42 offen offset:1024 lds
v_mfma_f32_16x16x32_bf16 v[84:87], a[204:207], a[108:111], v[84:87]
v_mfma_f32_16x16x32_bf16 v[88:91], a[200:203], a[112:115], 0
v_mfma_f32_16x16x32_bf16 v[88:91], a[204:207], a[116:119], v[88:91]
v_mfma_f32_16x16x32_bf16 v[92:95], a[200:203], a[120:123], 0
v_mfma_f32_16x16x32_bf16 v[92:95], a[204:207], a[124:127], v[92:95]
s_waitcnt lgkmcnt(2)
v_mfma_f32_16x16x32_bf16 v[96:99], a[208:211], a[96:99], 0
s_waitcnt lgkmcnt(0)
ds_read_b64_tr_b16 a[192:193], v59 offset:8
ds_read_b64_tr_b16 a[194:195], v59 offset:6152
v_mfma_f32_16x16x32_bf16 v[96:99], a[212:215], a[100:103], v[96:99]
ds_read_b64_tr_b16 a[196:197], v59 offset:12296
ds_read_b64_tr_b16 a[198:199], v59 offset:18440
v_mfma_f32_16x16x32_bf16 v[100:103], a[208:211], a[104:107], 0
buffer_load_dwordx4 v12, s[16:19], s42 offen offset:2048 lds
v_mfma_f32_16x16x32_bf16 v[100:103], a[212:215], a[108:111], v[100:103]
s_add_u32 s42, s42, 393216
v_mfma_f32_16x16x32_bf16 v[104:107], a[208:211], a[112:115], 0
v_mfma_f32_16x16x32_bf16 v[104:107], a[212:215], a[116:119], v[104:107]
v_mfma_f32_16x16x32_bf16 v[108:111], a[208:211], a[120:123], 0
v_mfma_f32_16x16x32_bf16 v[108:111], a[212:215], a[124:127], v[108:111]
s_waitcnt lgkmcnt(2)
v_mfma_f32_16x16x32_bf16 v[112:115], a[192:195], a[96:99], 0
s_waitcnt lgkmcnt(0)
ds_read_b64_tr_b16 a[200:201], v58 offset:128
ds_read_b64_tr_b16 a[202:203], v58 offset:6272
v_mfma_f32_16x16x32_bf16 v[112:115], a[196:199], a[100:103], v[112:115]
s_add_u32 m0, s39, 122880
ds_read_b64_tr_b16 a[204:205], v58 offset:12416
ds_read_b64_tr_b16 a[206:207], v58 offset:18560
v_mfma_f32_16x16x32_bf16 v[116:119], a[192:195], a[104:107], 0
buffer_load_dwordx4 v10, s[16:19], s42 offen offset:0 lds
v_mfma_f32_16x16x32_bf16 v[116:119], a[196:199], a[108:111], v[116:119]
v_mfma_f32_16x16x32_bf16 v[120:123], a[192:195], a[112:115], 0
v_mfma_f32_16x16x32_bf16 v[120:123], a[196:199], a[116:119], v[120:123]
v_mfma_f32_16x16x32_bf16 v[124:127], a[192:195], a[120:123], 0
v_mfma_f32_16x16x32_bf16 v[124:127], a[196:199], a[124:127], v[124:127]
s_waitcnt lgkmcnt(2)
v_mfma_f32_16x16x32_bf16 v[128:131], a[200:203], a[96:99], 0
s_waitcnt lgkmcnt(0)
ds_read_b64_tr_b16 a[208:209], v58 offset:136
ds_read_b64_tr_b16 a[210:211], v58 offset:6280
v_mfma_f32_16x16x32_bf16 v[128:131], a[204:207], a[100:103], v[128:131]
ds_read_b64_tr_b16 a[212:213], v58 offset:12424
ds_read_b64_tr_b16 a[214:215], v58 offset:18568
v_mfma_f32_16x16x32_bf16 v[132:135], a[200:203], a[104:107], 0
buffer_load_dwordx4 v11, s[16:19], s42 offen offset:1024 lds
v_mfma_f32_16x16x32_bf16 v[132:135], a[204:207], a[108:111], v[132:135]
v_mfma_f32_16x16x32_bf16 v[136:139], a[200:203], a[112:115], 0
v_mfma_f32_16x16x32_bf16 v[136:139], a[204:207], a[116:119], v[136:139]
v_mfma_f32_16x16x32_bf16 v[140:143], a[200:203], a[120:123], 0
v_mfma_f32_16x16x32_bf16 v[140:143], a[204:207], a[124:127], v[140:143]
s_waitcnt lgkmcnt(2)
v_mfma_f32_16x16x32_bf16 v[144:147], a[208:211], a[96:99], 0
s_waitcnt lgkmcnt(0)
ds_read_b64_tr_b16 a[192:193], v59 offset:128
ds_read_b64_tr_b16 a[194:195], v59 offset:6272
v_mfma_f32_16x16x32_bf16 v[144:147], a[212:215], a[100:103], v[144:147]
ds_read_b64_tr_b16 a[196:197], v59 offset:12416
ds_read_b64_tr_b16 a[198:199], v59 offset:18560
v_mfma_f32_16x16x32_bf16 v[148:151], a[208:211], a[104:107], 0
buffer_load_dwordx4 v12, s[16:19], s42 offen offset:2048 lds
v_mfma_f32_16x16x32_bf16 v[148:151], a[212:215], a[108:111], v[148:151]
s_add_u32 s42, s42, 393216
v_mfma_f32_16x16x32_bf16 v[152:155], a[208:211], a[112:115], 0
v_mfma_f32_16x16x32_bf16 v[152:155], a[212:215], a[116:119], v[152:155]
v_mfma_f32_16x16x32_bf16 v[156:159], a[208:211], a[120:123], 0
v_mfma_f32_16x16x32_bf16 v[156:159], a[212:215], a[124:127], v[156:159]
s_waitcnt lgkmcnt(2)
v_mfma_f32_16x16x32_bf16 v[160:163], a[192:195], a[96:99], 0
s_waitcnt lgkmcnt(0)
ds_read_b64_tr_b16 a[200:201], v59 offset:136
ds_read_b64_tr_b16 a[202:203], v59 offset:6280
v_mfma_f32_16x16x32_bf16 v[160:163], a[196:199], a[100:103], v[160:163]
s_add_u32 m0, s39, 135168
ds_read_b64_tr_b16 a[204:205], v59 offset:12424
ds_read_b64_tr_b16 a[206:207], v59 offset:18568
v_mfma_f32_16x16x32_bf16 v[164:167], a[192:195], a[104:107], 0
buffer_load_dwordx4 v13, s[20:23], s43 offen offset:0 lds
v_mfma_f32_16x16x32_bf16 v[164:167], a[196:199], a[108:111], v[164:167]
v_mfma_f32_16x16x32_bf16 v[168:171], a[192:195], a[112:115], 0
v_mfma_f32_16x16x32_bf16 v[168:171], a[196:199], a[116:119], v[168:171]
v_mfma_f32_16x16x32_bf16 v[172:175], a[192:195], a[120:123], 0
v_mfma_f32_16x16x32_bf16 v[172:175], a[196:199], a[124:127], v[172:175]
s_waitcnt lgkmcnt(2)
v_mfma_f32_16x16x32_bf16 v[176:179], a[200:203], a[96:99], 0
s_waitcnt lgkmcnt(0)
ds_read_b64_tr_b16 a[208:209], v58 offset:256
ds_read_b64_tr_b16 a[210:211], v58 offset:6400
v_mfma_f32_16x16x32_bf16 v[176:179], a[204:207], a[100:103], v[176:179]
ds_read_b64_tr_b16 a[212:213], v58 offset:12544
ds_read_b64_tr_b16 a[214:215], v58 offset:18688
v_mfma_f32_16x16x32_bf16 v[180:183], a[200:203], a[104:107], 0
buffer_load_dwordx4 v14, s[20:23], s43 offen offset:1024 lds
v_mfma_f32_16x16x32_bf16 v[180:183], a[204:207], a[108:111], v[180:183]
v_mfma_f32_16x16x32_bf16 v[184:187], a[200:203], a[112:115], 0
v_mfma_f32_16x16x32_bf16 v[184:187], a[204:207], a[116:119], v[184:187]
v_mfma_f32_16x16x32_bf16 v[188:191], a[200:203], a[120:123], 0
v_mfma_f32_16x16x32_bf16 v[188:191], a[204:207], a[124:127], v[188:191]
s_waitcnt lgkmcnt(2)
v_mfma_f32_16x16x32_bf16 v[192:195], a[208:211], a[96:99], 0
s_waitcnt lgkmcnt(0)
ds_read_b64_tr_b16 a[192:193], v58 offset:264
ds_read_b64_tr_b16 a[194:195], v58 offset:6408
v_mfma_f32_16x16x32_bf16 v[192:195], a[212:215], a[100:103], v[192:195]
ds_read_b64_tr_b16 a[196:197], v58 offset:12552
ds_read_b64_tr_b16 a[198:199], v58 offset:18696
v_mfma_f32_16x16x32_bf16 v[196:199], a[208:211], a[104:107], 0
buffer_load_dwordx4 v15, s[20:23], s43 offen offset:2048 lds
v_mfma_f32_16x16x32_bf16 v[196:199], a[212:215], a[108:111], v[196:199]
s_add_u32 s43, s43, 196608
v_mfma_f32_16x16x32_bf16 v[200:203], a[208:211], a[112:115], 0
v_mfma_f32_16x16x32_bf16 v[200:203], a[212:215], a[116:119], v[200:203]
v_mfma_f32_16x16x32_bf16 v[204:207], a[208:211], a[120:123], 0
v_mfma_f32_16x16x32_bf16 v[204:207], a[212:215], a[124:127], v[204:207]
s_waitcnt lgkmcnt(2)
v_mfma_f32_16x16x32_bf16 v[208:211], a[192:195], a[96:99], 0
s_waitcnt lgkmcnt(0)
ds_read_b64_tr_b16 a[200:201], v59 offset:256
ds_read_b64_tr_b16 a[202:203], v59 offset:6400
v_mfma_f32_16x16x32_bf16 v[208:211], a[196:199], a[100:103], v[208:211]
ds_read_b64_tr_b16 a[204:205], v59 offset:12544
ds_read_b64_tr_b16 a[206:207], v59 offset:18688
v_mfma_f32_16x16x32_bf16 v[212:215], a[192:195], a[104:107], 0
buffer_load_dwordx4 a[160:163], v53, s[24:27], s44 offen offset:0 sc1
v_mfma_f32_16x16x32_bf16 v[212:215], a[196:199], a[108:111], v[212:215]
v_mfma_f32_16x16x32_bf16 v[216:219], a[192:195], a[112:115], 0
v_mfma_f32_16x16x32_bf16 v[216:219], a[196:199], a[116:119], v[216:219]
v_mfma_f32_16x16x32_bf16 v[220:223], a[192:195], a[120:123], 0
v_mfma_f32_16x16x32_bf16 v[220:223], a[196:199], a[124:127], v[220:223]
s_waitcnt lgkmcnt(2)
v_mfma_f32_16x16x32_bf16 v[224:227], a[200:203], a[96:99], 0
s_waitcnt lgkmcnt(0)
ds_read_b64_tr_b16 a[208:209], v59 offset:264
ds_read_b64_tr_b16 a[210:211], v59 offset:6408
v_mfma_f32_16x16x32_bf16 v[224:227], a[204:207], a[100:103], v[224:227]
ds_read_b64_tr_b16 a[212:213], v59 offset:12552
ds_read_b64_tr_b16 a[214:215], v59 offset:18696
v_mfma_f32_16x16x32_bf16 v[228:231], a[200:203], a[104:107], 0
buffer_load_dwordx4 a[164:167], v53, s[24:27], s44 offen offset:1024 sc1
v_mfma_f32_16x16x32_bf16 v[228:231], a[204:207], a[108:111], v[228:231]
v_mfma_f32_16x16x32_bf16 v[232:235], a[200:203], a[112:115], 0
v_mfma_f32_16x16x32_bf16 v[232:235], a[204:207], a[116:119], v[232:235]
v_mfma_f32_16x16x32_bf16 v[236:239], a[200:203], a[120:123], 0
v_mfma_f32_16x16x32_bf16 v[236:239], a[204:207], a[124:127], v[236:239]
s_waitcnt lgkmcnt(2)
v_mfma_f32_16x16x32_bf16 v[240:243], a[208:211], a[96:99], 0
s_waitcnt lgkmcnt(0)
ds_read_b64_tr_b16 a[192:193], v28 offset:0
ds_read_b64_tr_b16 a[194:195], v28 offset:1536
v_mfma_f32_16x16x32_bf16 v[240:243], a[212:215], a[100:103], v[240:243]
ds_read_b64_tr_b16 a[196:197], v28 offset:3072
ds_read_b64_tr_b16 a[198:199], v28 offset:4608
v_mfma_f32_16x16x32_bf16 v[244:247], a[208:211], a[104:107], 0
buffer_load_dwordx4 a[168:171], v54, s[24:27], s44 offen offset:0 sc1
v_mfma_f32_16x16x32_bf16 v[244:247], a[212:215], a[108:111], v[244:247]
v_mfma_f32_16x16x32_bf16 v[248:251], a[208:211], a[112:115], 0
v_mfma_f32_16x16x32_bf16 v[248:251], a[212:215], a[116:119], v[248:251]
v_mfma_f32_16x16x32_bf16 v[252:255], a[208:211], a[120:123], 0
v_mfma_f32_16x16x32_bf16 v[252:255], a[212:215], a[124:127], v[252:255]
s_waitcnt lgkmcnt(2)
v_mfma_f32_16x16x32_bf16 a[0:3], a[192:195], a[96:99], 0
s_waitcnt lgkmcnt(0)
ds_read_b64_tr_b16 a[200:201], v28 offset:32
ds_read_b64_tr_b16 a[202:203], v28 offset:1568
v_mfma_f32_16x16x32_bf16 a[0:3], a[196:199], a[100:103], a[0:3]
ds_read_b64_tr_b16 a[204:205], v28 offset:3104
ds_read_b64_tr_b16 a[206:207], v28 offset:4640
v_mfma_f32_16x16x32_bf16 a[4:7], a[192:195], a[104:107], 0
buffer_load_dwordx4 a[172:175], v54, s[24:27], s44 offen offset:1024 sc1
v_mfma_f32_16x16x32_bf16 a[4:7], a[196:199], a[108:111], a[4:7]
v_mfma_f32_16x16x32_bf16 a[8:11], a[192:195], a[112:115], 0
v_mfma_f32_16x16x32_bf16 a[8:11], a[196:199], a[116:119], a[8:11]
v_mfma_f32_16x16x32_bf16 a[12:15], a[192:195], a[120:123], 0
v_mfma_f32_16x16x32_bf16 a[12:15], a[196:199], a[124:127], a[12:15]
s_waitcnt lgkmcnt(2)
v_mfma_f32_16x16x32_bf16 a[16:19], a[200:203], a[96:99], 0
s_waitcnt lgkmcnt(0)
ds_read_b64_tr_b16 a[208:209], v28 offset:64
ds_read_b64_tr_b16 a[210:211], v28 offset:1600
v_mfma_f32_16x16x32_bf16 a[16:19], a[204:207], a[100:103], a[16:19]
ds_read_b64_tr_b16 a[212:213], v28 offset:3136
ds_read_b64_tr_b16 a[214:215], v28 offset:4672
v_mfma_f32_16x16x32_bf16 a[20:23], a[200:203], a[104:107], 0
buffer_load_dwordx4 a[176:179], v55, s[24:27], s44 offen offset:0 sc1
v_mfma_f32_16x16x32_bf16 a[20:23], a[204:207], a[108:111], a[20:23]
v_mfma_f32_16x16x32_bf16 a[24:27], a[200:203], a[112:115], 0
v_mfma_f32_16x16x32_bf16 a[24:27], a[204:207], a[116:119], a[24:27]
v_mfma_f32_16x16x32_bf16 a[28:31], a[200:203], a[120:123], 0
v_mfma_f32_16x16x32_bf16 a[28:31], a[204:207], a[124:127], a[28:31]
s_waitcnt lgkmcnt(2)
v_mfma_f32_16x16x32_bf16 a[32:35], a[208:211], a[96:99], 0
s_waitcnt lgkmcnt(0)
ds_read_b64_tr_b16 a[192:193], v28 offset:6144
ds_read_b64_tr_b16 a[194:195], v28 offset:7680
v_mfma_f32_16x16x32_bf16 a[32:35], a[212:215], a[100:103], a[32:35]
ds_read_b64_tr_b16 a[196:197], v28 offset:9216
ds_read_b64_tr_b16 a[198:199], v28 offset:10752
v_mfma_f32_16x16x32_bf16 a[36:39], a[208:211], a[104:107], 0
buffer_load_dwordx4 a[180:183], v55, s[24:27], s44 offen offset:1024 sc1
v_mfma_f32_16x16x32_bf16 a[36:39], a[212:215], a[108:111], a[36:39]
v_mfma_f32_16x16x32_bf16 a[40:43], a[208:211], a[112:115], 0
v_mfma_f32_16x16x32_bf16 a[40:43], a[212:215], a[116:119], a[40:43]
v_mfma_f32_16x16x32_bf16 a[44:47], a[208:211], a[120:123], 0
v_mfma_f32_16x16x32_bf16 a[44:47], a[212:215], a[124:127], a[44:47]
s_waitcnt lgkmcnt(2)
v_mfma_f32_16x16x32_bf16 a[48:51], a[192:195], a[96:99], 0
s_waitcnt lgkmcnt(0)
ds_read_b64_tr_b16 a[200:201], v28 offset:6176
ds_read_b64_tr_b16 a[202:203], v28 offset:7712
v_mfma_f32_16x16x32_bf16 a[48:51], a[196:199], a[100:103], a[48:51]
ds_read_b64_tr_b16 a[204:205], v28 offset:9248
ds_read_b64_tr_b16 a[206:207], v28 offset:10784
v_mfma_f32_16x16x32_bf16 a[52:55], a[192:195], a[104:107], 0
buffer_load_dwordx4 a[184:187], v56, s[24:27], s44 offen offset:0 sc1
v_mfma_f32_16x16x32_bf16 a[52:55], a[196:199], a[108:111], a[52:55]
v_mfma_f32_16x16x32_bf16 a[56:59], a[192:195], a[112:115], 0
v_mfma_f32_16x16x32_bf16 a[56:59], a[196:199], a[116:119], a[56:59]
v_mfma_f32_16x16x32_bf16 a[60:63], a[192:195], a[120:123], 0
ds_read_b64_tr_b16 a[208:209], v28 offset:6208
ds_read_b64_tr_b16 a[210:211], v28 offset:7744
v_mfma_f32_16x16x32_bf16 a[60:63], a[196:199], a[124:127], a[60:63]
s_waitcnt lgkmcnt(4)
ds_read_b64_tr_b16 a[212:213], v28 offset:9280
ds_read_b64_tr_b16 a[214:215], v28 offset:10816
v_mfma_f32_16x16x32_bf16 a[64:67], a[200:203], a[96:99], 0
s_waitcnt lgkmcnt(4)
buffer_load_dwordx4 a[188:191], v56, s[24:27], s44 offen offset:1024 sc1
v_mfma_f32_16x16x32_bf16 a[64:67], a[204:207], a[100:103], a[64:67]
v_mfma_f32_16x16x32_bf16 a[68:71], a[200:203], a[104:107], 0
v_mfma_f32_16x16x32_bf16 a[68:71], a[204:207], a[108:111], a[68:71]
v_mfma_f32_16x16x32_bf16 a[72:75], a[200:203], a[112:115], 0
v_mfma_f32_16x16x32_bf16 a[72:75], a[204:207], a[116:119], a[72:75]
v_mfma_f32_16x16x32_bf16 a[76:79], a[200:203], a[120:123], 0
s_add_u32 s44, s44, 2048
v_mfma_f32_16x16x32_bf16 a[76:79], a[204:207], a[124:127], a[76:79]
s_waitcnt vmcnt(42)
s_waitcnt lgkmcnt(0)
s_barrier
v_mfma_f32_16x16x32_bf16 a[80:83], a[208:211], a[96:99], 0
ds_read_b64_tr_b16 a[192:193], v58 offset:36864
ds_read_b64_tr_b16 a[194:195], v58 offset:43008
v_mfma_f32_16x16x32_bf16 a[80:83], a[212:215], a[100:103], a[80:83]
ds_read_b64_tr_b16 a[196:197], v58 offset:49152
ds_read_b64_tr_b16 a[198:199], v58 offset:55296
v_mfma_f32_16x16x32_bf16 a[84:87], a[208:211], a[104:107], 0
v_mfma_f32_16x16x32_bf16 a[84:87], a[212:215], a[108:111], a[84:87]
v_mfma_f32_16x16x32_bf16 a[88:91], a[208:211], a[112:115], 0
v_mfma_f32_16x16x32_bf16 a[88:91], a[212:215], a[116:119], a[88:91]
v_mfma_f32_16x16x32_bf16 a[92:95], a[208:211], a[120:123], 0
v_mfma_f32_16x16x32_bf16 a[92:95], a[212:215], a[124:127], a[92:95]
s_waitcnt lgkmcnt(2) vmcnt(24)
v_mfma_f32_16x16x32_bf16 v[64:67], a[192:195], a[128:131], v[64:67]
s_waitcnt lgkmcnt(0) vmcnt(23)
ds_read_b64_tr_b16 a[200:201], v58 offset:36872
ds_read_b64_tr_b16 a[202:203], v58 offset:43016
v_mfma_f32_16x16x32_bf16 v[64:67], a[196:199], a[132:135], v[64:67]
s_waitcnt vmcnt(22)
ds_read_b64_tr_b16 a[204:205], v58 offset:49160
ds_read_b64_tr_b16 a[206:207], v58 offset:55304
v_mfma_f32_16x16x32_bf16 v[68:71], a[192:195], a[136:139], v[68:71]
s_waitcnt vmcnt(21)
s_add_u32 m0, s39, 0
v_mfma_f32_16x16x32_bf16 v[68:71], a[196:199], a[140:143], v[68:71]
s_waitcnt vmcnt(20)
buffer_load_dwordx4 v10, s[16:19], s42 offen offset:0 lds
v_mfma_f32_16x16x32_bf16 v[72:75], a[192:195], a[144:147], v[72:75]
s_waitcnt vmcnt(20)
v_mfma_f32_16x16x32_bf16 v[72:75], a[196:199], a[148:151], v[72:75]
s_waitcnt vmcnt(19)
v_mfma_f32_16x16x32_bf16 v[76:79], a[192:195], a[152:155], v[76:79]
s_waitcnt vmcnt(18)
v_mfma_f32_16x16x32_bf16 v[76:79], a[196:199], a[156:159], v[76:79]
s_waitcnt lgkmcnt(2)
v_mfma_f32_16x16x32_bf16 v[80:83], a[200:203], a[128:131], v[80:83]
s_waitcnt lgkmcnt(0)
ds_read_b64_tr_b16 a[208:209], v59 offset:36864
ds_read_b64_tr_b16 a[210:211], v59 offset:43008
v_mfma_f32_16x16x32_bf16 v[80:83], a[204:207], a[132:135], v[80:83]
ds_read_b64_tr_b16 a[212:213], v59 offset:49152
ds_read_b64_tr_b16 a[214:215], v59 offset:55296
v_mfma_f32_16x16x32_bf16 v[84:87], a[200:203], a[136:139], v[84:87]
buffer_load_dwordx4 v11, s[16:19], s42 offen offset:1024 lds
v_mfma_f32_16x16x32_bf16 v[84:87], a[204:207], a[140:143], v[84:87]
v_mfma_f32_16x16x32_bf16 v[88:91], a[200:203], a[144:147], v[88:91]
v_mfma_f32_16x16x32_bf16 v[88:91], a[204:207], a[148:151], v[88:91]
v_mfma_f32_16x16x32_bf16 v[92:95], a[200:203], a[152:155], v[92:95]
v_mfma_f32_16x16x32_bf16 v[92:95], a[204:207], a[156:159], v[92:95]
s_waitcnt lgkmcnt(2)
v_mfma_f32_16x16x32_bf16 v[96:99], a[208:211], a[128:131], v[96:99]
s_waitcnt lgkmcnt(0)
ds_read_b64_tr_b16 a[192:193], v59 offset:36872
ds_read_b64_tr_b16 a[194:195], v59 offset:43016
v_mfma_f32_16x16x32_bf16 v[96:99], a[212:215], a[132:135], v[96:99]
ds_read_b64_tr_b16 a[196:197], v59 offset:49160
ds_read_b64_tr_b16 a[198:199], v59 offset:55304
v_mfma_f32_16x16x32_bf16 v[100:103], a[208:211], a[136:139], v[100:103]
buffer_load_dwordx4 v12, s[16:19], s42 offen offset:2048 lds
v_mfma_f32_16x16x32_bf16 v[100:103], a[212:215], a[140:143], v[100:103]
s_add_u32 s42, s42, 393216
v_mfma_f32_16x16x32_bf16 v[104:107], a[208:211], a[144:147], v[104:107]
v_mfma_f32_16x16x32_bf16 v[104:107], a[212:215], a[148:151], v[104:107]
v_mfma_f32_16x16x32_bf16 v[108:111], a[208:211], a[152:155], v[108:111]
v_mfma_f32_16x16x32_bf16 v[108:111], a[212:215], a[156:159], v[108:111]
s_waitcnt lgkmcnt(2)
v_mfma_f32_16x16x32_bf16 v[112:115], a[192:195], a[128:131], v[112:115]
s_waitcnt lgkmcnt(0)
ds_read_b64_tr_b16 a[200:201], v58 offset:36992
ds_read_b64_tr_b16 a[202:203], v58 offset:43136
v_mfma_f32_16x16x32_bf16 v[112:115], a[196:199], a[132:135], v[112:115]
s_add_u32 m0, s39, 12288
ds_read_b64_tr_b16 a[204:205], v58 offset:49280
ds_read_b64_tr_b16 a[206:207], v58 offset:55424
v_mfma_f32_16x16x32_bf16 v[116:119], a[192:195], a[136:139], v[116:119]
buffer_load_dwordx4 v10, s[16:19], s42 offen offset:0 lds
v_mfma_f32_16x16x32_bf16 v[116:119], a[196:199], a[140:143], v[116:119]
v_mfma_f32_16x16x32_bf16 v[120:123], a[192:195], a[144:147], v[120:123]
v_mfma_f32_16x16x32_bf16 v[120:123], a[196:199], a[148:151], v[120:123]
v_mfma_f32_16x16x32_bf16 v[124:127], a[192:195], a[152:155], v[124:127]
v_mfma_f32_16x16x32_bf16 v[124:127], a[196:199], a[156:159], v[124:127]
s_waitcnt lgkmcnt(2)
v_mfma_f32_16x16x32_bf16 v[128:131], a[200:203], a[128:131], v[128:131]
s_waitcnt lgkmcnt(0)
ds_read_b64_tr_b16 a[208:209], v58 offset:37000
ds_read_b64_tr_b16 a[210:211], v58 offset:43144
v_mfma_f32_16x16x32_bf16 v[128:131], a[204:207], a[132:135], v[128:131]
ds_read_b64_tr_b16 a[212:213], v58 offset:49288
ds_read_b64_tr_b16 a[214:215], v58 offset:55432
v_mfma_f32_16x16x32_bf16 v[132:135], a[200:203], a[136:139], v[132:135]
buffer_load_dwordx4 v11, s[16:19], s42 offen offset:1024 lds
v_mfma_f32_16x16x32_bf16 v[132:135], a[204:207], a[140:143], v[132:135]
v_mfma_f32_16x16x32_bf16 v[136:139], a[200:203], a[144:147], v[136:139]
v_mfma_f32_16x16x32_bf16 v[136:139], a[204:207], a[148:151], v[136:139]
v_mfma_f32_16x16x32_bf16 v[140:143], a[200:203], a[152:155], v[140:143]
v_mfma_f32_16x16x32_bf16 v[140:143], a[204:207], a[156:159], v[140:143]
s_waitcnt lgkmcnt(2)
v_mfma_f32_16x16x32_bf16 v[144:147], a[208:211], a[128:131], v[144:147]
s_waitcnt lgkmcnt(0)
ds_read_b64_tr_b16 a[192:193], v59 offset:36992
ds_read_b64_tr_b16 a[194:195], v59 offset:43136
v_mfma_f32_16x16x32_bf16 v[144:147], a[212:215], a[132:135], v[144:147]
ds_read_b64_tr_b16 a[196:197], v59 offset:49280
ds_read_b64_tr_b16 a[198:199], v59 offset:55424
v_mfma_f32_16x16x32_bf16 v[148:151], a[208:211], a[136:139], v[148:151]
buffer_load_dwordx4 v12, s[16:19], s42 offen offset:2048 lds
v_mfma_f32_16x16x32_bf16 v[148:151], a[212:215], a[140:143], v[148:151]
s_add_u32 s42, s42, 393216
v_mfma_f32_16x16x32_bf16 v[152:155], a[208:211], a[144:147], v[152:155]
v_mfma_f32_16x16x32_bf16 v[152:155], a[212:215], a[148:151], v[152:155]
v_mfma_f32_16x16x32_bf16 v[156:159], a[208:211], a[152:155], v[156:159]
v_mfma_f32_16x16x32_bf16 v[156:159], a[212:215], a[156:159], v[156:159]
s_waitcnt lgkmcnt(2)
v_mfma_f32_16x16x32_bf16 v[160:163], a[192:195], a[128:131], v[160:163]
s_waitcnt lgkmcnt(0)
ds_read_b64_tr_b16 a[200:201], v59 offset:37000
ds_read_b64_tr_b16 a[202:203], v59 offset:43144
v_mfma_f32_16x16x32_bf16 v[160:163], a[196:199], a[132:135], v[160:163]
s_add_u32 m0, s39, 24576
ds_read_b64_tr_b16 a[204:205], v59 offset:49288
ds_read_b64_tr_b16 a[206:207], v59 offset:55432
v_mfma_f32_16x16x32_bf16 v[164:167], a[192:195], a[136:139], v[164:167]
buffer_load_dwordx4 v13, s[20:23], s43 offen offset:0 lds
v_mfma_f32_16x16x32_bf16 v[164:167], a[196:199], a[140:143], v[164:167]
v_mfma_f32_16x16x32_bf16 v[168:171], a[192:195], a[144:147], v[168:171]
v_mfma_f32_16x16x32_bf16 v[168:171], a[196:199], a[148:151], v[168:171]
v_mfma_f32_16x16x32_bf16 v[172:175], a[192:195], a[152:155], v[172:175]
v_mfma_f32_16x16x32_bf16 v[172:175], a[196:199], a[156:159], v[172:175]
s_waitcnt lgkmcnt(2)
v_mfma_f32_16x16x32_bf16 v[176:179], a[200:203], a[128:131], v[176:179]
s_waitcnt lgkmcnt(0)
ds_read_b64_tr_b16 a[208:209], v58 offset:37120
ds_read_b64_tr_b16 a[210:211], v58 offset:43264
v_mfma_f32_16x16x32_bf16 v[176:179], a[204:207], a[132:135], v[176:179]
ds_read_b64_tr_b16 a[212:213], v58 offset:49408
ds_read_b64_tr_b16 a[214:215], v58 offset:55552
v_mfma_f32_16x16x32_bf16 v[180:183], a[200:203], a[136:139], v[180:183]
buffer_load_dwordx4 v14, s[20:23], s43 offen offset:1024 lds
v_mfma_f32_16x16x32_bf16 v[180:183], a[204:207], a[140:143], v[180:183]
v_mfma_f32_16x16x32_bf16 v[184:187], a[200:203], a[144:147], v[184:187]
v_mfma_f32_16x16x32_bf16 v[184:187], a[204:207], a[148:151], v[184:187]
v_mfma_f32_16x16x32_bf16 v[188:191], a[200:203], a[152:155], v[188:191]
v_mfma_f32_16x16x32_bf16 v[188:191], a[204:207], a[156:159], v[188:191]
s_waitcnt lgkmcnt(2)
v_mfma_f32_16x16x32_bf16 v[192:195], a[208:211], a[128:131], v[192:195]
s_waitcnt lgkmcnt(0)
ds_read_b64_tr_b16 a[192:193], v58 offset:37128
ds_read_b64_tr_b16 a[194:195], v58 offset:43272
v_mfma_f32_16x16x32_bf16 v[192:195], a[212:215], a[132:135], v[192:195]
ds_read_b64_tr_b16 a[196:197], v58 offset:49416
ds_read_b64_tr_b16 a[198:199], v58 offset:55560
v_mfma_f32_16x16x32_bf16 v[196:199], a[208:211], a[136:139], v[196:199]
buffer_load_dwordx4 v15, s[20:23], s43 offen offset:2048 lds
v_mfma_f32_16x16x32_bf16 v[196:199], a[212:215], a[140:143], v[196:199]
s_add_u32 s43, s43, 196608
v_mfma_f32_16x16x32_bf16 v[200:203], a[208:211], a[144:147], v[200:203]
v_mfma_f32_16x16x32_bf16 v[200:203], a[212:215], a[148:151], v[200:203]
v_mfma_f32_16x16x32_bf16 v[204:207], a[208:211], a[152:155], v[204:207]
v_mfma_f32_16x16x32_bf16 v[204:207], a[212:215], a[156:159], v[204:207]
s_waitcnt lgkmcnt(2)
v_mfma_f32_16x16x32_bf16 v[208:211], a[192:195], a[128:131], v[208:211]
s_waitcnt lgkmcnt(0)
ds_read_b64_tr_b16 a[200:201], v59 offset:37120
ds_read_b64_tr_b16 a[202:203], v59 offset:43264
v_mfma_f32_16x16x32_bf16 v[208:211], a[196:199], a[132:135], v[208:211]
ds_read_b64_tr_b16 a[204:205], v59 offset:49408
ds_read_b64_tr_b16 a[206:207], v59 offset:55552
v_mfma_f32_16x16x32_bf16 v[212:215], a[192:195], a[136:139], v[212:215]
buffer_load_dwordx4 a[96:99], v53, s[24:27], s44 offen offset:0 sc1
v_mfma_f32_16x16x32_bf16 v[212:215], a[196:199], a[140:143], v[212:215]
v_mfma_f32_16x16x32_bf16 v[216:219], a[192:195], a[144:147], v[216:219]
v_mfma_f32_16x16x32_bf16 v[216:219], a[196:199], a[148:151], v[216:219]
v_mfma_f32_16x16x32_bf16 v[220:223], a[192:195], a[152:155], v[220:223]
v_mfma_f32_16x16x32_bf16 v[220:223], a[196:199], a[156:159], v[220:223]
s_waitcnt lgkmcnt(2)
v_mfma_f32_16x16x32_bf16 v[224:227], a[200:203], a[128:131], v[224:227]
s_waitcnt lgkmcnt(0)
ds_read_b64_tr_b16 a[208:209], v59 offset:37128
ds_read_b64_tr_b16 a[210:211], v59 offset:43272
v_mfma_f32_16x16x32_bf16 v[224:227], a[204:207], a[132:135], v[224:227]
ds_read_b64_tr_b16 a[212:213], v59 offset:49416
ds_read_b64_tr_b16 a[214:215], v59 offset:55560
v_mfma_f32_16x16x32_bf16 v[228:231], a[200:203], a[136:139], v[228:231]
buffer_load_dwordx4 a[100:103], v53, s[24:27], s44 offen offset:1024 sc1
v_mfma_f32_16x16x32_bf16 v[228:231], a[204:207], a[140:143], v[228:231]
v_mfma_f32_16x16x32_bf16 v[232:235], a[200:203], a[144:147], v[232:235]
v_mfma_f32_16x16x32_bf16 v[232:235], a[204:207], a[148:151], v[232:235]
v_mfma_f32_16x16x32_bf16 v[236:239], a[200:203], a[152:155], v[236:239]
v_mfma_f32_16x16x32_bf16 v[236:239], a[204:207], a[156:159], v[236:239]
s_waitcnt lgkmcnt(2)
v_mfma_f32_16x16x32_bf16 v[240:243], a[208:211], a[128:131], v[240:243]
s_waitcnt lgkmcnt(0)
ds_read_b64_tr_b16 a[192:193], v28 offset:36864
ds_read_b64_tr_b16 a[194:195], v28 offset:38400
v_mfma_f32_16x16x32_bf16 v[240:243], a[212:215], a[132:135], v[240:243]
ds_read_b64_tr_b16 a[196:197], v28 offset:39936
ds_read_b64_tr_b16 a[198:199], v28 offset:41472
v_mfma_f32_16x16x32_bf16 v[244:247], a[208:211], a[136:139], v[244:247]
buffer_load_dwordx4 a[104:107], v54, s[24:27], s44 offen offset:0 sc1
v_mfma_f32_16x16x32_bf16 v[244:247], a[212:215], a[140:143], v[244:247]
v_mfma_f32_16x16x32_bf16 v[248:251], a[208:211], a[144:147], v[248:251]
v_mfma_f32_16x16x32_bf16 v[248:251], a[212:215], a[148:151], v[248:251]
v_mfma_f32_16x16x32_bf16 v[252:255], a[208:211], a[152:155], v[252:255]
v_mfma_f32_16x16x32_bf16 v[252:255], a[212:215], a[156:159], v[252:255]
s_waitcnt lgkmcnt(2)
v_mfma_f32_16x16x32_bf16 a[0:3], a[192:195], a[128:131], a[0:3]
s_waitcnt lgkmcnt(0)
ds_read_b64_tr_b16 a[200:201], v28 offset:36896
ds_read_b64_tr_b16 a[202:203], v28 offset:38432
v_mfma_f32_16x16x32_bf16 a[0:3], a[196:199], a[132:135], a[0:3]
ds_read_b64_tr_b16 a[204:205], v28 offset:39968
ds_read_b64_tr_b16 a[206:207], v28 offset:41504
v_mfma_f32_16x16x32_bf16 a[4:7], a[192:195], a[136:139], a[4:7]
buffer_load_dwordx4 a[108:111], v54, s[24:27], s44 offen offset:1024 sc1
v_mfma_f32_16x16x32_bf16 a[4:7], a[196:199], a[140:143], a[4:7]
v_mfma_f32_16x16x32_bf16 a[8:11], a[192:195], a[144:147], a[8:11]
v_mfma_f32_16x16x32_bf16 a[8:11], a[196:199], a[148:151], a[8:11]
v_mfma_f32_16x16x32_bf16 a[12:15], a[192:195], a[152:155], a[12:15]
v_mfma_f32_16x16x32_bf16 a[12:15], a[196:199], a[156:159], a[12:15]
s_waitcnt lgkmcnt(2)
v_mfma_f32_16x16x32_bf16 a[16:19], a[200:203], a[128:131], a[16:19]
s_waitcnt lgkmcnt(0)
ds_read_b64_tr_b16 a[208:209], v28 offset:36928
ds_read_b64_tr_b16 a[210:211], v28 offset:38464
v_mfma_f32_16x16x32_bf16 a[16:19], a[204:207], a[132:135], a[16:19]
ds_read_b64_tr_b16 a[212:213], v28 offset:40000
ds_read_b64_tr_b16 a[214:215], v28 offset:41536
v_mfma_f32_16x16x32_bf16 a[20:23], a[200:203], a[136:139], a[20:23]
buffer_load_dwordx4 a[112:115], v55, s[24:27], s44 offen offset:0 sc1
v_mfma_f32_16x16x32_bf16 a[20:23], a[204:207], a[140:143], a[20:23]
v_mfma_f32_16x16x32_bf16 a[24:27], a[200:203], a[144:147], a[24:27]
v_mfma_f32_16x16x32_bf16 a[24:27], a[204:207], a[148:151], a[24:27]
v_mfma_f32_16x16x32_bf16 a[28:31], a[200:203], a[152:155], a[28:31]
v_mfma_f32_16x16x32_bf16 a[28:31], a[204:207], a[156:159], a[28:31]
s_waitcnt lgkmcnt(2)
v_mfma_f32_16x16x32_bf16 a[32:35], a[208:211], a[128:131], a[32:35]
s_waitcnt lgkmcnt(0)
ds_read_b64_tr_b16 a[192:193], v28 offset:43008
ds_read_b64_tr_b16 a[194:195], v28 offset:44544
v_mfma_f32_16x16x32_bf16 a[32:35], a[212:215], a[132:135], a[32:35]
ds_read_b64_tr_b16 a[196:197], v28 offset:46080
ds_read_b64_tr_b16 a[198:199], v28 offset:47616
v_mfma_f32_16x16x32_bf16 a[36:39], a[208:211], a[136:139], a[36:39]
buffer_load_dwordx4 a[116:119], v55, s[24:27], s44 offen offset:1024 sc1
v_mfma_f32_16x16x32_bf16 a[36:39], a[212:215], a[140:143], a[36:39]
v_mfma_f32_16x16x32_bf16 a[40:43], a[208:211], a[144:147], a[40:43]
v_mfma_f32_16x16x32_bf16 a[40:43], a[212:215], a[148:151], a[40:43]
v_mfma_f32_16x16x32_bf16 a[44:47], a[208:211], a[152:155], a[44:47]
v_mfma_f32_16x16x32_bf16 a[44:47], a[212:215], a[156:159], a[44:47]
s_waitcnt lgkmcnt(2)
v_mfma_f32_16x16x32_bf16 a[48:51], a[192:195], a[128:131], a[48:51]
s_waitcnt lgkmcnt(0)
ds_read_b64_tr_b16 a[200:201], v28 offset:43040
ds_read_b64_tr_b16 a[202:203], v28 offset:44576
v_mfma_f32_16x16x32_bf16 a[48:51], a[196:199], a[132:135], a[48:51]
ds_read_b64_tr_b16 a[204:205], v28 offset:46112
ds_read_b64_tr_b16 a[206:207], v28 offset:47648
v_mfma_f32_16x16x32_bf16 a[52:55], a[192:195], a[136:139], a[52:55]
buffer_load_dwordx4 a[120:123], v56, s[24:27], s44 offen offset:0 sc1
v_mfma_f32_16x16x32_bf16 a[52:55], a[196:199], a[140:143], a[52:55]
v_mfma_f32_16x16x32_bf16 a[56:59], a[192:195], a[144:147], a[56:59]
v_mfma_f32_16x16x32_bf16 a[56:59], a[196:199], a[148:151], a[56:59]
v_mfma_f32_16x16x32_bf16 a[60:63], a[192:195], a[152:155], a[60:63]
ds_read_b64_tr_b16 a[208:209], v28 offset:43072
ds_read_b64_tr_b16 a[210:211], v28 offset:44608
v_mfma_f32_16x16x32_bf16 a[60:63], a[196:199], a[156:159], a[60:63]
s_waitcnt lgkmcnt(4)
ds_read_b64_tr_b16 a[212:213], v28 offset:46144
ds_read_b64_tr_b16 a[214:215], v28 offset:47680
v_mfma_f32_16x16x32_bf16 a[64:67], a[200:203], a[128:131], a[64:67]
s_waitcnt lgkmcnt(4)
buffer_load_dwordx4 a[124:127], v56, s[24:27], s44 offen offset:1024 sc1
v_mfma_f32_16x16x32_bf16 a[64:67], a[204:207], a[132:135], a[64:67]
v_mfma_f32_16x16x32_bf16 a[68:71], a[200:203], a[136:139], a[68:71]
v_mfma_f32_16x16x32_bf16 a[68:71], a[204:207], a[140:143], a[68:71]
v_mfma_f32_16x16x32_bf16 a[72:75], a[200:203], a[144:147], a[72:75]
v_mfma_f32_16x16x32_bf16 a[72:75], a[204:207], a[148:151], a[72:75]
v_mfma_f32_16x16x32_bf16 a[76:79], a[200:203], a[152:155], a[76:79]
s_add_u32 s44, s44, 2048
v_mfma_f32_16x16x32_bf16 a[76:79], a[204:207], a[156:159], a[76:79]
s_waitcnt vmcnt(50)
s_waitcnt lgkmcnt(0)
s_barrier
v_mfma_f32_16x16x32_bf16 a[80:83], a[208:211], a[128:131], a[80:83]
ds_read_b64_tr_b16 a[192:193], v60 offset:0
ds_read_b64_tr_b16 a[194:195], v60 offset:6144
v_mfma_f32_16x16x32_bf16 a[80:83], a[212:215], a[132:135], a[80:83]
ds_read_b64_tr_b16 a[196:197], v60 offset:12288
ds_read_b64_tr_b16 a[198:199], v60 offset:18432
v_mfma_f32_16x16x32_bf16 a[84:87], a[208:211], a[136:139], a[84:87]
v_mfma_f32_16x16x32_bf16 a[84:87], a[212:215], a[140:143], a[84:87]
v_mfma_f32_16x16x32_bf16 a[88:91], a[208:211], a[144:147], a[88:91]
v_mfma_f32_16x16x32_bf16 a[88:91], a[212:215], a[148:151], a[88:91]
v_mfma_f32_16x16x32_bf16 a[92:95], a[208:211], a[152:155], a[92:95]
v_mfma_f32_16x16x32_bf16 a[92:95], a[212:215], a[156:159], a[92:95]
s_waitcnt lgkmcnt(2) vmcnt(24)
v_mfma_f32_16x16x32_bf16 v[64:67], a[192:195], a[160:163], v[64:67]
s_waitcnt lgkmcnt(0) vmcnt(23)
ds_read_b64_tr_b16 a[200:201], v60 offset:8
ds_read_b64_tr_b16 a[202:203], v60 offset:6152
v_mfma_f32_16x16x32_bf16 v[64:67], a[196:199], a[164:167], v[64:67]
s_waitcnt vmcnt(22)
ds_read_b64_tr_b16 a[204:205], v60 offset:12296
ds_read_b64_tr_b16 a[206:207], v60 offset:18440
v_mfma_f32_16x16x32_bf16 v[68:71], a[192:195], a[168:171], v[68:71]
s_waitcnt vmcnt(21)
s_add_u32 m0, s39, 36864
v_mfma_f32_16x16x32_bf16 v[68:71], a[196:199], a[172:175], v[68:71]
s_waitcnt vmcnt(20)
buffer_load_dwordx4 v10, s[16:19], s42 offen offset:0 lds
v_mfma_f32_16x16x32_bf16 v[72:75], a[192:195], a[176:179], v[72:75]
s_waitcnt vmcnt(20)
v_mfma_f32_16x16x32_bf16 v[72:75], a[196:199], a[180:183], v[72:75]
s_waitcnt vmcnt(19)
v_mfma_f32_16x16x32_bf16 v[76:79], a[192:195], a[184:187], v[76:79]
s_waitcnt vmcnt(18)
v_mfma_f32_16x16x32_bf16 v[76:79], a[196:199], a[188:191], v[76:79]
s_waitcnt lgkmcnt(2)
v_mfma_f32_16x16x32_bf16 v[80:83], a[200:203], a[160:163], v[80:83]
s_waitcnt lgkmcnt(0)
ds_read_b64_tr_b16 a[208:209], v61 offset:0
ds_read_b64_tr_b16 a[210:211], v61 offset:6144
v_mfma_f32_16x16x32_bf16 v[80:83], a[204:207], a[164:167], v[80:83]
ds_read_b64_tr_b16 a[212:213], v61 offset:12288
ds_read_b64_tr_b16 a[214:215], v61 offset:18432
v_mfma_f32_16x16x32_bf16 v[84:87], a[200:203], a[168:171], v[84:87]
buffer_load_dwordx4 v11, s[16:19], s42 offen offset:1024 lds
v_mfma_f32_16x16x32_bf16 v[84:87], a[204:207], a[172:175], v[84:87]
v_mfma_f32_16x16x32_bf16 v[88:91], a[200:203], a[176:179], v[88:91]
v_mfma_f32_16x16x32_bf16 v[88:91], a[204:207], a[180:183], v[88:91]
v_mfma_f32_16x16x32_bf16 v[92:95], a[200:203], a[184:187], v[92:95]
v_mfma_f32_16x16x32_bf16 v[92:95], a[204:207], a[188:191], v[92:95]
s_waitcnt lgkmcnt(2)
v_mfma_f32_16x16x32_bf16 v[96:99], a[208:211], a[160:163], v[96:99]
s_waitcnt lgkmcnt(0)
ds_read_b64_tr_b16 a[192:193], v61 offset:8
ds_read_b64_tr_b16 a[194:195], v61 offset:6152
v_mfma_f32_16x16x32_bf16 v[96:99], a[212:215], a[164:167], v[96:99]
ds_read_b64_tr_b16 a[196:197], v61 offset:12296
ds_read_b64_tr_b16 a[198:199], v61 offset:18440
v_mfma_f32_16x16x32_bf16 v[100:103], a[208:211], a[168:171], v[100:103]
buffer_load_dwordx4 v12, s[16:19], s42 offen offset:2048 lds
v_mfma_f32_16x16x32_bf16 v[100:103], a[212:215], a[172:175], v[100:103]
s_add_u32 s42, s42, 393216
v_mfma_f32_16x16x32_bf16 v[104:107], a[208:211], a[176:179], v[104:107]
v_mfma_f32_16x16x32_bf16 v[104:107], a[212:215], a[180:183], v[104:107]
v_mfma_f32_16x16x32_bf16 v[108:111], a[208:211], a[184:187], v[108:111]
v_mfma_f32_16x16x32_bf16 v[108:111], a[212:215], a[188:191], v[108:111]
s_waitcnt lgkmcnt(2)
v_mfma_f32_16x16x32_bf16 v[112:115], a[192:195], a[160:163], v[112:115]
s_waitcnt lgkmcnt(0)
ds_read_b64_tr_b16 a[200:201], v60 offset:128
ds_read_b64_tr_b16 a[202:203], v60 offset:6272
v_mfma_f32_16x16x32_bf16 v[112:115], a[196:199], a[164:167], v[112:115]
s_add_u32 m0, s39, 49152
ds_read_b64_tr_b16 a[204:205], v60 offset:12416
ds_read_b64_tr_b16 a[206:207], v60 offset:18560
v_mfma_f32_16x16x32_bf16 v[116:119], a[192:195], a[168:171], v[116:119]
buffer_load_dwordx4 v10, s[16:19], s42 offen offset:0 lds
v_mfma_f32_16x16x32_bf16 v[116:119], a[196:199], a[172:175], v[116:119]
v_mfma_f32_16x16x32_bf16 v[120:123], a[192:195], a[176:179], v[120:123]
v_mfma_f32_16x16x32_bf16 v[120:123], a[196:199], a[180:183], v[120:123]
v_mfma_f32_16x16x32_bf16 v[124:127], a[192:195], a[184:187], v[124:127]
v_mfma_f32_16x16x32_bf16 v[124:127], a[196:199], a[188:191], v[124:127]
s_waitcnt lgkmcnt(2)
v_mfma_f32_16x16x32_bf16 v[128:131], a[200:203], a[160:163], v[128:131]
s_waitcnt lgkmcnt(0)
ds_read_b64_tr_b16 a[208:209], v60 offset:136
ds_read_b64_tr_b16 a[210:211], v60 offset:6280
v_mfma_f32_16x16x32_bf16 v[128:131], a[204:207], a[164:167], v[128:131]
ds_read_b64_tr_b16 a[212:213], v60 offset:12424
ds_read_b64_tr_b16 a[214:215], v60 offset:18568
v_mfma_f32_16x16x32_bf16 v[132:135], a[200:203], a[168:171], v[132:135]
buffer_load_dwordx4 v11, s[16:19], s42 offen offset:1024 lds
v_mfma_f32_16x16x32_bf16 v[132:135], a[204:207], a[172:175], v[132:135]
v_mfma_f32_16x16x32_bf16 v[136:139], a[200:203], a[176:179], v[136:139]
v_mfma_f32_16x16x32_bf16 v[136:139], a[204:207], a[180:183], v[136:139]
v_mfma_f32_16x16x32_bf16 v[140:143], a[200:203], a[184:187], v[140:143]
v_mfma_f32_16x16x32_bf16 v[140:143], a[204:207], a[188:191], v[140:143]
s_waitcnt lgkmcnt(2)
v_mfma_f32_16x16x32_bf16 v[144:147], a[208:211], a[160:163], v[144:147]
s_waitcnt lgkmcnt(0)
ds_read_b64_tr_b16 a[192:193], v61 offset:128
ds_read_b64_tr_b16 a[194:195], v61 offset:6272
v_mfma_f32_16x16x32_bf16 v[144:147], a[212:215], a[164:167], v[144:147]
ds_read_b64_tr_b16 a[196:197], v61 offset:12416
ds_read_b64_tr_b16 a[198:199], v61 offset:18560
v_mfma_f32_16x16x32_bf16 v[148:151], a[208:211], a[168:171], v[148:151]
buffer_load_dwordx4 v12, s[16:19], s42 offen offset:2048 lds
v_mfma_f32_16x16x32_bf16 v[148:151], a[212:215], a[172:175], v[148:151]
s_add_u32 s42, s42, 393216
v_mfma_f32_16x16x32_bf16 v[152:155], a[208:211], a[176:179], v[152:155]
v_mfma_f32_16x16x32_bf16 v[152:155], a[212:215], a[180:183], v[152:155]
v_mfma_f32_16x16x32_bf16 v[156:159], a[208:211], a[184:187], v[156:159]
v_mfma_f32_16x16x32_bf16 v[156:159], a[212:215], a[188:191], v[156:159]
s_waitcnt lgkmcnt(2)
v_mfma_f32_16x16x32_bf16 v[160:163], a[192:195], a[160:163], v[160:163]
s_waitcnt lgkmcnt(0)
ds_read_b64_tr_b16 a[200:201], v61 offset:136
ds_read_b64_tr_b16 a[202:203], v61 offset:6280
v_mfma_f32_16x16x32_bf16 v[160:163], a[196:199], a[164:167], v[160:163]
s_add_u32 m0, s39, 61440
ds_read_b64_tr_b16 a[204:205], v61 offset:12424
ds_read_b64_tr_b16 a[206:207], v61 offset:18568
v_mfma_f32_16x16x32_bf16 v[164:167], a[192:195], a[168:171], v[164:167]
buffer_load_dwordx4 v13, s[20:23], s43 offen offset:0 lds
v_mfma_f32_16x16x32_bf16 v[164:167], a[196:199], a[172:175], v[164:167]
v_mfma_f32_16x16x32_bf16 v[168:171], a[192:195], a[176:179], v[168:171]
v_mfma_f32_16x16x32_bf16 v[168:171], a[196:199], a[180:183], v[168:171]
v_mfma_f32_16x16x32_bf16 v[172:175], a[192:195], a[184:187], v[172:175]
v_mfma_f32_16x16x32_bf16 v[172:175], a[196:199], a[188:191], v[172:175]
s_waitcnt lgkmcnt(2)
v_mfma_f32_16x16x32_bf16 v[176:179], a[200:203], a[160:163], v[176:179]
s_waitcnt lgkmcnt(0)
ds_read_b64_tr_b16 a[208:209], v60 offset:256
ds_read_b64_tr_b16 a[210:211], v60 offset:6400
v_mfma_f32_16x16x32_bf16 v[176:179], a[204:207], a[164:167], v[176:179]
ds_read_b64_tr_b16 a[212:213], v60 offset:12544
ds_read_b64_tr_b16 a[214:215], v60 offset:18688
v_mfma_f32_16x16x32_bf16 v[180:183], a[200:203], a[168:171], v[180:183]
buffer_load_dwordx4 v14, s[20:23], s43 offen offset:1024 lds
v_mfma_f32_16x16x32_bf16 v[180:183], a[204:207], a[172:175], v[180:183]
v_mfma_f32_16x16x32_bf16 v[184:187], a[200:203], a[176:179], v[184:187]
v_mfma_f32_16x16x32_bf16 v[184:187], a[204:207], a[180:183], v[184:187]
v_mfma_f32_16x16x32_bf16 v[188:191], a[200:203], a[184:187], v[188:191]
v_mfma_f32_16x16x32_bf16 v[188:191], a[204:207], a[188:191], v[188:191]
s_waitcnt lgkmcnt(2)
v_mfma_f32_16x16x32_bf16 v[192:195], a[208:211], a[160:163], v[192:195]
s_waitcnt lgkmcnt(0)
ds_read_b64_tr_b16 a[192:193], v60 offset:264
ds_read_b64_tr_b16 a[194:195], v60 offset:6408
v_mfma_f32_16x16x32_bf16 v[192:195], a[212:215], a[164:167], v[192:195]
ds_read_b64_tr_b16 a[196:197], v60 offset:12552
ds_read_b64_tr_b16 a[198:199], v60 offset:18696
v_mfma_f32_16x16x32_bf16 v[196:199], a[208:211], a[168:171], v[196:199]
buffer_load_dwordx4 v15, s[20:23], s43 offen offset:2048 lds
v_mfma_f32_16x16x32_bf16 v[196:199], a[212:215], a[172:175], v[196:199]
s_add_u32 s43, s43, 196608
v_mfma_f32_16x16x32_bf16 v[200:203], a[208:211], a[176:179], v[200:203]
v_mfma_f32_16x16x32_bf16 v[200:203], a[212:215], a[180:183], v[200:203]
v_mfma_f32_16x16x32_bf16 v[204:207], a[208:211], a[184:187], v[204:207]
v_mfma_f32_16x16x32_bf16 v[204:207], a[212:215], a[188:191], v[204:207]
s_waitcnt lgkmcnt(2)
v_mfma_f32_16x16x32_bf16 v[208:211], a[192:195], a[160:163], v[208:211]
s_waitcnt lgkmcnt(0)
ds_read_b64_tr_b16 a[200:201], v61 offset:256
ds_read_b64_tr_b16 a[202:203], v61 offset:6400
v_mfma_f32_16x16x32_bf16 v[208:211], a[196:199], a[164:167], v[208:211]
ds_read_b64_tr_b16 a[204:205], v61 offset:12544
ds_read_b64_tr_b16 a[206:207], v61 offset:18688
v_mfma_f32_16x16x32_bf16 v[212:215], a[192:195], a[168:171], v[212:215]
buffer_load_dwordx4 a[128:131], v53, s[24:27], s44 offen offset:0 sc1
v_mfma_f32_16x16x32_bf16 v[212:215], a[196:199], a[172:175], v[212:215]
v_mfma_f32_16x16x32_bf16 v[216:219], a[192:195], a[176:179], v[216:219]
v_mfma_f32_16x16x32_bf16 v[216:219], a[196:199], a[180:183], v[216:219]
v_mfma_f32_16x16x32_bf16 v[220:223], a[192:195], a[184:187], v[220:223]
v_mfma_f32_16x16x32_bf16 v[220:223], a[196:199], a[188:191], v[220:223]
s_waitcnt lgkmcnt(2)
v_mfma_f32_16x16x32_bf16 v[224:227], a[200:203], a[160:163], v[224:227]
s_waitcnt lgkmcnt(0)
ds_read_b64_tr_b16 a[208:209], v61 offset:264
ds_read_b64_tr_b16 a[210:211], v61 offset:6408
v_mfma_f32_16x16x32_bf16 v[224:227], a[204:207], a[164:167], v[224:227]
ds_read_b64_tr_b16 a[212:213], v61 offset:12552
ds_read_b64_tr_b16 a[214:215], v61 offset:18696
v_mfma_f32_16x16x32_bf16 v[228:231], a[200:203], a[168:171], v[228:231]
buffer_load_dwordx4 a[132:135], v53, s[24:27], s44 offen offset:1024 sc1
v_mfma_f32_16x16x32_bf16 v[228:231], a[204:207], a[172:175], v[228:231]
v_mfma_f32_16x16x32_bf16 v[232:235], a[200:203], a[176:179], v[232:235]
v_mfma_f32_16x16x32_bf16 v[232:235], a[204:207], a[180:183], v[232:235]
v_mfma_f32_16x16x32_bf16 v[236:239], a[200:203], a[184:187], v[236:239]
v_mfma_f32_16x16x32_bf16 v[236:239], a[204:207], a[188:191], v[236:239]
s_waitcnt lgkmcnt(2)
v_mfma_f32_16x16x32_bf16 v[240:243], a[208:211], a[160:163], v[240:243]
s_waitcnt lgkmcnt(0)
ds_read_b64_tr_b16 a[192:193], v29 offset:0
ds_read_b64_tr_b16 a[194:195], v29 offset:1536
v_mfma_f32_16x16x32_bf16 v[240:243], a[212:215], a[164:167], v[240:243]
ds_read_b64_tr_b16 a[196:197], v29 offset:3072
ds_read_b64_tr_b16 a[198:199], v29 offset:4608
v_mfma_f32_16x16x32_bf16 v[244:247], a[208:211], a[168:171], v[244:247]
buffer_load_dwordx4 a[136:139], v54, s[24:27], s44 offen offset:0 sc1
v_mfma_f32_16x16x32_bf16 v[244:247], a[212:215], a[172:175], v[244:247]
v_mfma_f32_16x16x32_bf16 v[248:251], a[208:211], a[176:179], v[248:251]
v_mfma_f32_16x16x32_bf16 v[248:251], a[212:215], a[180:183], v[248:251]
v_mfma_f32_16x16x32_bf16 v[252:255], a[208:211], a[184:187], v[252:255]
v_mfma_f32_16x16x32_bf16 v[252:255], a[212:215], a[188:191], v[252:255]
s_waitcnt lgkmcnt(2)
v_mfma_f32_16x16x32_bf16 a[0:3], a[192:195], a[160:163], a[0:3]
s_waitcnt lgkmcnt(0)
ds_read_b64_tr_b16 a[200:201], v29 offset:32
ds_read_b64_tr_b16 a[202:203], v29 offset:1568
v_mfma_f32_16x16x32_bf16 a[0:3], a[196:199], a[164:167], a[0:3]
ds_read_b64_tr_b16 a[204:205], v29 offset:3104
ds_read_b64_tr_b16 a[206:207], v29 offset:4640
v_mfma_f32_16x16x32_bf16 a[4:7], a[192:195], a[168:171], a[4:7]
buffer_load_dwordx4 a[140:143], v54, s[24:27], s44 offen offset:1024 sc1
v_mfma_f32_16x16x32_bf16 a[4:7], a[196:199], a[172:175], a[4:7]
v_mfma_f32_16x16x32_bf16 a[8:11], a[192:195], a[176:179], a[8:11]
v_mfma_f32_16x16x32_bf16 a[8:11], a[196:199], a[180:183], a[8:11]
v_mfma_f32_16x16x32_bf16 a[12:15], a[192:195], a[184:187], a[12:15]
v_mfma_f32_16x16x32_bf16 a[12:15], a[196:199], a[188:191], a[12:15]
s_waitcnt lgkmcnt(2)
v_mfma_f32_16x16x32_bf16 a[16:19], a[200:203], a[160:163], a[16:19]
s_waitcnt lgkmcnt(0)
ds_read_b64_tr_b16 a[208:209], v29 offset:64
ds_read_b64_tr_b16 a[210:211], v29 offset:1600
v_mfma_f32_16x16x32_bf16 a[16:19], a[204:207], a[164:167], a[16:19]
ds_read_b64_tr_b16 a[212:213], v29 offset:3136
ds_read_b64_tr_b16 a[214:215], v29 offset:4672
v_mfma_f32_16x16x32_bf16 a[20:23], a[200:203], a[168:171], a[20:23]
buffer_load_dwordx4 a[144:147], v55, s[24:27], s44 offen offset:0 sc1
v_mfma_f32_16x16x32_bf16 a[20:23], a[204:207], a[172:175], a[20:23]
v_mfma_f32_16x16x32_bf16 a[24:27], a[200:203], a[176:179], a[24:27]
v_mfma_f32_16x16x32_bf16 a[24:27], a[204:207], a[180:183], a[24:27]
v_mfma_f32_16x16x32_bf16 a[28:31], a[200:203], a[184:187], a[28:31]
v_mfma_f32_16x16x32_bf16 a[28:31], a[204:207], a[188:191], a[28:31]
s_waitcnt lgkmcnt(2)
v_mfma_f32_16x16x32_bf16 a[32:35], a[208:211], a[160:163], a[32:35]
s_waitcnt lgkmcnt(0)
ds_read_b64_tr_b16 a[192:193], v29 offset:6144
ds_read_b64_tr_b16 a[194:195], v29 offset:7680
v_mfma_f32_16x16x32_bf16 a[32:35], a[212:215], a[164:167], a[32:35]
ds_read_b64_tr_b16 a[196:197], v29 offset:9216
ds_read_b64_tr_b16 a[198:199], v29 offset:10752
v_mfma_f32_16x16x32_bf16 a[36:39], a[208:211], a[168:171], a[36:39]
buffer_load_dwordx4 a[148:151], v55, s[24:27], s44 offen offset:1024 sc1
v_mfma_f32_16x16x32_bf16 a[36:39], a[212:215], a[172:175], a[36:39]
v_mfma_f32_16x16x32_bf16 a[40:43], a[208:211], a[176:179], a[40:43]
v_mfma_f32_16x16x32_bf16 a[40:43], a[212:215], a[180:183], a[40:43]
v_mfma_f32_16x16x32_bf16 a[44:47], a[208:211], a[184:187], a[44:47]
v_mfma_f32_16x16x32_bf16 a[44:47], a[212:215], a[188:191], a[44:47]
s_waitcnt lgkmcnt(2)
v_mfma_f32_16x16x32_bf16 a[48:51], a[192:195], a[160:163], a[48:51]
s_waitcnt lgkmcnt(0)
ds_read_b64_tr_b16 a[200:201], v29 offset:6176
ds_read_b64_tr_b16 a[202:203], v29 offset:7712
v_mfma_f32_16x16x32_bf16 a[48:51], a[196:199], a[164:167], a[48:51]
ds_read_b64_tr_b16 a[204:205], v29 offset:9248
ds_read_b64_tr_b16 a[206:207], v29 offset:10784
v_mfma_f32_16x16x32_bf16 a[52:55], a[192:195], a[168:171], a[52:55]
buffer_load_dwordx4 a[152:155], v56, s[24:27], s44 offen offset:0 sc1
v_mfma_f32_16x16x32_bf16 a[52:55], a[196:199], a[172:175], a[52:55]
v_mfma_f32_16x16x32_bf16 a[56:59], a[192:195], a[176:179], a[56:59]
v_mfma_f32_16x16x32_bf16 a[56:59], a[196:199], a[180:183], a[56:59]
v_mfma_f32_16x16x32_bf16 a[60:63], a[192:195], a[184:187], a[60:63]
ds_read_b64_tr_b16 a[208:209], v29 offset:6208
ds_read_b64_tr_b16 a[210:211], v29 offset:7744
v_mfma_f32_16x16x32_bf16 a[60:63], a[196:199], a[188:191], a[60:63]
s_waitcnt lgkmcnt(4)
ds_read_b64_tr_b16 a[212:213], v29 offset:9280
ds_read_b64_tr_b16 a[214:215], v29 offset:10816
v_mfma_f32_16x16x32_bf16 a[64:67], a[200:203], a[160:163], a[64:67]
s_waitcnt lgkmcnt(4)
buffer_load_dwordx4 a[156:159], v56, s[24:27], s44 offen offset:1024 sc1
v_mfma_f32_16x16x32_bf16 a[64:67], a[204:207], a[164:167], a[64:67]
v_mfma_f32_16x16x32_bf16 a[68:71], a[200:203], a[168:171], a[68:71]
v_mfma_f32_16x16x32_bf16 a[68:71], a[204:207], a[172:175], a[68:71]
v_mfma_f32_16x16x32_bf16 a[72:75], a[200:203], a[176:179], a[72:75]
v_mfma_f32_16x16x32_bf16 a[72:75], a[204:207], a[180:183], a[72:75]
v_mfma_f32_16x16x32_bf16 a[76:79], a[200:203], a[184:187], a[76:79]
s_add_u32 s44, s44, 2048
v_mfma_f32_16x16x32_bf16 a[76:79], a[204:207], a[188:191], a[76:79]
s_waitcnt vmcnt(42)
s_waitcnt lgkmcnt(0)
s_barrier
v_mfma_f32_16x16x32_bf16 a[80:83], a[208:211], a[160:163], a[80:83]
ds_read_b64_tr_b16 a[192:193], v60 offset:36864
ds_read_b64_tr_b16 a[194:195], v60 offset:43008
v_mfma_f32_16x16x32_bf16 a[80:83], a[212:215], a[164:167], a[80:83]
ds_read_b64_tr_b16 a[196:197], v60 offset:49152
ds_read_b64_tr_b16 a[198:199], v60 offset:55296
v_mfma_f32_16x16x32_bf16 a[84:87], a[208:211], a[168:171], a[84:87]
v_mfma_f32_16x16x32_bf16 a[84:87], a[212:215], a[172:175], a[84:87]
v_mfma_f32_16x16x32_bf16 a[88:91], a[208:211], a[176:179], a[88:91]
v_mfma_f32_16x16x32_bf16 a[88:91], a[212:215], a[180:183], a[88:91]
v_mfma_f32_16x16x32_bf16 a[92:95], a[208:211], a[184:187], a[92:95]
v_mfma_f32_16x16x32_bf16 a[92:95], a[212:215], a[188:191], a[92:95]
s_waitcnt lgkmcnt(2) vmcnt(24)
v_mfma_f32_16x16x32_bf16 v[64:67], a[192:195], a[96:99], v[64:67]
s_waitcnt lgkmcnt(0) vmcnt(23)
ds_read_b64_tr_b16 a[200:201], v60 offset:36872
ds_read_b64_tr_b16 a[202:203], v60 offset:43016
v_mfma_f32_16x16x32_bf16 v[64:67], a[196:199], a[100:103], v[64:67]
s_waitcnt vmcnt(22)
ds_read_b64_tr_b16 a[204:205], v60 offset:49160
ds_read_b64_tr_b16 a[206:207], v60 offset:55304
v_mfma_f32_16x16x32_bf16 v[68:71], a[192:195], a[104:107], v[68:71]
s_waitcnt vmcnt(21)
s_add_u32 m0, s39, 73728
v_mfma_f32_16x16x32_bf16 v[68:71], a[196:199], a[108:111], v[68:71]
s_waitcnt vmcnt(20)
buffer_load_dwordx4 v10, s[16:19], s42 offen offset:0 lds
v_mfma_f32_16x16x32_bf16 v[72:75], a[192:195], a[112:115], v[72:75]
s_waitcnt vmcnt(20)
v_mfma_f32_16x16x32_bf16 v[72:75], a[196:199], a[116:119], v[72:75]
s_waitcnt vmcnt(19)
v_mfma_f32_16x16x32_bf16 v[76:79], a[192:195], a[120:123], v[76:79]
s_waitcnt vmcnt(18)
v_mfma_f32_16x16x32_bf16 v[76:79], a[196:199], a[124:127], v[76:79]
s_waitcnt lgkmcnt(2)
v_mfma_f32_16x16x32_bf16 v[80:83], a[200:203], a[96:99], v[80:83]
s_waitcnt lgkmcnt(0)
ds_read_b64_tr_b16 a[208:209], v61 offset:36864
ds_read_b64_tr_b16 a[210:211], v61 offset:43008
v_mfma_f32_16x16x32_bf16 v[80:83], a[204:207], a[100:103], v[80:83]
ds_read_b64_tr_b16 a[212:213], v61 offset:49152
ds_read_b64_tr_b16 a[214:215], v61 offset:55296
v_mfma_f32_16x16x32_bf16 v[84:87], a[200:203], a[104:107], v[84:87]
buffer_load_dwordx4 v11, s[16:19], s42 offen offset:1024 lds
v_mfma_f32_16x16x32_bf16 v[84:87], a[204:207], a[108:111], v[84:87]
v_mfma_f32_16x16x32_bf16 v[88:91], a[200:203], a[112:115], v[88:91]
v_mfma_f32_16x16x32_bf16 v[88:91], a[204:207], a[116:119], v[88:91]
v_mfma_f32_16x16x32_bf16 v[92:95], a[200:203], a[120:123], v[92:95]
v_mfma_f32_16x16x32_bf16 v[92:95], a[204:207], a[124:127], v[92:95]
s_waitcnt lgkmcnt(2)
v_mfma_f32_16x16x32_bf16 v[96:99], a[208:211], a[96:99], v[96:99]
s_waitcnt lgkmcnt(0)
ds_read_b64_tr_b16 a[192:193], v61 offset:36872
ds_read_b64_tr_b16 a[194:195], v61 offset:43016
v_mfma_f32_16x16x32_bf16 v[96:99], a[212:215], a[100:103], v[96:99]
ds_read_b64_tr_b16 a[196:197], v61 offset:49160
ds_read_b64_tr_b16 a[198:199], v61 offset:55304
v_mfma_f32_16x16x32_bf16 v[100:103], a[208:211], a[104:107], v[100:103]
buffer_load_dwordx4 v12, s[16:19], s42 offen offset:2048 lds
v_mfma_f32_16x16x32_bf16 v[100:103], a[212:215], a[108:111], v[100:103]
s_add_u32 s42, s42, 393216
v_mfma_f32_16x16x32_bf16 v[104:107], a[208:211], a[112:115], v[104:107]
v_mfma_f32_16x16x32_bf16 v[104:107], a[212:215], a[116:119], v[104:107]
v_mfma_f32_16x16x32_bf16 v[108:111], a[208:211], a[120:123], v[108:111]
v_mfma_f32_16x16x32_bf16 v[108:111], a[212:215], a[124:127], v[108:111]
s_waitcnt lgkmcnt(2)
v_mfma_f32_16x16x32_bf16 v[112:115], a[192:195], a[96:99], v[112:115]
s_waitcnt lgkmcnt(0)
ds_read_b64_tr_b16 a[200:201], v60 offset:36992
ds_read_b64_tr_b16 a[202:203], v60 offset:43136
v_mfma_f32_16x16x32_bf16 v[112:115], a[196:199], a[100:103], v[112:115]
s_add_u32 m0, s39, 86016
ds_read_b64_tr_b16 a[204:205], v60 offset:49280
ds_read_b64_tr_b16 a[206:207], v60 offset:55424
v_mfma_f32_16x16x32_bf16 v[116:119], a[192:195], a[104:107], v[116:119]
buffer_load_dwordx4 v10, s[16:19], s42 offen offset:0 lds
v_mfma_f32_16x16x32_bf16 v[116:119], a[196:199], a[108:111], v[116:119]
v_mfma_f32_16x16x32_bf16 v[120:123], a[192:195], a[112:115], v[120:123]
v_mfma_f32_16x16x32_bf16 v[120:123], a[196:199], a[116:119], v[120:123]
v_mfma_f32_16x16x32_bf16 v[124:127], a[192:195], a[120:123], v[124:127]
v_mfma_f32_16x16x32_bf16 v[124:127], a[196:199], a[124:127], v[124:127]
s_waitcnt lgkmcnt(2)
v_mfma_f32_16x16x32_bf16 v[128:131], a[200:203], a[96:99], v[128:131]
s_waitcnt lgkmcnt(0)
ds_read_b64_tr_b16 a[208:209], v60 offset:37000
ds_read_b64_tr_b16 a[210:211], v60 offset:43144
v_mfma_f32_16x16x32_bf16 v[128:131], a[204:207], a[100:103], v[128:131]
ds_read_b64_tr_b16 a[212:213], v60 offset:49288
ds_read_b64_tr_b16 a[214:215], v60 offset:55432
v_mfma_f32_16x16x32_bf16 v[132:135], a[200:203], a[104:107], v[132:135]
buffer_load_dwordx4 v11, s[16:19], s42 offen offset:1024 lds
v_mfma_f32_16x16x32_bf16 v[132:135], a[204:207], a[108:111], v[132:135]
v_mfma_f32_16x16x32_bf16 v[136:139], a[200:203], a[112:115], v[136:139]
v_mfma_f32_16x16x32_bf16 v[136:139], a[204:207], a[116:119], v[136:139]
v_mfma_f32_16x16x32_bf16 v[140:143], a[200:203], a[120:123], v[140:143]
v_mfma_f32_16x16x32_bf16 v[140:143], a[204:207], a[124:127], v[140:143]
s_waitcnt lgkmcnt(2)
v_mfma_f32_16x16x32_bf16 v[144:147], a[208:211], a[96:99], v[144:147]
s_waitcnt lgkmcnt(0)
ds_read_b64_tr_b16 a[192:193], v61 offset:36992
ds_read_b64_tr_b16 a[194:195], v61 offset:43136
v_mfma_f32_16x16x32_bf16 v[144:147], a[212:215], a[100:103], v[144:147]
ds_read_b64_tr_b16 a[196:197], v61 offset:49280
ds_read_b64_tr_b16 a[198:199], v61 offset:55424
v_mfma_f32_16x16x32_bf16 v[148:151], a[208:211], a[104:107], v[148:151]
buffer_load_dwordx4 v12, s[16:19], s42 offen offset:2048 lds
v_mfma_f32_16x16x32_bf16 v[148:151], a[212:215], a[108:111], v[148:151]
s_add_u32 s42, s42, 393216
v_mfma_f32_16x16x32_bf16 v[152:155], a[208:211], a[112:115], v[152:155]
v_mfma_f32_16x16x32_bf16 v[152:155], a[212:215], a[116:119], v[152:155]
v_mfma_f32_16x16x32_bf16 v[156:159], a[208:211], a[120:123], v[156:159]
v_mfma_f32_16x16x32_bf16 v[156:159], a[212:215], a[124:127], v[156:159]
s_waitcnt lgkmcnt(2)
v_mfma_f32_16x16x32_bf16 v[160:163], a[192:195], a[96:99], v[160:163]
s_waitcnt lgkmcnt(0)
ds_read_b64_tr_b16 a[200:201], v61 offset:37000
ds_read_b64_tr_b16 a[202:203], v61 offset:43144
v_mfma_f32_16x16x32_bf16 v[160:163], a[196:199], a[100:103], v[160:163]
s_add_u32 m0, s39, 98304
ds_read_b64_tr_b16 a[204:205], v61 offset:49288
ds_read_b64_tr_b16 a[206:207], v61 offset:55432
v_mfma_f32_16x16x32_bf16 v[164:167], a[192:195], a[104:107], v[164:167]
buffer_load_dwordx4 v13, s[20:23], s43 offen offset:0 lds
v_mfma_f32_16x16x32_bf16 v[164:167], a[196:199], a[108:111], v[164:167]
v_mfma_f32_16x16x32_bf16 v[168:171], a[192:195], a[112:115], v[168:171]
v_mfma_f32_16x16x32_bf16 v[168:171], a[196:199], a[116:119], v[168:171]
v_mfma_f32_16x16x32_bf16 v[172:175], a[192:195], a[120:123], v[172:175]
v_mfma_f32_16x16x32_bf16 v[172:175], a[196:199], a[124:127], v[172:175]
s_waitcnt lgkmcnt(2)
v_mfma_f32_16x16x32_bf16 v[176:179], a[200:203], a[96:99], v[176:179]
s_waitcnt lgkmcnt(0)
ds_read_b64_tr_b16 a[208:209], v60 offset:37120
ds_read_b64_tr_b16 a[210:211], v60 offset:43264
v_mfma_f32_16x16x32_bf16 v[176:179], a[204:207], a[100:103], v[176:179]
ds_read_b64_tr_b16 a[212:213], v60 offset:49408
ds_read_b64_tr_b16 a[214:215], v60 offset:55552
v_mfma_f32_16x16x32_bf16 v[180:183], a[200:203], a[104:107], v[180:183]
buffer_load_dwordx4 v14, s[20:23], s43 offen offset:1024 lds
v_mfma_f32_16x16x32_bf16 v[180:183], a[204:207], a[108:111], v[180:183]
v_mfma_f32_16x16x32_bf16 v[184:187], a[200:203], a[112:115], v[184:187]
v_mfma_f32_16x16x32_bf16 v[184:187], a[204:207], a[116:119], v[184:187]
v_mfma_f32_16x16x32_bf16 v[188:191], a[200:203], a[120:123], v[188:191]
v_mfma_f32_16x16x32_bf16 v[188:191], a[204:207], a[124:127], v[188:191]
s_waitcnt lgkmcnt(2)
v_mfma_f32_16x16x32_bf16 v[192:195], a[208:211], a[96:99], v[192:195]
s_waitcnt lgkmcnt(0)
ds_read_b64_tr_b16 a[192:193], v60 offset:37128
ds_read_b64_tr_b16 a[194:195], v60 offset:43272
v_mfma_f32_16x16x32_bf16 v[192:195], a[212:215], a[100:103], v[192:195]
ds_read_b64_tr_b16 a[196:197], v60 offset:49416
ds_read_b64_tr_b16 a[198:199], v60 offset:55560
v_mfma_f32_16x16x32_bf16 v[196:199], a[208:211], a[104:107], v[196:199]
buffer_load_dwordx4 v15, s[20:23], s43 offen offset:2048 lds
v_mfma_f32_16x16x32_bf16 v[196:199], a[212:215], a[108:111], v[196:199]
s_add_u32 s43, s43, 196608
v_mfma_f32_16x16x32_bf16 v[200:203], a[208:211], a[112:115], v[200:203]
v_mfma_f32_16x16x32_bf16 v[200:203], a[212:215], a[116:119], v[200:203]
v_mfma_f32_16x16x32_bf16 v[204:207], a[208:211], a[120:123], v[204:207]
v_mfma_f32_16x16x32_bf16 v[204:207], a[212:215], a[124:127], v[204:207]
s_waitcnt lgkmcnt(2)
v_mfma_f32_16x16x32_bf16 v[208:211], a[192:195], a[96:99], v[208:211]
s_waitcnt lgkmcnt(0)
ds_read_b64_tr_b16 a[200:201], v61 offset:37120
ds_read_b64_tr_b16 a[202:203], v61 offset:43264
v_mfma_f32_16x16x32_bf16 v[208:211], a[196:199], a[100:103], v[208:211]
ds_read_b64_tr_b16 a[204:205], v61 offset:49408
ds_read_b64_tr_b16 a[206:207], v61 offset:55552
v_mfma_f32_16x16x32_bf16 v[212:215], a[192:195], a[104:107], v[212:215]
buffer_load_dwordx4 a[160:163], v53, s[24:27], s44 offen offset:0 sc1
v_mfma_f32_16x16x32_bf16 v[212:215], a[196:199], a[108:111], v[212:215]
v_mfma_f32_16x16x32_bf16 v[216:219], a[192:195], a[112:115], v[216:219]
v_mfma_f32_16x16x32_bf16 v[216:219], a[196:199], a[116:119], v[216:219]
v_mfma_f32_16x16x32_bf16 v[220:223], a[192:195], a[120:123], v[220:223]
v_mfma_f32_16x16x32_bf16 v[220:223], a[196:199], a[124:127], v[220:223]
s_waitcnt lgkmcnt(2)
v_mfma_f32_16x16x32_bf16 v[224:227], a[200:203], a[96:99], v[224:227]
s_waitcnt lgkmcnt(0)
ds_read_b64_tr_b16 a[208:209], v61 offset:37128
ds_read_b64_tr_b16 a[210:211], v61 offset:43272
v_mfma_f32_16x16x32_bf16 v[224:227], a[204:207], a[100:103], v[224:227]
ds_read_b64_tr_b16 a[212:213], v61 offset:49416
ds_read_b64_tr_b16 a[214:215], v61 offset:55560
v_mfma_f32_16x16x32_bf16 v[228:231], a[200:203], a[104:107], v[228:231]
buffer_load_dwordx4 a[164:167], v53, s[24:27], s44 offen offset:1024 sc1
v_mfma_f32_16x16x32_bf16 v[228:231], a[204:207], a[108:111], v[228:231]
v_mfma_f32_16x16x32_bf16 v[232:235], a[200:203], a[112:115], v[232:235]
v_mfma_f32_16x16x32_bf16 v[232:235], a[204:207], a[116:119], v[232:235]
v_mfma_f32_16x16x32_bf16 v[236:239], a[200:203], a[120:123], v[236:239]
v_mfma_f32_16x16x32_bf16 v[236:239], a[204:207], a[124:127], v[236:239]
s_waitcnt lgkmcnt(2)
v_mfma_f32_16x16x32_bf16 v[240:243], a[208:211], a[96:99], v[240:243]
s_waitcnt lgkmcnt(0)
ds_read_b64_tr_b16 a[192:193], v29 offset:36864
ds_read_b64_tr_b16 a[194:195], v29 offset:38400
v_mfma_f32_16x16x32_bf16 v[240:243], a[212:215], a[100:103], v[240:243]
ds_read_b64_tr_b16 a[196:197], v29 offset:39936
ds_read_b64_tr_b16 a[198:199], v29 offset:41472
v_mfma_f32_16x16x32_bf16 v[244:247], a[208:211], a[104:107], v[244:247]
buffer_load_dwordx4 a[168:171], v54, s[24:27], s44 offen offset:0 sc1
v_mfma_f32_16x16x32_bf16 v[244:247], a[212:215], a[108:111], v[244:247]
v_mfma_f32_16x16x32_bf16 v[248:251], a[208:211], a[112:115], v[248:251]
v_mfma_f32_16x16x32_bf16 v[248:251], a[212:215], a[116:119], v[248:251]
v_mfma_f32_16x16x32_bf16 v[252:255], a[208:211], a[120:123], v[252:255]
v_mfma_f32_16x16x32_bf16 v[252:255], a[212:215], a[124:127], v[252:255]
s_waitcnt lgkmcnt(2)
v_mfma_f32_16x16x32_bf16 a[0:3], a[192:195], a[96:99], a[0:3]
s_waitcnt lgkmcnt(0)
ds_read_b64_tr_b16 a[200:201], v29 offset:36896
ds_read_b64_tr_b16 a[202:203], v29 offset:38432
v_mfma_f32_16x16x32_bf16 a[0:3], a[196:199], a[100:103], a[0:3]
ds_read_b64_tr_b16 a[204:205], v29 offset:39968
ds_read_b64_tr_b16 a[206:207], v29 offset:41504
v_mfma_f32_16x16x32_bf16 a[4:7], a[192:195], a[104:107], a[4:7]
buffer_load_dwordx4 a[172:175], v54, s[24:27], s44 offen offset:1024 sc1
v_mfma_f32_16x16x32_bf16 a[4:7], a[196:199], a[108:111], a[4:7]
v_mfma_f32_16x16x32_bf16 a[8:11], a[192:195], a[112:115], a[8:11]
v_mfma_f32_16x16x32_bf16 a[8:11], a[196:199], a[116:119], a[8:11]
v_mfma_f32_16x16x32_bf16 a[12:15], a[192:195], a[120:123], a[12:15]
v_mfma_f32_16x16x32_bf16 a[12:15], a[196:199], a[124:127], a[12:15]
s_waitcnt lgkmcnt(2)
v_mfma_f32_16x16x32_bf16 a[16:19], a[200:203], a[96:99], a[16:19]
s_waitcnt lgkmcnt(0)
ds_read_b64_tr_b16 a[208:209], v29 offset:36928
ds_read_b64_tr_b16 a[210:211], v29 offset:38464
v_mfma_f32_16x16x32_bf16 a[16:19], a[204:207], a[100:103], a[16:19]
ds_read_b64_tr_b16 a[212:213], v29 offset:40000
ds_read_b64_tr_b16 a[214:215], v29 offset:41536
v_mfma_f32_16x16x32_bf16 a[20:23], a[200:203], a[104:107], a[20:23]
buffer_load_dwordx4 a[176:179], v55, s[24:27], s44 offen offset:0 sc1
v_mfma_f32_16x16x32_bf16 a[20:23], a[204:207], a[108:111], a[20:23]
v_mfma_f32_16x16x32_bf16 a[24:27], a[200:203], a[112:115], a[24:27]
v_mfma_f32_16x16x32_bf16 a[24:27], a[204:207], a[116:119], a[24:27]
v_mfma_f32_16x16x32_bf16 a[28:31], a[200:203], a[120:123], a[28:31]
v_mfma_f32_16x16x32_bf16 a[28:31], a[204:207], a[124:127], a[28:31]
s_waitcnt lgkmcnt(2)
v_mfma_f32_16x16x32_bf16 a[32:35], a[208:211], a[96:99], a[32:35]
s_waitcnt lgkmcnt(0)
ds_read_b64_tr_b16 a[192:193], v29 offset:43008
ds_read_b64_tr_b16 a[194:195], v29 offset:44544
v_mfma_f32_16x16x32_bf16 a[32:35], a[212:215], a[100:103], a[32:35]
ds_read_b64_tr_b16 a[196:197], v29 offset:46080
ds_read_b64_tr_b16 a[198:199], v29 offset:47616
v_mfma_f32_16x16x32_bf16 a[36:39], a[208:211], a[104:107], a[36:39]
buffer_load_dwordx4 a[180:183], v55, s[24:27], s44 offen offset:1024 sc1
v_mfma_f32_16x16x32_bf16 a[36:39], a[212:215], a[108:111], a[36:39]
v_mfma_f32_16x16x32_bf16 a[40:43], a[208:211], a[112:115], a[40:43]
v_mfma_f32_16x16x32_bf16 a[40:43], a[212:215], a[116:119], a[40:43]
v_mfma_f32_16x16x32_bf16 a[44:47], a[208:211], a[120:123], a[44:47]
v_mfma_f32_16x16x32_bf16 a[44:47], a[212:215], a[124:127], a[44:47]
s_waitcnt lgkmcnt(2)
v_mfma_f32_16x16x32_bf16 a[48:51], a[192:195], a[96:99], a[48:51]
s_waitcnt lgkmcnt(0)
ds_read_b64_tr_b16 a[200:201], v29 offset:43040
ds_read_b64_tr_b16 a[202:203], v29 offset:44576
v_mfma_f32_16x16x32_bf16 a[48:51], a[196:199], a[100:103], a[48:51]
ds_read_b64_tr_b16 a[204:205], v29 offset:46112
ds_read_b64_tr_b16 a[206:207], v29 offset:47648
v_mfma_f32_16x16x32_bf16 a[52:55], a[192:195], a[104:107], a[52:55]
buffer_load_dwordx4 a[184:187], v56, s[24:27], s44 offen offset:0 sc1
v_mfma_f32_16x16x32_bf16 a[52:55], a[196:199], a[108:111], a[52:55]
v_mfma_f32_16x16x32_bf16 a[56:59], a[192:195], a[112:115], a[56:59]
v_mfma_f32_16x16x32_bf16 a[56:59], a[196:199], a[116:119], a[56:59]
v_mfma_f32_16x16x32_bf16 a[60:63], a[192:195], a[120:123], a[60:63]
ds_read_b64_tr_b16 a[208:209], v29 offset:43072
ds_read_b64_tr_b16 a[210:211], v29 offset:44608
v_mfma_f32_16x16x32_bf16 a[60:63], a[196:199], a[124:127], a[60:63]
s_waitcnt lgkmcnt(4)
ds_read_b64_tr_b16 a[212:213], v29 offset:46144
ds_read_b64_tr_b16 a[214:215], v29 offset:47680
v_mfma_f32_16x16x32_bf16 a[64:67], a[200:203], a[96:99], a[64:67]
s_waitcnt lgkmcnt(4)
buffer_load_dwordx4 a[188:191], v56, s[24:27], s44 offen offset:1024 sc1
v_mfma_f32_16x16x32_bf16 a[64:67], a[204:207], a[100:103], a[64:67]
v_mfma_f32_16x16x32_bf16 a[68:71], a[200:203], a[104:107], a[68:71]
v_mfma_f32_16x16x32_bf16 a[68:71], a[204:207], a[108:111], a[68:71]
v_mfma_f32_16x16x32_bf16 a[72:75], a[200:203], a[112:115], a[72:75]
v_mfma_f32_16x16x32_bf16 a[72:75], a[204:207], a[116:119], a[72:75]
v_mfma_f32_16x16x32_bf16 a[76:79], a[200:203], a[120:123], a[76:79]
s_add_u32 s44, s44, 2048
v_mfma_f32_16x16x32_bf16 a[76:79], a[204:207], a[124:127], a[76:79]
s_waitcnt vmcnt(42)
s_waitcnt lgkmcnt(0)
s_barrier
v_mfma_f32_16x16x32_bf16 a[80:83], a[208:211], a[96:99], a[80:83]
ds_read_b64_tr_b16 a[192:193], v58 offset:0
ds_read_b64_tr_b16 a[194:195], v58 offset:6144
v_mfma_f32_16x16x32_bf16 a[80:83], a[212:215], a[100:103], a[80:83]
ds_read_b64_tr_b16 a[196:197], v58 offset:12288
ds_read_b64_tr_b16 a[198:199], v58 offset:18432
v_mfma_f32_16x16x32_bf16 a[84:87], a[208:211], a[104:107], a[84:87]
v_mfma_f32_16x16x32_bf16 a[84:87], a[212:215], a[108:111], a[84:87]
v_mfma_f32_16x16x32_bf16 a[88:91], a[208:211], a[112:115], a[88:91]
v_mfma_f32_16x16x32_bf16 a[88:91], a[212:215], a[116:119], a[88:91]
v_mfma_f32_16x16x32_bf16 a[92:95], a[208:211], a[120:123], a[92:95]
v_mfma_f32_16x16x32_bf16 a[92:95], a[212:215], a[124:127], a[92:95]
s_waitcnt lgkmcnt(2) vmcnt(24)
v_mfma_f32_16x16x32_bf16 v[64:67], a[192:195], a[128:131], v[64:67]
s_waitcnt lgkmcnt(0) vmcnt(23)
ds_read_b64_tr_b16 a[200:201], v58 offset:8
ds_read_b64_tr_b16 a[202:203], v58 offset:6152
v_mfma_f32_16x16x32_bf16 v[64:67], a[196:199], a[132:135], v[64:67]
s_waitcnt vmcnt(22)
ds_read_b64_tr_b16 a[204:205], v58 offset:12296
ds_read_b64_tr_b16 a[206:207], v58 offset:18440
v_mfma_f32_16x16x32_bf16 v[68:71], a[192:195], a[136:139], v[68:71]
s_waitcnt vmcnt(21)
s_add_u32 m0, s39, 110592
v_mfma_f32_16x16x32_bf16 v[68:71], a[196:199], a[140:143], v[68:71]
s_waitcnt vmcnt(20)
buffer_load_dwordx4 v10, s[16:19], s42 offen offset:0 lds
v_mfma_f32_16x16x32_bf16 v[72:75], a[192:195], a[144:147], v[72:75]
s_waitcnt vmcnt(20)
v_mfma_f32_16x16x32_bf16 v[72:75], a[196:199], a[148:151], v[72:75]
s_waitcnt vmcnt(19)
v_mfma_f32_16x16x32_bf16 v[76:79], a[192:195], a[152:155], v[76:79]
s_waitcnt vmcnt(18)
v_mfma_f32_16x16x32_bf16 v[76:79], a[196:199], a[156:159], v[76:79]
s_waitcnt lgkmcnt(2)
v_mfma_f32_16x16x32_bf16 v[80:83], a[200:203], a[128:131], v[80:83]
s_waitcnt lgkmcnt(0)
ds_read_b64_tr_b16 a[208:209], v59 offset:0
ds_read_b64_tr_b16 a[210:211], v59 offset:6144
v_mfma_f32_16x16x32_bf16 v[80:83], a[204:207], a[132:135], v[80:83]
ds_read_b64_tr_b16 a[212:213], v59 offset:12288
ds_read_b64_tr_b16 a[214:215], v59 offset:18432
v_mfma_f32_16x16x32_bf16 v[84:87], a[200:203], a[136:139], v[84:87]
buffer_load_dwordx4 v11, s[16:19], s42 offen offset:1024 lds
v_mfma_f32_16x16x32_bf16 v[84:87], a[204:207], a[140:143], v[84:87]
v_mfma_f32_16x16x32_bf16 v[88:91], a[200:203], a[144:147], v[88:91]
v_mfma_f32_16x16x32_bf16 v[88:91], a[204:207], a[148:151], v[88:91]
v_mfma_f32_16x16x32_bf16 v[92:95], a[200:203], a[152:155], v[92:95]
v_mfma_f32_16x16x32_bf16 v[92:95], a[204:207], a[156:159], v[92:95]
s_waitcnt lgkmcnt(2)
v_mfma_f32_16x16x32_bf16 v[96:99], a[208:211], a[128:131], v[96:99]
s_waitcnt lgkmcnt(0)
ds_read_b64_tr_b16 a[192:193], v59 offset:8
ds_read_b64_tr_b16 a[194:195], v59 offset:6152
v_mfma_f32_16x16x32_bf16 v[96:99], a[212:215], a[132:135], v[96:99]
ds_read_b64_tr_b16 a[196:197], v59 offset:12296
ds_read_b64_tr_b16 a[198:199], v59 offset:18440
v_mfma_f32_16x16x32_bf16 v[100:103], a[208:211], a[136:139], v[100:103]
buffer_load_dwordx4 v12, s[16:19], s42 offen offset:2048 lds
v_mfma_f32_16x16x32_bf16 v[100:103], a[212:215], a[140:143], v[100:103]
s_add_u32 s42, s42, 393216
v_mfma_f32_16x16x32_bf16 v[104:107], a[208:211], a[144:147], v[104:107]
v_mfma_f32_16x16x32_bf16 v[104:107], a[212:215], a[148:151], v[104:107]
v_mfma_f32_16x16x32_bf16 v[108:111], a[208:211], a[152:155], v[108:111]
v_mfma_f32_16x16x32_bf16 v[108:111], a[212:215], a[156:159], v[108:111]
s_waitcnt lgkmcnt(2)
v_mfma_f32_16x16x32_bf16 v[112:115], a[192:195], a[128:131], v[112:115]
s_waitcnt lgkmcnt(0)
ds_read_b64_tr_b16 a[200:201], v58 offset:128
ds_read_b64_tr_b16 a[202:203], v58 offset:6272
v_mfma_f32_16x16x32_bf16 v[112:115], a[196:199], a[132:135], v[112:115]
s_add_u32 m0, s39, 122880
ds_read_b64_tr_b16 a[204:205], v58 offset:12416
ds_read_b64_tr_b16 a[206:207], v58 offset:18560
v_mfma_f32_16x16x32_bf16 v[116:119], a[192:195], a[136:139], v[116:119]
buffer_load_dwordx4 v10, s[16:19], s42 offen offset:0 lds
v_mfma_f32_16x16x32_bf16 v[116:119], a[196:199], a[140:143], v[116:119]
v_mfma_f32_16x16x32_bf16 v[120:123], a[192:195], a[144:147], v[120:123]
v_mfma_f32_16x16x32_bf16 v[120:123], a[196:199], a[148:151], v[120:123]
v_mfma_f32_16x16x32_bf16 v[124:127], a[192:195], a[152:155], v[124:127]
v_mfma_f32_16x16x32_bf16 v[124:127], a[196:199], a[156:159], v[124:127]
s_waitcnt lgkmcnt(2)
v_mfma_f32_16x16x32_bf16 v[128:131], a[200:203], a[128:131], v[128:131]
s_waitcnt lgkmcnt(0)
ds_read_b64_tr_b16 a[208:209], v58 offset:136
ds_read_b64_tr_b16 a[210:211], v58 offset:6280
v_mfma_f32_16x16x32_bf16 v[128:131], a[204:207], a[132:135], v[128:131]
ds_read_b64_tr_b16 a[212:213], v58 offset:12424
ds_read_b64_tr_b16 a[214:215], v58 offset:18568
v_mfma_f32_16x16x32_bf16 v[132:135], a[200:203], a[136:139], v[132:135]
buffer_load_dwordx4 v11, s[16:19], s42 offen offset:1024 lds
v_mfma_f32_16x16x32_bf16 v[132:135], a[204:207], a[140:143], v[132:135]
v_mfma_f32_16x16x32_bf16 v[136:139], a[200:203], a[144:147], v[136:139]
v_mfma_f32_16x16x32_bf16 v[136:139], a[204:207], a[148:151], v[136:139]
v_mfma_f32_16x16x32_bf16 v[140:143], a[200:203], a[152:155], v[140:143]
v_mfma_f32_16x16x32_bf16 v[140:143], a[204:207], a[156:159], v[140:143]
s_waitcnt lgkmcnt(2)
v_mfma_f32_16x16x32_bf16 v[144:147], a[208:211], a[128:131], v[144:147]
s_waitcnt lgkmcnt(0)
ds_read_b64_tr_b16 a[192:193], v59 offset:128
ds_read_b64_tr_b16 a[194:195], v59 offset:6272
v_mfma_f32_16x16x32_bf16 v[144:147], a[212:215], a[132:135], v[144:147]
ds_read_b64_tr_b16 a[196:197], v59 offset:12416
ds_read_b64_tr_b16 a[198:199], v59 offset:18560
v_mfma_f32_16x16x32_bf16 v[148:151], a[208:211], a[136:139], v[148:151]
buffer_load_dwordx4 v12, s[16:19], s42 offen offset:2048 lds
v_mfma_f32_16x16x32_bf16 v[148:151], a[212:215], a[140:143], v[148:151]
s_add_u32 s42, s42, 393216
v_mfma_f32_16x16x32_bf16 v[152:155], a[208:211], a[144:147], v[152:155]
v_mfma_f32_16x16x32_bf16 v[152:155], a[212:215], a[148:151], v[152:155]
v_mfma_f32_16x16x32_bf16 v[156:159], a[208:211], a[152:155], v[156:159]
v_mfma_f32_16x16x32_bf16 v[156:159], a[212:215], a[156:159], v[156:159]
s_waitcnt lgkmcnt(2)
v_mfma_f32_16x16x32_bf16 v[160:163], a[192:195], a[128:131], v[160:163]
s_waitcnt lgkmcnt(0)
ds_read_b64_tr_b16 a[200:201], v59 offset:136
ds_read_b64_tr_b16 a[202:203], v59 offset:6280
v_mfma_f32_16x16x32_bf16 v[160:163], a[196:199], a[132:135], v[160:163]
s_add_u32 m0, s39, 135168
ds_read_b64_tr_b16 a[204:205], v59 offset:12424
ds_read_b64_tr_b16 a[206:207], v59 offset:18568
v_mfma_f32_16x16x32_bf16 v[164:167], a[192:195], a[136:139], v[164:167]
buffer_load_dwordx4 v13, s[20:23], s43 offen offset:0 lds
v_mfma_f32_16x16x32_bf16 v[164:167], a[196:199], a[140:143], v[164:167]
v_mfma_f32_16x16x32_bf16 v[168:171], a[192:195], a[144:147], v[168:171]
v_mfma_f32_16x16x32_bf16 v[168:171], a[196:199], a[148:151], v[168:171]
v_mfma_f32_16x16x32_bf16 v[172:175], a[192:195], a[152:155], v[172:175]
v_mfma_f32_16x16x32_bf16 v[172:175], a[196:199], a[156:159], v[172:175]
s_waitcnt lgkmcnt(2)
v_mfma_f32_16x16x32_bf16 v[176:179], a[200:203], a[128:131], v[176:179]
s_waitcnt lgkmcnt(0)
ds_read_b64_tr_b16 a[208:209], v58 offset:256
ds_read_b64_tr_b16 a[210:211], v58 offset:6400
v_mfma_f32_16x16x32_bf16 v[176:179], a[204:207], a[132:135], v[176:179]
ds_read_b64_tr_b16 a[212:213], v58 offset:12544
ds_read_b64_tr_b16 a[214:215], v58 offset:18688
v_mfma_f32_16x16x32_bf16 v[180:183], a[200:203], a[136:139], v[180:183]
buffer_load_dwordx4 v14, s[20:23], s43 offen offset:1024 lds
v_mfma_f32_16x16x32_bf16 v[180:183], a[204:207], a[140:143], v[180:183]
v_mfma_f32_16x16x32_bf16 v[184:187], a[200:203], a[144:147], v[184:187]
v_mfma_f32_16x16x32_bf16 v[184:187], a[204:207], a[148:151], v[184:187]
v_mfma_f32_16x16x32_bf16 v[188:191], a[200:203], a[152:155], v[188:191]
v_mfma_f32_16x16x32_bf16 v[188:191], a[204:207], a[156:159], v[188:191]
s_waitcnt lgkmcnt(2)
v_mfma_f32_16x16x32_bf16 v[192:195], a[208:211], a[128:131], v[192:195]
s_waitcnt lgkmcnt(0)
ds_read_b64_tr_b16 a[192:193], v58 offset:264
ds_read_b64_tr_b16 a[194:195], v58 offset:6408
v_mfma_f32_16x16x32_bf16 v[192:195], a[212:215], a[132:135], v[192:195]
ds_read_b64_tr_b16 a[196:197], v58 offset:12552
ds_read_b64_tr_b16 a[198:199], v58 offset:18696
v_mfma_f32_16x16x32_bf16 v[196:199], a[208:211], a[136:139], v[196:199]
buffer_load_dwordx4 v15, s[20:23], s43 offen offset:2048 lds
v_mfma_f32_16x16x32_bf16 v[196:199], a[212:215], a[140:143], v[196:199]
s_add_u32 s43, s43, 196608
v_mfma_f32_16x16x32_bf16 v[200:203], a[208:211], a[144:147], v[200:203]
v_mfma_f32_16x16x32_bf16 v[200:203], a[212:215], a[148:151], v[200:203]
v_mfma_f32_16x16x32_bf16 v[204:207], a[208:211], a[152:155], v[204:207]
v_mfma_f32_16x16x32_bf16 v[204:207], a[212:215], a[156:159], v[204:207]
s_waitcnt lgkmcnt(2)
v_mfma_f32_16x16x32_bf16 v[208:211], a[192:195], a[128:131], v[208:211]
s_waitcnt lgkmcnt(0)
ds_read_b64_tr_b16 a[200:201], v59 offset:256
ds_read_b64_tr_b16 a[202:203], v59 offset:6400
v_mfma_f32_16x16x32_bf16 v[208:211], a[196:199], a[132:135], v[208:211]
ds_read_b64_tr_b16 a[204:205], v59 offset:12544
ds_read_b64_tr_b16 a[206:207], v59 offset:18688
v_mfma_f32_16x16x32_bf16 v[212:215], a[192:195], a[136:139], v[212:215]
buffer_load_dwordx4 a[96:99], v53, s[24:27], s44 offen offset:0 sc1
v_mfma_f32_16x16x32_bf16 v[212:215], a[196:199], a[140:143], v[212:215]
v_mfma_f32_16x16x32_bf16 v[216:219], a[192:195], a[144:147], v[216:219]
v_mfma_f32_16x16x32_bf16 v[216:219], a[196:199], a[148:151], v[216:219]
v_mfma_f32_16x16x32_bf16 v[220:223], a[192:195], a[152:155], v[220:223]
v_mfma_f32_16x16x32_bf16 v[220:223], a[196:199], a[156:159], v[220:223]
s_waitcnt lgkmcnt(2)
v_mfma_f32_16x16x32_bf16 v[224:227], a[200:203], a[128:131], v[224:227]
s_waitcnt lgkmcnt(0)
ds_read_b64_tr_b16 a[208:209], v59 offset:264
ds_read_b64_tr_b16 a[210:211], v59 offset:6408
v_mfma_f32_16x16x32_bf16 v[224:227], a[204:207], a[132:135], v[224:227]
ds_read_b64_tr_b16 a[212:213], v59 offset:12552
ds_read_b64_tr_b16 a[214:215], v59 offset:18696
v_mfma_f32_16x16x32_bf16 v[228:231], a[200:203], a[136:139], v[228:231]
buffer_load_dwordx4 a[100:103], v53, s[24:27], s44 offen offset:1024 sc1
v_mfma_f32_16x16x32_bf16 v[228:231], a[204:207], a[140:143], v[228:231]
v_mfma_f32_16x16x32_bf16 v[232:235], a[200:203], a[144:147], v[232:235]
v_mfma_f32_16x16x32_bf16 v[232:235], a[204:207], a[148:151], v[232:235]
v_mfma_f32_16x16x32_bf16 v[236:239], a[200:203], a[152:155], v[236:239]
v_mfma_f32_16x16x32_bf16 v[236:239], a[204:207], a[156:159], v[236:239]
s_waitcnt lgkmcnt(2)
v_mfma_f32_16x16x32_bf16 v[240:243], a[208:211], a[128:131], v[240:243]
s_waitcnt lgkmcnt(0)
ds_read_b64_tr_b16 a[192:193], v28 offset:0
ds_read_b64_tr_b16 a[194:195], v28 offset:1536
v_mfma_f32_16x16x32_bf16 v[240:243], a[212:215], a[132:135], v[240:243]
ds_read_b64_tr_b16 a[196:197], v28 offset:3072
ds_read_b64_tr_b16 a[198:199], v28 offset:4608
v_mfma_f32_16x16x32_bf16 v[244:247], a[208:211], a[136:139], v[244:247]
buffer_load_dwordx4 a[104:107], v54, s[24:27], s44 offen offset:0 sc1
v_mfma_f32_16x16x32_bf16 v[244:247], a[212:215], a[140:143], v[244:247]
v_mfma_f32_16x16x32_bf16 v[248:251], a[208:211], a[144:147], v[248:251]
v_mfma_f32_16x16x32_bf16 v[248:251], a[212:215], a[148:151], v[248:251]
v_mfma_f32_16x16x32_bf16 v[252:255], a[208:211], a[152:155], v[252:255]
v_mfma_f32_16x16x32_bf16 v[252:255], a[212:215], a[156:159], v[252:255]
s_waitcnt lgkmcnt(2)
v_mfma_f32_16x16x32_bf16 a[0:3], a[192:195], a[128:131], a[0:3]
s_waitcnt lgkmcnt(0)
ds_read_b64_tr_b16 a[200:201], v28 offset:32
ds_read_b64_tr_b16 a[202:203], v28 offset:1568
v_mfma_f32_16x16x32_bf16 a[0:3], a[196:199], a[132:135], a[0:3]
ds_read_b64_tr_b16 a[204:205], v28 offset:3104
ds_read_b64_tr_b16 a[206:207], v28 offset:4640
v_mfma_f32_16x16x32_bf16 a[4:7], a[192:195], a[136:139], a[4:7]
buffer_load_dwordx4 a[108:111], v54, s[24:27], s44 offen offset:1024 sc1
v_mfma_f32_16x16x32_bf16 a[4:7], a[196:199], a[140:143], a[4:7]
v_mfma_f32_16x16x32_bf16 a[8:11], a[192:195], a[144:147], a[8:11]
v_mfma_f32_16x16x32_bf16 a[8:11], a[196:199], a[148:151], a[8:11]
v_mfma_f32_16x16x32_bf16 a[12:15], a[192:195], a[152:155], a[12:15]
v_mfma_f32_16x16x32_bf16 a[12:15], a[196:199], a[156:159], a[12:15]
s_waitcnt lgkmcnt(2)
v_mfma_f32_16x16x32_bf16 a[16:19], a[200:203], a[128:131], a[16:19]
s_waitcnt lgkmcnt(0)
ds_read_b64_tr_b16 a[208:209], v28 offset:64
ds_read_b64_tr_b16 a[210:211], v28 offset:1600
v_mfma_f32_16x16x32_bf16 a[16:19], a[204:207], a[132:135], a[16:19]
ds_read_b64_tr_b16 a[212:213], v28 offset:3136
ds_read_b64_tr_b16 a[214:215], v28 offset:4672
v_mfma_f32_16x16x32_bf16 a[20:23], a[200:203], a[136:139], a[20:23]
buffer_load_dwordx4 a[112:115], v55, s[24:27], s44 offen offset:0 sc1
v_mfma_f32_16x16x32_bf16 a[20:23], a[204:207], a[140:143], a[20:23]
v_mfma_f32_16x16x32_bf16 a[24:27], a[200:203], a[144:147], a[24:27]
v_mfma_f32_16x16x32_bf16 a[24:27], a[204:207], a[148:151], a[24:27]
v_mfma_f32_16x16x32_bf16 a[28:31], a[200:203], a[152:155], a[28:31]
v_mfma_f32_16x16x32_bf16 a[28:31], a[204:207], a[156:159], a[28:31]
s_waitcnt lgkmcnt(2)
v_mfma_f32_16x16x32_bf16 a[32:35], a[208:211], a[128:131], a[32:35]
s_waitcnt lgkmcnt(0)
ds_read_b64_tr_b16 a[192:193], v28 offset:6144
ds_read_b64_tr_b16 a[194:195], v28 offset:7680
v_mfma_f32_16x16x32_bf16 a[32:35], a[212:215], a[132:135], a[32:35]
ds_read_b64_tr_b16 a[196:197], v28 offset:9216
ds_read_b64_tr_b16 a[198:199], v28 offset:10752
v_mfma_f32_16x16x32_bf16 a[36:39], a[208:211], a[136:139], a[36:39]
buffer_load_dwordx4 a[116:119], v55, s[24:27], s44 offen offset:1024 sc1
v_mfma_f32_16x16x32_bf16 a[36:39], a[212:215], a[140:143], a[36:39]
v_mfma_f32_16x16x32_bf16 a[40:43], a[208:211], a[144:147], a[40:43]
v_mfma_f32_16x16x32_bf16 a[40:43], a[212:215], a[148:151], a[40:43]
v_mfma_f32_16x16x32_bf16 a[44:47], a[208:211], a[152:155], a[44:47]
v_mfma_f32_16x16x32_bf16 a[44:47], a[212:215], a[156:159], a[44:47]
s_waitcnt lgkmcnt(2)
v_mfma_f32_16x16x32_bf16 a[48:51], a[192:195], a[128:131], a[48:51]
s_waitcnt lgkmcnt(0)
ds_read_b64_tr_b16 a[200:201], v28 offset:6176
ds_read_b64_tr_b16 a[202:203], v28 offset:7712
v_mfma_f32_16x16x32_bf16 a[48:51], a[196:199], a[132:135], a[48:51]
ds_read_b64_tr_b16 a[204:205], v28 offset:9248
ds_read_b64_tr_b16 a[206:207], v28 offset:10784
v_mfma_f32_16x16x32_bf16 a[52:55], a[192:195], a[136:139], a[52:55]
buffer_load_dwordx4 a[120:123], v56, s[24:27], s44 offen offset:0 sc1
v_mfma_f32_16x16x32_bf16 a[52:55], a[196:199], a[140:143], a[52:55]
v_mfma_f32_16x16x32_bf16 a[56:59], a[192:195], a[144:147], a[56:59]
v_mfma_f32_16x16x32_bf16 a[56:59], a[196:199], a[148:151], a[56:59]
v_mfma_f32_16x16x32_bf16 a[60:63], a[192:195], a[152:155], a[60:63]
ds_read_b64_tr_b16 a[208:209], v28 offset:6208
ds_read_b64_tr_b16 a[210:211], v28 offset:7744
v_mfma_f32_16x16x32_bf16 a[60:63], a[196:199], a[156:159], a[60:63]
s_waitcnt lgkmcnt(4)
ds_read_b64_tr_b16 a[212:213], v28 offset:9280
ds_read_b64_tr_b16 a[214:215], v28 offset:10816
v_mfma_f32_16x16x32_bf16 a[64:67], a[200:203], a[128:131], a[64:67]
s_waitcnt lgkmcnt(4)
buffer_load_dwordx4 a[124:127], v56, s[24:27], s44 offen offset:1024 sc1
v_mfma_f32_16x16x32_bf16 a[64:67], a[204:207], a[132:135], a[64:67]
v_mfma_f32_16x16x32_bf16 a[68:71], a[200:203], a[136:139], a[68:71]
v_mfma_f32_16x16x32_bf16 a[68:71], a[204:207], a[140:143], a[68:71]
v_mfma_f32_16x16x32_bf16 a[72:75], a[200:203], a[144:147], a[72:75]
v_mfma_f32_16x16x32_bf16 a[72:75], a[204:207], a[148:151], a[72:75]
v_mfma_f32_16x16x32_bf16 a[76:79], a[200:203], a[152:155], a[76:79]
s_add_u32 s44, s44, 2048
v_mfma_f32_16x16x32_bf16 a[76:79], a[204:207], a[156:159], a[76:79]
s_waitcnt vmcnt(42)
s_waitcnt lgkmcnt(0)
s_barrier
v_mfma_f32_16x16x32_bf16 a[80:83], a[208:211], a[128:131], a[80:83]
ds_read_b64_tr_b16 a[192:193], v58 offset:36864
ds_read_b64_tr_b16 a[194:195], v58 offset:43008
v_mfma_f32_16x16x32_bf16 a[80:83], a[212:215], a[132:135], a[80:83]
ds_read_b64_tr_b16 a[196:197], v58 offset:49152
ds_read_b64_tr_b16 a[198:199], v58 offset:55296
v_mfma_f32_16x16x32_bf16 a[84:87], a[208:211], a[136:139], a[84:87]
v_mfma_f32_16x16x32_bf16 a[84:87], a[212:215], a[140:143], a[84:87]
v_mfma_f32_16x16x32_bf16 a[88:91], a[208:211], a[144:147], a[88:91]
v_mfma_f32_16x16x32_bf16 a[88:91], a[212:215], a[148:151], a[88:91]
v_mfma_f32_16x16x32_bf16 a[92:95], a[208:211], a[152:155], a[92:95]
v_mfma_f32_16x16x32_bf16 a[92:95], a[212:215], a[156:159], a[92:95]
s_waitcnt lgkmcnt(2) vmcnt(24)
v_mfma_f32_16x16x32_bf16 v[64:67], a[192:195], a[160:163], v[64:67]
s_waitcnt lgkmcnt(0) vmcnt(23)
ds_read_b64_tr_b16 a[200:201], v58 offset:36872
ds_read_b64_tr_b16 a[202:203], v58 offset:43016
v_mfma_f32_16x16x32_bf16 v[64:67], a[196:199], a[164:167], v[64:67]
s_waitcnt vmcnt(22)
ds_read_b64_tr_b16 a[204:205], v58 offset:49160
ds_read_b64_tr_b16 a[206:207], v58 offset:55304
v_mfma_f32_16x16x32_bf16 v[68:71], a[192:195], a[168:171], v[68:71]
s_waitcnt vmcnt(21)
s_add_u32 m0, s39, 0
v_mfma_f32_16x16x32_bf16 v[68:71], a[196:199], a[172:175], v[68:71]
s_waitcnt vmcnt(20)
buffer_load_dwordx4 v10, s[16:19], s42 offen offset:0 lds
v_mfma_f32_16x16x32_bf16 v[72:75], a[192:195], a[176:179], v[72:75]
s_waitcnt vmcnt(20)
v_mfma_f32_16x16x32_bf16 v[72:75], a[196:199], a[180:183], v[72:75]
s_waitcnt vmcnt(19)
v_mfma_f32_16x16x32_bf16 v[76:79], a[192:195], a[184:187], v[76:79]
s_waitcnt vmcnt(18)
v_mfma_f32_16x16x32_bf16 v[76:79], a[196:199], a[188:191], v[76:79]
s_waitcnt lgkmcnt(2)
v_mfma_f32_16x16x32_bf16 v[80:83], a[200:203], a[160:163], v[80:83]
s_waitcnt lgkmcnt(0)
ds_read_b64_tr_b16 a[208:209], v59 offset:36864
ds_read_b64_tr_b16 a[210:211], v59 offset:43008
v_mfma_f32_16x16x32_bf16 v[80:83], a[204:207], a[164:167], v[80:83]
ds_read_b64_tr_b16 a[212:213], v59 offset:49152
ds_read_b64_tr_b16 a[214:215], v59 offset:55296
v_mfma_f32_16x16x32_bf16 v[84:87], a[200:203], a[168:171], v[84:87]
buffer_load_dwordx4 v11, s[16:19], s42 offen offset:1024 lds
v_mfma_f32_16x16x32_bf16 v[84:87], a[204:207], a[172:175], v[84:87]
v_mfma_f32_16x16x32_bf16 v[88:91], a[200:203], a[176:179], v[88:91]
v_mfma_f32_16x16x32_bf16 v[88:91], a[204:207], a[180:183], v[88:91]
v_mfma_f32_16x16x32_bf16 v[92:95], a[200:203], a[184:187], v[92:95]
v_mfma_f32_16x16x32_bf16 v[92:95], a[204:207], a[188:191], v[92:95]
s_waitcnt lgkmcnt(2)
v_mfma_f32_16x16x32_bf16 v[96:99], a[208:211], a[160:163], v[96:99]
s_waitcnt lgkmcnt(0)
ds_read_b64_tr_b16 a[192:193], v59 offset:36872
ds_read_b64_tr_b16 a[194:195], v59 offset:43016
v_mfma_f32_16x16x32_bf16 v[96:99], a[212:215], a[164:167], v[96:99]
ds_read_b64_tr_b16 a[196:197], v59 offset:49160
ds_read_b64_tr_b16 a[198:199], v59 offset:55304
v_mfma_f32_16x16x32_bf16 v[100:103], a[208:211], a[168:171], v[100:103]
buffer_load_dwordx4 v12, s[16:19], s42 offen offset:2048 lds
v_mfma_f32_16x16x32_bf16 v[100:103], a[212:215], a[172:175], v[100:103]
s_add_u32 s42, s42, 393216
v_mfma_f32_16x16x32_bf16 v[104:107], a[208:211], a[176:179], v[104:107]
v_mfma_f32_16x16x32_bf16 v[104:107], a[212:215], a[180:183], v[104:107]
v_mfma_f32_16x16x32_bf16 v[108:111], a[208:211], a[184:187], v[108:111]
v_mfma_f32_16x16x32_bf16 v[108:111], a[212:215], a[188:191], v[108:111]
s_waitcnt lgkmcnt(2)
v_mfma_f32_16x16x32_bf16 v[112:115], a[192:195], a[160:163], v[112:115]
s_waitcnt lgkmcnt(0)
ds_read_b64_tr_b16 a[200:201], v58 offset:36992
ds_read_b64_tr_b16 a[202:203], v58 offset:43136
v_mfma_f32_16x16x32_bf16 v[112:115], a[196:199], a[164:167], v[112:115]
s_add_u32 m0, s39, 12288
ds_read_b64_tr_b16 a[204:205], v58 offset:49280
ds_read_b64_tr_b16 a[206:207], v58 offset:55424
v_mfma_f32_16x16x32_bf16 v[116:119], a[192:195], a[168:171], v[116:119]
buffer_load_dwordx4 v10, s[16:19], s42 offen offset:0 lds
v_mfma_f32_16x16x32_bf16 v[116:119], a[196:199], a[172:175], v[116:119]
v_mfma_f32_16x16x32_bf16 v[120:123], a[192:195], a[176:179], v[120:123]
v_mfma_f32_16x16x32_bf16 v[120:123], a[196:199], a[180:183], v[120:123]
v_mfma_f32_16x16x32_bf16 v[124:127], a[192:195], a[184:187], v[124:127]
v_mfma_f32_16x16x32_bf16 v[124:127], a[196:199], a[188:191], v[124:127]
s_waitcnt lgkmcnt(2)
v_mfma_f32_16x16x32_bf16 v[128:131], a[200:203], a[160:163], v[128:131]
s_waitcnt lgkmcnt(0)
ds_read_b64_tr_b16 a[208:209], v58 offset:37000
ds_read_b64_tr_b16 a[210:211], v58 offset:43144
v_mfma_f32_16x16x32_bf16 v[128:131], a[204:207], a[164:167], v[128:131]
ds_read_b64_tr_b16 a[212:213], v58 offset:49288
ds_read_b64_tr_b16 a[214:215], v58 offset:55432
v_mfma_f32_16x16x32_bf16 v[132:135], a[200:203], a[168:171], v[132:135]
buffer_load_dwordx4 v11, s[16:19], s42 offen offset:1024 lds
v_mfma_f32_16x16x32_bf16 v[132:135], a[204:207], a[172:175], v[132:135]
v_mfma_f32_16x16x32_bf16 v[136:139], a[200:203], a[176:179], v[136:139]
v_mfma_f32_16x16x32_bf16 v[136:139], a[204:207], a[180:183], v[136:139]
v_mfma_f32_16x16x32_bf16 v[140:143], a[200:203], a[184:187], v[140:143]
v_mfma_f32_16x16x32_bf16 v[140:143], a[204:207], a[188:191], v[140:143]
s_waitcnt lgkmcnt(2)
v_mfma_f32_16x16x32_bf16 v[144:147], a[208:211], a[160:163], v[144:147]
s_waitcnt lgkmcnt(0)
ds_read_b64_tr_b16 a[192:193], v59 offset:36992
ds_read_b64_tr_b16 a[194:195], v59 offset:43136
v_mfma_f32_16x16x32_bf16 v[144:147], a[212:215], a[164:167], v[144:147]
ds_read_b64_tr_b16 a[196:197], v59 offset:49280
ds_read_b64_tr_b16 a[198:199], v59 offset:55424
v_mfma_f32_16x16x32_bf16 v[148:151], a[208:211], a[168:171], v[148:151]
buffer_load_dwordx4 v12, s[16:19], s42 offen offset:2048 lds
v_mfma_f32_16x16x32_bf16 v[148:151], a[212:215], a[172:175], v[148:151]
s_add_u32 s42, s42, 393216
v_mfma_f32_16x16x32_bf16 v[152:155], a[208:211], a[176:179], v[152:155]
v_mfma_f32_16x16x32_bf16 v[152:155], a[212:215], a[180:183], v[152:155]
v_mfma_f32_16x16x32_bf16 v[156:159], a[208:211], a[184:187], v[156:159]
v_mfma_f32_16x16x32_bf16 v[156:159], a[212:215], a[188:191], v[156:159]
s_waitcnt lgkmcnt(2)
v_mfma_f32_16x16x32_bf16 v[160:163], a[192:195], a[160:163], v[160:163]
s_waitcnt lgkmcnt(0)
ds_read_b64_tr_b16 a[200:201], v59 offset:37000
ds_read_b64_tr_b16 a[202:203], v59 offset:43144
v_mfma_f32_16x16x32_bf16 v[160:163], a[196:199], a[164:167], v[160:163]
s_add_u32 m0, s39, 24576
ds_read_b64_tr_b16 a[204:205], v59 offset:49288
ds_read_b64_tr_b16 a[206:207], v59 offset:55432
v_mfma_f32_16x16x32_bf16 v[164:167], a[192:195], a[168:171], v[164:167]
buffer_load_dwordx4 v13, s[20:23], s43 offen offset:0 lds
v_mfma_f32_16x16x32_bf16 v[164:167], a[196:199], a[172:175], v[164:167]
v_mfma_f32_16x16x32_bf16 v[168:171], a[192:195], a[176:179], v[168:171]
v_mfma_f32_16x16x32_bf16 v[168:171], a[196:199], a[180:183], v[168:171]
v_mfma_f32_16x16x32_bf16 v[172:175], a[192:195], a[184:187], v[172:175]
v_mfma_f32_16x16x32_bf16 v[172:175], a[196:199], a[188:191], v[172:175]
s_waitcnt lgkmcnt(2)
v_mfma_f32_16x16x32_bf16 v[176:179], a[200:203], a[160:163], v[176:179]
s_waitcnt lgkmcnt(0)
ds_read_b64_tr_b16 a[208:209], v58 offset:37120
ds_read_b64_tr_b16 a[210:211], v58 offset:43264
v_mfma_f32_16x16x32_bf16 v[176:179], a[204:207], a[164:167], v[176:179]
ds_read_b64_tr_b16 a[212:213], v58 offset:49408
ds_read_b64_tr_b16 a[214:215], v58 offset:55552
v_mfma_f32_16x16x32_bf16 v[180:183], a[200:203], a[168:171], v[180:183]
buffer_load_dwordx4 v14, s[20:23], s43 offen offset:1024 lds
v_mfma_f32_16x16x32_bf16 v[180:183], a[204:207], a[172:175], v[180:183]
v_mfma_f32_16x16x32_bf16 v[184:187], a[200:203], a[176:179], v[184:187]
v_mfma_f32_16x16x32_bf16 v[184:187], a[204:207], a[180:183], v[184:187]
v_mfma_f32_16x16x32_bf16 v[188:191], a[200:203], a[184:187], v[188:191]
v_mfma_f32_16x16x32_bf16 v[188:191], a[204:207], a[188:191], v[188:191]
s_waitcnt lgkmcnt(2)
v_mfma_f32_16x16x32_bf16 v[192:195], a[208:211], a[160:163], v[192:195]
s_waitcnt lgkmcnt(0)
ds_read_b64_tr_b16 a[192:193], v58 offset:37128
ds_read_b64_tr_b16 a[194:195], v58 offset:43272
v_mfma_f32_16x16x32_bf16 v[192:195], a[212:215], a[164:167], v[192:195]
ds_read_b64_tr_b16 a[196:197], v58 offset:49416
ds_read_b64_tr_b16 a[198:199], v58 offset:55560
v_mfma_f32_16x16x32_bf16 v[196:199], a[208:211], a[168:171], v[196:199]
buffer_load_dwordx4 v15, s[20:23], s43 offen offset:2048 lds
v_mfma_f32_16x16x32_bf16 v[196:199], a[212:215], a[172:175], v[196:199]
s_add_u32 s43, s43, 196608
v_mfma_f32_16x16x32_bf16 v[200:203], a[208:211], a[176:179], v[200:203]
v_mfma_f32_16x16x32_bf16 v[200:203], a[212:215], a[180:183], v[200:203]
v_mfma_f32_16x16x32_bf16 v[204:207], a[208:211], a[184:187], v[204:207]
v_mfma_f32_16x16x32_bf16 v[204:207], a[212:215], a[188:191], v[204:207]
s_waitcnt lgkmcnt(2)
v_mfma_f32_16x16x32_bf16 v[208:211], a[192:195], a[160:163], v[208:211]
s_waitcnt lgkmcnt(0)
ds_read_b64_tr_b16 a[200:201], v59 offset:37120
ds_read_b64_tr_b16 a[202:203], v59 offset:43264
v_mfma_f32_16x16x32_bf16 v[208:211], a[196:199], a[164:167], v[208:211]
ds_read_b64_tr_b16 a[204:205], v59 offset:49408
ds_read_b64_tr_b16 a[206:207], v59 offset:55552
v_mfma_f32_16x16x32_bf16 v[212:215], a[192:195], a[168:171], v[212:215]
buffer_load_dwordx4 a[128:131], v53, s[24:27], s44 offen offset:0 sc1
v_mfma_f32_16x16x32_bf16 v[212:215], a[196:199], a[172:175], v[212:215]
v_mfma_f32_16x16x32_bf16 v[216:219], a[192:195], a[176:179], v[216:219]
v_mfma_f32_16x16x32_bf16 v[216:219], a[196:199], a[180:183], v[216:219]
v_mfma_f32_16x16x32_bf16 v[220:223], a[192:195], a[184:187], v[220:223]
v_mfma_f32_16x16x32_bf16 v[220:223], a[196:199], a[188:191], v[220:223]
s_waitcnt lgkmcnt(2)
v_mfma_f32_16x16x32_bf16 v[224:227], a[200:203], a[160:163], v[224:227]
s_waitcnt lgkmcnt(0)
ds_read_b64_tr_b16 a[208:209], v59 offset:37128
ds_read_b64_tr_b16 a[210:211], v59 offset:43272
v_mfma_f32_16x16x32_bf16 v[224:227], a[204:207], a[164:167], v[224:227]
ds_read_b64_tr_b16 a[212:213], v59 offset:49416
ds_read_b64_tr_b16 a[214:215], v59 offset:55560
v_mfma_f32_16x16x32_bf16 v[228:231], a[200:203], a[168:171], v[228:231]
buffer_load_dwordx4 a[132:135], v53, s[24:27], s44 offen offset:1024 sc1
v_mfma_f32_16x16x32_bf16 v[228:231], a[204:207], a[172:175], v[228:231]
v_mfma_f32_16x16x32_bf16 v[232:235], a[200:203], a[176:179], v[232:235]
v_mfma_f32_16x16x32_bf16 v[232:235], a[204:207], a[180:183], v[232:235]
v_mfma_f32_16x16x32_bf16 v[236:239], a[200:203], a[184:187], v[236:239]
v_mfma_f32_16x16x32_bf16 v[236:239], a[204:207], a[188:191], v[236:239]
s_waitcnt lgkmcnt(2)
v_mfma_f32_16x16x32_bf16 v[240:243], a[208:211], a[160:163], v[240:243]
s_waitcnt lgkmcnt(0)
ds_read_b64_tr_b16 a[192:193], v28 offset:36864
ds_read_b64_tr_b16 a[194:195], v28 offset:38400
v_mfma_f32_16x16x32_bf16 v[240:243], a[212:215], a[164:167], v[240:243]
ds_read_b64_tr_b16 a[196:197], v28 offset:39936
ds_read_b64_tr_b16 a[198:199], v28 offset:41472
v_mfma_f32_16x16x32_bf16 v[244:247], a[208:211], a[168:171], v[244:247]
buffer_load_dwordx4 a[136:139], v54, s[24:27], s44 offen offset:0 sc1
v_mfma_f32_16x16x32_bf16 v[244:247], a[212:215], a[172:175], v[244:247]
v_mfma_f32_16x16x32_bf16 v[248:251], a[208:211], a[176:179], v[248:251]
v_mfma_f32_16x16x32_bf16 v[248:251], a[212:215], a[180:183], v[248:251]
v_mfma_f32_16x16x32_bf16 v[252:255], a[208:211], a[184:187], v[252:255]
v_mfma_f32_16x16x32_bf16 v[252:255], a[212:215], a[188:191], v[252:255]
s_waitcnt lgkmcnt(2)
v_mfma_f32_16x16x32_bf16 a[0:3], a[192:195], a[160:163], a[0:3]
s_waitcnt lgkmcnt(0)
ds_read_b64_tr_b16 a[200:201], v28 offset:36896
ds_read_b64_tr_b16 a[202:203], v28 offset:38432
v_mfma_f32_16x16x32_bf16 a[0:3], a[196:199], a[164:167], a[0:3]
ds_read_b64_tr_b16 a[204:205], v28 offset:39968
ds_read_b64_tr_b16 a[206:207], v28 offset:41504
v_mfma_f32_16x16x32_bf16 a[4:7], a[192:195], a[168:171], a[4:7]
buffer_load_dwordx4 a[140:143], v54, s[24:27], s44 offen offset:1024 sc1
v_mfma_f32_16x16x32_bf16 a[4:7], a[196:199], a[172:175], a[4:7]
v_mfma_f32_16x16x32_bf16 a[8:11], a[192:195], a[176:179], a[8:11]
v_mfma_f32_16x16x32_bf16 a[8:11], a[196:199], a[180:183], a[8:11]
v_mfma_f32_16x16x32_bf16 a[12:15], a[192:195], a[184:187], a[12:15]
v_mfma_f32_16x16x32_bf16 a[12:15], a[196:199], a[188:191], a[12:15]
s_waitcnt lgkmcnt(2)
v_mfma_f32_16x16x32_bf16 a[16:19], a[200:203], a[160:163], a[16:19]
s_waitcnt lgkmcnt(0)
ds_read_b64_tr_b16 a[208:209], v28 offset:36928
ds_read_b64_tr_b16 a[210:211], v28 offset:38464
v_mfma_f32_16x16x32_bf16 a[16:19], a[204:207], a[164:167], a[16:19]
ds_read_b64_tr_b16 a[212:213], v28 offset:40000
ds_read_b64_tr_b16 a[214:215], v28 offset:41536
v_mfma_f32_16x16x32_bf16 a[20:23], a[200:203], a[168:171], a[20:23]
buffer_load_dwordx4 a[144:147], v55, s[24:27], s44 offen offset:0 sc1
v_mfma_f32_16x16x32_bf16 a[20:23], a[204:207], a[172:175], a[20:23]
v_mfma_f32_16x16x32_bf16 a[24:27], a[200:203], a[176:179], a[24:27]
v_mfma_f32_16x16x32_bf16 a[24:27], a[204:207], a[180:183], a[24:27]
v_mfma_f32_16x16x32_bf16 a[28:31], a[200:203], a[184:187], a[28:31]
v_mfma_f32_16x16x32_bf16 a[28:31], a[204:207], a[188:191], a[28:31]
s_waitcnt lgkmcnt(2)
v_mfma_f32_16x16x32_bf16 a[32:35], a[208:211], a[160:163], a[32:35]
s_waitcnt lgkmcnt(0)
ds_read_b64_tr_b16 a[192:193], v28 offset:43008
ds_read_b64_tr_b16 a[194:195], v28 offset:44544
v_mfma_f32_16x16x32_bf16 a[32:35], a[212:215], a[164:167], a[32:35]
ds_read_b64_tr_b16 a[196:197], v28 offset:46080
ds_read_b64_tr_b16 a[198:199], v28 offset:47616
v_mfma_f32_16x16x32_bf16 a[36:39], a[208:211], a[168:171], a[36:39]
buffer_load_dwordx4 a[148:151], v55, s[24:27], s44 offen offset:1024 sc1
v_mfma_f32_16x16x32_bf16 a[36:39], a[212:215], a[172:175], a[36:39]
v_mfma_f32_16x16x32_bf16 a[40:43], a[208:211], a[176:179], a[40:43]
v_mfma_f32_16x16x32_bf16 a[40:43], a[212:215], a[180:183], a[40:43]
v_mfma_f32_16x16x32_bf16 a[44:47], a[208:211], a[184:187], a[44:47]
v_mfma_f32_16x16x32_bf16 a[44:47], a[212:215], a[188:191], a[44:47]
s_waitcnt lgkmcnt(2)
v_mfma_f32_16x16x32_bf16 a[48:51], a[192:195], a[160:163], a[48:51]
s_waitcnt lgkmcnt(0)
ds_read_b64_tr_b16 a[200:201], v28 offset:43040
ds_read_b64_tr_b16 a[202:203], v28 offset:44576
v_mfma_f32_16x16x32_bf16 a[48:51], a[196:199], a[164:167], a[48:51]
ds_read_b64_tr_b16 a[204:205], v28 offset:46112
ds_read_b64_tr_b16 a[206:207], v28 offset:47648
v_mfma_f32_16x16x32_bf16 a[52:55], a[192:195], a[168:171], a[52:55]
buffer_load_dwordx4 a[152:155], v56, s[24:27], s44 offen offset:0 sc1
v_mfma_f32_16x16x32_bf16 a[52:55], a[196:199], a[172:175], a[52:55]
v_mfma_f32_16x16x32_bf16 a[56:59], a[192:195], a[176:179], a[56:59]
v_mfma_f32_16x16x32_bf16 a[56:59], a[196:199], a[180:183], a[56:59]
v_mfma_f32_16x16x32_bf16 a[60:63], a[192:195], a[184:187], a[60:63]
ds_read_b64_tr_b16 a[208:209], v28 offset:43072
ds_read_b64_tr_b16 a[210:211], v28 offset:44608
v_mfma_f32_16x16x32_bf16 a[60:63], a[196:199], a[188:191], a[60:63]
s_waitcnt lgkmcnt(4)
ds_read_b64_tr_b16 a[212:213], v28 offset:46144
ds_read_b64_tr_b16 a[214:215], v28 offset:47680
v_mfma_f32_16x16x32_bf16 a[64:67], a[200:203], a[160:163], a[64:67]
s_waitcnt lgkmcnt(4)
buffer_load_dwordx4 a[156:159], v56, s[24:27], s44 offen offset:1024 sc1
v_mfma_f32_16x16x32_bf16 a[64:67], a[204:207], a[164:167], a[64:67]
v_mfma_f32_16x16x32_bf16 a[68:71], a[200:203], a[168:171], a[68:71]
v_mfma_f32_16x16x32_bf16 a[68:71], a[204:207], a[172:175], a[68:71]
v_mfma_f32_16x16x32_bf16 a[72:75], a[200:203], a[176:179], a[72:75]
v_mfma_f32_16x16x32_bf16 a[72:75], a[204:207], a[180:183], a[72:75]
v_mfma_f32_16x16x32_bf16 a[76:79], a[200:203], a[184:187], a[76:79]
s_add_u32 s44, s44, 2048
v_mfma_f32_16x16x32_bf16 a[76:79], a[204:207], a[188:191], a[76:79]
s_waitcnt vmcnt(42)
s_waitcnt lgkmcnt(0)
s_barrier
v_mfma_f32_16x16x32_bf16 a[80:83], a[208:211], a[160:163], a[80:83]
ds_read_b64_tr_b16 a[192:193], v60 offset:0
ds_read_b64_tr_b16 a[194:195], v60 offset:6144
v_mfma_f32_16x16x32_bf16 a[80:83], a[212:215], a[164:167], a[80:83]
ds_read_b64_tr_b16 a[196:197], v60 offset:12288
ds_read_b64_tr_b16 a[198:199], v60 offset:18432
v_mfma_f32_16x16x32_bf16 a[84:87], a[208:211], a[168:171], a[84:87]
v_mfma_f32_16x16x32_bf16 a[84:87], a[212:215], a[172:175], a[84:87]
v_mfma_f32_16x16x32_bf16 a[88:91], a[208:211], a[176:179], a[88:91]
v_mfma_f32_16x16x32_bf16 a[88:91], a[212:215], a[180:183], a[88:91]
v_mfma_f32_16x16x32_bf16 a[92:95], a[208:211], a[184:187], a[92:95]
v_mfma_f32_16x16x32_bf16 a[92:95], a[212:215], a[188:191], a[92:95]
s_waitcnt lgkmcnt(2) vmcnt(24)
v_mfma_f32_16x16x32_bf16 v[64:67], a[192:195], a[96:99], v[64:67]
s_waitcnt lgkmcnt(0) vmcnt(23)
ds_read_b64_tr_b16 a[200:201], v60 offset:8
ds_read_b64_tr_b16 a[202:203], v60 offset:6152
v_mfma_f32_16x16x32_bf16 v[64:67], a[196:199], a[100:103], v[64:67]
s_waitcnt vmcnt(22)
ds_read_b64_tr_b16 a[204:205], v60 offset:12296
ds_read_b64_tr_b16 a[206:207], v60 offset:18440
v_mfma_f32_16x16x32_bf16 v[68:71], a[192:195], a[104:107], v[68:71]
s_waitcnt vmcnt(21)
s_add_u32 m0, s39, 36864
v_mfma_f32_16x16x32_bf16 v[68:71], a[196:199], a[108:111], v[68:71]
s_waitcnt vmcnt(20)
buffer_load_dwordx4 v10, s[16:19], s42 offen offset:0 lds
v_mfma_f32_16x16x32_bf16 v[72:75], a[192:195], a[112:115], v[72:75]
s_waitcnt vmcnt(20)
v_mfma_f32_16x16x32_bf16 v[72:75], a[196:199], a[116:119], v[72:75]
s_waitcnt vmcnt(19)
v_mfma_f32_16x16x32_bf16 v[76:79], a[192:195], a[120:123], v[76:79]
s_waitcnt vmcnt(18)
v_mfma_f32_16x16x32_bf16 v[76:79], a[196:199], a[124:127], v[76:79]
s_waitcnt lgkmcnt(2)
v_mfma_f32_16x16x32_bf16 v[80:83], a[200:203], a[96:99], v[80:83]
s_waitcnt lgkmcnt(0)
ds_read_b64_tr_b16 a[208:209], v61 offset:0
ds_read_b64_tr_b16 a[210:211], v61 offset:6144
v_mfma_f32_16x16x32_bf16 v[80:83], a[204:207], a[100:103], v[80:83]
ds_read_b64_tr_b16 a[212:213], v61 offset:12288
ds_read_b64_tr_b16 a[214:215], v61 offset:18432
v_mfma_f32_16x16x32_bf16 v[84:87], a[200:203], a[104:107], v[84:87]
buffer_load_dwordx4 v11, s[16:19], s42 offen offset:1024 lds
v_mfma_f32_16x16x32_bf16 v[84:87], a[204:207], a[108:111], v[84:87]
v_mfma_f32_16x16x32_bf16 v[88:91], a[200:203], a[112:115], v[88:91]
v_mfma_f32_16x16x32_bf16 v[88:91], a[204:207], a[116:119], v[88:91]
v_mfma_f32_16x16x32_bf16 v[92:95], a[200:203], a[120:123], v[92:95]
v_mfma_f32_16x16x32_bf16 v[92:95], a[204:207], a[124:127], v[92:95]
s_waitcnt lgkmcnt(2)
v_mfma_f32_16x16x32_bf16 v[96:99], a[208:211], a[96:99], v[96:99]
s_waitcnt lgkmcnt(0)
ds_read_b64_tr_b16 a[192:193], v61 offset:8
ds_read_b64_tr_b16 a[194:195], v61 offset:6152
v_mfma_f32_16x16x32_bf16 v[96:99], a[212:215], a[100:103], v[96:99]
ds_read_b64_tr_b16 a[196:197], v61 offset:12296
ds_read_b64_tr_b16 a[198:199], v61 offset:18440
v_mfma_f32_16x16x32_bf16 v[100:103], a[208:211], a[104:107], v[100:103]
buffer_load_dwordx4 v12, s[16:19], s42 offen offset:2048 lds
v_mfma_f32_16x16x32_bf16 v[100:103], a[212:215], a[108:111], v[100:103]
s_add_u32 s42, s42, 393216
v_mfma_f32_16x16x32_bf16 v[104:107], a[208:211], a[112:115], v[104:107]
v_mfma_f32_16x16x32_bf16 v[104:107], a[212:215], a[116:119], v[104:107]
v_mfma_f32_16x16x32_bf16 v[108:111], a[208:211], a[120:123], v[108:111]
v_mfma_f32_16x16x32_bf16 v[108:111], a[212:215], a[124:127], v[108:111]
s_waitcnt lgkmcnt(2)
v_mfma_f32_16x16x32_bf16 v[112:115], a[192:195], a[96:99], v[112:115]
s_waitcnt lgkmcnt(0)
ds_read_b64_tr_b16 a[200:201], v60 offset:128
ds_read_b64_tr_b16 a[202:203], v60 offset:6272
v_mfma_f32_16x16x32_bf16 v[112:115], a[196:199], a[100:103], v[112:115]
s_add_u32 m0, s39, 49152
ds_read_b64_tr_b16 a[204:205], v60 offset:12416
ds_read_b64_tr_b16 a[206:207], v60 offset:18560
v_mfma_f32_16x16x32_bf16 v[116:119], a[192:195], a[104:107], v[116:119]
buffer_load_dwordx4 v10, s[16:19], s42 offen offset:0 lds
v_mfma_f32_16x16x32_bf16 v[116:119], a[196:199], a[108:111], v[116:119]
v_mfma_f32_16x16x32_bf16 v[120:123], a[192:195], a[112:115], v[120:123]
v_mfma_f32_16x16x32_bf16 v[120:123], a[196:199], a[116:119], v[120:123]
v_mfma_f32_16x16x32_bf16 v[124:127], a[192:195], a[120:123], v[124:127]
v_mfma_f32_16x16x32_bf16 v[124:127], a[196:199], a[124:127], v[124:127]
s_waitcnt lgkmcnt(2)
v_mfma_f32_16x16x32_bf16 v[128:131], a[200:203], a[96:99], v[128:131]
s_waitcnt lgkmcnt(0)
ds_read_b64_tr_b16 a[208:209], v60 offset:136
ds_read_b64_tr_b16 a[210:211], v60 offset:6280
v_mfma_f32_16x16x32_bf16 v[128:131], a[204:207], a[100:103], v[128:131]
ds_read_b64_tr_b16 a[212:213], v60 offset:12424
ds_read_b64_tr_b16 a[214:215], v60 offset:18568
v_mfma_f32_16x16x32_bf16 v[132:135], a[200:203], a[104:107], v[132:135]
buffer_load_dwordx4 v11, s[16:19], s42 offen offset:1024 lds
v_mfma_f32_16x16x32_bf16 v[132:135], a[204:207], a[108:111], v[132:135]
v_mfma_f32_16x16x32_bf16 v[136:139], a[200:203], a[112:115], v[136:139]
v_mfma_f32_16x16x32_bf16 v[136:139], a[204:207], a[116:119], v[136:139]
v_mfma_f32_16x16x32_bf16 v[140:143], a[200:203], a[120:123], v[140:143]
v_mfma_f32_16x16x32_bf16 v[140:143], a[204:207], a[124:127], v[140:143]
s_waitcnt lgkmcnt(2)
v_mfma_f32_16x16x32_bf16 v[144:147], a[208:211], a[96:99], v[144:147]
s_waitcnt lgkmcnt(0)
ds_read_b64_tr_b16 a[192:193], v61 offset:128
ds_read_b64_tr_b16 a[194:195], v61 offset:6272
v_mfma_f32_16x16x32_bf16 v[144:147], a[212:215], a[100:103], v[144:147]
ds_read_b64_tr_b16 a[196:197], v61 offset:12416
ds_read_b64_tr_b16 a[198:199], v61 offset:18560
v_mfma_f32_16x16x32_bf16 v[148:151], a[208:211], a[104:107], v[148:151]
buffer_load_dwordx4 v12, s[16:19], s42 offen offset:2048 lds
v_mfma_f32_16x16x32_bf16 v[148:151], a[212:215], a[108:111], v[148:151]
s_add_u32 s42, s42, 393216
v_mfma_f32_16x16x32_bf16 v[152:155], a[208:211], a[112:115], v[152:155]
v_mfma_f32_16x16x32_bf16 v[152:155], a[212:215], a[116:119], v[152:155]
v_mfma_f32_16x16x32_bf16 v[156:159], a[208:211], a[120:123], v[156:159]
v_mfma_f32_16x16x32_bf16 v[156:159], a[212:215], a[124:127], v[156:159]
s_waitcnt lgkmcnt(2)
v_mfma_f32_16x16x32_bf16 v[160:163], a[192:195], a[96:99], v[160:163]
s_waitcnt lgkmcnt(0)
ds_read_b64_tr_b16 a[200:201], v61 offset:136
ds_read_b64_tr_b16 a[202:203], v61 offset:6280
v_mfma_f32_16x16x32_bf16 v[160:163], a[196:199], a[100:103], v[160:163]
s_add_u32 m0, s39, 61440
ds_read_b64_tr_b16 a[204:205], v61 offset:12424
ds_read_b64_tr_b16 a[206:207], v61 offset:18568
v_mfma_f32_16x16x32_bf16 v[164:167], a[192:195], a[104:107], v[164:167]
buffer_load_dwordx4 v13, s[20:23], s43 offen offset:0 lds
v_mfma_f32_16x16x32_bf16 v[164:167], a[196:199], a[108:111], v[164:167]
v_mfma_f32_16x16x32_bf16 v[168:171], a[192:195], a[112:115], v[168:171]
v_mfma_f32_16x16x32_bf16 v[168:171], a[196:199], a[116:119], v[168:171]
v_mfma_f32_16x16x32_bf16 v[172:175], a[192:195], a[120:123], v[172:175]
v_mfma_f32_16x16x32_bf16 v[172:175], a[196:199], a[124:127], v[172:175]
s_waitcnt lgkmcnt(2)
v_mfma_f32_16x16x32_bf16 v[176:179], a[200:203], a[96:99], v[176:179]
s_waitcnt lgkmcnt(0)
ds_read_b64_tr_b16 a[208:209], v60 offset:256
ds_read_b64_tr_b16 a[210:211], v60 offset:6400
v_mfma_f32_16x16x32_bf16 v[176:179], a[204:207], a[100:103], v[176:179]
ds_read_b64_tr_b16 a[212:213], v60 offset:12544
ds_read_b64_tr_b16 a[214:215], v60 offset:18688
v_mfma_f32_16x16x32_bf16 v[180:183], a[200:203], a[104:107], v[180:183]
buffer_load_dwordx4 v14, s[20:23], s43 offen offset:1024 lds
v_mfma_f32_16x16x32_bf16 v[180:183], a[204:207], a[108:111], v[180:183]
v_mfma_f32_16x16x32_bf16 v[184:187], a[200:203], a[112:115], v[184:187]
v_mfma_f32_16x16x32_bf16 v[184:187], a[204:207], a[116:119], v[184:187]
v_mfma_f32_16x16x32_bf16 v[188:191], a[200:203], a[120:123], v[188:191]
v_mfma_f32_16x16x32_bf16 v[188:191], a[204:207], a[124:127], v[188:191]
s_waitcnt lgkmcnt(2)
v_mfma_f32_16x16x32_bf16 v[192:195], a[208:211], a[96:99], v[192:195]
s_waitcnt lgkmcnt(0)
ds_read_b64_tr_b16 a[192:193], v60 offset:264
ds_read_b64_tr_b16 a[194:195], v60 offset:6408
v_mfma_f32_16x16x32_bf16 v[192:195], a[212:215], a[100:103], v[192:195]
ds_read_b64_tr_b16 a[196:197], v60 offset:12552
ds_read_b64_tr_b16 a[198:199], v60 offset:18696
v_mfma_f32_16x16x32_bf16 v[196:199], a[208:211], a[104:107], v[196:199]
buffer_load_dwordx4 v15, s[20:23], s43 offen offset:2048 lds
v_mfma_f32_16x16x32_bf16 v[196:199], a[212:215], a[108:111], v[196:199]
s_add_u32 s43, s43, 196608
v_mfma_f32_16x16x32_bf16 v[200:203], a[208:211], a[112:115], v[200:203]
v_mfma_f32_16x16x32_bf16 v[200:203], a[212:215], a[116:119], v[200:203]
v_mfma_f32_16x16x32_bf16 v[204:207], a[208:211], a[120:123], v[204:207]
v_mfma_f32_16x16x32_bf16 v[204:207], a[212:215], a[124:127], v[204:207]
s_waitcnt lgkmcnt(2)
v_mfma_f32_16x16x32_bf16 v[208:211], a[192:195], a[96:99], v[208:211]
s_waitcnt lgkmcnt(0)
ds_read_b64_tr_b16 a[200:201], v61 offset:256
ds_read_b64_tr_b16 a[202:203], v61 offset:6400
v_mfma_f32_16x16x32_bf16 v[208:211], a[196:199], a[100:103], v[208:211]
ds_read_b64_tr_b16 a[204:205], v61 offset:12544
ds_read_b64_tr_b16 a[206:207], v61 offset:18688
v_mfma_f32_16x16x32_bf16 v[212:215], a[192:195], a[104:107], v[212:215]
buffer_load_dwordx4 a[160:163], v53, s[24:27], s44 offen offset:0 sc1
v_mfma_f32_16x16x32_bf16 v[212:215], a[196:199], a[108:111], v[212:215]
v_mfma_f32_16x16x32_bf16 v[216:219], a[192:195], a[112:115], v[216:219]
v_mfma_f32_16x16x32_bf16 v[216:219], a[196:199], a[116:119], v[216:219]
v_mfma_f32_16x16x32_bf16 v[220:223], a[192:195], a[120:123], v[220:223]
v_mfma_f32_16x16x32_bf16 v[220:223], a[196:199], a[124:127], v[220:223]
s_waitcnt lgkmcnt(2)
v_mfma_f32_16x16x32_bf16 v[224:227], a[200:203], a[96:99], v[224:227]
s_waitcnt lgkmcnt(0)
ds_read_b64_tr_b16 a[208:209], v61 offset:264
ds_read_b64_tr_b16 a[210:211], v61 offset:6408
v_mfma_f32_16x16x32_bf16 v[224:227], a[204:207], a[100:103], v[224:227]
ds_read_b64_tr_b16 a[212:213], v61 offset:12552
ds_read_b64_tr_b16 a[214:215], v61 offset:18696
v_mfma_f32_16x16x32_bf16 v[228:231], a[200:203], a[104:107], v[228:231]
buffer_load_dwordx4 a[164:167], v53, s[24:27], s44 offen offset:1024 sc1
v_mfma_f32_16x16x32_bf16 v[228:231], a[204:207], a[108:111], v[228:231]
v_mfma_f32_16x16x32_bf16 v[232:235], a[200:203], a[112:115], v[232:235]
v_mfma_f32_16x16x32_bf16 v[232:235], a[204:207], a[116:119], v[232:235]
v_mfma_f32_16x16x32_bf16 v[236:239], a[200:203], a[120:123], v[236:239]
v_mfma_f32_16x16x32_bf16 v[236:239], a[204:207], a[124:127], v[236:239]
s_waitcnt lgkmcnt(2)
v_mfma_f32_16x16x32_bf16 v[240:243], a[208:211], a[96:99], v[240:243]
s_waitcnt lgkmcnt(0)
ds_read_b64_tr_b16 a[192:193], v29 offset:0
ds_read_b64_tr_b16 a[194:195], v29 offset:1536
v_mfma_f32_16x16x32_bf16 v[240:243], a[212:215], a[100:103], v[240:243]
ds_read_b64_tr_b16 a[196:197], v29 offset:3072
ds_read_b64_tr_b16 a[198:199], v29 offset:4608
v_mfma_f32_16x16x32_bf16 v[244:247], a[208:211], a[104:107], v[244:247]
buffer_load_dwordx4 a[168:171], v54, s[24:27], s44 offen offset:0 sc1
v_mfma_f32_16x16x32_bf16 v[244:247], a[212:215], a[108:111], v[244:247]
v_mfma_f32_16x16x32_bf16 v[248:251], a[208:211], a[112:115], v[248:251]
v_mfma_f32_16x16x32_bf16 v[248:251], a[212:215], a[116:119], v[248:251]
v_mfma_f32_16x16x32_bf16 v[252:255], a[208:211], a[120:123], v[252:255]
v_mfma_f32_16x16x32_bf16 v[252:255], a[212:215], a[124:127], v[252:255]
s_waitcnt lgkmcnt(2)
v_mfma_f32_16x16x32_bf16 a[0:3], a[192:195], a[96:99], a[0:3]
s_waitcnt lgkmcnt(0)
ds_read_b64_tr_b16 a[200:201], v29 offset:32
ds_read_b64_tr_b16 a[202:203], v29 offset:1568
v_mfma_f32_16x16x32_bf16 a[0:3], a[196:199], a[100:103], a[0:3]
ds_read_b64_tr_b16 a[204:205], v29 offset:3104
ds_read_b64_tr_b16 a[206:207], v29 offset:4640
v_mfma_f32_16x16x32_bf16 a[4:7], a[192:195], a[104:107], a[4:7]
buffer_load_dwordx4 a[172:175], v54, s[24:27], s44 offen offset:1024 sc1
v_mfma_f32_16x16x32_bf16 a[4:7], a[196:199], a[108:111], a[4:7]
v_mfma_f32_16x16x32_bf16 a[8:11], a[192:195], a[112:115], a[8:11]
v_mfma_f32_16x16x32_bf16 a[8:11], a[196:199], a[116:119], a[8:11]
v_mfma_f32_16x16x32_bf16 a[12:15], a[192:195], a[120:123], a[12:15]
v_mfma_f32_16x16x32_bf16 a[12:15], a[196:199], a[124:127], a[12:15]
s_waitcnt lgkmcnt(2)
v_mfma_f32_16x16x32_bf16 a[16:19], a[200:203], a[96:99], a[16:19]
s_waitcnt lgkmcnt(0)
ds_read_b64_tr_b16 a[208:209], v29 offset:64
ds_read_b64_tr_b16 a[210:211], v29 offset:1600
v_mfma_f32_16x16x32_bf16 a[16:19], a[204:207], a[100:103], a[16:19]
ds_read_b64_tr_b16 a[212:213], v29 offset:3136
ds_read_b64_tr_b16 a[214:215], v29 offset:4672
v_mfma_f32_16x16x32_bf16 a[20:23], a[200:203], a[104:107], a[20:23]
buffer_load_dwordx4 a[176:179], v55, s[24:27], s44 offen offset:0 sc1
v_mfma_f32_16x16x32_bf16 a[20:23], a[204:207], a[108:111], a[20:23]
v_mfma_f32_16x16x32_bf16 a[24:27], a[200:203], a[112:115], a[24:27]
v_mfma_f32_16x16x32_bf16 a[24:27], a[204:207], a[116:119], a[24:27]
v_mfma_f32_16x16x32_bf16 a[28:31], a[200:203], a[120:123], a[28:31]
v_mfma_f32_16x16x32_bf16 a[28:31], a[204:207], a[124:127], a[28:31]
s_waitcnt lgkmcnt(2)
v_mfma_f32_16x16x32_bf16 a[32:35], a[208:211], a[96:99], a[32:35]
s_waitcnt lgkmcnt(0)
ds_read_b64_tr_b16 a[192:193], v29 offset:6144
ds_read_b64_tr_b16 a[194:195], v29 offset:7680
v_mfma_f32_16x16x32_bf16 a[32:35], a[212:215], a[100:103], a[32:35]
ds_read_b64_tr_b16 a[196:197], v29 offset:9216
ds_read_b64_tr_b16 a[198:199], v29 offset:10752
v_mfma_f32_16x16x32_bf16 a[36:39], a[208:211], a[104:107], a[36:39]
buffer_load_dwordx4 a[180:183], v55, s[24:27], s44 offen offset:1024 sc1
v_mfma_f32_16x16x32_bf16 a[36:39], a[212:215], a[108:111], a[36:39]
v_mfma_f32_16x16x32_bf16 a[40:43], a[208:211], a[112:115], a[40:43]
v_mfma_f32_16x16x32_bf16 a[40:43], a[212:215], a[116:119], a[40:43]
v_mfma_f32_16x16x32_bf16 a[44:47], a[208:211], a[120:123], a[44:47]
v_mfma_f32_16x16x32_bf16 a[44:47], a[212:215], a[124:127], a[44:47]
s_waitcnt lgkmcnt(2)
v_mfma_f32_16x16x32_bf16 a[48:51], a[192:195], a[96:99], a[48:51]
s_waitcnt lgkmcnt(0)
ds_read_b64_tr_b16 a[200:201], v29 offset:6176
ds_read_b64_tr_b16 a[202:203], v29 offset:7712
v_mfma_f32_16x16x32_bf16 a[48:51], a[196:199], a[100:103], a[48:51]
ds_read_b64_tr_b16 a[204:205], v29 offset:9248
ds_read_b64_tr_b16 a[206:207], v29 offset:10784
v_mfma_f32_16x16x32_bf16 a[52:55], a[192:195], a[104:107], a[52:55]
buffer_load_dwordx4 a[184:187], v56, s[24:27], s44 offen offset:0 sc1
v_mfma_f32_16x16x32_bf16 a[52:55], a[196:199], a[108:111], a[52:55]
v_mfma_f32_16x16x32_bf16 a[56:59], a[192:195], a[112:115], a[56:59]
v_mfma_f32_16x16x32_bf16 a[56:59], a[196:199], a[116:119], a[56:59]
v_mfma_f32_16x16x32_bf16 a[60:63], a[192:195], a[120:123], a[60:63]
ds_read_b64_tr_b16 a[208:209], v29 offset:6208
ds_read_b64_tr_b16 a[210:211], v29 offset:7744
v_mfma_f32_16x16x32_bf16 a[60:63], a[196:199], a[124:127], a[60:63]
s_waitcnt lgkmcnt(4)
ds_read_b64_tr_b16 a[212:213], v29 offset:9280
ds_read_b64_tr_b16 a[214:215], v29 offset:10816
v_mfma_f32_16x16x32_bf16 a[64:67], a[200:203], a[96:99], a[64:67]
s_waitcnt lgkmcnt(4)
buffer_load_dwordx4 a[188:191], v56, s[24:27], s44 offen offset:1024 sc1
v_mfma_f32_16x16x32_bf16 a[64:67], a[204:207], a[100:103], a[64:67]
v_mfma_f32_16x16x32_bf16 a[68:71], a[200:203], a[104:107], a[68:71]
v_mfma_f32_16x16x32_bf16 a[68:71], a[204:207], a[108:111], a[68:71]
v_mfma_f32_16x16x32_bf16 a[72:75], a[200:203], a[112:115], a[72:75]
v_mfma_f32_16x16x32_bf16 a[72:75], a[204:207], a[116:119], a[72:75]
v_mfma_f32_16x16x32_bf16 a[76:79], a[200:203], a[120:123], a[76:79]
s_add_u32 s44, s44, 2048
v_mfma_f32_16x16x32_bf16 a[76:79], a[204:207], a[124:127], a[76:79]
s_waitcnt vmcnt(42)
s_waitcnt lgkmcnt(0)
s_barrier
v_mfma_f32_16x16x32_bf16 a[80:83], a[208:211], a[96:99], a[80:83]
ds_read_b64_tr_b16 a[192:193], v60 offset:36864
ds_read_b64_tr_b16 a[194:195], v60 offset:43008
v_mfma_f32_16x16x32_bf16 a[80:83], a[212:215], a[100:103], a[80:83]
ds_read_b64_tr_b16 a[196:197], v60 offset:49152
ds_read_b64_tr_b16 a[198:199], v60 offset:55296
v_mfma_f32_16x16x32_bf16 a[84:87], a[208:211], a[104:107], a[84:87]
v_mfma_f32_16x16x32_bf16 a[84:87], a[212:215], a[108:111], a[84:87]
v_mfma_f32_16x16x32_bf16 a[88:91], a[208:211], a[112:115], a[88:91]
v_mfma_f32_16x16x32_bf16 a[88:91], a[212:215], a[116:119], a[88:91]
v_mfma_f32_16x16x32_bf16 a[92:95], a[208:211], a[120:123], a[92:95]
v_mfma_f32_16x16x32_bf16 a[92:95], a[212:215], a[124:127], a[92:95]
s_waitcnt lgkmcnt(2) vmcnt(24)
v_mfma_f32_16x16x32_bf16 v[64:67], a[192:195], a[128:131], v[64:67]
s_waitcnt lgkmcnt(0) vmcnt(23)
ds_read_b64_tr_b16 a[200:201], v60 offset:36872
ds_read_b64_tr_b16 a[202:203], v60 offset:43016
s_mov_b32 s53, 0xc15db3d7
s_mov_b32 s54, 0x3c319c33
v_mfma_f32_16x16x32_bf16 v[64:67], a[196:199], a[132:135], v[64:67]
s_waitcnt vmcnt(22)
ds_read_b64_tr_b16 a[204:205], v60 offset:49160
ds_read_b64_tr_b16 a[206:207], v60 offset:55304
s_mul_i32 s55, s50, 49152
s_mul_i32 s56, s36, 3
v_mfma_f32_16x16x32_bf16 v[68:71], a[192:195], a[136:139], v[68:71]
s_waitcnt vmcnt(21)
s_add_u32 m0, s39, 73728
v_lshlrev_b32 v62, 3, v2
s_add_u32 s57, s56, 1
s_lshr_b32 s57, s57, 1
v_mfma_f32_16x16x32_bf16 v[68:71], a[196:199], a[140:143], v[68:71]
s_waitcnt vmcnt(20)
buffer_load_dwordx4 v4, s[8:11], s40 offen offset:0 lds
s_lshl_b32 s57, s57, 10
s_add_u32 s57, s57, s55
v_mfma_f32_16x16x32_bf16 v[72:75], a[192:195], a[144:147], v[72:75]
s_waitcnt vmcnt(20)
s_and_b32 s93, s36, 1
s_lshl_b32 s94, s93, 1
v_mfma_f32_16x16x32_bf16 v[72:75], a[196:199], a[148:151], v[72:75]
s_waitcnt vmcnt(19)
s_sub_u32 s58, s56, s94
s_add_u32 s58, s58, 2
v_mfma_f32_16x16x32_bf16 v[76:79], a[192:195], a[152:155], v[76:79]
s_waitcnt vmcnt(18)
s_lshr_b32 s58, s58, 1
s_lshl_b32 s58, s58, 10
v_mfma_f32_16x16x32_bf16 v[76:79], a[196:199], a[156:159], v[76:79]
s_waitcnt lgkmcnt(2)
s_lshl_b32 s93, s93, 9
s_add_u32 s58, s58, s93
v_mfma_f32_16x16x32_bf16 v[80:83], a[200:203], a[128:131], v[80:83]
s_waitcnt lgkmcnt(0)
ds_read_b64_tr_b16 a[208:209], v61 offset:36864
ds_read_b64_tr_b16 a[210:211], v61 offset:43008
s_add_u32 s58, s58, s55
v_mfma_f32_16x16x32_bf16 v[80:83], a[204:207], a[132:135], v[80:83]
ds_read_b64_tr_b16 a[212:213], v61 offset:49152
ds_read_b64_tr_b16 a[214:215], v61 offset:55296
v_mfma_f32_16x16x32_bf16 v[84:87], a[200:203], a[136:139], v[84:87]
buffer_load_dwordx4 v5, s[8:11], s40 offen offset:1024 lds
v_mfma_f32_16x16x32_bf16 v[84:87], a[204:207], a[140:143], v[84:87]
v_mfma_f32_16x16x32_bf16 v[88:91], a[200:203], a[144:147], v[88:91]
v_mfma_f32_16x16x32_bf16 v[88:91], a[204:207], a[148:151], v[88:91]
v_mfma_f32_16x16x32_bf16 v[92:95], a[200:203], a[152:155], v[92:95]
v_mfma_f32_16x16x32_bf16 v[92:95], a[204:207], a[156:159], v[92:95]
s_waitcnt lgkmcnt(2)
v_mfma_f32_16x16x32_bf16 v[96:99], a[208:211], a[128:131], v[96:99]
s_waitcnt lgkmcnt(0)
ds_read_b64_tr_b16 a[192:193], v61 offset:36872
ds_read_b64_tr_b16 a[194:195], v61 offset:43016
v_mfma_f32_16x16x32_bf16 v[96:99], a[212:215], a[132:135], v[96:99]
ds_read_b64_tr_b16 a[196:197], v61 offset:49160
ds_read_b64_tr_b16 a[198:199], v61 offset:55304
v_mfma_f32_16x16x32_bf16 v[100:103], a[208:211], a[136:139], v[100:103]
buffer_load_dwordx4 v6, s[8:11], s40 offen offset:2048 lds
v_mfma_f32_16x16x32_bf16 v[100:103], a[212:215], a[140:143], v[100:103]
s_add_u32 s40, s40, 12288
v_mfma_f32_16x16x32_bf16 v[104:107], a[208:211], a[144:147], v[104:107]
v_mfma_f32_16x16x32_bf16 v[104:107], a[212:215], a[148:151], v[104:107]
v_mfma_f32_16x16x32_bf16 v[108:111], a[208:211], a[152:155], v[108:111]
v_mfma_f32_16x16x32_bf16 v[108:111], a[212:215], a[156:159], v[108:111]
s_waitcnt lgkmcnt(2)
v_mfma_f32_16x16x32_bf16 v[112:115], a[192:195], a[128:131], v[112:115]
s_waitcnt lgkmcnt(0)
ds_read_b64_tr_b16 a[200:201], v60 offset:36992
ds_read_b64_tr_b16 a[202:203], v60 offset:43136
v_mfma_f32_16x16x32_bf16 v[112:115], a[196:199], a[132:135], v[112:115]
s_add_u32 m0, s39, 86016
ds_read_b64_tr_b16 a[204:205], v60 offset:49280
ds_read_b64_tr_b16 a[206:207], v60 offset:55424
v_mfma_f32_16x16x32_bf16 v[116:119], a[192:195], a[136:139], v[116:119]
buffer_load_dwordx4 v4, s[8:11], s40 offen offset:0 lds
v_mfma_f32_16x16x32_bf16 v[116:119], a[196:199], a[140:143], v[116:119]
v_mfma_f32_16x16x32_bf16 v[120:123], a[192:195], a[144:147], v[120:123]
v_mfma_f32_16x16x32_bf16 v[120:123], a[196:199], a[148:151], v[120:123]
v_mfma_f32_16x16x32_bf16 v[124:127], a[192:195], a[152:155], v[124:127]
v_mfma_f32_16x16x32_bf16 v[124:127], a[196:199], a[156:159], v[124:127]
s_waitcnt lgkmcnt(2)
v_mfma_f32_16x16x32_bf16 v[128:131], a[200:203], a[128:131], v[128:131]
s_waitcnt lgkmcnt(0)
ds_read_b64_tr_b16 a[208:209], v60 offset:37000
ds_read_b64_tr_b16 a[210:211], v60 offset:43144
v_mfma_f32_16x16x32_bf16 v[128:131], a[204:207], a[132:135], v[128:131]
ds_read_b64_tr_b16 a[212:213], v60 offset:49288
ds_read_b64_tr_b16 a[214:215], v60 offset:55432
v_mfma_f32_16x16x32_bf16 v[132:135], a[200:203], a[136:139], v[132:135]
buffer_load_dwordx4 v5, s[8:11], s40 offen offset:1024 lds
v_mfma_f32_16x16x32_bf16 v[132:135], a[204:207], a[140:143], v[132:135]
v_mfma_f32_16x16x32_bf16 v[136:139], a[200:203], a[144:147], v[136:139]
v_mfma_f32_16x16x32_bf16 v[136:139], a[204:207], a[148:151], v[136:139]
v_mfma_f32_16x16x32_bf16 v[140:143], a[200:203], a[152:155], v[140:143]
v_mfma_f32_16x16x32_bf16 v[140:143], a[204:207], a[156:159], v[140:143]
s_waitcnt lgkmcnt(2)
v_mfma_f32_16x16x32_bf16 v[144:147], a[208:211], a[128:131], v[144:147]
s_waitcnt lgkmcnt(0)
ds_read_b64_tr_b16 a[192:193], v61 offset:36992
ds_read_b64_tr_b16 a[194:195], v61 offset:43136
v_mfma_f32_16x16x32_bf16 v[144:147], a[212:215], a[132:135], v[144:147]
ds_read_b64_tr_b16 a[196:197], v61 offset:49280
ds_read_b64_tr_b16 a[198:199], v61 offset:55424
v_mfma_f32_16x16x32_bf16 v[148:151], a[208:211], a[136:139], v[148:151]
buffer_load_dwordx4 v6, s[8:11], s40 offen offset:2048 lds
v_mfma_f32_16x16x32_bf16 v[148:151], a[212:215], a[140:143], v[148:151]
s_add_u32 s40, s40, 12288
v_mfma_f32_16x16x32_bf16 v[152:155], a[208:211], a[144:147], v[152:155]
v_mfma_f32_16x16x32_bf16 v[152:155], a[212:215], a[148:151], v[152:155]
v_mfma_f32_16x16x32_bf16 v[156:159], a[208:211], a[152:155], v[156:159]
v_mfma_f32_16x16x32_bf16 v[156:159], a[212:215], a[156:159], v[156:159]
s_waitcnt lgkmcnt(2)
v_mfma_f32_16x16x32_bf16 v[160:163], a[192:195], a[128:131], v[160:163]
s_waitcnt lgkmcnt(0)
ds_read_b64_tr_b16 a[200:201], v61 offset:37000
ds_read_b64_tr_b16 a[202:203], v61 offset:43144
v_mfma_f32_16x16x32_bf16 v[160:163], a[196:199], a[132:135], v[160:163]
s_add_u32 m0, s39, 98304
ds_read_b64_tr_b16 a[204:205], v61 offset:49288
ds_read_b64_tr_b16 a[206:207], v61 offset:55432
v_mfma_f32_16x16x32_bf16 v[164:167], a[192:195], a[136:139], v[164:167]
buffer_load_dwordx4 v4, s[8:11], s40 offen offset:0 lds
v_mfma_f32_16x16x32_bf16 v[164:167], a[196:199], a[140:143], v[164:167]
v_mfma_f32_16x16x32_bf16 v[168:171], a[192:195], a[144:147], v[168:171]
v_mfma_f32_16x16x32_bf16 v[168:171], a[196:199], a[148:151], v[168:171]
v_mfma_f32_16x16x32_bf16 v[172:175], a[192:195], a[152:155], v[172:175]
v_mfma_f32_16x16x32_bf16 v[172:175], a[196:199], a[156:159], v[172:175]
s_waitcnt lgkmcnt(2)
v_mfma_f32_16x16x32_bf16 v[176:179], a[200:203], a[128:131], v[176:179]
s_waitcnt lgkmcnt(0)
ds_read_b64_tr_b16 a[208:209], v60 offset:37120
ds_read_b64_tr_b16 a[210:211], v60 offset:43264
v_mfma_f32_16x16x32_bf16 v[176:179], a[204:207], a[132:135], v[176:179]
ds_read_b64_tr_b16 a[212:213], v60 offset:49408
ds_read_b64_tr_b16 a[214:215], v60 offset:55552
v_mfma_f32_16x16x32_bf16 v[180:183], a[200:203], a[136:139], v[180:183]
buffer_load_dwordx4 v5, s[8:11], s40 offen offset:1024 lds
v_mfma_f32_16x16x32_bf16 v[180:183], a[204:207], a[140:143], v[180:183]
v_mfma_f32_16x16x32_bf16 v[184:187], a[200:203], a[144:147], v[184:187]
v_mfma_f32_16x16x32_bf16 v[184:187], a[204:207], a[148:151], v[184:187]
v_mfma_f32_16x16x32_bf16 v[188:191], a[200:203], a[152:155], v[188:191]
v_mfma_f32_16x16x32_bf16 v[188:191], a[204:207], a[156:159], v[188:191]
s_waitcnt lgkmcnt(2)
v_mfma_f32_16x16x32_bf16 v[192:195], a[208:211], a[128:131], v[192:195]
s_waitcnt lgkmcnt(0)
ds_read_b64_tr_b16 a[192:193], v60 offset:37128
ds_read_b64_tr_b16 a[194:195], v60 offset:43272
v_mfma_f32_16x16x32_bf16 v[192:195], a[212:215], a[132:135], v[192:195]
ds_read_b64_tr_b16 a[196:197], v60 offset:49416
ds_read_b64_tr_b16 a[198:199], v60 offset:55560
v_mfma_f32_16x16x32_bf16 v[196:199], a[208:211], a[136:139], v[196:199]
buffer_load_dwordx4 v6, s[8:11], s40 offen offset:2048 lds
v_mfma_f32_16x16x32_bf16 v[196:199], a[212:215], a[140:143], v[196:199]
s_add_u32 s40, s40, 12288
v_mfma_f32_16x16x32_bf16 v[200:203], a[208:211], a[144:147], v[200:203]
v_mfma_f32_16x16x32_bf16 v[200:203], a[212:215], a[148:151], v[200:203]
v_mfma_f32_16x16x32_bf16 v[204:207], a[208:211], a[152:155], v[204:207]
v_mfma_f32_16x16x32_bf16 v[204:207], a[212:215], a[156:159], v[204:207]
s_waitcnt lgkmcnt(2)
v_mfma_f32_16x16x32_bf16 v[208:211], a[192:195], a[128:131], v[208:211]
s_waitcnt lgkmcnt(0)
ds_read_b64_tr_b16 a[200:201], v61 offset:37120
ds_read_b64_tr_b16 a[202:203], v61 offset:43264
v_mfma_f32_16x16x32_bf16 v[208:211], a[196:199], a[132:135], v[208:211]
ds_read_b64_tr_b16 a[204:205], v61 offset:49408
ds_read_b64_tr_b16 a[206:207], v61 offset:55552
v_mfma_f32_16x16x32_bf16 v[212:215], a[192:195], a[136:139], v[212:215]
buffer_load_dwordx4 a[96:99], v53, s[24:27], s44 offen offset:0 sc1
v_mfma_f32_16x16x32_bf16 v[212:215], a[196:199], a[140:143], v[212:215]
v_mfma_f32_16x16x32_bf16 v[216:219], a[192:195], a[144:147], v[216:219]
v_mfma_f32_16x16x32_bf16 v[216:219], a[196:199], a[148:151], v[216:219]
v_mfma_f32_16x16x32_bf16 v[220:223], a[192:195], a[152:155], v[220:223]
v_mfma_f32_16x16x32_bf16 v[220:223], a[196:199], a[156:159], v[220:223]
s_waitcnt lgkmcnt(2)
v_mfma_f32_16x16x32_bf16 v[224:227], a[200:203], a[128:131], v[224:227]
s_waitcnt lgkmcnt(0)
ds_read_b64_tr_b16 a[208:209], v61 offset:37128
ds_read_b64_tr_b16 a[210:211], v61 offset:43272
v_mfma_f32_16x16x32_bf16 v[224:227], a[204:207], a[132:135], v[224:227]
ds_read_b64_tr_b16 a[212:213], v61 offset:49416
ds_read_b64_tr_b16 a[214:215], v61 offset:55560
v_mfma_f32_16x16x32_bf16 v[228:231], a[200:203], a[136:139], v[228:231]
buffer_load_dwordx4 a[100:103], v53, s[24:27], s44 offen offset:1024 sc1
v_mfma_f32_16x16x32_bf16 v[228:231], a[204:207], a[140:143], v[228:231]
v_mfma_f32_16x16x32_bf16 v[232:235], a[200:203], a[144:147], v[232:235]
v_mfma_f32_16x16x32_bf16 v[232:235], a[204:207], a[148:151], v[232:235]
v_mfma_f32_16x16x32_bf16 v[236:239], a[200:203], a[152:155], v[236:239]
v_mfma_f32_16x16x32_bf16 v[236:239], a[204:207], a[156:159], v[236:239]
s_waitcnt lgkmcnt(2)
v_mfma_f32_16x16x32_bf16 v[240:243], a[208:211], a[128:131], v[240:243]
s_waitcnt lgkmcnt(0)
ds_read_b64_tr_b16 a[192:193], v29 offset:36864
ds_read_b64_tr_b16 a[194:195], v29 offset:38400
v_mfma_f32_16x16x32_bf16 v[240:243], a[212:215], a[132:135], v[240:243]
ds_read_b64_tr_b16 a[196:197], v29 offset:39936
ds_read_b64_tr_b16 a[198:199], v29 offset:41472
v_mfma_f32_16x16x32_bf16 v[244:247], a[208:211], a[136:139], v[244:247]
buffer_load_dwordx4 a[104:107], v54, s[24:27], s44 offen offset:0 sc1
v_mfma_f32_16x16x32_bf16 v[244:247], a[212:215], a[140:143], v[244:247]
v_mfma_f32_16x16x32_bf16 v[248:251], a[208:211], a[144:147], v[248:251]
v_mfma_f32_16x16x32_bf16 v[248:251], a[212:215], a[148:151], v[248:251]
v_mfma_f32_16x16x32_bf16 v[252:255], a[208:211], a[152:155], v[252:255]
v_mfma_f32_16x16x32_bf16 v[252:255], a[212:215], a[156:159], v[252:255]
s_waitcnt lgkmcnt(2)
v_mfma_f32_16x16x32_bf16 a[0:3], a[192:195], a[128:131], a[0:3]
s_waitcnt lgkmcnt(0)
ds_read_b64_tr_b16 a[200:201], v29 offset:36896
ds_read_b64_tr_b16 a[202:203], v29 offset:38432
v_mfma_f32_16x16x32_bf16 a[0:3], a[196:199], a[132:135], a[0:3]
ds_read_b64_tr_b16 a[204:205], v29 offset:39968
ds_read_b64_tr_b16 a[206:207], v29 offset:41504
v_mfma_f32_16x16x32_bf16 a[4:7], a[192:195], a[136:139], a[4:7]
buffer_load_dwordx4 a[108:111], v54, s[24:27], s44 offen offset:1024 sc1
v_mfma_f32_16x16x32_bf16 a[4:7], a[196:199], a[140:143], a[4:7]
v_mfma_f32_16x16x32_bf16 a[8:11], a[192:195], a[144:147], a[8:11]
v_mfma_f32_16x16x32_bf16 a[8:11], a[196:199], a[148:151], a[8:11]
v_mfma_f32_16x16x32_bf16 a[12:15], a[192:195], a[152:155], a[12:15]
v_mfma_f32_16x16x32_bf16 a[12:15], a[196:199], a[156:159], a[12:15]
s_waitcnt lgkmcnt(2)
v_mfma_f32_16x16x32_bf16 a[16:19], a[200:203], a[128:131], a[16:19]
s_waitcnt lgkmcnt(0)
ds_read_b64_tr_b16 a[208:209], v29 offset:36928
ds_read_b64_tr_b16 a[210:211], v29 offset:38464
v_mfma_f32_16x16x32_bf16 a[16:19], a[204:207], a[132:135], a[16:19]
ds_read_b64_tr_b16 a[212:213], v29 offset:40000
ds_read_b64_tr_b16 a[214:215], v29 offset:41536
v_mfma_f32_16x16x32_bf16 a[20:23], a[200:203], a[136:139], a[20:23]
buffer_load_dwordx4 a[112:115], v55, s[24:27], s44 offen offset:0 sc1
v_mfma_f32_16x16x32_bf16 a[20:23], a[204:207], a[140:143], a[20:23]
v_mfma_f32_16x16x32_bf16 a[24:27], a[200:203], a[144:147], a[24:27]
v_mfma_f32_16x16x32_bf16 a[24:27], a[204:207], a[148:151], a[24:27]
v_mfma_f32_16x16x32_bf16 a[28:31], a[200:203], a[152:155], a[28:31]
v_mfma_f32_16x16x32_bf16 a[28:31], a[204:207], a[156:159], a[28:31]
s_waitcnt lgkmcnt(2)
v_mfma_f32_16x16x32_bf16 a[32:35], a[208:211], a[128:131], a[32:35]
s_waitcnt lgkmcnt(0)
ds_read_b64_tr_b16 a[192:193], v29 offset:43008
ds_read_b64_tr_b16 a[194:195], v29 offset:44544
v_mfma_f32_16x16x32_bf16 a[32:35], a[212:215], a[132:135], a[32:35]
ds_read_b64_tr_b16 a[196:197], v29 offset:46080
ds_read_b64_tr_b16 a[198:199], v29 offset:47616
v_mfma_f32_16x16x32_bf16 a[36:39], a[208:211], a[136:139], a[36:39]
buffer_load_dwordx4 a[116:119], v55, s[24:27], s44 offen offset:1024 sc1
v_mfma_f32_16x16x32_bf16 a[36:39], a[212:215], a[140:143], a[36:39]
v_mfma_f32_16x16x32_bf16 a[40:43], a[208:211], a[144:147], a[40:43]
v_mfma_f32_16x16x32_bf16 a[40:43], a[212:215], a[148:151], a[40:43]
v_mfma_f32_16x16x32_bf16 a[44:47], a[208:211], a[152:155], a[44:47]
v_mfma_f32_16x16x32_bf16 a[44:47], a[212:215], a[156:159], a[44:47]
s_waitcnt lgkmcnt(2)
v_mfma_f32_16x16x32_bf16 a[48:51], a[192:195], a[128:131], a[48:51]
s_waitcnt lgkmcnt(0)
ds_read_b64_tr_b16 a[200:201], v29 offset:43040
ds_read_b64_tr_b16 a[202:203], v29 offset:44576
v_mfma_f32_16x16x32_bf16 a[48:51], a[196:199], a[132:135], a[48:51]
ds_read_b64_tr_b16 a[204:205], v29 offset:46112
ds_read_b64_tr_b16 a[206:207], v29 offset:47648
v_mfma_f32_16x16x32_bf16 a[52:55], a[192:195], a[136:139], a[52:55]
buffer_load_dwordx4 a[120:123], v56, s[24:27], s44 offen offset:0 sc1
v_mfma_f32_16x16x32_bf16 a[52:55], a[196:199], a[140:143], a[52:55]
v_mfma_f32_16x16x32_bf16 a[56:59], a[192:195], a[144:147], a[56:59]
v_mfma_f32_16x16x32_bf16 a[56:59], a[196:199], a[148:151], a[56:59]
v_mfma_f32_16x16x32_bf16 a[60:63], a[192:195], a[152:155], a[60:63]
ds_read_b64_tr_b16 a[208:209], v29 offset:43072
ds_read_b64_tr_b16 a[210:211], v29 offset:44608
v_mfma_f32_16x16x32_bf16 a[60:63], a[196:199], a[156:159], a[60:63]
s_waitcnt lgkmcnt(4)
ds_read_b64_tr_b16 a[212:213], v29 offset:46144
ds_read_b64_tr_b16 a[214:215], v29 offset:47680
v_mfma_f32_16x16x32_bf16 a[64:67], a[200:203], a[128:131], a[64:67]
s_waitcnt lgkmcnt(4)
buffer_load_dwordx4 a[124:127], v56, s[24:27], s44 offen offset:1024 sc1
v_mfma_f32_16x16x32_bf16 a[64:67], a[204:207], a[132:135], a[64:67]
v_mfma_f32_16x16x32_bf16 a[68:71], a[200:203], a[136:139], a[68:71]
v_mfma_f32_16x16x32_bf16 a[68:71], a[204:207], a[140:143], a[68:71]
v_mfma_f32_16x16x32_bf16 a[72:75], a[200:203], a[144:147], a[72:75]
v_mfma_f32_16x16x32_bf16 a[72:75], a[204:207], a[148:151], a[72:75]
v_mfma_f32_16x16x32_bf16 a[76:79], a[200:203], a[152:155], a[76:79]
s_add_u32 s44, s44, 2048
v_mfma_f32_16x16x32_bf16 a[76:79], a[204:207], a[156:159], a[76:79]
s_waitcnt vmcnt(25)
s_waitcnt lgkmcnt(0)
s_barrier
v_mfma_f32_16x16x32_bf16 a[80:83], a[208:211], a[128:131], a[80:83]
ds_read_b64_tr_b16 a[192:193], v28 offset:0
ds_read_b64_tr_b16 a[194:195], v28 offset:1536
v_mfma_f32_16x16x32_bf16 a[80:83], a[212:215], a[132:135], a[80:83]
ds_read_b64_tr_b16 a[196:197], v28 offset:3072
ds_read_b64_tr_b16 a[198:199], v28 offset:4608
v_mfma_f32_16x16x32_bf16 a[84:87], a[208:211], a[136:139], a[84:87]
v_mfma_f32_16x16x32_bf16 a[84:87], a[212:215], a[140:143], a[84:87]
v_mfma_f32_16x16x32_bf16 a[88:91], a[208:211], a[144:147], a[88:91]
v_mfma_f32_16x16x32_bf16 a[88:91], a[212:215], a[148:151], a[88:91]
v_mfma_f32_16x16x32_bf16 a[92:95], a[208:211], a[152:155], a[92:95]
v_mfma_f32_16x16x32_bf16 a[92:95], a[212:215], a[156:159], a[92:95]
s_waitcnt lgkmcnt(2) vmcnt(24)
v_mfma_f32_16x16x32_bf16 a[0:3], a[192:195], a[160:163], a[0:3]
s_waitcnt lgkmcnt(0) vmcnt(23)
ds_read_b64_tr_b16 a[200:201], v28 offset:32
ds_read_b64_tr_b16 a[202:203], v28 offset:1568
v_mfma_f32_16x16x32_bf16 a[0:3], a[196:199], a[164:167], a[0:3]
s_waitcnt vmcnt(22)
ds_read_b64_tr_b16 a[204:205], v28 offset:3104
ds_read_b64_tr_b16 a[206:207], v28 offset:4640
v_mfma_f32_16x16x32_bf16 a[4:7], a[192:195], a[168:171], a[4:7]
s_waitcnt vmcnt(21)
s_add_u32 m0, s39, 110592
v_mfma_f32_16x16x32_bf16 a[4:7], a[196:199], a[172:175], a[4:7]
s_waitcnt vmcnt(20)
buffer_load_dwordx4 v4, s[8:11], s40 offen offset:0 lds
v_mfma_f32_16x16x32_bf16 a[8:11], a[192:195], a[176:179], a[8:11]
s_waitcnt vmcnt(20)
v_mfma_f32_16x16x32_bf16 a[8:11], a[196:199], a[180:183], a[8:11]
s_waitcnt vmcnt(19)
v_mfma_f32_16x16x32_bf16 a[12:15], a[192:195], a[184:187], a[12:15]
s_waitcnt vmcnt(18)
v_mfma_f32_16x16x32_bf16 a[12:15], a[196:199], a[188:191], a[12:15]
s_waitcnt lgkmcnt(2)
v_mfma_f32_16x16x32_bf16 a[16:19], a[200:203], a[160:163], a[16:19]
s_waitcnt lgkmcnt(0)
ds_read_b64_tr_b16 a[208:209], v28 offset:64
ds_read_b64_tr_b16 a[210:211], v28 offset:1600
v_mfma_f32_16x16x32_bf16 a[16:19], a[204:207], a[164:167], a[16:19]
ds_read_b64_tr_b16 a[212:213], v28 offset:3136
ds_read_b64_tr_b16 a[214:215], v28 offset:4672
v_mfma_f32_16x16x32_bf16 a[20:23], a[200:203], a[168:171], a[20:23]
buffer_load_dwordx4 v5, s[8:11], s40 offen offset:1024 lds
v_mfma_f32_16x16x32_bf16 a[20:23], a[204:207], a[172:175], a[20:23]
v_mfma_f32_16x16x32_bf16 a[24:27], a[200:203], a[176:179], a[24:27]
v_mfma_f32_16x16x32_bf16 a[24:27], a[204:207], a[180:183], a[24:27]
v_mfma_f32_16x16x32_bf16 a[28:31], a[200:203], a[184:187], a[28:31]
v_mfma_f32_16x16x32_bf16 a[28:31], a[204:207], a[188:191], a[28:31]
s_waitcnt lgkmcnt(2)
v_mfma_f32_16x16x32_bf16 a[32:35], a[208:211], a[160:163], a[32:35]
s_waitcnt lgkmcnt(0)
ds_read_b64_tr_b16 a[192:193], v28 offset:6144
ds_read_b64_tr_b16 a[194:195], v28 offset:7680
v_mfma_f32_16x16x32_bf16 a[32:35], a[212:215], a[164:167], a[32:35]
ds_read_b64_tr_b16 a[196:197], v28 offset:9216
ds_read_b64_tr_b16 a[198:199], v28 offset:10752
v_mfma_f32_16x16x32_bf16 a[36:39], a[208:211], a[168:171], a[36:39]
buffer_load_dwordx4 v6, s[8:11], s40 offen offset:2048 lds
v_mfma_f32_16x16x32_bf16 a[36:39], a[212:215], a[172:175], a[36:39]
s_add_u32 s40, s40, 12288
v_mfma_f32_16x16x32_bf16 a[40:43], a[208:211], a[176:179], a[40:43]
v_mfma_f32_16x16x32_bf16 a[40:43], a[212:215], a[180:183], a[40:43]
v_mfma_f32_16x16x32_bf16 a[44:47], a[208:211], a[184:187], a[44:47]
v_mfma_f32_16x16x32_bf16 a[44:47], a[212:215], a[188:191], a[44:47]
s_waitcnt lgkmcnt(2)
v_mfma_f32_16x16x32_bf16 a[48:51], a[192:195], a[160:163], a[48:51]
s_waitcnt lgkmcnt(0)
ds_read_b64_tr_b16 a[200:201], v28 offset:6176
ds_read_b64_tr_b16 a[202:203], v28 offset:7712
v_mfma_f32_16x16x32_bf16 a[48:51], a[196:199], a[164:167], a[48:51]
s_add_u32 m0, s39, 122880
ds_read_b64_tr_b16 a[204:205], v28 offset:9248
ds_read_b64_tr_b16 a[206:207], v28 offset:10784
v_mfma_f32_16x16x32_bf16 a[52:55], a[192:195], a[168:171], a[52:55]
buffer_load_dwordx4 v4, s[8:11], s40 offen offset:0 lds
v_mfma_f32_16x16x32_bf16 a[52:55], a[196:199], a[172:175], a[52:55]
v_mfma_f32_16x16x32_bf16 a[56:59], a[192:195], a[176:179], a[56:59]
v_mfma_f32_16x16x32_bf16 a[56:59], a[196:199], a[180:183], a[56:59]
v_mfma_f32_16x16x32_bf16 a[60:63], a[192:195], a[184:187], a[60:63]
v_mfma_f32_16x16x32_bf16 a[60:63], a[196:199], a[188:191], a[60:63]
s_waitcnt lgkmcnt(2)
v_mfma_f32_16x16x32_bf16 a[64:67], a[200:203], a[160:163], a[64:67]
s_waitcnt lgkmcnt(0)
ds_read_b64_tr_b16 a[208:209], v28 offset:6208
ds_read_b64_tr_b16 a[210:211], v28 offset:7744
v_mfma_f32_16x16x32_bf16 a[64:67], a[204:207], a[164:167], a[64:67]
ds_read_b64_tr_b16 a[212:213], v28 offset:9280
ds_read_b64_tr_b16 a[214:215], v28 offset:10816
v_mfma_f32_16x16x32_bf16 a[68:71], a[200:203], a[168:171], a[68:71]
buffer_load_dwordx4 v5, s[8:11], s40 offen offset:1024 lds
v_mfma_f32_16x16x32_bf16 a[68:71], a[204:207], a[172:175], a[68:71]
v_mfma_f32_16x16x32_bf16 a[72:75], a[200:203], a[176:179], a[72:75]
v_mfma_f32_16x16x32_bf16 a[72:75], a[204:207], a[180:183], a[72:75]
v_mfma_f32_16x16x32_bf16 a[76:79], a[200:203], a[184:187], a[76:79]
v_mfma_f32_16x16x32_bf16 a[76:79], a[204:207], a[188:191], a[76:79]
s_waitcnt lgkmcnt(2)
v_mfma_f32_16x16x32_bf16 a[80:83], a[208:211], a[160:163], a[80:83]
s_waitcnt lgkmcnt(0)
ds_read_b64_tr_b16 a[192:193], v28 offset:36864
ds_read_b64_tr_b16 a[194:195], v28 offset:38400
v_mfma_f32_16x16x32_bf16 a[80:83], a[212:215], a[164:167], a[80:83]
ds_read_b64_tr_b16 a[196:197], v28 offset:39936
ds_read_b64_tr_b16 a[198:199], v28 offset:41472
v_mfma_f32_16x16x32_bf16 a[84:87], a[208:211], a[168:171], a[84:87]
buffer_load_dwordx4 v6, s[8:11], s40 offen offset:2048 lds
v_mfma_f32_16x16x32_bf16 a[84:87], a[212:215], a[172:175], a[84:87]
s_add_u32 s40, s40, 12288
v_mfma_f32_16x16x32_bf16 a[88:91], a[208:211], a[176:179], a[88:91]
v_mfma_f32_16x16x32_bf16 a[88:91], a[212:215], a[180:183], a[88:91]
v_mfma_f32_16x16x32_bf16 a[92:95], a[208:211], a[184:187], a[92:95]
v_mfma_f32_16x16x32_bf16 a[92:95], a[212:215], a[188:191], a[92:95]
s_waitcnt lgkmcnt(2) vmcnt(13)
v_mfma_f32_16x16x32_bf16 a[0:3], a[192:195], a[96:99], a[0:3]
s_waitcnt lgkmcnt(0) vmcnt(12)
ds_read_b64_tr_b16 a[200:201], v28 offset:36896
ds_read_b64_tr_b16 a[202:203], v28 offset:38432
v_mfma_f32_16x16x32_bf16 a[0:3], a[196:199], a[100:103], a[0:3]
s_waitcnt vmcnt(11)
s_add_u32 m0, s39, 135168
ds_read_b64_tr_b16 a[204:205], v28 offset:39968
ds_read_b64_tr_b16 a[206:207], v28 offset:41504
v_mfma_f32_16x16x32_bf16 a[4:7], a[192:195], a[104:107], a[4:7]
s_waitcnt vmcnt(10)
buffer_load_dwordx4 v4, s[8:11], s40 offen offset:0 lds
v_mfma_f32_16x16x32_bf16 a[4:7], a[196:199], a[108:111], a[4:7]
s_waitcnt vmcnt(10)
v_mfma_f32_16x16x32_bf16 a[8:11], a[192:195], a[112:115], a[8:11]
s_waitcnt vmcnt(9)
v_mfma_f32_16x16x32_bf16 a[8:11], a[196:199], a[116:119], a[8:11]
s_waitcnt vmcnt(8)
v_mfma_f32_16x16x32_bf16 a[12:15], a[192:195], a[120:123], a[12:15]
s_waitcnt vmcnt(7)
v_mfma_f32_16x16x32_bf16 a[12:15], a[196:199], a[124:127], a[12:15]
s_waitcnt lgkmcnt(2)
v_mfma_f32_16x16x32_bf16 a[16:19], a[200:203], a[96:99], a[16:19]
s_waitcnt lgkmcnt(0)
ds_read_b64_tr_b16 a[208:209], v28 offset:36928
ds_read_b64_tr_b16 a[210:211], v28 offset:38464
v_mfma_f32_16x16x32_bf16 a[16:19], a[204:207], a[100:103], a[16:19]
ds_read_b64_tr_b16 a[212:213], v28 offset:40000
ds_read_b64_tr_b16 a[214:215], v28 offset:41536
v_mfma_f32_16x16x32_bf16 a[20:23], a[200:203], a[104:107], a[20:23]
buffer_load_dwordx4 v5, s[8:11], s40 offen offset:1024 lds
v_mfma_f32_16x16x32_bf16 a[20:23], a[204:207], a[108:111], a[20:23]
v_mfma_f32_16x16x32_bf16 a[24:27], a[200:203], a[112:115], a[24:27]
v_mfma_f32_16x16x32_bf16 a[24:27], a[204:207], a[116:119], a[24:27]
v_mfma_f32_16x16x32_bf16 a[28:31], a[200:203], a[120:123], a[28:31]
v_mfma_f32_16x16x32_bf16 a[28:31], a[204:207], a[124:127], a[28:31]
s_waitcnt lgkmcnt(2)
v_mfma_f32_16x16x32_bf16 a[32:35], a[208:211], a[96:99], a[32:35]
s_waitcnt lgkmcnt(0)
ds_read_b64_tr_b16 a[192:193], v28 offset:43008
ds_read_b64_tr_b16 a[194:195], v28 offset:44544
v_mfma_f32_16x16x32_bf16 a[32:35], a[212:215], a[100:103], a[32:35]
ds_read_b64_tr_b16 a[196:197], v28 offset:46080
ds_read_b64_tr_b16 a[198:199], v28 offset:47616
v_mfma_f32_16x16x32_bf16 a[36:39], a[208:211], a[104:107], a[36:39]
buffer_load_dwordx4 v6, s[8:11], s40 offen offset:2048 lds
v_mfma_f32_16x16x32_bf16 a[36:39], a[212:215], a[108:111], a[36:39]
s_add_u32 s40, s40, 12288
v_mfma_f32_16x16x32_bf16 a[40:43], a[208:211], a[112:115], a[40:43]
v_mfma_f32_16x16x32_bf16 a[40:43], a[212:215], a[116:119], a[40:43]
v_mfma_f32_16x16x32_bf16 a[44:47], a[208:211], a[120:123], a[44:47]
v_mfma_f32_16x16x32_bf16 a[44:47], a[212:215], a[124:127], a[44:47]
s_waitcnt lgkmcnt(2)
v_mfma_f32_16x16x32_bf16 a[48:51], a[192:195], a[96:99], a[48:51]
s_waitcnt lgkmcnt(0)
ds_read_b64_tr_b16 a[200:201], v28 offset:43040
ds_read_b64_tr_b16 a[202:203], v28 offset:44576
v_mfma_f32_16x16x32_bf16 a[48:51], a[196:199], a[100:103], a[48:51]
ds_read_b64_tr_b16 a[204:205], v28 offset:46112
ds_read_b64_tr_b16 a[206:207], v28 offset:47648
v_mfma_f32_16x16x32_bf16 a[52:55], a[192:195], a[104:107], a[52:55]
v_mfma_f32_16x16x32_bf16 a[52:55], a[196:199], a[108:111], a[52:55]
v_mfma_f32_16x16x32_bf16 a[56:59], a[192:195], a[112:115], a[56:59]
v_mfma_f32_16x16x32_bf16 a[56:59], a[196:199], a[116:119], a[56:59]
v_mfma_f32_16x16x32_bf16 a[60:63], a[192:195], a[120:123], a[60:63]
v_mfma_f32_16x16x32_bf16 a[60:63], a[196:199], a[124:127], a[60:63]
s_waitcnt lgkmcnt(2)
v_mfma_f32_16x16x32_bf16 a[64:67], a[200:203], a[96:99], a[64:67]
s_waitcnt lgkmcnt(0)
ds_read_b64_tr_b16 a[208:209], v28 offset:43072
ds_read_b64_tr_b16 a[210:211], v28 offset:44608
v_mfma_f32_16x16x32_bf16 a[64:67], a[204:207], a[100:103], a[64:67]
ds_read_b64_tr_b16 a[212:213], v28 offset:46144
ds_read_b64_tr_b16 a[214:215], v28 offset:47680
v_mfma_f32_16x16x32_bf16 a[68:71], a[200:203], a[104:107], a[68:71]
v_mfma_f32_16x16x32_bf16 a[68:71], a[204:207], a[108:111], a[68:71]
v_mfma_f32_16x16x32_bf16 a[72:75], a[200:203], a[112:115], a[72:75]
v_mfma_f32_16x16x32_bf16 a[72:75], a[204:207], a[116:119], a[72:75]
v_mfma_f32_16x16x32_bf16 a[76:79], a[200:203], a[120:123], a[76:79]
v_mfma_f32_16x16x32_bf16 a[76:79], a[204:207], a[124:127], a[76:79]
s_waitcnt lgkmcnt(2)
v_mfma_f32_16x16x32_bf16 a[80:83], a[208:211], a[96:99], a[80:83]
s_waitcnt lgkmcnt(0)
ds_read_b64_tr_b16 a[192:193], v58 offset:0
ds_read_b64_tr_b16 a[194:195], v58 offset:6144
v_mfma_f32_16x16x32_bf16 a[80:83], a[212:215], a[100:103], a[80:83]
ds_read_b64_tr_b16 a[196:197], v58 offset:12288
ds_read_b64_tr_b16 a[198:199], v58 offset:18432
v_mfma_f32_16x16x32_bf16 a[84:87], a[208:211], a[104:107], a[84:87]
v_mfma_f32_16x16x32_bf16 a[84:87], a[212:215], a[108:111], a[84:87]
v_mfma_f32_16x16x32_bf16 a[88:91], a[208:211], a[112:115], a[88:91]
v_mfma_f32_16x16x32_bf16 a[88:91], a[212:215], a[116:119], a[88:91]
v_mfma_f32_16x16x32_bf16 a[92:95], a[208:211], a[120:123], a[92:95]
v_mfma_f32_16x16x32_bf16 a[92:95], a[212:215], a[124:127], a[92:95]
s_waitcnt lgkmcnt(2)
v_mfma_f32_16x16x32_bf16 v[64:67], a[192:195], a[160:163], v[64:67]
s_waitcnt lgkmcnt(0)
ds_read_b64_tr_b16 a[200:201], v58 offset:8
ds_read_b64_tr_b16 a[202:203], v58 offset:6152
v_mfma_f32_16x16x32_bf16 v[64:67], a[196:199], a[164:167], v[64:67]
ds_read_b64_tr_b16 a[204:205], v58 offset:12296
ds_read_b64_tr_b16 a[206:207], v58 offset:18440
v_mfma_f32_16x16x32_bf16 v[68:71], a[192:195], a[168:171], v[68:71]
v_mfma_f32_16x16x32_bf16 v[68:71], a[196:199], a[172:175], v[68:71]
v_mfma_f32_16x16x32_bf16 v[72:75], a[192:195], a[176:179], v[72:75]
v_accvgpr_read_b32 v32, a0
v_accvgpr_read_b32 v33, a1
v_mfma_f32_16x16x32_bf16 v[72:75], a[196:199], a[180:183], v[72:75]
v_accvgpr_read_b32 v34, a2
v_accvgpr_read_b32 v35, a3
v_mfma_f32_16x16x32_bf16 v[76:79], a[192:195], a[184:187], v[76:79]
v_accvgpr_read_b32 v36, a48
v_accvgpr_read_b32 v37, a49
v_mfma_f32_16x16x32_bf16 v[76:79], a[196:199], a[188:191], v[76:79]
s_waitcnt lgkmcnt(2)
v_accvgpr_read_b32 v38, a50
v_accvgpr_read_b32 v39, a51
v_mfma_f32_16x16x32_bf16 v[80:83], a[200:203], a[160:163], v[80:83]
s_waitcnt lgkmcnt(0)
ds_read_b64_tr_b16 a[208:209], v59 offset:0
ds_read_b64_tr_b16 a[210:211], v59 offset:6144
v_mfma_f32_16x16x32_bf16 v[80:83], a[204:207], a[164:167], v[80:83]
ds_read_b64_tr_b16 a[212:213], v59 offset:12288
ds_read_b64_tr_b16 a[214:215], v59 offset:18432
v_mfma_f32_16x16x32_bf16 v[84:87], a[200:203], a[168:171], v[84:87]
v_mul_f32 v40, s53, v32
v_mul_f32 v41, s53, v33
v_mfma_f32_16x16x32_bf16 v[84:87], a[204:207], a[172:175], v[84:87]
v_mul_f32 v42, s53, v34
v_mul_f32 v43, s53, v35
v_mfma_f32_16x16x32_bf16 v[88:91], a[200:203], a[176:179], v[88:91]
v_exp_f32 v40, v40
v_mfma_f32_16x16x32_bf16 v[88:91], a[204:207], a[180:183], v[88:91]
v_exp_f32 v41, v41
v_mfma_f32_16x16x32_bf16 v[92:95], a[200:203], a[184:187], v[92:95]
v_exp_f32 v42, v42
v_mfma_f32_16x16x32_bf16 v[92:95], a[204:207], a[188:191], v[92:95]
s_waitcnt lgkmcnt(2)
v_exp_f32 v43, v43
v_mfma_f32_16x16x32_bf16 v[96:99], a[208:211], a[160:163], v[96:99]
s_waitcnt lgkmcnt(0)
ds_read_b64_tr_b16 a[192:193], v59 offset:8
ds_read_b64_tr_b16 a[194:195], v59 offset:6152
v_mfma_f32_16x16x32_bf16 v[96:99], a[212:215], a[164:167], v[96:99]
ds_read_b64_tr_b16 a[196:197], v59 offset:12296
ds_read_b64_tr_b16 a[198:199], v59 offset:18440
v_mfma_f32_16x16x32_bf16 v[100:103], a[208:211], a[168:171], v[100:103]
v_mul_f32 v32, v32, v36
v_mul_f32 v33, v33, v37
v_mfma_f32_16x16x32_bf16 v[100:103], a[212:215], a[172:175], v[100:103]
v_mul_f32 v34, v34, v38
v_mul_f32 v35, v35, v39
v_mfma_f32_16x16x32_bf16 v[104:107], a[208:211], a[176:179], v[104:107]
v_fma_f32 v40, v40, s54, s54
v_fma_f32 v41, v41, s54, s54
v_mfma_f32_16x16x32_bf16 v[104:107], a[212:215], a[180:183], v[104:107]
v_fma_f32 v42, v42, s54, s54
v_fma_f32 v43, v43, s54, s54
v_mfma_f32_16x16x32_bf16 v[108:111], a[208:211], a[184:187], v[108:111]
v_rcp_f32 v40, v40
v_mfma_f32_16x16x32_bf16 v[108:111], a[212:215], a[188:191], v[108:111]
s_waitcnt lgkmcnt(2)
v_rcp_f32 v41, v41
v_mfma_f32_16x16x32_bf16 v[112:115], a[192:195], a[160:163], v[112:115]
s_waitcnt lgkmcnt(0)
ds_read_b64_tr_b16 a[200:201], v58 offset:128
ds_read_b64_tr_b16 a[202:203], v58 offset:6272
v_mfma_f32_16x16x32_bf16 v[112:115], a[196:199], a[164:167], v[112:115]
ds_read_b64_tr_b16 a[204:205], v58 offset:12416
ds_read_b64_tr_b16 a[206:207], v58 offset:18560
v_mfma_f32_16x16x32_bf16 v[116:119], a[192:195], a[168:171], v[116:119]
v_rcp_f32 v42, v42
v_mfma_f32_16x16x32_bf16 v[116:119], a[196:199], a[172:175], v[116:119]
v_rcp_f32 v43, v43
v_mfma_f32_16x16x32_bf16 v[120:123], a[192:195], a[176:179], v[120:123]
v_mul_f32 v32, v32, v40
v_mul_f32 v33, v33, v41
v_mfma_f32_16x16x32_bf16 v[120:123], a[196:199], a[180:183], v[120:123]
v_mul_f32 v34, v34, v42
v_mul_f32 v35, v35, v43
v_mfma_f32_16x16x32_bf16 v[124:127], a[192:195], a[184:187], v[124:127]
ds_read_b64_tr_b16 a[208:209], v58 offset:136
ds_read_b64_tr_b16 a[210:211], v58 offset:6280
v_mfma_f32_16x16x32_bf16 v[124:127], a[196:199], a[188:191], v[124:127]
s_waitcnt lgkmcnt(4)
ds_read_b64_tr_b16 a[212:213], v58 offset:12424
ds_read_b64_tr_b16 a[214:215], v58 offset:18568
v_mfma_f32_16x16x32_bf16 v[128:131], a[200:203], a[160:163], v[128:131]
s_waitcnt lgkmcnt(4)
v_cvt_pk_bf16_f32 v44, v32, v33
v_cvt_pk_bf16_f32 v45, v34, v35
v_mfma_f32_16x16x32_bf16 v[128:131], a[204:207], a[164:167], v[128:131]
v_accvgpr_read_b32 v32, a16
v_accvgpr_read_b32 v33, a17
v_mfma_f32_16x16x32_bf16 v[132:135], a[200:203], a[168:171], v[132:135]
v_accvgpr_read_b32 v34, a18
v_accvgpr_read_b32 v35, a19
v_mfma_f32_16x16x32_bf16 v[132:135], a[204:207], a[172:175], v[132:135]
v_accvgpr_read_b32 v36, a64
v_accvgpr_read_b32 v37, a65
v_mfma_f32_16x16x32_bf16 v[136:139], a[200:203], a[176:179], v[136:139]
v_accvgpr_read_b32 v38, a66
v_accvgpr_read_b32 v39, a67
v_mfma_f32_16x16x32_bf16 v[136:139], a[204:207], a[180:183], v[136:139]
v_mul_f32 v40, s53, v32
v_mul_f32 v41, s53, v33
v_mfma_f32_16x16x32_bf16 v[140:143], a[200:203], a[184:187], v[140:143]
s_add_u32 s44, s44, 2048
v_mul_f32 v42, s53, v34
v_mul_f32 v43, s53, v35
v_mfma_f32_16x16x32_bf16 v[140:143], a[204:207], a[188:191], v[140:143]
s_waitcnt lgkmcnt(2)
v_exp_f32 v40, v40
v_mfma_f32_16x16x32_bf16 v[144:147], a[208:211], a[160:163], v[144:147]
s_waitcnt lgkmcnt(0)
ds_read_b64_tr_b16 a[192:193], v59 offset:128
ds_read_b64_tr_b16 a[194:195], v59 offset:6272
v_mfma_f32_16x16x32_bf16 v[144:147], a[212:215], a[164:167], v[144:147]
ds_read_b64_tr_b16 a[196:197], v59 offset:12416
ds_read_b64_tr_b16 a[198:199], v59 offset:18560
v_mfma_f32_16x16x32_bf16 v[148:151], a[208:211], a[168:171], v[148:151]
v_exp_f32 v41, v41
v_mfma_f32_16x16x32_bf16 v[148:151], a[212:215], a[172:175], v[148:151]
v_exp_f32 v42, v42
v_mfma_f32_16x16x32_bf16 v[152:155], a[208:211], a[176:179], v[152:155]
v_exp_f32 v43, v43
v_mfma_f32_16x16x32_bf16 v[152:155], a[212:215], a[180:183], v[152:155]
v_mul_f32 v32, v32, v36
v_mul_f32 v33, v33, v37
v_mfma_f32_16x16x32_bf16 v[156:159], a[208:211], a[184:187], v[156:159]
v_mul_f32 v34, v34, v38
v_mul_f32 v35, v35, v39
v_mfma_f32_16x16x32_bf16 v[156:159], a[212:215], a[188:191], v[156:159]
s_waitcnt lgkmcnt(2)
v_fma_f32 v40, v40, s54, s54
v_fma_f32 v41, v41, s54, s54
v_mfma_f32_16x16x32_bf16 v[160:163], a[192:195], a[160:163], v[160:163]
s_waitcnt lgkmcnt(0)
ds_read_b64_tr_b16 a[200:201], v59 offset:136
ds_read_b64_tr_b16 a[202:203], v59 offset:6280
v_mfma_f32_16x16x32_bf16 v[160:163], a[196:199], a[164:167], v[160:163]
ds_read_b64_tr_b16 a[204:205], v59 offset:12424
ds_read_b64_tr_b16 a[206:207], v59 offset:18568
v_mfma_f32_16x16x32_bf16 v[164:167], a[192:195], a[168:171], v[164:167]
v_fma_f32 v42, v42, s54, s54
v_fma_f32 v43, v43, s54, s54
v_mfma_f32_16x16x32_bf16 v[164:167], a[196:199], a[172:175], v[164:167]
v_rcp_f32 v40, v40
v_mfma_f32_16x16x32_bf16 v[168:171], a[192:195], a[176:179], v[168:171]
v_rcp_f32 v41, v41
v_mfma_f32_16x16x32_bf16 v[168:171], a[196:199], a[180:183], v[168:171]
v_rcp_f32 v42, v42
v_mfma_f32_16x16x32_bf16 v[172:175], a[192:195], a[184:187], v[172:175]
v_rcp_f32 v43, v43
v_mfma_f32_16x16x32_bf16 v[172:175], a[196:199], a[188:191], v[172:175]
s_waitcnt lgkmcnt(2)
v_mul_f32 v32, v32, v40
v_mul_f32 v33, v33, v41
v_mfma_f32_16x16x32_bf16 v[176:179], a[200:203], a[160:163], v[176:179]
s_waitcnt lgkmcnt(0)
ds_read_b64_tr_b16 a[208:209], v58 offset:256
ds_read_b64_tr_b16 a[210:211], v58 offset:6400
v_mfma_f32_16x16x32_bf16 v[176:179], a[204:207], a[164:167], v[176:179]
ds_read_b64_tr_b16 a[212:213], v58 offset:12544
ds_read_b64_tr_b16 a[214:215], v58 offset:18688
v_mfma_f32_16x16x32_bf16 v[180:183], a[200:203], a[168:171], v[180:183]
v_mul_f32 v34, v34, v42
v_mul_f32 v35, v35, v43
v_mfma_f32_16x16x32_bf16 v[180:183], a[204:207], a[172:175], v[180:183]
v_cvt_pk_bf16_f32 v46, v32, v33
v_cvt_pk_bf16_f32 v47, v34, v35
v_mfma_f32_16x16x32_bf16 v[184:187], a[200:203], a[176:179], v[184:187]
buffer_store_dwordx4 v[44:47], v57, s[32:35], s57 offen sc1
v_mfma_f32_16x16x32_bf16 v[184:187], a[204:207], a[180:183], v[184:187]
v_accvgpr_read_b32 v32, a32
v_accvgpr_read_b32 v33, a33
v_mfma_f32_16x16x32_bf16 v[188:191], a[200:203], a[184:187], v[188:191]
v_accvgpr_read_b32 v34, a34
v_accvgpr_read_b32 v35, a35
v_mfma_f32_16x16x32_bf16 v[188:191], a[204:207], a[188:191], v[188:191]
s_waitcnt lgkmcnt(2)
v_accvgpr_read_b32 v36, a80
v_accvgpr_read_b32 v37, a81
v_mfma_f32_16x16x32_bf16 v[192:195], a[208:211], a[160:163], v[192:195]
s_waitcnt lgkmcnt(0)
ds_read_b64_tr_b16 a[192:193], v58 offset:264
ds_read_b64_tr_b16 a[194:195], v58 offset:6408
v_mfma_f32_16x16x32_bf16 v[192:195], a[212:215], a[164:167], v[192:195]
ds_read_b64_tr_b16 a[196:197], v58 offset:12552
ds_read_b64_tr_b16 a[198:199], v58 offset:18696
v_mfma_f32_16x16x32_bf16 v[196:199], a[208:211], a[168:171], v[196:199]
v_accvgpr_read_b32 v38, a82
v_accvgpr_read_b32 v39, a83
v_mfma_f32_16x16x32_bf16 v[196:199], a[212:215], a[172:175], v[196:199]
v_mul_f32 v40, s53, v32
v_mul_f32 v41, s53, v33
v_mfma_f32_16x16x32_bf16 v[200:203], a[208:211], a[176:179], v[200:203]
v_mul_f32 v42, s53, v34
v_mul_f32 v43, s53, v35
v_mfma_f32_16x16x32_bf16 v[200:203], a[212:215], a[180:183], v[200:203]
v_exp_f32 v40, v40
v_mfma_f32_16x16x32_bf16 v[204:207], a[208:211], a[184:187], v[204:207]
v_exp_f32 v41, v41
v_mfma_f32_16x16x32_bf16 v[204:207], a[212:215], a[188:191], v[204:207]
s_waitcnt lgkmcnt(2)
v_exp_f32 v42, v42
v_mfma_f32_16x16x32_bf16 v[208:211], a[192:195], a[160:163], v[208:211]
s_waitcnt lgkmcnt(0)
ds_read_b64_tr_b16 a[200:201], v59 offset:256
ds_read_b64_tr_b16 a[202:203], v59 offset:6400
v_mfma_f32_16x16x32_bf16 v[208:211], a[196:199], a[164:167], v[208:211]
ds_read_b64_tr_b16 a[204:205], v59 offset:12544
ds_read_b64_tr_b16 a[206:207], v59 offset:18688
v_mfma_f32_16x16x32_bf16 v[212:215], a[192:195], a[168:171], v[212:215]
v_exp_f32 v43, v43
v_mfma_f32_16x16x32_bf16 v[212:215], a[196:199], a[172:175], v[212:215]
v_mul_f32 v32, v32, v36
v_mul_f32 v33, v33, v37
v_mfma_f32_16x16x32_bf16 v[216:219], a[192:195], a[176:179], v[216:219]
v_mul_f32 v34, v34, v38
v_mul_f32 v35, v35, v39
v_mfma_f32_16x16x32_bf16 v[216:219], a[196:199], a[180:183], v[216:219]
v_fma_f32 v40, v40, s54, s54
v_fma_f32 v41, v41, s54, s54
v_mfma_f32_16x16x32_bf16 v[220:223], a[192:195], a[184:187], v[220:223]
v_fma_f32 v42, v42, s54, s54
v_fma_f32 v43, v43, s54, s54
v_mfma_f32_16x16x32_bf16 v[220:223], a[196:199], a[188:191], v[220:223]
s_waitcnt lgkmcnt(2)
v_rcp_f32 v40, v40
v_mfma_f32_16x16x32_bf16 v[224:227], a[200:203], a[160:163], v[224:227]
s_waitcnt lgkmcnt(0)
ds_read_b64_tr_b16 a[208:209], v59 offset:264
ds_read_b64_tr_b16 a[210:211], v59 offset:6408
v_mfma_f32_16x16x32_bf16 v[224:227], a[204:207], a[164:167], v[224:227]
ds_read_b64_tr_b16 a[212:213], v59 offset:12552
ds_read_b64_tr_b16 a[214:215], v59 offset:18696
v_mfma_f32_16x16x32_bf16 v[228:231], a[200:203], a[168:171], v[228:231]
v_rcp_f32 v41, v41
v_mfma_f32_16x16x32_bf16 v[228:231], a[204:207], a[172:175], v[228:231]
v_rcp_f32 v42, v42
v_mfma_f32_16x16x32_bf16 v[232:235], a[200:203], a[176:179], v[232:235]
v_rcp_f32 v43, v43
v_mfma_f32_16x16x32_bf16 v[232:235], a[204:207], a[180:183], v[232:235]
v_mul_f32 v32, v32, v40
v_mul_f32 v33, v33, v41
v_mfma_f32_16x16x32_bf16 v[236:239], a[200:203], a[184:187], v[236:239]
v_mul_f32 v34, v34, v42
v_mul_f32 v35, v35, v43
v_mfma_f32_16x16x32_bf16 v[236:239], a[204:207], a[188:191], v[236:239]
s_waitcnt lgkmcnt(2)
v_cvt_pk_bf16_f32 v48, v32, v33
v_cvt_pk_bf16_f32 v49, v34, v35
v_mfma_f32_16x16x32_bf16 v[240:243], a[208:211], a[160:163], v[240:243]
s_waitcnt lgkmcnt(0)
ds_read_b64_tr_b16 a[192:193], v58 offset:36864
ds_read_b64_tr_b16 a[194:195], v58 offset:43008
v_mfma_f32_16x16x32_bf16 v[240:243], a[212:215], a[164:167], v[240:243]
ds_read_b64_tr_b16 a[196:197], v58 offset:49152
ds_read_b64_tr_b16 a[198:199], v58 offset:55296
v_mfma_f32_16x16x32_bf16 v[244:247], a[208:211], a[168:171], v[244:247]
buffer_store_dwordx2 v[48:49], v62, s[32:35], s58 offen sc1
s_add_u32 s57, s57, 49152
s_add_u32 s58, s58, 49152
v_mfma_f32_16x16x32_bf16 v[244:247], a[212:215], a[172:175], v[244:247]
v_accvgpr_read_b32 v32, a4
v_accvgpr_read_b32 v33, a5
v_mfma_f32_16x16x32_bf16 v[248:251], a[208:211], a[176:179], v[248:251]
v_accvgpr_read_b32 v34, a6
v_accvgpr_read_b32 v35, a7
v_mfma_f32_16x16x32_bf16 v[248:251], a[212:215], a[180:183], v[248:251]
v_accvgpr_read_b32 v36, a52
v_accvgpr_read_b32 v37, a53
v_mfma_f32_16x16x32_bf16 v[252:255], a[208:211], a[184:187], v[252:255]
v_accvgpr_read_b32 v38, a54
v_accvgpr_read_b32 v39, a55
v_mfma_f32_16x16x32_bf16 v[252:255], a[212:215], a[188:191], v[252:255]
s_waitcnt lgkmcnt(2)
v_mul_f32 v40, s53, v32
v_mul_f32 v41, s53, v33
v_mfma_f32_16x16x32_bf16 v[64:67], a[192:195], a[96:99], v[64:67]
s_waitcnt lgkmcnt(0)
ds_read_b64_tr_b16 a[200:201], v58 offset:36872
ds_read_b64_tr_b16 a[202:203], v58 offset:43016
v_mfma_f32_16x16x32_bf16 v[64:67], a[196:199], a[100:103], v[64:67]
ds_read_b64_tr_b16 a[204:205], v58 offset:49160
ds_read_b64_tr_b16 a[206:207], v58 offset:55304
v_mfma_f32_16x16x32_bf16 v[68:71], a[192:195], a[104:107], v[68:71]
s_barrier
v_mul_f32 v42, s53, v34
v_mul_f32 v43, s53, v35
v_mfma_f32_16x16x32_bf16 v[68:71], a[196:199], a[108:111], v[68:71]
s_add_u32 m0, s39, 0
v_exp_f32 v40, v40
v_mfma_f32_16x16x32_bf16 v[72:75], a[192:195], a[112:115], v[72:75]
v_exp_f32 v41, v41
v_mfma_f32_16x16x32_bf16 v[72:75], a[196:199], a[116:119], v[72:75]
v_exp_f32 v42, v42
v_mfma_f32_16x16x32_bf16 v[76:79], a[192:195], a[120:123], v[76:79]
v_exp_f32 v43, v43
v_mfma_f32_16x16x32_bf16 v[76:79], a[196:199], a[124:127], v[76:79]
s_waitcnt lgkmcnt(2)
buffer_load_dwordx4 v7, s[12:15], s41 offen offset:0 lds
v_mfma_f32_16x16x32_bf16 v[80:83], a[200:203], a[96:99], v[80:83]
s_waitcnt lgkmcnt(0)
ds_read_b64_tr_b16 a[208:209], v59 offset:36864
ds_read_b64_tr_b16 a[210:211], v59 offset:43008
v_mfma_f32_16x16x32_bf16 v[80:83], a[204:207], a[100:103], v[80:83]
ds_read_b64_tr_b16 a[212:213], v59 offset:49152
ds_read_b64_tr_b16 a[214:215], v59 offset:55296
v_mfma_f32_16x16x32_bf16 v[84:87], a[200:203], a[104:107], v[84:87]
v_mul_f32 v32, v32, v36
v_mul_f32 v33, v33, v37
v_mfma_f32_16x16x32_bf16 v[84:87], a[204:207], a[108:111], v[84:87]
buffer_load_dwordx4 v8, s[12:15], s41 offen offset:1024 lds
v_mfma_f32_16x16x32_bf16 v[88:91], a[200:203], a[112:115], v[88:91]
v_mul_f32 v34, v34, v38
v_mul_f32 v35, v35, v39
v_mfma_f32_16x16x32_bf16 v[88:91], a[204:207], a[116:119], v[88:91]
v_fma_f32 v40, v40, s54, s54
v_fma_f32 v41, v41, s54, s54
v_mfma_f32_16x16x32_bf16 v[92:95], a[200:203], a[120:123], v[92:95]
v_fma_f32 v42, v42, s54, s54
v_fma_f32 v43, v43, s54, s54
v_mfma_f32_16x16x32_bf16 v[92:95], a[204:207], a[124:127], v[92:95]
s_waitcnt lgkmcnt(2)
buffer_load_dwordx4 v9, s[12:15], s41 offen offset:2048 lds
s_add_u32 s41, s41, 12288
s_add_u32 m0, s39, 12288
v_mfma_f32_16x16x32_bf16 v[96:99], a[208:211], a[96:99], v[96:99]
s_waitcnt lgkmcnt(0)
ds_read_b64_tr_b16 a[192:193], v59 offset:36872
ds_read_b64_tr_b16 a[194:195], v59 offset:43016
v_mfma_f32_16x16x32_bf16 v[96:99], a[212:215], a[100:103], v[96:99]
ds_read_b64_tr_b16 a[196:197], v59 offset:49160
ds_read_b64_tr_b16 a[198:199], v59 offset:55304
v_mfma_f32_16x16x32_bf16 v[100:103], a[208:211], a[104:107], v[100:103]
v_rcp_f32 v40, v40
v_mfma_f32_16x16x32_bf16 v[100:103], a[212:215], a[108:111], v[100:103]
buffer_load_dwordx4 v7, s[12:15], s41 offen offset:0 lds
v_mfma_f32_16x16x32_bf16 v[104:107], a[208:211], a[112:115], v[104:107]
v_rcp_f32 v41, v41
v_mfma_f32_16x16x32_bf16 v[104:107], a[212:215], a[116:119], v[104:107]
v_cvt_pk_bf16_f32 v64, v64, v65
v_cvt_pk_bf16_f32 v65, v66, v67
v_mfma_f32_16x16x32_bf16 v[108:111], a[208:211], a[120:123], v[108:111]
v_cvt_pk_bf16_f32 v66, v80, v81
v_cvt_pk_bf16_f32 v67, v82, v83
v_mfma_f32_16x16x32_bf16 v[108:111], a[212:215], a[124:127], v[108:111]
s_waitcnt lgkmcnt(2)
buffer_load_dwordx4 v8, s[12:15], s41 offen offset:1024 lds
v_mfma_f32_16x16x32_bf16 v[112:115], a[192:195], a[96:99], v[112:115]
s_waitcnt lgkmcnt(0)
ds_read_b64_tr_b16 a[200:201], v58 offset:36992
ds_read_b64_tr_b16 a[202:203], v58 offset:43136
v_mfma_f32_16x16x32_bf16 v[112:115], a[196:199], a[100:103], v[112:115]
ds_read_b64_tr_b16 a[204:205], v58 offset:49280
ds_read_b64_tr_b16 a[206:207], v58 offset:55424
v_mfma_f32_16x16x32_bf16 v[116:119], a[192:195], a[104:107], v[116:119]
v_cvt_pk_bf16_f32 v68, v68, v69
v_cvt_pk_bf16_f32 v69, v70, v71
v_mfma_f32_16x16x32_bf16 v[116:119], a[196:199], a[108:111], v[116:119]
buffer_load_dwordx4 v9, s[12:15], s41 offen offset:2048 lds
s_add_u32 s41, s41, 12288
s_add_u32 m0, s39, 24576
v_mfma_f32_16x16x32_bf16 v[120:123], a[192:195], a[112:115], v[120:123]
v_cvt_pk_bf16_f32 v70, v84, v85
v_cvt_pk_bf16_f32 v71, v86, v87
v_mfma_f32_16x16x32_bf16 v[120:123], a[196:199], a[116:119], v[120:123]
v_cvt_pk_bf16_f32 v72, v72, v73
v_cvt_pk_bf16_f32 v73, v74, v75
v_mfma_f32_16x16x32_bf16 v[124:127], a[192:195], a[120:123], v[124:127]
v_cvt_pk_bf16_f32 v74, v88, v89
v_cvt_pk_bf16_f32 v75, v90, v91
v_mfma_f32_16x16x32_bf16 v[124:127], a[196:199], a[124:127], v[124:127]
s_waitcnt lgkmcnt(2)
buffer_load_dwordx4 v7, s[12:15], s41 offen offset:0 lds
v_mfma_f32_16x16x32_bf16 v[128:131], a[200:203], a[96:99], v[128:131]
s_waitcnt lgkmcnt(0)
ds_read_b64_tr_b16 a[208:209], v58 offset:37000
ds_read_b64_tr_b16 a[210:211], v58 offset:43144
v_mfma_f32_16x16x32_bf16 v[128:131], a[204:207], a[100:103], v[128:131]
ds_read_b64_tr_b16 a[212:213], v58 offset:49288
ds_read_b64_tr_b16 a[214:215], v58 offset:55432
v_mfma_f32_16x16x32_bf16 v[132:135], a[200:203], a[104:107], v[132:135]
v_cvt_pk_bf16_f32 v76, v76, v77
v_cvt_pk_bf16_f32 v77, v78, v79
v_mfma_f32_16x16x32_bf16 v[132:135], a[204:207], a[108:111], v[132:135]
buffer_load_dwordx4 v8, s[12:15], s41 offen offset:1024 lds
v_mfma_f32_16x16x32_bf16 v[136:139], a[200:203], a[112:115], v[136:139]
v_cvt_pk_bf16_f32 v78, v92, v93
v_cvt_pk_bf16_f32 v79, v94, v95
v_mfma_f32_16x16x32_bf16 v[136:139], a[204:207], a[116:119], v[136:139]
v_cvt_pk_bf16_f32 v80, v96, v97
v_cvt_pk_bf16_f32 v81, v98, v99
v_mfma_f32_16x16x32_bf16 v[140:143], a[200:203], a[120:123], v[140:143]
v_cvt_pk_bf16_f32 v82, v112, v113
v_cvt_pk_bf16_f32 v83, v114, v115
v_mfma_f32_16x16x32_bf16 v[140:143], a[204:207], a[124:127], v[140:143]
s_waitcnt lgkmcnt(2)
buffer_load_dwordx4 v9, s[12:15], s41 offen offset:2048 lds
s_add_u32 s41, s41, 12288
v_mfma_f32_16x16x32_bf16 v[144:147], a[208:211], a[96:99], v[144:147]
s_waitcnt lgkmcnt(0)
ds_read_b64_tr_b16 a[192:193], v59 offset:36992
ds_read_b64_tr_b16 a[194:195], v59 offset:43136
v_mfma_f32_16x16x32_bf16 v[144:147], a[212:215], a[100:103], v[144:147]
ds_read_b64_tr_b16 a[196:197], v59 offset:49280
ds_read_b64_tr_b16 a[198:199], v59 offset:55424
v_mfma_f32_16x16x32_bf16 v[148:151], a[208:211], a[104:107], v[148:151]
v_cvt_pk_bf16_f32 v84, v100, v101
v_cvt_pk_bf16_f32 v85, v102, v103
v_mfma_f32_16x16x32_bf16 v[148:151], a[212:215], a[108:111], v[148:151]
v_cvt_pk_bf16_f32 v86, v116, v117
v_cvt_pk_bf16_f32 v87, v118, v119
v_mfma_f32_16x16x32_bf16 v[152:155], a[208:211], a[112:115], v[152:155]
v_cvt_pk_bf16_f32 v88, v104, v105
v_cvt_pk_bf16_f32 v89, v106, v107
v_mfma_f32_16x16x32_bf16 v[152:155], a[212:215], a[116:119], v[152:155]
v_cvt_pk_bf16_f32 v90, v120, v121
v_cvt_pk_bf16_f32 v91, v122, v123
v_mfma_f32_16x16x32_bf16 v[156:159], a[208:211], a[120:123], v[156:159]
v_cvt_pk_bf16_f32 v92, v108, v109
v_cvt_pk_bf16_f32 v93, v110, v111
v_mfma_f32_16x16x32_bf16 v[156:159], a[212:215], a[124:127], v[156:159]
s_waitcnt lgkmcnt(2)
v_cvt_pk_bf16_f32 v94, v124, v125
v_cvt_pk_bf16_f32 v95, v126, v127
v_mfma_f32_16x16x32_bf16 v[160:163], a[192:195], a[96:99], v[160:163]
s_waitcnt lgkmcnt(0)
ds_read_b64_tr_b16 a[200:201], v59 offset:37000
ds_read_b64_tr_b16 a[202:203], v59 offset:43144
v_mfma_f32_16x16x32_bf16 v[160:163], a[196:199], a[100:103], v[160:163]
ds_read_b64_tr_b16 a[204:205], v59 offset:49288
ds_read_b64_tr_b16 a[206:207], v59 offset:55432
v_mfma_f32_16x16x32_bf16 v[164:167], a[192:195], a[104:107], v[164:167]
v_rcp_f32 v42, v42
v_mfma_f32_16x16x32_bf16 v[164:167], a[196:199], a[108:111], v[164:167]
v_rcp_f32 v43, v43
v_mfma_f32_16x16x32_bf16 v[168:171], a[192:195], a[112:115], v[168:171]
v_mul_f32 v32, v32, v40
v_mul_f32 v33, v33, v41
v_mfma_f32_16x16x32_bf16 v[168:171], a[196:199], a[116:119], v[168:171]
v_cvt_pk_bf16_f32 v96, v128, v129
v_cvt_pk_bf16_f32 v97, v130, v131
v_mfma_f32_16x16x32_bf16 v[172:175], a[192:195], a[120:123], v[172:175]
v_cvt_pk_bf16_f32 v98, v144, v145
v_cvt_pk_bf16_f32 v99, v146, v147
v_mfma_f32_16x16x32_bf16 v[172:175], a[196:199], a[124:127], v[172:175]
s_waitcnt lgkmcnt(2)
v_cvt_pk_bf16_f32 v100, v132, v133
v_cvt_pk_bf16_f32 v101, v134, v135
v_mfma_f32_16x16x32_bf16 v[176:179], a[200:203], a[96:99], v[176:179]
s_waitcnt lgkmcnt(0)
ds_read_b64_tr_b16 a[208:209], v58 offset:37120
ds_read_b64_tr_b16 a[210:211], v58 offset:43264
v_mfma_f32_16x16x32_bf16 v[176:179], a[204:207], a[100:103], v[176:179]
ds_read_b64_tr_b16 a[212:213], v58 offset:49408
ds_read_b64_tr_b16 a[214:215], v58 offset:55552
v_mfma_f32_16x16x32_bf16 v[180:183], a[200:203], a[104:107], v[180:183]
v_cvt_pk_bf16_f32 v102, v148, v149
v_cvt_pk_bf16_f32 v103, v150, v151
v_mfma_f32_16x16x32_bf16 v[180:183], a[204:207], a[108:111], v[180:183]
v_cvt_pk_bf16_f32 v104, v136, v137
v_cvt_pk_bf16_f32 v105, v138, v139
v_mfma_f32_16x16x32_bf16 v[184:187], a[200:203], a[112:115], v[184:187]
v_cvt_pk_bf16_f32 v106, v152, v153
v_cvt_pk_bf16_f32 v107, v154, v155
v_mfma_f32_16x16x32_bf16 v[184:187], a[204:207], a[116:119], v[184:187]
v_cvt_pk_bf16_f32 v108, v140, v141
v_cvt_pk_bf16_f32 v109, v142, v143
v_mfma_f32_16x16x32_bf16 v[188:191], a[200:203], a[120:123], v[188:191]
v_cvt_pk_bf16_f32 v110, v156, v157
v_cvt_pk_bf16_f32 v111, v158, v159
v_mfma_f32_16x16x32_bf16 v[188:191], a[204:207], a[124:127], v[188:191]
s_waitcnt lgkmcnt(2)
v_mul_f32 v34, v34, v42
v_mul_f32 v35, v35, v43
v_mfma_f32_16x16x32_bf16 v[192:195], a[208:211], a[96:99], v[192:195]
s_waitcnt lgkmcnt(0)
ds_read_b64_tr_b16 a[192:193], v58 offset:37128
ds_read_b64_tr_b16 a[194:195], v58 offset:43272
v_mfma_f32_16x16x32_bf16 v[192:195], a[212:215], a[100:103], v[192:195]
ds_read_b64_tr_b16 a[196:197], v58 offset:49416
ds_read_b64_tr_b16 a[198:199], v58 offset:55560
v_mfma_f32_16x16x32_bf16 v[196:199], a[208:211], a[104:107], v[196:199]
v_cvt_pk_bf16_f32 v50, v32, v33
v_cvt_pk_bf16_f32 v51, v34, v35
v_mfma_f32_16x16x32_bf16 v[196:199], a[212:215], a[108:111], v[196:199]
v_accvgpr_read_b32 v32, a20
v_accvgpr_read_b32 v33, a21
v_mfma_f32_16x16x32_bf16 v[200:203], a[208:211], a[112:115], v[200:203]
v_accvgpr_read_b32 v34, a22
v_accvgpr_read_b32 v35, a23
v_mfma_f32_16x16x32_bf16 v[200:203], a[212:215], a[116:119], v[200:203]
v_cvt_pk_bf16_f32 v112, v160, v161
v_cvt_pk_bf16_f32 v113, v162, v163
v_mfma_f32_16x16x32_bf16 v[204:207], a[208:211], a[120:123], v[204:207]
v_cvt_pk_bf16_f32 v114, v176, v177
v_cvt_pk_bf16_f32 v115, v178, v179
v_mfma_f32_16x16x32_bf16 v[204:207], a[212:215], a[124:127], v[204:207]
s_waitcnt lgkmcnt(2)
v_cvt_pk_bf16_f32 v116, v164, v165
v_cvt_pk_bf16_f32 v117, v166, v167
v_mfma_f32_16x16x32_bf16 v[208:211], a[192:195], a[96:99], v[208:211]
s_waitcnt lgkmcnt(0)
ds_read_b64_tr_b16 a[200:201], v59 offset:37120
ds_read_b64_tr_b16 a[202:203], v59 offset:43264
v_mfma_f32_16x16x32_bf16 v[208:211], a[196:199], a[100:103], v[208:211]
ds_read_b64_tr_b16 a[204:205], v59 offset:49408
ds_read_b64_tr_b16 a[206:207], v59 offset:55552
v_mfma_f32_16x16x32_bf16 v[212:215], a[192:195], a[104:107], v[212:215]
v_cvt_pk_bf16_f32 v118, v180, v181
v_cvt_pk_bf16_f32 v119, v182, v183
v_mfma_f32_16x16x32_bf16 v[212:215], a[196:199], a[108:111], v[212:215]
v_cvt_pk_bf16_f32 v120, v168, v169
v_cvt_pk_bf16_f32 v121, v170, v171
v_mfma_f32_16x16x32_bf16 v[216:219], a[192:195], a[112:115], v[216:219]
v_cvt_pk_bf16_f32 v122, v184, v185
v_cvt_pk_bf16_f32 v123, v186, v187
v_mfma_f32_16x16x32_bf16 v[216:219], a[196:199], a[116:119], v[216:219]
v_accvgpr_write_b32 a216, v120
v_accvgpr_write_b32 a217, v121
v_mfma_f32_16x16x32_bf16 v[220:223], a[192:195], a[120:123], v[220:223]
ds_read_b64_tr_b16 a[208:209], v59 offset:37128
ds_read_b64_tr_b16 a[210:211], v59 offset:43272
v_mfma_f32_16x16x32_bf16 v[220:223], a[196:199], a[124:127], v[220:223]
s_waitcnt lgkmcnt(4)
ds_read_b64_tr_b16 a[212:213], v59 offset:49416
ds_read_b64_tr_b16 a[214:215], v59 offset:55560
v_mfma_f32_16x16x32_bf16 v[224:227], a[200:203], a[96:99], v[224:227]
s_waitcnt lgkmcnt(4)
v_accvgpr_write_b32 a218, v122
v_accvgpr_write_b32 a219, v123
v_mfma_f32_16x16x32_bf16 v[224:227], a[204:207], a[100:103], v[224:227]
v_cvt_pk_bf16_f32 v124, v172, v173
v_cvt_pk_bf16_f32 v125, v174, v175
v_mfma_f32_16x16x32_bf16 v[228:231], a[200:203], a[104:107], v[228:231]
v_cvt_pk_bf16_f32 v126, v188, v189
v_cvt_pk_bf16_f32 v127, v190, v191
v_mfma_f32_16x16x32_bf16 v[228:231], a[204:207], a[108:111], v[228:231]
v_accvgpr_write_b32 a220, v124
v_accvgpr_write_b32 a221, v125
v_mfma_f32_16x16x32_bf16 v[232:235], a[200:203], a[112:115], v[232:235]
v_accvgpr_write_b32 a222, v126
v_accvgpr_write_b32 a223, v127
v_mfma_f32_16x16x32_bf16 v[232:235], a[204:207], a[116:119], v[232:235]
v_cvt_pk_bf16_f32 v128, v192, v193
v_cvt_pk_bf16_f32 v129, v194, v195
v_mfma_f32_16x16x32_bf16 v[236:239], a[200:203], a[120:123], v[236:239]
s_add_u32 s44, s44, 2048
v_cvt_pk_bf16_f32 v130, v208, v209
v_cvt_pk_bf16_f32 v131, v210, v211
v_mfma_f32_16x16x32_bf16 v[236:239], a[204:207], a[124:127], v[236:239]
s_waitcnt lgkmcnt(2)
v_accvgpr_write_b32 a224, v128
v_accvgpr_write_b32 a225, v129
v_mfma_f32_16x16x32_bf16 v[240:243], a[208:211], a[96:99], v[240:243]
s_waitcnt lgkmcnt(0)
v_accvgpr_write_b32 a226, v130
v_accvgpr_write_b32 a227, v131
v_mfma_f32_16x16x32_bf16 v[240:243], a[212:215], a[100:103], v[240:243]
v_cvt_pk_bf16_f32 v132, v196, v197
v_cvt_pk_bf16_f32 v133, v198, v199
v_mfma_f32_16x16x32_bf16 v[244:247], a[208:211], a[104:107], v[244:247]
v_cvt_pk_bf16_f32 v134, v212, v213
v_cvt_pk_bf16_f32 v135, v214, v215
v_mfma_f32_16x16x32_bf16 v[244:247], a[212:215], a[108:111], v[244:247]
v_accvgpr_write_b32 a228, v132
v_accvgpr_write_b32 a229, v133
v_mfma_f32_16x16x32_bf16 v[248:251], a[208:211], a[112:115], v[248:251]
v_accvgpr_write_b32 a230, v134
v_accvgpr_write_b32 a231, v135
v_mfma_f32_16x16x32_bf16 v[248:251], a[212:215], a[116:119], v[248:251]
v_cvt_pk_bf16_f32 v136, v200, v201
v_cvt_pk_bf16_f32 v137, v202, v203
v_mfma_f32_16x16x32_bf16 v[252:255], a[208:211], a[120:123], v[252:255]
v_cvt_pk_bf16_f32 v138, v216, v217
v_cvt_pk_bf16_f32 v139, v218, v219
v_mfma_f32_16x16x32_bf16 v[252:255], a[212:215], a[124:127], v[252:255]
v_accvgpr_write_b32 a232, v136
v_accvgpr_write_b32 a233, v137
s_barrier
s_mov_b32 s24, s45
s_add_u32 m0, s39, 36864
s_nop 0
buffer_load_dwordx4 v7, s[12:15], s41 offen offset:0 lds
buffer_load_dwordx4 v8, s[12:15], s41 offen offset:1024 lds
buffer_load_dwordx4 v9, s[12:15], s41 offen offset:2048 lds
s_add_u32 s41, s41, 12288
v_and_b32 v61, 7, v2
v_lshlrev_b32 v56, 5, v61
global_load_dword v63, v56, s[6:7] sc1
v_accvgpr_read_b32 v36, a68
v_accvgpr_read_b32 v37, a69
v_accvgpr_read_b32 v38, a70
v_accvgpr_read_b32 v39, a71
v_mul_f32 v40, s53, v32
v_mul_f32 v41, s53, v33
v_mul_f32 v42, s53, v34
v_mul_f32 v43, s53, v35
v_exp_f32 v40, v40
v_exp_f32 v41, v41
v_exp_f32 v42, v42
v_exp_f32 v43, v43
v_mul_f32 v32, v32, v36
v_mul_f32 v33, v33, v37
v_mul_f32 v34, v34, v38
v_mul_f32 v35, v35, v39
v_fma_f32 v40, v40, s54, s54
v_fma_f32 v41, v41, s54, s54
v_fma_f32 v42, v42, s54, s54
v_fma_f32 v43, v43, s54, s54
v_rcp_f32 v40, v40
v_rcp_f32 v41, v41
v_rcp_f32 v42, v42
v_rcp_f32 v43, v43
v_mul_f32 v32, v32, v40
v_mul_f32 v33, v33, v41
v_mul_f32 v34, v34, v42
v_mul_f32 v35, v35, v43
v_cvt_pk_bf16_f32 v52, v32, v33
v_cvt_pk_bf16_f32 v53, v34, v35
buffer_store_dwordx4 v[50:53], v57, s[32:35], s57 offen sc1
v_accvgpr_write_b32 a234, v138
v_accvgpr_write_b32 a235, v139
v_cvt_pk_bf16_f32 v140, v204, v205
v_cvt_pk_bf16_f32 v141, v206, v207
v_cvt_pk_bf16_f32 v142, v220, v221
v_cvt_pk_bf16_f32 v143, v222, v223
v_accvgpr_write_b32 a236, v140
v_accvgpr_write_b32 a237, v141
v_accvgpr_write_b32 a238, v142
v_accvgpr_write_b32 a239, v143
v_accvgpr_read_b32 v32, a36
v_accvgpr_read_b32 v33, a37
v_accvgpr_read_b32 v34, a38
v_accvgpr_read_b32 v35, a39
v_accvgpr_read_b32 v36, a84
v_accvgpr_read_b32 v37, a85
v_accvgpr_read_b32 v38, a86
v_accvgpr_read_b32 v39, a87
v_pk_mul_f32 v[40:41], v[32:33], s[52:53] op_sel:[0,1] op_sel_hi:[1,1]
v_pk_mul_f32 v[42:43], v[34:35], s[52:53] op_sel:[0,1] op_sel_hi:[1,1]
v_exp_f32 v40, v40
v_exp_f32 v41, v41
v_exp_f32 v42, v42
v_exp_f32 v43, v43
v_pk_mul_f32 v[32:33], v[32:33], v[36:37]
v_pk_mul_f32 v[34:35], v[34:35], v[38:39]
v_pk_fma_f32 v[40:41], v[40:41], s[54:55], s[54:55] op_sel_hi:[1,0,0]
v_pk_fma_f32 v[42:43], v[42:43], s[54:55], s[54:55] op_sel_hi:[1,0,0]
v_rcp_f32 v40, v40
v_rcp_f32 v41, v41
v_rcp_f32 v42, v42
v_rcp_f32 v43, v43
s_nop 0
v_pk_mul_f32 v[32:33], v[32:33], v[40:41]
v_pk_mul_f32 v[34:35], v[34:35], v[42:43]
v_cvt_pk_bf16_f32 v54, v32, v33
v_cvt_pk_bf16_f32 v55, v34, v35
buffer_store_dwordx2 v[54:55], v62, s[32:35], s58 offen sc1
s_add_u32 s57, s57, 49152
s_add_u32 s58, s58, 49152
v_accvgpr_read_b32 v32, a8
v_accvgpr_read_b32 v33, a9
v_accvgpr_read_b32 v34, a10
v_accvgpr_read_b32 v35, a11
v_accvgpr_read_b32 v36, a56
v_accvgpr_read_b32 v37, a57
v_accvgpr_read_b32 v38, a58
v_accvgpr_read_b32 v39, a59
v_pk_mul_f32 v[40:41], v[32:33], s[52:53] op_sel:[0,1] op_sel_hi:[1,1]
v_pk_mul_f32 v[42:43], v[34:35], s[52:53] op_sel:[0,1] op_sel_hi:[1,1]
v_exp_f32 v40, v40
v_exp_f32 v41, v41
v_exp_f32 v42, v42
v_exp_f32 v43, v43
v_pk_mul_f32 v[32:33], v[32:33], v[36:37]
v_pk_mul_f32 v[34:35], v[34:35], v[38:39]
v_pk_fma_f32 v[40:41], v[40:41], s[54:55], s[54:55] op_sel_hi:[1,0,0]
v_pk_fma_f32 v[42:43], v[42:43], s[54:55], s[54:55] op_sel_hi:[1,0,0]
v_rcp_f32 v40, v40
v_rcp_f32 v41, v41
v_rcp_f32 v42, v42
v_rcp_f32 v43, v43
s_nop 0
v_pk_mul_f32 v[32:33], v[32:33], v[40:41]
v_pk_mul_f32 v[34:35], v[34:35], v[42:43]
v_cvt_pk_bf16_f32 v44, v32, v33
v_cvt_pk_bf16_f32 v45, v34, v35
v_accvgpr_read_b32 v32, a24
v_accvgpr_read_b32 v33, a25
v_accvgpr_read_b32 v34, a26
v_accvgpr_read_b32 v35, a27
v_accvgpr_read_b32 v36, a72
v_accvgpr_read_b32 v37, a73
v_accvgpr_read_b32 v38, a74
v_accvgpr_read_b32 v39, a75
v_pk_mul_f32 v[40:41], v[32:33], s[52:53] op_sel:[0,1] op_sel_hi:[1,1]
v_pk_mul_f32 v[42:43], v[34:35], s[52:53] op_sel:[0,1] op_sel_hi:[1,1]
v_exp_f32 v40, v40
v_exp_f32 v41, v41
v_exp_f32 v42, v42
v_exp_f32 v43, v43
v_pk_mul_f32 v[32:33], v[32:33], v[36:37]
v_pk_mul_f32 v[34:35], v[34:35], v[38:39]
v_pk_fma_f32 v[40:41], v[40:41], s[54:55], s[54:55] op_sel_hi:[1,0,0]
v_pk_fma_f32 v[42:43], v[42:43], s[54:55], s[54:55] op_sel_hi:[1,0,0]
v_rcp_f32 v40, v40
v_rcp_f32 v41, v41
v_rcp_f32 v42, v42
v_rcp_f32 v43, v43
s_nop 0
v_pk_mul_f32 v[32:33], v[32:33], v[40:41]
v_pk_mul_f32 v[34:35], v[34:35], v[42:43]
v_cvt_pk_bf16_f32 v46, v32, v33
v_cvt_pk_bf16_f32 v47, v34, v35
buffer_store_dwordx4 v[44:47], v57, s[32:35], s57 offen sc1
v_accvgpr_read_b32 v32, a40
v_accvgpr_read_b32 v33, a41
v_accvgpr_read_b32 v34, a42
v_accvgpr_read_b32 v35, a43
v_accvgpr_read_b32 v36, a88
v_accvgpr_read_b32 v37, a89
v_accvgpr_read_b32 v38, a90
v_accvgpr_read_b32 v39, a91
v_pk_mul_f32 v[40:41], v[32:33], s[52:53] op_sel:[0,1] op_sel_hi:[1,1]
v_pk_mul_f32 v[42:43], v[34:35], s[52:53] op_sel:[0,1] op_sel_hi:[1,1]
v_exp_f32 v40, v40
v_exp_f32 v41, v41
v_exp_f32 v42, v42
v_exp_f32 v43, v43
v_pk_mul_f32 v[32:33], v[32:33], v[36:37]
v_pk_mul_f32 v[34:35], v[34:35], v[38:39]
v_pk_fma_f32 v[40:41], v[40:41], s[54:55], s[54:55] op_sel_hi:[1,0,0]
v_pk_fma_f32 v[42:43], v[42:43], s[54:55], s[54:55] op_sel_hi:[1,0,0]
v_rcp_f32 v40, v40
v_rcp_f32 v41, v41
v_rcp_f32 v42, v42
v_rcp_f32 v43, v43
s_nop 0
v_pk_mul_f32 v[32:33], v[32:33], v[40:41]
v_pk_mul_f32 v[34:35], v[34:35], v[42:43]
v_cvt_pk_bf16_f32 v48, v32, v33
v_cvt_pk_bf16_f32 v49, v34, v35
buffer_store_dwordx2 v[48:49], v62, s[32:35], s58 offen sc1
s_add_u32 s57, s57, 49152
s_add_u32 s58, s58, 49152
v_accvgpr_read_b32 v32, a12
v_accvgpr_read_b32 v33, a13
v_accvgpr_read_b32 v34, a14
v_accvgpr_read_b32 v35, a15
v_accvgpr_read_b32 v36, a60
v_accvgpr_read_b32 v37, a61
v_accvgpr_read_b32 v38, a62
v_accvgpr_read_b32 v39, a63
v_pk_mul_f32 v[40:41], v[32:33], s[52:53] op_sel:[0,1] op_sel_hi:[1,1]
v_pk_mul_f32 v[42:43], v[34:35], s[52:53] op_sel:[0,1] op_sel_hi:[1,1]
v_exp_f32 v40, v40
v_exp_f32 v41, v41
v_exp_f32 v42, v42
v_exp_f32 v43, v43
v_pk_mul_f32 v[32:33], v[32:33], v[36:37]
v_pk_mul_f32 v[34:35], v[34:35], v[38:39]
v_pk_fma_f32 v[40:41], v[40:41], s[54:55], s[54:55] op_sel_hi:[1,0,0]
v_pk_fma_f32 v[42:43], v[42:43], s[54:55], s[54:55] op_sel_hi:[1,0,0]
v_rcp_f32 v40, v40
v_rcp_f32 v41, v41
v_rcp_f32 v42, v42
v_rcp_f32 v43, v43
s_nop 0
v_pk_mul_f32 v[32:33], v[32:33], v[40:41]
v_pk_mul_f32 v[34:35], v[34:35], v[42:43]
v_cvt_pk_bf16_f32 v50, v32, v33
v_cvt_pk_bf16_f32 v51, v34, v35
v_accvgpr_read_b32 v32, a28
v_accvgpr_read_b32 v33, a29
v_accvgpr_read_b32 v34, a30
v_accvgpr_read_b32 v35, a31
v_accvgpr_read_b32 v36, a76
v_accvgpr_read_b32 v37, a77
v_accvgpr_read_b32 v38, a78
v_accvgpr_read_b32 v39, a79
v_pk_mul_f32 v[40:41], v[32:33], s[52:53] op_sel:[0,1] op_sel_hi:[1,1]
v_pk_mul_f32 v[42:43], v[34:35], s[52:53] op_sel:[0,1] op_sel_hi:[1,1]
v_exp_f32 v40, v40
v_exp_f32 v41, v41
v_exp_f32 v42, v42
v_exp_f32 v43, v43
v_pk_mul_f32 v[32:33], v[32:33], v[36:37]
v_pk_mul_f32 v[34:35], v[34:35], v[38:39]
v_pk_fma_f32 v[40:41], v[40:41], s[54:55], s[54:55] op_sel_hi:[1,0,0]
v_pk_fma_f32 v[42:43], v[42:43], s[54:55], s[54:55] op_sel_hi:[1,0,0]
v_rcp_f32 v40, v40
v_rcp_f32 v41, v41
v_rcp_f32 v42, v42
v_rcp_f32 v43, v43
s_nop 0
v_pk_mul_f32 v[32:33], v[32:33], v[40:41]
v_pk_mul_f32 v[34:35], v[34:35], v[42:43]
v_cvt_pk_bf16_f32 v52, v32, v33
v_cvt_pk_bf16_f32 v53, v34, v35
buffer_store_dwordx4 v[50:53], v57, s[32:35], s57 offen sc1
v_accvgpr_read_b32 v32, a44
v_accvgpr_read_b32 v33, a45
v_accvgpr_read_b32 v34, a46
v_accvgpr_read_b32 v35, a47
v_accvgpr_read_b32 v36, a92
v_accvgpr_read_b32 v37, a93
v_accvgpr_read_b32 v38, a94
v_accvgpr_read_b32 v39, a95
v_pk_mul_f32 v[40:41], v[32:33], s[52:53] op_sel:[0,1] op_sel_hi:[1,1]
v_pk_mul_f32 v[42:43], v[34:35], s[52:53] op_sel:[0,1] op_sel_hi:[1,1]
v_exp_f32 v40, v40
v_exp_f32 v41, v41
v_exp_f32 v42, v42
v_exp_f32 v43, v43
v_pk_mul_f32 v[32:33], v[32:33], v[36:37]
v_pk_mul_f32 v[34:35], v[34:35], v[38:39]
v_pk_fma_f32 v[40:41], v[40:41], s[54:55], s[54:55] op_sel_hi:[1,0,0]
v_pk_fma_f32 v[42:43], v[42:43], s[54:55], s[54:55] op_sel_hi:[1,0,0]
v_rcp_f32 v40, v40
v_rcp_f32 v41, v41
v_rcp_f32 v42, v42
v_rcp_f32 v43, v43
s_nop 0
v_pk_mul_f32 v[32:33], v[32:33], v[40:41]
v_pk_mul_f32 v[34:35], v[34:35], v[42:43]
v_cvt_pk_bf16_f32 v54, v32, v33
v_cvt_pk_bf16_f32 v55, v34, v35
buffer_store_dwordx2 v[54:55], v62, s[32:35], s58 offen sc1
v_cvt_pk_bf16_f32 v144, v224, v225
v_cvt_pk_bf16_f32 v145, v226, v227
v_cvt_pk_bf16_f32 v146, v240, v241
v_cvt_pk_bf16_f32 v147, v242, v243
v_accvgpr_write_b32 a240, v144
v_accvgpr_write_b32 a241, v145
v_accvgpr_write_b32 a242, v146
v_accvgpr_write_b32 a243, v147
v_cvt_pk_bf16_f32 v148, v228, v229
v_cvt_pk_bf16_f32 v149, v230, v231
v_cvt_pk_bf16_f32 v150, v244, v245
v_cvt_pk_bf16_f32 v151, v246, v247
v_accvgpr_write_b32 a244, v148
v_accvgpr_write_b32 a245, v149
v_accvgpr_write_b32 a246, v150
v_accvgpr_write_b32 a247, v151
v_cvt_pk_bf16_f32 v152, v232, v233
v_cvt_pk_bf16_f32 v153, v234, v235
v_cvt_pk_bf16_f32 v154, v248, v249
v_cvt_pk_bf16_f32 v155, v250, v251
v_accvgpr_write_b32 a248, v152
v_accvgpr_write_b32 a249, v153
v_accvgpr_write_b32 a250, v154
v_accvgpr_write_b32 a251, v155
v_cvt_pk_bf16_f32 v156, v236, v237
v_cvt_pk_bf16_f32 v157, v238, v239
v_cvt_pk_bf16_f32 v158, v252, v253
v_cvt_pk_bf16_f32 v159, v254, v255
v_accvgpr_write_b32 a252, v156
v_accvgpr_write_b32 a253, v157
v_accvgpr_write_b32 a254, v158
v_accvgpr_write_b32 a255, v159
v_mov_b32 v10, v62
v_and_b32 v62, 7, v2
v_mov_b32 v32, 0
v_mov_b32 v33, 0
v_mov_b32 v34, 0
v_mov_b32 v35, 0
s_waitcnt vmcnt(41)
s_barrier
ds_read_b128 a[192:195], v16 offset:0
ds_read_b128 a[196:199], v17 offset:0
s_waitcnt lgkmcnt(1)
v_mfma_f32_16x16x32_bf16 v[120:123], a[192:195], v[64:67], 0
s_waitcnt lgkmcnt(0)
ds_read_b128 a[200:203], v16 offset:128
s_lshr_b32 s44, s2, 3
s_lshl_b32 s44, s44, 2
v_mfma_f32_16x16x32_bf16 v[120:123], a[196:199], v[80:83], v[120:123]
ds_read_b128 a[204:207], v17 offset:128
s_add_u32 s44, s44, s38
s_lshl_b32 s26, s44, 10
v_mfma_f32_16x16x32_bf16 v[124:127], a[192:195], v[68:71], 0
s_mul_i32 s44, s44, 7680
s_lshl_b32 s42, s2, 2
v_mfma_f32_16x16x32_bf16 v[124:127], a[196:199], v[84:87], v[124:127]
s_add_u32 s42, s42, s38
s_mul_i32 s42, s42, 1920
v_mfma_f32_16x16x32_bf16 v[128:131], a[192:195], v[72:75], 0
s_lshl_b32 s43, s38, 10
s_add_u32 s43, s43, 147456
v_add_u32 v58, s3, v57
v_mfma_f32_16x16x32_bf16 v[128:131], a[196:199], v[88:91], v[128:131]
v_add_u32 v59, 196608, v58
v_add_u32 v60, s100, v57
v_mfma_f32_16x16x32_bf16 v[132:135], a[192:195], v[76:79], 0
v_add_u32 v61, 49152, v60
v_add_u32 v11, s100, v10
v_mfma_f32_16x16x32_bf16 v[132:135], a[196:199], v[92:95], v[132:135]
s_waitcnt lgkmcnt(1)
v_add_u32 v18, 49152, v11
v_lshlrev_b32 v62, 2, v62
v_mfma_f32_16x16x32_bf16 v[120:123], a[200:203], v[96:99], v[120:123]
s_waitcnt lgkmcnt(0)
ds_read_b128 a[208:211], v16 offset:256
v_add_u32 v19, s26, v57
v_mfma_f32_16x16x32_bf16 v[120:123], a[204:207], v[112:115], v[120:123]
ds_read_b128 a[212:215], v17 offset:256
v_min_u32 v19, L_code_end-L_tail0-16, v19
v_mfma_f32_16x16x32_bf16 v[124:127], a[200:203], v[100:103], v[124:127]
v_add_u32 v19, L_tail0-L_pc1, v19
v_and_b32 v28, 15, v2
v_mfma_f32_16x16x32_bf16 v[124:127], a[204:207], v[116:119], v[124:127]
v_mul_u32_u24 v28, 1280, v28
v_lshrrev_b32 v29, 4, v2
v_mfma_f32_16x16x32_bf16 v[128:131], a[200:203], v[104:107], v[128:131]
v_lshl_add_u32 v28, v29, 3, v28
v_add_u32 v30, s101, v28
v_mfma_f32_16x16x32_bf16 v[128:131], a[204:207], a[216:219], v[128:131]
v_mul_u32_u24 v3, 320, v1
v_add_u32 v3, v3, v2
s_mov_b32 s93, 214748365
v_mfma_f32_16x16x32_bf16 v[132:135], a[200:203], v[108:111], v[132:135]
v_add_u32 v28, 0, v3
v_mul_hi_u32 v29, v28, s93
v_mfma_f32_16x16x32_bf16 v[132:135], a[204:207], a[220:223], v[132:135]
s_waitcnt lgkmcnt(1)
ds_read_b128 a[192:195], v16 offset:6144
v_mul_u32_u24 v54, 20, v29
v_mfma_f32_16x16x32_bf16 v[120:123], a[208:211], a[224:227], v[120:123]
s_waitcnt lgkmcnt(1)
v_sub_u32 v54, v28, v54
v_bfe_u32 v55, v29, 2, 1
v_mfma_f32_16x16x32_bf16 v[120:123], a[212:215], a[240:243], v[120:123]
ds_read_b128 a[196:199], v17 offset:6144
v_lshlrev_b32 v55, 1, v55
v_mfma_f32_16x16x32_bf16 v[124:127], a[208:211], a[228:231], v[124:127]
v_xor_b32 v54, v54, v55
v_mul_u32_u24 v29, 1280, v29
v_mfma_f32_16x16x32_bf16 v[124:127], a[212:215], a[244:247], v[124:127]
v_lshl_add_u32 v49, v54, 4, v29
v_add_u32 v28, 64, v3
v_mfma_f32_16x16x32_bf16 v[128:131], a[208:211], a[232:235], v[128:131]
v_mul_hi_u32 v29, v28, s93
v_mul_u32_u24 v54, 20, v29
v_mfma_f32_16x16x32_bf16 v[128:131], a[212:215], a[248:251], v[128:131]
v_sub_u32 v54, v28, v54
v_bfe_u32 v55, v29, 2, 1
v_mfma_f32_16x16x32_bf16 v[132:135], a[208:211], a[236:239], v[132:135]
v_lshlrev_b32 v55, 1, v55
v_xor_b32 v54, v54, v55
v_mfma_f32_16x16x32_bf16 v[132:135], a[212:215], a[252:255], v[132:135]
s_waitcnt lgkmcnt(1)
v_mul_u32_u24 v29, 1280, v29
v_lshl_add_u32 v50, v54, 4, v29
v_mfma_f32_16x16x32_bf16 v[136:139], a[192:195], v[64:67], 0
s_waitcnt lgkmcnt(0)
ds_read_b128 a[200:203], v16 offset:6272
v_subrev_u32 v50, 1024, v50
v_mfma_f32_16x16x32_bf16 v[136:139], a[196:199], v[80:83], v[136:139]
ds_read_b128 a[204:207], v17 offset:6272
v_add_u32 v28, 128, v3
v_mfma_f32_16x16x32_bf16 v[140:143], a[192:195], v[68:71], 0
v_mul_hi_u32 v29, v28, s93
v_mul_u32_u24 v54, 20, v29
v_mfma_f32_16x16x32_bf16 v[140:143], a[196:199], v[84:87], v[140:143]
v_sub_u32 v54, v28, v54
v_bfe_u32 v55, v29, 2, 1
v_mfma_f32_16x16x32_bf16 v[144:147], a[192:195], v[72:75], 0
v_lshlrev_b32 v55, 1, v55
v_xor_b32 v54, v54, v55
v_mfma_f32_16x16x32_bf16 v[144:147], a[196:199], v[88:91], v[144:147]
v_mul_u32_u24 v29, 1280, v29
v_lshl_add_u32 v51, v54, 4, v29
v_mfma_f32_16x16x32_bf16 v[148:151], a[192:195], v[76:79], 0
v_subrev_u32 v51, 2048, v51
v_add_u32 v28, 192, v3
v_mfma_f32_16x16x32_bf16 v[148:151], a[196:199], v[92:95], v[148:151]
s_waitcnt lgkmcnt(1)
v_mul_hi_u32 v29, v28, s93
v_mul_u32_u24 v54, 20, v29
v_mfma_f32_16x16x32_bf16 v[136:139], a[200:203], v[96:99], v[136:139]
s_waitcnt lgkmcnt(0)
ds_read_b128 a[208:211], v16 offset:6400
v_sub_u32 v54, v28, v54
v_mfma_f32_16x16x32_bf16 v[136:139], a[204:207], v[112:115], v[136:139]
ds_read_b128 a[212:215], v17 offset:6400
v_bfe_u32 v55, v29, 2, 1
v_mfma_f32_16x16x32_bf16 v[140:143], a[200:203], v[100:103], v[140:143]
v_lshlrev_b32 v55, 1, v55
v_xor_b32 v54, v54, v55
v_mfma_f32_16x16x32_bf16 v[140:143], a[204:207], v[116:119], v[140:143]
v_mul_u32_u24 v29, 1280, v29
v_lshl_add_u32 v52, v54, 4, v29
v_mfma_f32_16x16x32_bf16 v[144:147], a[200:203], v[104:107], v[144:147]
v_subrev_u32 v52, 3072, v52
v_add_u32 v28, 256, v3
v_mfma_f32_16x16x32_bf16 v[144:147], a[204:207], a[216:219], v[144:147]
v_mul_hi_u32 v29, v28, s93
v_mul_u32_u24 v54, 20, v29
v_mfma_f32_16x16x32_bf16 v[148:151], a[200:203], v[108:111], v[148:151]
v_sub_u32 v54, v28, v54
v_bfe_u32 v55, v29, 2, 1
v_mfma_f32_16x16x32_bf16 v[148:151], a[204:207], a[220:223], v[148:151]
s_waitcnt lgkmcnt(1)
v_lshlrev_b32 v55, 1, v55
v_xor_b32 v54, v54, v55
v_mfma_f32_16x16x32_bf16 v[136:139], a[208:211], a[224:227], v[136:139]
s_waitcnt lgkmcnt(0)
ds_read_b128 a[192:195], v16 offset:12288
v_mul_u32_u24 v29, 1280, v29
v_mfma_f32_16x16x32_bf16 v[136:139], a[212:215], a[240:243], v[136:139]
ds_read_b128 a[196:199], v17 offset:12288
v_lshl_add_u32 v53, v54, 4, v29
v_mfma_f32_16x16x32_bf16 v[140:143], a[208:211], a[228:231], v[140:143]
v_lshrrev_b32 v28, 2, v2
v_mul_u32_u24 v29, 320, v28
v_mfma_f32_16x16x32_bf16 v[140:143], a[212:215], a[244:247], v[140:143]
v_and_b32 v3, 3, v2
v_lshl_add_u32 v29, v3, 3, v29
v_mfma_f32_16x16x32_bf16 v[144:147], a[208:211], a[232:235], v[144:147]
v_bfe_u32 v28, v28, 2, 1
v_lshl_add_u32 v54, v28, 5, v29
v_mfma_f32_16x16x32_bf16 v[144:147], a[212:215], a[248:251], v[144:147]
v_xor_b32 v28, 1, v28
v_lshl_add_u32 v55, v28, 5, v29
s_and_b32 s17, s2, 7
s_mul_i32 s19, s17, 983040
v_mfma_f32_16x16x32_bf16 v[148:151], a[208:211], a[236:239], v[148:151]
s_add_u32 s44, s44, s19
s_add_u32 s26, s26, s19
v_mfma_f32_16x16x32_bf16 v[148:151], a[212:215], a[252:255], v[148:151]
s_waitcnt lgkmcnt(1)
s_add_u32 s48, s48, s19
s_mul_i32 s51, s17, 24576
v_mfma_f32_16x16x32_bf16 v[152:155], a[192:195], v[64:67], 0
s_waitcnt lgkmcnt(0)
ds_read_b128 a[200:203], v16 offset:12416
s_and_b32 s25, s87, 0xffffff00
s_lshl_b32 s25, s25, 1
v_mfma_f32_16x16x32_bf16 v[152:155], a[196:199], v[80:83], v[152:155]
ds_read_b128 a[204:207], v17 offset:12416
s_bfe_u32 s18, s88, 0x1000a
s_lshl_b32 s18, s18, 6
v_mfma_f32_16x16x32_bf16 v[156:159], a[192:195], v[68:71], 0
s_add_u32 s25, s25, s18
s_add_u32 s25, s25, 36864
v_mfma_f32_16x16x32_bf16 v[156:159], a[196:199], v[84:87], v[156:159]
s_xor_b32 s19, s17, 2
s_sub_u32 s19, s19, s17
v_mfma_f32_16x16x32_bf16 v[160:163], a[192:195], v[72:75], 0
v_max3_f32 v40, v120, v121, v122
v_max3_f32 v40, v40, v123, v136
v_mfma_f32_16x16x32_bf16 v[160:163], a[196:199], v[88:91], v[160:163]
v_max3_f32 v40, v40, v137, v138
v_max_f32 v40, v40, v139
v_mfma_f32_16x16x32_bf16 v[164:167], a[192:195], v[76:79], 0
v_mov_b32 v41, v40
v_mov_b32 v42, v40
s_nop 1
v_mfma_f32_16x16x32_bf16 v[164:167], a[196:199], v[92:95], v[164:167]
s_waitcnt lgkmcnt(1)
v_permlane32_swap_b32 v41, v42
s_nop 1
v_max_f32 v40, v41, v42
v_mfma_f32_16x16x32_bf16 v[152:155], a[200:203], v[96:99], v[152:155]
s_waitcnt lgkmcnt(0)
ds_read_b128 a[208:211], v16 offset:12544
v_mov_b32 v41, v40
v_mfma_f32_16x16x32_bf16 v[152:155], a[204:207], v[112:115], v[152:155]
ds_read_b128 a[212:215], v17 offset:12544
v_mov_b32 v42, v40
s_nop 1
v_mfma_f32_16x16x32_bf16 v[156:159], a[200:203], v[100:103], v[156:159]
v_permlane16_swap_b32 v41, v42
s_nop 1
v_max_f32 v40, v41, v42
v_mfma_f32_16x16x32_bf16 v[156:159], a[204:207], v[116:119], v[156:159]
v_sub_f32 v248, 0, v40
v_sub_f32 v249, 0, v40
v_mfma_f32_16x16x32_bf16 v[160:163], a[200:203], v[104:107], v[160:163]
v_sub_f32 v250, 0, v40
v_sub_f32 v251, 0, v40
v_mfma_f32_16x16x32_bf16 v[160:163], a[204:207], a[216:219], v[160:163]
v_sub_f32 v120, v120, v40
v_sub_f32 v121, v121, v40
v_mfma_f32_16x16x32_bf16 v[164:167], a[200:203], v[108:111], v[164:167]
v_sub_f32 v122, v122, v40
v_sub_f32 v123, v123, v40
v_mfma_f32_16x16x32_bf16 v[164:167], a[204:207], a[220:223], v[164:167]
s_waitcnt lgkmcnt(1)
v_sub_f32 v136, v136, v40
v_sub_f32 v137, v137, v40
v_mfma_f32_16x16x32_bf16 v[152:155], a[208:211], a[224:227], v[152:155]
s_waitcnt lgkmcnt(0)
ds_read_b128 a[192:195], v16 offset:18432
v_sub_f32 v138, v138, v40
v_mfma_f32_16x16x32_bf16 v[152:155], a[212:215], a[240:243], v[152:155]
ds_read_b128 a[196:199], v17 offset:18432
v_sub_f32 v139, v139, v40
v_mfma_f32_16x16x32_bf16 v[156:159], a[208:211], a[228:231], v[156:159]
v_max3_f32 v44, v124, v125, v126
v_max3_f32 v44, v44, v127, v140
v_mfma_f32_16x16x32_bf16 v[156:159], a[212:215], a[244:247], v[156:159]
v_max3_f32 v44, v44, v141, v142
v_max_f32 v44, v44, v143
v_mfma_f32_16x16x32_bf16 v[160:163], a[208:211], a[232:235], v[160:163]
v_mov_b32 v45, v44
v_mov_b32 v46, v44
s_nop 1
v_mfma_f32_16x16x32_bf16 v[160:163], a[212:215], a[248:251], v[160:163]
v_permlane32_swap_b32 v45, v46
s_nop 1
v_max_f32 v44, v45, v46
v_mfma_f32_16x16x32_bf16 v[164:167], a[208:211], a[236:239], v[164:167]
v_mov_b32 v45, v44
v_mov_b32 v46, v44
s_nop 1
v_mfma_f32_16x16x32_bf16 v[164:167], a[212:215], a[252:255], v[164:167]
s_waitcnt lgkmcnt(1)
v_permlane16_swap_b32 v45, v46
s_nop 1
v_max_f32 v44, v45, v46
v_mfma_f32_16x16x32_bf16 v[168:171], a[192:195], v[64:67], 0
s_waitcnt lgkmcnt(0)
ds_read_b128 a[200:203], v16 offset:18560
v_sub_f32 v252, 0, v44
v_mfma_f32_16x16x32_bf16 v[168:171], a[196:199], v[80:83], v[168:171]
ds_read_b128 a[204:207], v17 offset:18560
v_sub_f32 v253, 0, v44
v_mfma_f32_16x16x32_bf16 v[172:175], a[192:195], v[68:71], 0
v_sub_f32 v254, 0, v44
v_sub_f32 v255, 0, v44
v_mfma_f32_16x16x32_bf16 v[172:175], a[196:199], v[84:87], v[172:175]
v_sub_f32 v124, v124, v44
v_sub_f32 v125, v125, v44
v_mfma_f32_16x16x32_bf16 v[176:179], a[192:195], v[72:75], 0
v_sub_f32 v126, v126, v44
v_sub_f32 v127, v127, v44
v_mfma_f32_16x16x32_bf16 v[176:179], a[196:199], v[88:91], v[176:179]
v_sub_f32 v140, v140, v44
v_sub_f32 v141, v141, v44
v_mfma_f32_16x16x32_bf16 v[180:183], a[192:195], v[76:79], 0
v_sub_f32 v142, v142, v44
v_sub_f32 v143, v143, v44
v_mfma_f32_16x16x32_bf16 v[180:183], a[196:199], v[92:95], v[180:183]
s_waitcnt lgkmcnt(1)
v_max3_f32 v40, v128, v129, v130
v_max3_f32 v40, v40, v131, v144
v_mfma_f32_16x16x32_bf16 v[168:171], a[200:203], v[96:99], v[168:171]
s_waitcnt lgkmcnt(0)
ds_read_b128 a[208:211], v16 offset:18688
v_max3_f32 v40, v40, v145, v146
v_mfma_f32_16x16x32_bf16 v[168:171], a[204:207], v[112:115], v[168:171]
ds_read_b128 a[212:215], v17 offset:18688
v_max_f32 v40, v40, v147
v_mfma_f32_16x16x32_bf16 v[172:175], a[200:203], v[100:103], v[172:175]
v_mov_b32 v41, v40
v_mov_b32 v42, v40
s_nop 1
v_mfma_f32_16x16x32_bf16 v[172:175], a[204:207], v[116:119], v[172:175]
v_permlane32_swap_b32 v41, v42
s_nop 1
v_max_f32 v40, v41, v42
v_mfma_f32_16x16x32_bf16 v[176:179], a[200:203], v[104:107], v[176:179]
v_mov_b32 v41, v40
v_mov_b32 v42, v40
s_nop 1
v_mfma_f32_16x16x32_bf16 v[176:179], a[204:207], a[216:219], v[176:179]
v_permlane16_swap_b32 v41, v42
s_nop 1
v_max_f32 v40, v41, v42
v_mfma_f32_16x16x32_bf16 v[180:183], a[200:203], v[108:111], v[180:183]
v_sub_f32 v24, 0, v40
v_sub_f32 v25, 0, v40
v_mfma_f32_16x16x32_bf16 v[180:183], a[204:207], a[220:223], v[180:183]
s_waitcnt lgkmcnt(1)
v_sub_f32 v26, 0, v40
v_sub_f32 v27, 0, v40
v_mfma_f32_16x16x32_bf16 v[168:171], a[208:211], a[224:227], v[168:171]
s_waitcnt lgkmcnt(0)
v_sub_f32 v128, v128, v40
v_sub_f32 v129, v129, v40
v_mfma_f32_16x16x32_bf16 v[168:171], a[212:215], a[240:243], v[168:171]
v_sub_f32 v130, v130, v40
v_sub_f32 v131, v131, v40
v_mfma_f32_16x16x32_bf16 v[172:175], a[208:211], a[228:231], v[172:175]
v_sub_f32 v144, v144, v40
v_sub_f32 v145, v145, v40
v_mfma_f32_16x16x32_bf16 v[172:175], a[212:215], a[244:247], v[172:175]
v_sub_f32 v146, v146, v40
v_sub_f32 v147, v147, v40
v_mfma_f32_16x16x32_bf16 v[176:179], a[208:211], a[232:235], v[176:179]
v_max3_f32 v44, v132, v133, v134
v_max3_f32 v44, v44, v135, v148
v_mfma_f32_16x16x32_bf16 v[176:179], a[212:215], a[248:251], v[176:179]
v_max3_f32 v44, v44, v149, v150
v_max_f32 v44, v44, v151
v_mfma_f32_16x16x32_bf16 v[180:183], a[208:211], a[236:239], v[180:183]
v_mov_b32 v45, v44
v_mov_b32 v46, v44
s_nop 1
v_mfma_f32_16x16x32_bf16 v[180:183], a[212:215], a[252:255], v[180:183]
v_permlane32_swap_b32 v45, v46
s_nop 1
v_max_f32 v44, v45, v46
v_mov_b32 v45, v44
v_mov_b32 v46, v44
s_nop 1
v_permlane16_swap_b32 v45, v46
s_nop 1
v_max_f32 v44, v45, v46
v_sub_f32 v12, 0, v44
v_sub_f32 v13, 0, v44
v_sub_f32 v14, 0, v44
v_sub_f32 v15, 0, v44
v_sub_f32 v132, v132, v44
v_sub_f32 v133, v133, v44
v_sub_f32 v134, v134, v44
v_sub_f32 v135, v135, v44
v_sub_f32 v148, v148, v44
v_sub_f32 v149, v149, v44
v_sub_f32 v150, v150, v44
v_sub_f32 v151, v151, v44
s_nop 4
v_add_f32 v152, v152, v248
v_add_f32 v153, v153, v248
v_add_f32 v154, v154, v248
v_add_f32 v155, v155, v248
v_add_f32 v156, v156, v252
v_add_f32 v157, v157, v252
v_add_f32 v158, v158, v252
v_add_f32 v159, v159, v252
v_add_f32 v160, v160, v24
v_add_f32 v161, v161, v24
v_add_f32 v162, v162, v24
v_add_f32 v163, v163, v24
v_add_f32 v164, v164, v12
v_add_f32 v165, v165, v12
v_add_f32 v166, v166, v12
v_add_f32 v167, v167, v12
v_add_f32 v168, v168, v248
v_add_f32 v169, v169, v248
v_add_f32 v170, v170, v248
v_add_f32 v171, v171, v248
v_add_f32 v172, v172, v252
v_add_f32 v173, v173, v252
v_add_f32 v174, v174, v252
v_add_f32 v175, v175, v252
v_add_f32 v176, v176, v24
v_add_f32 v177, v177, v24
v_add_f32 v178, v178, v24
v_add_f32 v179, v179, v24
v_add_f32 v180, v180, v12
v_add_f32 v181, v181, v12
v_add_f32 v182, v182, v12
v_add_f32 v183, v183, v12
s_add_u32 s53, s39, 49152
s_mov_b32 s54, s39
s_add_u32 s27, s39, 24576
s_waitcnt vmcnt(13)
s_barrier
v_exp_f32 v40, v120
v_exp_f32 v41, v121
v_exp_f32 v42, v122
v_exp_f32 v43, v123
v_add_f32 v36, v40, v41
v_cvt_pk_bf16_f32 v184, v40, v41
v_add_f32 v36, v36, v42
v_add_f32 v36, v36, v43
v_cvt_pk_bf16_f32 v185, v42, v43
v_exp_f32 v44, v124
v_exp_f32 v45, v125
v_exp_f32 v46, v126
v_exp_f32 v47, v127
v_add_f32 v37, v44, v45
v_cvt_pk_bf16_f32 v188, v44, v45
v_add_f32 v37, v37, v46
v_add_f32 v37, v37, v47
v_cvt_pk_bf16_f32 v189, v46, v47
v_exp_f32 v40, v128
v_exp_f32 v41, v129
v_exp_f32 v42, v130
v_exp_f32 v43, v131
v_add_f32 v38, v40, v41
v_cvt_pk_bf16_f32 v192, v40, v41
v_add_f32 v38, v38, v42
v_add_f32 v38, v38, v43
v_cvt_pk_bf16_f32 v193, v42, v43
v_exp_f32 v44, v132
v_exp_f32 v45, v133
v_exp_f32 v46, v134
v_exp_f32 v47, v135
v_add_f32 v39, v44, v45
v_cvt_pk_bf16_f32 v196, v44, v45
v_add_f32 v39, v39, v46
v_add_f32 v39, v39, v47
v_cvt_pk_bf16_f32 v197, v46, v47
v_exp_f32 v40, v136
v_exp_f32 v41, v137
v_exp_f32 v42, v138
v_exp_f32 v43, v139
v_add_f32 v36, v36, v40
v_add_f32 v36, v36, v41
v_cvt_pk_bf16_f32 v186, v40, v41
v_add_f32 v36, v36, v42
v_add_f32 v36, v36, v43
v_cvt_pk_bf16_f32 v187, v42, v43
v_exp_f32 v44, v140
v_exp_f32 v45, v141
v_exp_f32 v46, v142
v_exp_f32 v47, v143
v_add_f32 v37, v37, v44
v_add_f32 v37, v37, v45
v_cvt_pk_bf16_f32 v190, v44, v45
v_add_f32 v37, v37, v46
v_add_f32 v37, v37, v47
v_cvt_pk_bf16_f32 v191, v46, v47
v_exp_f32 v40, v144
v_exp_f32 v41, v145
v_exp_f32 v42, v146
v_exp_f32 v43, v147
v_add_f32 v38, v38, v40
v_add_f32 v38, v38, v41
v_cvt_pk_bf16_f32 v194, v40, v41
v_add_f32 v38, v38, v42
v_add_f32 v38, v38, v43
v_cvt_pk_bf16_f32 v195, v42, v43
v_exp_f32 v44, v148
v_exp_f32 v45, v149
v_exp_f32 v46, v150
v_exp_f32 v47, v151
v_add_f32 v39, v39, v44
v_add_f32 v39, v39, v45
v_cvt_pk_bf16_f32 v198, v44, v45
v_add_f32 v39, v39, v46
v_add_f32 v39, v39, v47
v_cvt_pk_bf16_f32 v199, v46, v47
v_exp_f32 v40, v152
v_exp_f32 v41, v153
v_exp_f32 v42, v154
v_exp_f32 v43, v155
v_add_f32 v36, v36, v40
v_add_f32 v36, v36, v41
v_cvt_pk_bf16_f32 v200, v40, v41
v_add_f32 v36, v36, v42
v_add_f32 v36, v36, v43
v_cvt_pk_bf16_f32 v201, v42, v43
v_exp_f32 v44, v156
v_exp_f32 v45, v157
v_exp_f32 v46, v158
v_exp_f32 v47, v159
v_add_f32 v37, v37, v44
v_add_f32 v37, v37, v45
v_cvt_pk_bf16_f32 v204, v44, v45
v_add_f32 v37, v37, v46
v_add_f32 v37, v37, v47
v_cvt_pk_bf16_f32 v205, v46, v47
v_exp_f32 v40, v160
v_exp_f32 v41, v161
v_exp_f32 v42, v162
v_exp_f32 v43, v163
v_add_f32 v38, v38, v40
v_add_f32 v38, v38, v41
v_cvt_pk_bf16_f32 v208, v40, v41
v_add_f32 v38, v38, v42
v_add_f32 v38, v38, v43
v_cvt_pk_bf16_f32 v209, v42, v43
v_exp_f32 v44, v164
v_exp_f32 v45, v165
v_exp_f32 v46, v166
v_exp_f32 v47, v167
v_add_f32 v39, v39, v44
v_add_f32 v39, v39, v45
v_cvt_pk_bf16_f32 v212, v44, v45
v_add_f32 v39, v39, v46
v_add_f32 v39, v39, v47
v_cvt_pk_bf16_f32 v213, v46, v47
v_exp_f32 v40, v168
v_exp_f32 v41, v169
v_exp_f32 v42, v170
v_exp_f32 v43, v171
v_add_f32 v36, v36, v40
v_add_f32 v36, v36, v41
v_cvt_pk_bf16_f32 v202, v40, v41
v_add_f32 v36, v36, v42
v_add_f32 v36, v36, v43
v_cvt_pk_bf16_f32 v203, v42, v43
v_exp_f32 v44, v172
v_exp_f32 v45, v173
v_exp_f32 v46, v174
v_exp_f32 v47, v175
v_add_f32 v37, v37, v44
v_add_f32 v37, v37, v45
v_cvt_pk_bf16_f32 v206, v44, v45
v_add_f32 v37, v37, v46
v_add_f32 v37, v37, v47
v_cvt_pk_bf16_f32 v207, v46, v47
v_exp_f32 v40, v176
v_exp_f32 v41, v177
v_exp_f32 v42, v178
v_exp_f32 v43, v179
v_add_f32 v38, v38, v40
v_add_f32 v38, v38, v41
v_cvt_pk_bf16_f32 v210, v40, v41
v_add_f32 v38, v38, v42
v_add_f32 v38, v38, v43
v_cvt_pk_bf16_f32 v211, v42, v43
v_exp_f32 v44, v180
v_exp_f32 v45, v181
v_exp_f32 v46, v182
v_exp_f32 v47, v183
v_add_f32 v39, v39, v44
v_add_f32 v39, v39, v45
v_cvt_pk_bf16_f32 v214, v44, v45
v_add_f32 v39, v39, v46
v_add_f32 v39, v39, v47
v_cvt_pk_bf16_f32 v215, v46, v47
s_sub_u32 s3, s27, s54
v_add_u32 v16, s3, v16
v_add_u32 v17, s3, v17
s_mov_b32 s101, s53
s_mov_b32 s53, s54
s_mov_b32 s54, s27
s_mov_b32 s27, s101
ds_read_b128 a[192:195], v16 offset:0
ds_read_b128 a[196:199], v17 offset:0
v_max3_f32 v48, v36, v37, v38
v_max_f32 v48, v48, v39
v_cmp_lt_f32 vcc, 0x49800000, v48
s_nop 0
s_cbranch_vccnz L_stub0
L_back0:
s_waitcnt lgkmcnt(1)
v_mfma_f32_16x16x32_bf16 v[120:123], a[192:195], v[64:67], v[248:251]
s_waitcnt lgkmcnt(0)
ds_read_b128 a[200:203], v16 offset:128
v_add_f32 v32, v32, v36
s_mul_i32 s19, s19, 12
s_sub_u32 s19, s19, 11
v_mfma_f32_16x16x32_bf16 v[120:123], a[196:199], v[80:83], v[120:123]
ds_read_b128 a[204:207], v17 offset:128
v_add_f32 v33, v33, v37
s_mul_i32 s22, s19, 81920
s_lshl_b32 s19, s19, 11
v_mfma_f32_16x16x32_bf16 v[124:127], a[192:195], v[68:71], v[252:255]
s_lshr_b32 s18, s17, 1
s_lshl_b32 s18, s18, 7
v_mfma_f32_16x16x32_bf16 v[124:127], a[196:199], v[84:87], v[124:127]
s_add_u32 m0, s53, 73728
s_and_b32 s17, s17, 1
s_lshl_b32 s17, s17, 5
v_mfma_f32_16x16x32_bf16 v[128:131], a[192:195], v[72:75], v[24:27]
buffer_load_dwordx4 v4, s[8:11], s40 offen offset:0 lds
s_add_u32 s18, s18, s17
v_mfma_f32_16x16x32_bf16 v[128:131], a[196:199], v[88:91], v[128:131]
v_add_f32 v34, v34, v38
v_add_f32 v35, v35, v39
v_mfma_f32_16x16x32_bf16 v[132:135], a[192:195], v[76:79], v[12:15]
v_add_u32 v3, s18, v62
v_xor_b32 v28, 128, v3
s_lshl_b32 s21, s2, 2
s_lshl_b32 s17, s38, 8
v_mfma_f32_16x16x32_bf16 v[132:135], a[196:199], v[92:95], v[132:135]
s_waitcnt lgkmcnt(1)
s_add_u32 s21, s21, s17
s_cmp_lt_u32 s21, 32
s_cselect_b32 s21, s21, 0x100000
v_mfma_f32_16x16x32_bf16 v[120:123], a[200:203], v[96:99], v[120:123]
s_waitcnt lgkmcnt(0)
ds_read_b128 a[208:211], v16 offset:256
s_add_u32 s21, s21, 2048
v_mfma_f32_16x16x32_bf16 v[120:123], a[204:207], v[112:115], v[120:123]
ds_read_b128 a[212:215], v17 offset:256
v_mfma_f32_16x16x32_bf16 v[124:127], a[200:203], v[100:103], v[124:127]
buffer_load_dwordx4 v5, s[8:11], s40 offen offset:1024 lds
v_mfma_f32_16x16x32_bf16 v[124:127], a[204:207], v[116:119], v[124:127]
v_mfma_f32_16x16x32_bf16 v[128:131], a[200:203], v[104:107], v[128:131]
v_mfma_f32_16x16x32_bf16 v[128:131], a[204:207], a[216:219], v[128:131]
v_mfma_f32_16x16x32_bf16 v[132:135], a[200:203], v[108:111], v[132:135]
v_mfma_f32_16x16x32_bf16 v[132:135], a[204:207], a[220:223], v[132:135]
s_waitcnt lgkmcnt(1)
ds_read_b128 a[192:195], v16 offset:6144
v_mfma_f32_16x16x32_bf16 v[120:123], a[208:211], a[224:227], v[120:123]
s_waitcnt lgkmcnt(1)
buffer_load_dwordx4 v6, s[8:11], s40 offen offset:2048 lds
v_mfma_f32_16x16x32_bf16 v[120:123], a[212:215], a[240:243], v[120:123]
ds_read_b128 a[196:199], v17 offset:6144
v_mfma_f32_16x16x32_bf16 v[124:127], a[208:211], a[228:231], v[124:127]
s_add_u32 s40, s40, 12288
v_mfma_f32_16x16x32_bf16 v[124:127], a[212:215], a[244:247], v[124:127]
v_mfma_f32_16x16x32_bf16 v[128:131], a[208:211], a[232:235], v[128:131]
v_mfma_f32_16x16x32_bf16 v[128:131], a[212:215], a[248:251], v[128:131]
s_add_u32 m0, s53, 86016
v_mfma_f32_16x16x32_bf16 v[132:135], a[208:211], a[236:239], v[132:135]
buffer_load_dwordx4 v4, s[8:11], s40 offen offset:0 lds
v_mfma_f32_16x16x32_bf16 v[132:135], a[212:215], a[252:255], v[132:135]
s_waitcnt lgkmcnt(1)
v_mfma_f32_16x16x32_bf16 v[136:139], a[192:195], v[64:67], v[248:251]
s_waitcnt lgkmcnt(0)
ds_read_b128 a[200:203], v16 offset:6272
v_mfma_f32_16x16x32_bf16 v[136:139], a[196:199], v[80:83], v[136:139]
ds_read_b128 a[204:207], v17 offset:6272
v_mfma_f32_16x16x32_bf16 v[140:143], a[192:195], v[68:71], v[252:255]
v_exp_f32 v40, v120
v_mfma_f32_16x16x32_bf16 v[140:143], a[196:199], v[84:87], v[140:143]
v_exp_f32 v41, v121
v_mfma_f32_16x16x32_bf16 v[144:147], a[192:195], v[72:75], v[24:27]
buffer_load_dwordx4 v5, s[8:11], s40 offen offset:1024 lds
v_mfma_f32_16x16x32_bf16 v[144:147], a[196:199], v[88:91], v[144:147]
v_add_f32 v36, v40, v41
v_cvt_pk_bf16_f32 v216, v40, v41
v_mfma_f32_16x16x32_bf16 v[148:151], a[192:195], v[76:79], v[12:15]
v_exp_f32 v42, v122
v_mfma_f32_16x16x32_bf16 v[148:151], a[196:199], v[92:95], v[148:151]
s_waitcnt lgkmcnt(1)
v_exp_f32 v43, v123
v_mfma_f32_16x16x32_bf16 v[136:139], a[200:203], v[96:99], v[136:139]
s_waitcnt lgkmcnt(0)
ds_read_b128 a[208:211], v16 offset:6400
v_add_f32 v36, v36, v42
v_mfma_f32_16x16x32_bf16 v[136:139], a[204:207], v[112:115], v[136:139]
ds_read_b128 a[212:215], v17 offset:6400
v_add_f32 v36, v36, v43
v_mfma_f32_16x16x32_bf16 v[140:143], a[200:203], v[100:103], v[140:143]
buffer_load_dwordx4 v6, s[8:11], s40 offen offset:2048 lds
v_mfma_f32_16x16x32_bf16 v[140:143], a[204:207], v[116:119], v[140:143]
v_exp_f32 v44, v124
v_mfma_f32_16x16x32_bf16 v[144:147], a[200:203], v[104:107], v[144:147]
s_add_u32 s40, s40, 12288
v_exp_f32 v45, v125
v_mfma_f32_16x16x32_bf16 v[144:147], a[204:207], a[216:219], v[144:147]
v_cvt_pk_bf16_f32 v217, v42, v43
v_add_f32 v37, v44, v45
v_mfma_f32_16x16x32_bf16 v[148:151], a[200:203], v[108:111], v[148:151]
v_exp_f32 v46, v126
v_mfma_f32_16x16x32_bf16 v[148:151], a[204:207], a[220:223], v[148:151]
s_waitcnt lgkmcnt(1)
v_cvt_pk_bf16_f32 v220, v44, v45
v_add_f32 v37, v37, v46
v_mfma_f32_16x16x32_bf16 v[136:139], a[208:211], a[224:227], v[136:139]
s_waitcnt lgkmcnt(0)
ds_read_b128 a[192:195], v16 offset:12288
v_mfma_f32_16x16x32_bf16 v[136:139], a[212:215], a[240:243], v[136:139]
ds_read_b128 a[196:199], v17 offset:12288
v_mfma_f32_16x16x32_bf16 v[140:143], a[208:211], a[228:231], v[140:143]
v_exp_f32 v47, v127
v_mfma_f32_16x16x32_bf16 v[140:143], a[212:215], a[244:247], v[140:143]
s_mov_b32 m0, s43
v_add_f32 v37, v37, v47
v_cvt_pk_bf16_f32 v221, v46, v47
v_mfma_f32_16x16x32_bf16 v[144:147], a[208:211], a[232:235], v[144:147]
buffer_load_dwordx4 v57, s[80:83], s42 offen lds
v_mfma_f32_16x16x32_bf16 v[144:147], a[212:215], a[248:251], v[144:147]
v_exp_f32 v40, v128
v_mfma_f32_16x16x32_bf16 v[148:151], a[208:211], a[236:239], v[148:151]
s_add_u32 s42, s42, 1024
v_exp_f32 v41, v129
v_mfma_f32_16x16x32_bf16 v[148:151], a[212:215], a[252:255], v[148:151]
s_waitcnt lgkmcnt(1)
v_add_f32 v38, v40, v41
v_cvt_pk_bf16_f32 v224, v40, v41
v_mfma_f32_16x16x32_bf16 v[152:155], a[192:195], v[64:67], v[248:251]
s_waitcnt lgkmcnt(0)
ds_read_b128 a[200:203], v16 offset:12416
v_mfma_f32_16x16x32_bf16 v[152:155], a[196:199], v[80:83], v[152:155]
ds_read_b128 a[204:207], v17 offset:12416
v_mfma_f32_16x16x32_bf16 v[156:159], a[192:195], v[68:71], v[252:255]
v_exp_f32 v42, v130
v_mfma_f32_16x16x32_bf16 v[156:159], a[196:199], v[84:87], v[156:159]
v_exp_f32 v43, v131
v_mfma_f32_16x16x32_bf16 v[160:163], a[192:195], v[72:75], v[24:27]
v_add_f32 v38, v38, v42
v_add_f32 v38, v38, v43
v_mfma_f32_16x16x32_bf16 v[160:163], a[196:199], v[88:91], v[160:163]
v_exp_f32 v44, v132
v_mfma_f32_16x16x32_bf16 v[164:167], a[192:195], v[76:79], v[12:15]
v_exp_f32 v45, v133
v_mfma_f32_16x16x32_bf16 v[164:167], a[196:199], v[92:95], v[164:167]
s_waitcnt lgkmcnt(1)
v_cvt_pk_bf16_f32 v225, v42, v43
v_add_f32 v39, v44, v45
v_mfma_f32_16x16x32_bf16 v[152:155], a[200:203], v[96:99], v[152:155]
s_waitcnt lgkmcnt(0)
ds_read_b128 a[208:211], v16 offset:12544
v_cvt_pk_bf16_f32 v228, v44, v45
v_mfma_f32_16x16x32_bf16 v[152:155], a[204:207], v[112:115], v[152:155]
ds_read_b128 a[212:215], v17 offset:12544
v_mfma_f32_16x16x32_bf16 v[156:159], a[200:203], v[100:103], v[156:159]
v_exp_f32 v46, v134
v_mfma_f32_16x16x32_bf16 v[156:159], a[204:207], v[116:119], v[156:159]
v_exp_f32 v47, v135
v_mfma_f32_16x16x32_bf16 v[160:163], a[200:203], v[104:107], v[160:163]
v_add_f32 v39, v39, v46
v_add_f32 v39, v39, v47
v_mfma_f32_16x16x32_bf16 v[160:163], a[204:207], a[216:219], v[160:163]
v_exp_f32 v40, v136
v_mfma_f32_16x16x32_bf16 v[164:167], a[200:203], v[108:111], v[164:167]
v_cvt_pk_bf16_f32 v229, v46, v47
v_add_f32 v36, v36, v40
v_mfma_f32_16x16x32_bf16 v[164:167], a[204:207], a[220:223], v[164:167]
s_waitcnt lgkmcnt(1)
v_exp_f32 v41, v137
v_mfma_f32_16x16x32_bf16 v[152:155], a[208:211], a[224:227], v[152:155]
s_waitcnt lgkmcnt(0)
ds_read_b128 a[192:195], v16 offset:18432
v_add_f32 v36, v36, v41
v_mfma_f32_16x16x32_bf16 v[152:155], a[212:215], a[240:243], v[152:155]
ds_read_b128 a[196:199], v17 offset:18432
v_cvt_pk_bf16_f32 v218, v40, v41
v_mfma_f32_16x16x32_bf16 v[156:159], a[208:211], a[228:231], v[156:159]
v_exp_f32 v42, v138
v_mfma_f32_16x16x32_bf16 v[156:159], a[212:215], a[244:247], v[156:159]
v_exp_f32 v43, v139
v_mfma_f32_16x16x32_bf16 v[160:163], a[208:211], a[232:235], v[160:163]
v_add_f32 v36, v36, v42
v_add_f32 v36, v36, v43
v_mfma_f32_16x16x32_bf16 v[160:163], a[212:215], a[248:251], v[160:163]
v_exp_f32 v44, v140
v_mfma_f32_16x16x32_bf16 v[164:167], a[208:211], a[236:239], v[164:167]
v_cvt_pk_bf16_f32 v219, v42, v43
v_add_f32 v37, v37, v44
v_mfma_f32_16x16x32_bf16 v[164:167], a[212:215], a[252:255], v[164:167]
s_waitcnt lgkmcnt(1)
v_exp_f32 v45, v141
v_mfma_f32_16x16x32_bf16 v[168:171], a[192:195], v[64:67], v[248:251]
s_waitcnt lgkmcnt(0)
ds_read_b128 a[200:203], v16 offset:18560
v_add_f32 v37, v37, v45
v_mfma_f32_16x16x32_bf16 v[168:171], a[196:199], v[80:83], v[168:171]
ds_read_b128 a[204:207], v17 offset:18560
v_cvt_pk_bf16_f32 v222, v44, v45
v_mfma_f32_16x16x32_bf16 v[172:175], a[192:195], v[68:71], v[252:255]
v_exp_f32 v46, v142
v_mfma_f32_16x16x32_bf16 v[172:175], a[196:199], v[84:87], v[172:175]
v_exp_f32 v47, v143
v_mfma_f32_16x16x32_bf16 v[176:179], a[192:195], v[72:75], v[24:27]
v_add_f32 v37, v37, v46
v_add_f32 v37, v37, v47
v_mfma_f32_16x16x32_bf16 v[176:179], a[196:199], v[88:91], v[176:179]
v_exp_f32 v40, v144
v_mfma_f32_16x16x32_bf16 v[180:183], a[192:195], v[76:79], v[12:15]
v_cvt_pk_bf16_f32 v223, v46, v47
v_add_f32 v38, v38, v40
v_mfma_f32_16x16x32_bf16 v[180:183], a[196:199], v[92:95], v[180:183]
s_waitcnt lgkmcnt(1)
v_exp_f32 v41, v145
v_mfma_f32_16x16x32_bf16 v[168:171], a[200:203], v[96:99], v[168:171]
s_waitcnt lgkmcnt(0)
ds_read_b128 a[208:211], v16 offset:18688
v_add_f32 v38, v38, v41
v_mfma_f32_16x16x32_bf16 v[168:171], a[204:207], v[112:115], v[168:171]
ds_read_b128 a[212:215], v17 offset:18688
v_cvt_pk_bf16_f32 v226, v40, v41
v_mfma_f32_16x16x32_bf16 v[172:175], a[200:203], v[100:103], v[172:175]
v_exp_f32 v42, v146
v_mfma_f32_16x16x32_bf16 v[172:175], a[204:207], v[116:119], v[172:175]
v_exp_f32 v43, v147
v_mfma_f32_16x16x32_bf16 v[176:179], a[200:203], v[104:107], v[176:179]
v_add_f32 v38, v38, v42
v_add_f32 v38, v38, v43
v_mfma_f32_16x16x32_bf16 v[176:179], a[204:207], a[216:219], v[176:179]
v_exp_f32 v44, v148
v_mfma_f32_16x16x32_bf16 v[180:183], a[200:203], v[108:111], v[180:183]
v_cvt_pk_bf16_f32 v227, v42, v43
v_add_f32 v39, v39, v44
v_mfma_f32_16x16x32_bf16 v[180:183], a[204:207], a[220:223], v[180:183]
s_waitcnt lgkmcnt(1)
v_exp_f32 v45, v149
v_mfma_f32_16x16x32_bf16 v[168:171], a[208:211], a[224:227], v[168:171]
s_waitcnt lgkmcnt(0)
ds_read_b64_tr_b16 a[192:193], v20 offset:0
ds_read_b64_tr_b16 a[194:195], v20 offset:6144
v_mfma_f32_16x16x32_bf16 v[168:171], a[212:215], a[240:243], v[168:171]
ds_read_b64_tr_b16 a[196:197], v20 offset:12288
ds_read_b64_tr_b16 a[198:199], v20 offset:18432
v_mfma_f32_16x16x32_bf16 v[172:175], a[208:211], a[228:231], v[172:175]
v_add_f32 v39, v39, v45
v_cvt_pk_bf16_f32 v230, v44, v45
v_mfma_f32_16x16x32_bf16 v[172:175], a[212:215], a[244:247], v[172:175]
v_exp_f32 v46, v150
v_mfma_f32_16x16x32_bf16 v[176:179], a[208:211], a[232:235], v[176:179]
v_exp_f32 v47, v151
v_mfma_f32_16x16x32_bf16 v[176:179], a[212:215], a[248:251], v[176:179]
v_add_f32 v39, v39, v46
v_add_f32 v39, v39, v47
v_mfma_f32_16x16x32_bf16 v[180:183], a[208:211], a[236:239], v[180:183]
v_exp_f32 v40, v152
v_mfma_f32_16x16x32_bf16 v[180:183], a[212:215], a[252:255], v[180:183]
s_waitcnt lgkmcnt(2)
v_cvt_pk_bf16_f32 v231, v46, v47
v_add_f32 v36, v36, v40
v_mfma_f32_16x16x32_bf16 a[0:3], a[192:195], v[184:187], 0
s_waitcnt lgkmcnt(0)
ds_read_b64_tr_b16 a[200:201], v21 offset:0
ds_read_b64_tr_b16 a[202:203], v21 offset:6144
v_mfma_f32_16x16x32_bf16 a[0:3], a[196:199], v[200:203], a[0:3]
ds_read_b64_tr_b16 a[204:205], v21 offset:12288
ds_read_b64_tr_b16 a[206:207], v21 offset:18432
v_mfma_f32_16x16x32_bf16 a[4:7], a[192:195], v[188:191], 0
v_exp_f32 v41, v153
v_mfma_f32_16x16x32_bf16 a[4:7], a[196:199], v[204:207], a[4:7]
v_add_f32 v36, v36, v41
v_cvt_pk_bf16_f32 v232, v40, v41
v_mfma_f32_16x16x32_bf16 a[8:11], a[192:195], v[192:195], 0
s_waitcnt vmcnt(13)
s_barrier
s_mov_b32 s93, 0x200000
v_cmp_le_u32 vcc, 32, v63
s_nop 1
s_cmp_eq_u64 vcc, -1
s_cbranch_scc1 L_pd1
L_pl1:
s_sleep 1
global_load_dword v63, v56, s[6:7] sc1
s_waitcnt vmcnt(0)
v_cmp_le_u32 vcc, 32, v63
s_sub_u32 s93, s93, 1
s_cmp_eq_u64 vcc, -1
s_cbranch_scc1 L_pd1
s_cmp_lg_u32 s93, 0
s_cbranch_scc1 L_pl1
L_pd1:
v_mfma_f32_16x16x32_bf16 a[8:11], a[196:199], v[208:211], a[8:11]
v_exp_f32 v42, v154
v_mfma_f32_16x16x32_bf16 a[12:15], a[192:195], v[196:199], 0
s_add_u32 m0, s27, 0
v_exp_f32 v43, v155
v_mfma_f32_16x16x32_bf16 a[12:15], a[196:199], v[212:215], a[12:15]
s_waitcnt lgkmcnt(2)
buffer_load_dwordx4 v7, s[12:15], s41 offen offset:0 lds
v_mfma_f32_16x16x32_bf16 a[16:19], a[200:203], v[184:187], 0
s_waitcnt lgkmcnt(0)
ds_read_b64_tr_b16 a[208:209], v22 offset:0
ds_read_b64_tr_b16 a[210:211], v22 offset:6144
v_mfma_f32_16x16x32_bf16 a[16:19], a[204:207], v[200:203], a[16:19]
ds_read_b64_tr_b16 a[212:213], v22 offset:12288
ds_read_b64_tr_b16 a[214:215], v22 offset:18432
v_mfma_f32_16x16x32_bf16 a[20:23], a[200:203], v[188:191], 0
v_add_f32 v36, v36, v42
v_add_f32 v36, v36, v43
v_mfma_f32_16x16x32_bf16 a[20:23], a[204:207], v[204:207], a[20:23]
buffer_load_dwordx4 v8, s[12:15], s41 offen offset:1024 lds
v_mfma_f32_16x16x32_bf16 a[24:27], a[200:203], v[192:195], 0
v_exp_f32 v44, v156
v_mfma_f32_16x16x32_bf16 a[24:27], a[204:207], v[208:211], a[24:27]
v_cvt_pk_bf16_f32 v233, v42, v43
v_add_f32 v37, v37, v44
v_mfma_f32_16x16x32_bf16 a[28:31], a[200:203], v[196:199], 0
v_exp_f32 v45, v157
v_mfma_f32_16x16x32_bf16 a[28:31], a[204:207], v[212:215], a[28:31]
s_waitcnt lgkmcnt(2)
buffer_load_dwordx4 v9, s[12:15], s41 offen offset:2048 lds
v_mfma_f32_16x16x32_bf16 a[32:35], a[208:211], v[184:187], 0
s_waitcnt lgkmcnt(0)
ds_read_b64_tr_b16 a[192:193], v23 offset:0
ds_read_b64_tr_b16 a[194:195], v23 offset:6144
v_mfma_f32_16x16x32_bf16 a[32:35], a[212:215], v[200:203], a[32:35]
s_add_u32 s41, s41, 12288
ds_read_b64_tr_b16 a[196:197], v23 offset:12288
ds_read_b64_tr_b16 a[198:199], v23 offset:18432
v_mfma_f32_16x16x32_bf16 a[36:39], a[208:211], v[188:191], 0
s_add_u32 m0, s27, 12288
v_add_f32 v37, v37, v45
v_cvt_pk_bf16_f32 v236, v44, v45
v_mfma_f32_16x16x32_bf16 a[36:39], a[212:215], v[204:207], a[36:39]
buffer_load_dwordx4 v7, s[12:15], s41 offen offset:0 lds
v_mfma_f32_16x16x32_bf16 a[40:43], a[208:211], v[192:195], 0
v_exp_f32 v46, v158
v_mfma_f32_16x16x32_bf16 a[40:43], a[212:215], v[208:211], a[40:43]
v_exp_f32 v47, v159
v_mfma_f32_16x16x32_bf16 a[44:47], a[208:211], v[196:199], 0
v_add_f32 v37, v37, v46
v_add_f32 v37, v37, v47
v_mfma_f32_16x16x32_bf16 a[44:47], a[212:215], v[212:215], a[44:47]
s_waitcnt lgkmcnt(2)
buffer_load_dwordx4 v8, s[12:15], s41 offen offset:1024 lds
v_mfma_f32_16x16x32_bf16 a[48:51], a[192:195], v[184:187], 0
s_waitcnt lgkmcnt(0)
ds_read_b64_tr_b16 a[200:201], v20 offset:128
ds_read_b64_tr_b16 a[202:203], v20 offset:6272
v_mfma_f32_16x16x32_bf16 a[48:51], a[196:199], v[200:203], a[48:51]
ds_read_b64_tr_b16 a[204:205], v20 offset:12416
ds_read_b64_tr_b16 a[206:207], v20 offset:18560
v_mfma_f32_16x16x32_bf16 a[52:55], a[192:195], v[188:191], 0
v_exp_f32 v40, v160
v_mfma_f32_16x16x32_bf16 a[52:55], a[196:199], v[204:207], a[52:55]
buffer_load_dwordx4 v9, s[12:15], s41 offen offset:2048 lds
v_mfma_f32_16x16x32_bf16 a[56:59], a[192:195], v[192:195], 0
v_cvt_pk_bf16_f32 v237, v46, v47
v_add_f32 v38, v38, v40
v_mfma_f32_16x16x32_bf16 a[56:59], a[196:199], v[208:211], a[56:59]
s_add_u32 s41, s41, 12288
v_exp_f32 v41, v161
v_mfma_f32_16x16x32_bf16 a[60:63], a[192:195], v[196:199], 0
v_add_f32 v38, v38, v41
v_cvt_pk_bf16_f32 v240, v40, v41
v_mfma_f32_16x16x32_bf16 a[60:63], a[196:199], v[212:215], a[60:63]
s_waitcnt lgkmcnt(2)
v_exp_f32 v42, v162
v_mfma_f32_16x16x32_bf16 a[64:67], a[200:203], v[184:187], 0
s_waitcnt lgkmcnt(0)
ds_read_b64_tr_b16 a[208:209], v21 offset:128
ds_read_b64_tr_b16 a[210:211], v21 offset:6272
v_mfma_f32_16x16x32_bf16 a[64:67], a[204:207], v[200:203], a[64:67]
ds_read_b64_tr_b16 a[212:213], v21 offset:12416
ds_read_b64_tr_b16 a[214:215], v21 offset:18560
v_mfma_f32_16x16x32_bf16 a[68:71], a[200:203], v[188:191], 0
v_exp_f32 v43, v163
v_mfma_f32_16x16x32_bf16 a[68:71], a[204:207], v[204:207], a[68:71]
v_add_f32 v38, v38, v42
v_add_f32 v38, v38, v43
v_mfma_f32_16x16x32_bf16 a[72:75], a[200:203], v[192:195], 0
v_mfma_f32_16x16x32_bf16 a[72:75], a[204:207], v[208:211], a[72:75]
v_exp_f32 v44, v164
v_mfma_f32_16x16x32_bf16 a[76:79], a[200:203], v[196:199], 0
v_cvt_pk_bf16_f32 v241, v42, v43
v_add_f32 v39, v39, v44
v_mfma_f32_16x16x32_bf16 a[76:79], a[204:207], v[212:215], a[76:79]
s_waitcnt lgkmcnt(2)
v_exp_f32 v45, v165
v_mfma_f32_16x16x32_bf16 a[80:83], a[208:211], v[184:187], 0
s_waitcnt lgkmcnt(0)
ds_read_b64_tr_b16 a[192:193], v22 offset:128
ds_read_b64_tr_b16 a[194:195], v22 offset:6272
v_mfma_f32_16x16x32_bf16 a[80:83], a[212:215], v[200:203], a[80:83]
ds_read_b64_tr_b16 a[196:197], v22 offset:12416
ds_read_b64_tr_b16 a[198:199], v22 offset:18560
v_mfma_f32_16x16x32_bf16 a[84:87], a[208:211], v[188:191], 0
v_add_f32 v39, v39, v45
v_cvt_pk_bf16_f32 v244, v44, v45
v_mfma_f32_16x16x32_bf16 a[84:87], a[212:215], v[204:207], a[84:87]
s_mov_b32 m0, s43
v_exp_f32 v46, v166
v_mfma_f32_16x16x32_bf16 a[88:91], a[208:211], v[192:195], 0
buffer_load_dwordx4 v57, s[80:83], s42 offen lds
v_mfma_f32_16x16x32_bf16 a[88:91], a[212:215], v[208:211], a[88:91]
v_exp_f32 v47, v167
v_mfma_f32_16x16x32_bf16 a[92:95], a[208:211], v[196:199], 0
s_add_u32 s42, s42, 1024
v_add_f32 v39, v39, v46
v_add_f32 v39, v39, v47
v_mfma_f32_16x16x32_bf16 a[92:95], a[212:215], v[212:215], a[92:95]
s_waitcnt lgkmcnt(2)
v_exp_f32 v40, v168
v_mfma_f32_16x16x32_bf16 a[96:99], a[192:195], v[184:187], 0
s_waitcnt lgkmcnt(0)
ds_read_b64_tr_b16 a[200:201], v23 offset:128
ds_read_b64_tr_b16 a[202:203], v23 offset:6272
v_mfma_f32_16x16x32_bf16 a[96:99], a[196:199], v[200:203], a[96:99]
ds_read_b64_tr_b16 a[204:205], v23 offset:12416
ds_read_b64_tr_b16 a[206:207], v23 offset:18560
v_mfma_f32_16x16x32_bf16 a[100:103], a[192:195], v[188:191], 0
v_cvt_pk_bf16_f32 v245, v46, v47
v_add_f32 v36, v36, v40
v_mfma_f32_16x16x32_bf16 a[100:103], a[196:199], v[204:207], a[100:103]
v_exp_f32 v41, v169
v_mfma_f32_16x16x32_bf16 a[104:107], a[192:195], v[192:195], 0
v_add_f32 v36, v36, v41
v_cvt_pk_bf16_f32 v234, v40, v41
v_mfma_f32_16x16x32_bf16 a[104:107], a[196:199], v[208:211], a[104:107]
v_exp_f32 v42, v170
v_mfma_f32_16x16x32_bf16 a[108:111], a[192:195], v[196:199], 0
s_sub_u32 s3, s27, s54
v_exp_f32 v43, v171
v_mfma_f32_16x16x32_bf16 a[108:111], a[196:199], v[212:215], a[108:111]
s_waitcnt lgkmcnt(2)
v_add_f32 v36, v36, v42
v_add_f32 v36, v36, v43
v_mfma_f32_16x16x32_bf16 a[112:115], a[200:203], v[184:187], 0
s_waitcnt lgkmcnt(0)
ds_read_b64_tr_b16 a[208:209], v20 offset:256
ds_read_b64_tr_b16 a[210:211], v20 offset:6400
v_mfma_f32_16x16x32_bf16 a[112:115], a[204:207], v[200:203], a[112:115]
ds_read_b64_tr_b16 a[212:213], v20 offset:12544
ds_read_b64_tr_b16 a[214:215], v20 offset:18688
v_mfma_f32_16x16x32_bf16 a[116:119], a[200:203], v[188:191], 0
v_add_u32 v16, s3, v16
v_add_u32 v17, s3, v17
v_mfma_f32_16x16x32_bf16 a[116:119], a[204:207], v[204:207], a[116:119]
v_exp_f32 v44, v172
v_mfma_f32_16x16x32_bf16 a[120:123], a[200:203], v[192:195], 0
v_cvt_pk_bf16_f32 v235, v42, v43
v_add_f32 v37, v37, v44
v_mfma_f32_16x16x32_bf16 a[120:123], a[204:207], v[208:211], a[120:123]
v_exp_f32 v45, v173
v_mfma_f32_16x16x32_bf16 a[124:127], a[200:203], v[196:199], 0
v_add_f32 v37, v37, v45
v_cvt_pk_bf16_f32 v238, v44, v45
v_mfma_f32_16x16x32_bf16 a[124:127], a[204:207], v[212:215], a[124:127]
s_waitcnt lgkmcnt(2)
v_exp_f32 v46, v174
v_mfma_f32_16x16x32_bf16 a[128:131], a[208:211], v[184:187], 0
s_waitcnt lgkmcnt(0)
ds_read_b64_tr_b16 a[192:193], v21 offset:256
ds_read_b64_tr_b16 a[194:195], v21 offset:6400
v_mfma_f32_16x16x32_bf16 a[128:131], a[212:215], v[200:203], a[128:131]
ds_read_b64_tr_b16 a[196:197], v21 offset:12544
ds_read_b64_tr_b16 a[198:199], v21 offset:18688
v_mfma_f32_16x16x32_bf16 a[132:135], a[208:211], v[188:191], 0
s_mov_b32 s101, s53
v_exp_f32 v47, v175
v_mfma_f32_16x16x32_bf16 a[132:135], a[212:215], v[204:207], a[132:135]
v_add_f32 v37, v37, v46
v_add_f32 v37, v37, v47
v_mfma_f32_16x16x32_bf16 a[136:139], a[208:211], v[192:195], 0
s_mov_b32 s53, s54
v_exp_f32 v40, v176
v_mfma_f32_16x16x32_bf16 a[136:139], a[212:215], v[208:211], a[136:139]
v_cvt_pk_bf16_f32 v239, v46, v47
v_add_f32 v38, v38, v40
v_mfma_f32_16x16x32_bf16 a[140:143], a[208:211], v[196:199], 0
s_mov_b32 s54, s27
v_exp_f32 v41, v177
v_mfma_f32_16x16x32_bf16 a[140:143], a[212:215], v[212:215], a[140:143]
s_waitcnt lgkmcnt(2)
v_add_f32 v38, v38, v41
v_cvt_pk_bf16_f32 v242, v40, v41
v_mfma_f32_16x16x32_bf16 a[144:147], a[192:195], v[184:187], 0
s_waitcnt lgkmcnt(0)
s_mov_b32 s27, s101
ds_read_b64_tr_b16 a[200:201], v22 offset:256
ds_read_b64_tr_b16 a[202:203], v22 offset:6400
v_mfma_f32_16x16x32_bf16 a[144:147], a[196:199], v[200:203], a[144:147]
ds_read_b64_tr_b16 a[204:205], v22 offset:12544
ds_read_b64_tr_b16 a[206:207], v22 offset:18688
v_mfma_f32_16x16x32_bf16 a[148:151], a[192:195], v[188:191], 0
v_exp_f32 v42, v178
v_mfma_f32_16x16x32_bf16 a[148:151], a[196:199], v[204:207], a[148:151]
v_exp_f32 v43, v179
v_mfma_f32_16x16x32_bf16 a[152:155], a[192:195], v[192:195], 0
v_add_f32 v38, v38, v42
v_add_f32 v38, v38, v43
v_mfma_f32_16x16x32_bf16 a[152:155], a[196:199], v[208:211], a[152:155]
v_exp_f32 v44, v180
v_mfma_f32_16x16x32_bf16 a[156:159], a[192:195], v[196:199], 0
v_cvt_pk_bf16_f32 v243, v42, v43
v_add_f32 v39, v39, v44
v_mfma_f32_16x16x32_bf16 a[156:159], a[196:199], v[212:215], a[156:159]
s_waitcnt lgkmcnt(2)
v_exp_f32 v45, v181
v_mfma_f32_16x16x32_bf16 a[160:163], a[200:203], v[184:187], 0
s_waitcnt lgkmcnt(0)
ds_read_b64_tr_b16 a[208:209], v23 offset:256
ds_read_b64_tr_b16 a[210:211], v23 offset:6400
v_mfma_f32_16x16x32_bf16 a[160:163], a[204:207], v[200:203], a[160:163]
ds_read_b64_tr_b16 a[212:213], v23 offset:12544
ds_read_b64_tr_b16 a[214:215], v23 offset:18688
v_mfma_f32_16x16x32_bf16 a[164:167], a[200:203], v[188:191], 0
v_add_f32 v39, v39, v45
v_cvt_pk_bf16_f32 v246, v44, v45
v_mfma_f32_16x16x32_bf16 a[164:167], a[204:207], v[204:207], a[164:167]
v_exp_f32 v46, v182
v_mfma_f32_16x16x32_bf16 a[168:171], a[200:203], v[192:195], 0
v_exp_f32 v47, v183
v_mfma_f32_16x16x32_bf16 a[168:171], a[204:207], v[208:211], a[168:171]
v_add_f32 v39, v39, v46
v_add_f32 v39, v39, v47
v_mfma_f32_16x16x32_bf16 a[172:175], a[200:203], v[196:199], 0
v_cvt_pk_bf16_f32 v247, v46, v47
v_mfma_f32_16x16x32_bf16 a[172:175], a[204:207], v[212:215], a[172:175]
s_waitcnt lgkmcnt(2)
v_mfma_f32_16x16x32_bf16 a[176:179], a[208:211], v[184:187], 0
s_waitcnt lgkmcnt(0)
ds_read_b128 a[192:195], v16 offset:0
v_mfma_f32_16x16x32_bf16 a[176:179], a[212:215], v[200:203], a[176:179]
ds_read_b128 a[196:199], v17 offset:0
v_mfma_f32_16x16x32_bf16 a[180:183], a[208:211], v[188:191], 0
v_mfma_f32_16x16x32_bf16 a[180:183], a[212:215], v[204:207], a[180:183]
v_mfma_f32_16x16x32_bf16 a[184:187], a[208:211], v[192:195], 0
v_max3_f32 v48, v36, v37, v38
v_max_f32 v48, v48, v39
v_mfma_f32_16x16x32_bf16 a[184:187], a[212:215], v[208:211], a[184:187]
v_cmp_lt_f32 vcc, 0x49800000, v48
v_mfma_f32_16x16x32_bf16 a[188:191], a[208:211], v[196:199], 0
v_mfma_f32_16x16x32_bf16 a[188:191], a[212:215], v[212:215], a[188:191]
s_cbranch_vccnz L_stub1
L_back1:
s_getpc_b64 s[96:97]
L_pc1:
s_mov_b32 s45, 14
.p2align 6
L_at_loop:
s_waitcnt lgkmcnt(1)
v_mfma_f32_16x16x32_bf16 v[120:123], a[192:195], v[64:67], v[248:251]
s_waitcnt lgkmcnt(0)
s_sub_u32 s100, s53, s27
ds_read_b128 a[200:203], v16 offset:128
v_add_f32 v32, v32, v36
v_mfma_f32_16x16x32_bf16 v[120:123], a[196:199], v[80:83], v[120:123]
ds_read_b128 a[204:207], v17 offset:128
v_add_f32 v33, v33, v37
v_mfma_f32_16x16x32_bf16 v[124:127], a[192:195], v[68:71], v[252:255]
v_add_u32 v20, s100, v20
v_add_u32 v21, s100, v21
v_mfma_f32_16x16x32_bf16 v[124:127], a[196:199], v[84:87], v[124:127]
s_add_u32 m0, s53, 73728
v_add_u32 v22, s100, v22
v_add_u32 v23, s100, v23
v_mfma_f32_16x16x32_bf16 v[128:131], a[192:195], v[72:75], v[24:27]
buffer_load_dwordx4 v4, s[8:11], s40 offen offset:0 lds
v_mfma_f32_16x16x32_bf16 v[128:131], a[196:199], v[88:91], v[128:131]
v_add_f32 v34, v34, v38
v_add_f32 v35, v35, v39
v_mfma_f32_16x16x32_bf16 v[132:135], a[192:195], v[76:79], v[12:15]
v_mfma_f32_16x16x32_bf16 v[132:135], a[196:199], v[92:95], v[132:135]
s_waitcnt lgkmcnt(1)
v_mfma_f32_16x16x32_bf16 v[120:123], a[200:203], v[96:99], v[120:123]
s_waitcnt lgkmcnt(0)
ds_read_b128 a[208:211], v16 offset:256
v_mfma_f32_16x16x32_bf16 v[120:123], a[204:207], v[112:115], v[120:123]
ds_read_b128 a[212:215], v17 offset:256
v_mfma_f32_16x16x32_bf16 v[124:127], a[200:203], v[100:103], v[124:127]
buffer_load_dwordx4 v5, s[8:11], s40 offen offset:1024 lds
v_mfma_f32_16x16x32_bf16 v[124:127], a[204:207], v[116:119], v[124:127]
v_mfma_f32_16x16x32_bf16 v[128:131], a[200:203], v[104:107], v[128:131]
v_mfma_f32_16x16x32_bf16 v[128:131], a[204:207], a[216:219], v[128:131]
v_mfma_f32_16x16x32_bf16 v[132:135], a[200:203], v[108:111], v[132:135]
v_mfma_f32_16x16x32_bf16 v[132:135], a[204:207], a[220:223], v[132:135]
s_waitcnt lgkmcnt(1)
ds_read_b128 a[192:195], v16 offset:6144
v_mfma_f32_16x16x32_bf16 v[120:123], a[208:211], a[224:227], v[120:123]
s_waitcnt lgkmcnt(1)
buffer_load_dwordx4 v6, s[8:11], s40 offen offset:2048 lds
v_mfma_f32_16x16x32_bf16 v[120:123], a[212:215], a[240:243], v[120:123]
ds_read_b128 a[196:199], v17 offset:6144
v_mfma_f32_16x16x32_bf16 v[124:127], a[208:211], a[228:231], v[124:127]
s_add_u32 s40, s40, 12288
v_mfma_f32_16x16x32_bf16 v[124:127], a[212:215], a[244:247], v[124:127]
v_mfma_f32_16x16x32_bf16 v[128:131], a[208:211], a[232:235], v[128:131]
v_mfma_f32_16x16x32_bf16 v[128:131], a[212:215], a[248:251], v[128:131]
s_add_u32 m0, s53, 86016
v_mfma_f32_16x16x32_bf16 v[132:135], a[208:211], a[236:239], v[132:135]
buffer_load_dwordx4 v4, s[8:11], s40 offen offset:0 lds
v_mfma_f32_16x16x32_bf16 v[132:135], a[212:215], a[252:255], v[132:135]
s_waitcnt lgkmcnt(1)
v_mfma_f32_16x16x32_bf16 v[136:139], a[192:195], v[64:67], v[248:251]
s_waitcnt lgkmcnt(0)
ds_read_b128 a[200:203], v16 offset:6272
v_mfma_f32_16x16x32_bf16 v[136:139], a[196:199], v[80:83], v[136:139]
ds_read_b128 a[204:207], v17 offset:6272
v_mfma_f32_16x16x32_bf16 v[140:143], a[192:195], v[68:71], v[252:255]
v_exp_f32 v40, v120
v_mfma_f32_16x16x32_bf16 v[140:143], a[196:199], v[84:87], v[140:143]
v_exp_f32 v41, v121
v_mfma_f32_16x16x32_bf16 v[144:147], a[192:195], v[72:75], v[24:27]
buffer_load_dwordx4 v5, s[8:11], s40 offen offset:1024 lds
v_mfma_f32_16x16x32_bf16 v[144:147], a[196:199], v[88:91], v[144:147]
v_add_f32 v36, v40, v41
v_cvt_pk_bf16_f32 v184, v40, v41
v_mfma_f32_16x16x32_bf16 v[148:151], a[192:195], v[76:79], v[12:15]
v_exp_f32 v42, v122
v_mfma_f32_16x16x32_bf16 v[148:151], a[196:199], v[92:95], v[148:151]
s_waitcnt lgkmcnt(1)
v_exp_f32 v43, v123
v_mfma_f32_16x16x32_bf16 v[136:139], a[200:203], v[96:99], v[136:139]
s_waitcnt lgkmcnt(0)
ds_read_b128 a[208:211], v16 offset:6400
v_add_f32 v36, v36, v42
v_mfma_f32_16x16x32_bf16 v[136:139], a[204:207], v[112:115], v[136:139]
ds_read_b128 a[212:215], v17 offset:6400
v_add_f32 v36, v36, v43
v_mfma_f32_16x16x32_bf16 v[140:143], a[200:203], v[100:103], v[140:143]
buffer_load_dwordx4 v6, s[8:11], s40 offen offset:2048 lds
v_mfma_f32_16x16x32_bf16 v[140:143], a[204:207], v[116:119], v[140:143]
v_exp_f32 v44, v124
v_mfma_f32_16x16x32_bf16 v[144:147], a[200:203], v[104:107], v[144:147]
s_add_u32 s40, s40, 12288
v_exp_f32 v45, v125
v_mfma_f32_16x16x32_bf16 v[144:147], a[204:207], a[216:219], v[144:147]
v_cvt_pk_bf16_f32 v185, v42, v43
v_add_f32 v37, v44, v45
v_mfma_f32_16x16x32_bf16 v[148:151], a[200:203], v[108:111], v[148:151]
v_exp_f32 v46, v126
v_mfma_f32_16x16x32_bf16 v[148:151], a[204:207], a[220:223], v[148:151]
s_waitcnt lgkmcnt(1)
v_cvt_pk_bf16_f32 v188, v44, v45
v_add_f32 v37, v37, v46
v_mfma_f32_16x16x32_bf16 v[136:139], a[208:211], a[224:227], v[136:139]
s_waitcnt lgkmcnt(0)
ds_read_b128 a[192:195], v16 offset:12288
v_mfma_f32_16x16x32_bf16 v[136:139], a[212:215], a[240:243], v[136:139]
ds_read_b128 a[196:199], v17 offset:12288
v_mfma_f32_16x16x32_bf16 v[140:143], a[208:211], a[228:231], v[140:143]
v_exp_f32 v47, v127
v_mfma_f32_16x16x32_bf16 v[140:143], a[212:215], a[244:247], v[140:143]
v_add_f32 v37, v37, v47
v_cvt_pk_bf16_f32 v189, v46, v47
v_mfma_f32_16x16x32_bf16 v[144:147], a[208:211], a[232:235], v[144:147]
v_mfma_f32_16x16x32_bf16 v[144:147], a[212:215], a[248:251], v[144:147]
v_exp_f32 v40, v128
v_mfma_f32_16x16x32_bf16 v[148:151], a[208:211], a[236:239], v[148:151]
v_exp_f32 v41, v129
v_mfma_f32_16x16x32_bf16 v[148:151], a[212:215], a[252:255], v[148:151]
s_waitcnt lgkmcnt(1)
v_add_f32 v38, v40, v41
v_cvt_pk_bf16_f32 v192, v40, v41
v_mfma_f32_16x16x32_bf16 v[152:155], a[192:195], v[64:67], v[248:251]
s_waitcnt lgkmcnt(0)
ds_read_b128 a[200:203], v16 offset:12416
v_mfma_f32_16x16x32_bf16 v[152:155], a[196:199], v[80:83], v[152:155]
ds_read_b128 a[204:207], v17 offset:12416
v_mfma_f32_16x16x32_bf16 v[156:159], a[192:195], v[68:71], v[252:255]
v_exp_f32 v42, v130
v_mfma_f32_16x16x32_bf16 v[156:159], a[196:199], v[84:87], v[156:159]
v_exp_f32 v43, v131
v_mfma_f32_16x16x32_bf16 v[160:163], a[192:195], v[72:75], v[24:27]
v_add_f32 v38, v38, v42
v_add_f32 v38, v38, v43
v_mfma_f32_16x16x32_bf16 v[160:163], a[196:199], v[88:91], v[160:163]
v_exp_f32 v44, v132
v_mfma_f32_16x16x32_bf16 v[164:167], a[192:195], v[76:79], v[12:15]
v_exp_f32 v45, v133
v_mfma_f32_16x16x32_bf16 v[164:167], a[196:199], v[92:95], v[164:167]
s_waitcnt lgkmcnt(1)
v_cvt_pk_bf16_f32 v193, v42, v43
v_add_f32 v39, v44, v45
v_mfma_f32_16x16x32_bf16 v[152:155], a[200:203], v[96:99], v[152:155]
s_waitcnt lgkmcnt(0)
ds_read_b128 a[208:211], v16 offset:12544
v_cvt_pk_bf16_f32 v196, v44, v45
v_mfma_f32_16x16x32_bf16 v[152:155], a[204:207], v[112:115], v[152:155]
ds_read_b128 a[212:215], v17 offset:12544
v_mfma_f32_16x16x32_bf16 v[156:159], a[200:203], v[100:103], v[156:159]
v_exp_f32 v46, v134
v_mfma_f32_16x16x32_bf16 v[156:159], a[204:207], v[116:119], v[156:159]
v_exp_f32 v47, v135
v_mfma_f32_16x16x32_bf16 v[160:163], a[200:203], v[104:107], v[160:163]
v_add_f32 v39, v39, v46
v_add_f32 v39, v39, v47
v_mfma_f32_16x16x32_bf16 v[160:163], a[204:207], a[216:219], v[160:163]
v_exp_f32 v40, v136
v_mfma_f32_16x16x32_bf16 v[164:167], a[200:203], v[108:111], v[164:167]
v_cvt_pk_bf16_f32 v197, v46, v47
v_add_f32 v36, v36, v40
v_mfma_f32_16x16x32_bf16 v[164:167], a[204:207], a[220:223], v[164:167]
s_waitcnt lgkmcnt(1)
v_exp_f32 v41, v137
v_mfma_f32_16x16x32_bf16 v[152:155], a[208:211], a[224:227], v[152:155]
s_waitcnt lgkmcnt(0)
ds_read_b128 a[192:195], v16 offset:18432
v_add_f32 v36, v36, v41
v_mfma_f32_16x16x32_bf16 v[152:155], a[212:215], a[240:243], v[152:155]
ds_read_b128 a[196:199], v17 offset:18432
v_cvt_pk_bf16_f32 v186, v40, v41
v_mfma_f32_16x16x32_bf16 v[156:159], a[208:211], a[228:231], v[156:159]
v_exp_f32 v42, v138
v_mfma_f32_16x16x32_bf16 v[156:159], a[212:215], a[244:247], v[156:159]
v_exp_f32 v43, v139
v_mfma_f32_16x16x32_bf16 v[160:163], a[208:211], a[232:235], v[160:163]
v_add_f32 v36, v36, v42
v_add_f32 v36, v36, v43
v_mfma_f32_16x16x32_bf16 v[160:163], a[212:215], a[248:251], v[160:163]
v_exp_f32 v44, v140
v_mfma_f32_16x16x32_bf16 v[164:167], a[208:211], a[236:239], v[164:167]
v_cvt_pk_bf16_f32 v187, v42, v43
v_add_f32 v37, v37, v44
v_mfma_f32_16x16x32_bf16 v[164:167], a[212:215], a[252:255], v[164:167]
s_waitcnt lgkmcnt(1)
v_exp_f32 v45, v141
v_mfma_f32_16x16x32_bf16 v[168:171], a[192:195], v[64:67], v[248:251]
s_waitcnt lgkmcnt(0)
ds_read_b128 a[200:203], v16 offset:18560
v_add_f32 v37, v37, v45
v_mfma_f32_16x16x32_bf16 v[168:171], a[196:199], v[80:83], v[168:171]
ds_read_b128 a[204:207], v17 offset:18560
v_cvt_pk_bf16_f32 v190, v44, v45
v_mfma_f32_16x16x32_bf16 v[172:175], a[192:195], v[68:71], v[252:255]
v_exp_f32 v46, v142
v_mfma_f32_16x16x32_bf16 v[172:175], a[196:199], v[84:87], v[172:175]
v_exp_f32 v47, v143
v_mfma_f32_16x16x32_bf16 v[176:179], a[192:195], v[72:75], v[24:27]
v_add_f32 v37, v37, v46
v_add_f32 v37, v37, v47
v_mfma_f32_16x16x32_bf16 v[176:179], a[196:199], v[88:91], v[176:179]
v_exp_f32 v40, v144
v_mfma_f32_16x16x32_bf16 v[180:183], a[192:195], v[76:79], v[12:15]
v_cvt_pk_bf16_f32 v191, v46, v47
v_add_f32 v38, v38, v40
v_mfma_f32_16x16x32_bf16 v[180:183], a[196:199], v[92:95], v[180:183]
s_waitcnt lgkmcnt(1)
v_exp_f32 v41, v145
v_mfma_f32_16x16x32_bf16 v[168:171], a[200:203], v[96:99], v[168:171]
s_waitcnt lgkmcnt(0)
ds_read_b128 a[208:211], v16 offset:18688
v_add_f32 v38, v38, v41
v_mfma_f32_16x16x32_bf16 v[168:171], a[204:207], v[112:115], v[168:171]
ds_read_b128 a[212:215], v17 offset:18688
v_cvt_pk_bf16_f32 v194, v40, v41
v_mfma_f32_16x16x32_bf16 v[172:175], a[200:203], v[100:103], v[172:175]
v_exp_f32 v42, v146
v_mfma_f32_16x16x32_bf16 v[172:175], a[204:207], v[116:119], v[172:175]
v_exp_f32 v43, v147
v_mfma_f32_16x16x32_bf16 v[176:179], a[200:203], v[104:107], v[176:179]
v_add_f32 v38, v38, v42
v_add_f32 v38, v38, v43
v_mfma_f32_16x16x32_bf16 v[176:179], a[204:207], a[216:219], v[176:179]
v_exp_f32 v44, v148
v_mfma_f32_16x16x32_bf16 v[180:183], a[200:203], v[108:111], v[180:183]
v_cvt_pk_bf16_f32 v195, v42, v43
v_add_f32 v39, v39, v44
v_mfma_f32_16x16x32_bf16 v[180:183], a[204:207], a[220:223], v[180:183]
s_waitcnt lgkmcnt(1)
v_exp_f32 v45, v149
v_mfma_f32_16x16x32_bf16 v[168:171], a[208:211], a[224:227], v[168:171]
s_waitcnt lgkmcnt(0)
ds_read_b64_tr_b16 a[192:193], v20 offset:0
ds_read_b64_tr_b16 a[194:195], v20 offset:6144
v_mfma_f32_16x16x32_bf16 v[168:171], a[212:215], a[240:243], v[168:171]
ds_read_b64_tr_b16 a[196:197], v20 offset:12288
ds_read_b64_tr_b16 a[198:199], v20 offset:18432
v_mfma_f32_16x16x32_bf16 v[172:175], a[208:211], a[228:231], v[172:175]
v_add_f32 v39, v39, v45
v_cvt_pk_bf16_f32 v198, v44, v45
v_mfma_f32_16x16x32_bf16 v[172:175], a[212:215], a[244:247], v[172:175]
v_exp_f32 v46, v150
v_mfma_f32_16x16x32_bf16 v[176:179], a[208:211], a[232:235], v[176:179]
v_exp_f32 v47, v151
v_mfma_f32_16x16x32_bf16 v[176:179], a[212:215], a[248:251], v[176:179]
v_add_f32 v39, v39, v46
v_add_f32 v39, v39, v47
v_mfma_f32_16x16x32_bf16 v[180:183], a[208:211], a[236:239], v[180:183]
v_exp_f32 v40, v152
v_mfma_f32_16x16x32_bf16 v[180:183], a[212:215], a[252:255], v[180:183]
s_waitcnt lgkmcnt(2)
v_cvt_pk_bf16_f32 v199, v46, v47
v_add_f32 v36, v36, v40
v_mfma_f32_16x16x32_bf16 a[0:3], a[192:195], v[216:219], a[0:3]
s_waitcnt lgkmcnt(0)
ds_read_b64_tr_b16 a[200:201], v21 offset:0
ds_read_b64_tr_b16 a[202:203], v21 offset:6144
v_mfma_f32_16x16x32_bf16 a[0:3], a[196:199], v[232:235], a[0:3]
ds_read_b64_tr_b16 a[204:205], v21 offset:12288
ds_read_b64_tr_b16 a[206:207], v21 offset:18432
v_mfma_f32_16x16x32_bf16 a[4:7], a[192:195], v[220:223], a[4:7]
v_exp_f32 v41, v153
v_mfma_f32_16x16x32_bf16 a[4:7], a[196:199], v[236:239], a[4:7]
v_add_f32 v36, v36, v41
v_cvt_pk_bf16_f32 v200, v40, v41
v_mfma_f32_16x16x32_bf16 a[8:11], a[192:195], v[224:227], a[8:11]
s_waitcnt vmcnt(6)
s_barrier
v_mfma_f32_16x16x32_bf16 a[8:11], a[196:199], v[240:243], a[8:11]
v_exp_f32 v42, v154
v_mfma_f32_16x16x32_bf16 a[12:15], a[192:195], v[228:231], a[12:15]
s_add_u32 m0, s27, 0
v_exp_f32 v43, v155
v_mfma_f32_16x16x32_bf16 a[12:15], a[196:199], v[244:247], a[12:15]
s_waitcnt lgkmcnt(2)
buffer_load_dwordx4 v7, s[12:15], s41 offen offset:0 lds
v_mfma_f32_16x16x32_bf16 a[16:19], a[200:203], v[216:219], a[16:19]
s_waitcnt lgkmcnt(0)
ds_read_b64_tr_b16 a[208:209], v22 offset:0
ds_read_b64_tr_b16 a[210:211], v22 offset:6144
v_mfma_f32_16x16x32_bf16 a[16:19], a[204:207], v[232:235], a[16:19]
ds_read_b64_tr_b16 a[212:213], v22 offset:12288
ds_read_b64_tr_b16 a[214:215], v22 offset:18432
v_mfma_f32_16x16x32_bf16 a[20:23], a[200:203], v[220:223], a[20:23]
v_add_f32 v36, v36, v42
v_add_f32 v36, v36, v43
v_mfma_f32_16x16x32_bf16 a[20:23], a[204:207], v[236:239], a[20:23]
buffer_load_dwordx4 v8, s[12:15], s41 offen offset:1024 lds
v_mfma_f32_16x16x32_bf16 a[24:27], a[200:203], v[224:227], a[24:27]
v_exp_f32 v44, v156
v_mfma_f32_16x16x32_bf16 a[24:27], a[204:207], v[240:243], a[24:27]
v_cvt_pk_bf16_f32 v201, v42, v43
v_add_f32 v37, v37, v44
v_mfma_f32_16x16x32_bf16 a[28:31], a[200:203], v[228:231], a[28:31]
v_exp_f32 v45, v157
v_mfma_f32_16x16x32_bf16 a[28:31], a[204:207], v[244:247], a[28:31]
s_waitcnt lgkmcnt(2)
buffer_load_dwordx4 v9, s[12:15], s41 offen offset:2048 lds
v_mfma_f32_16x16x32_bf16 a[32:35], a[208:211], v[216:219], a[32:35]
s_waitcnt lgkmcnt(0)
ds_read_b64_tr_b16 a[192:193], v23 offset:0
ds_read_b64_tr_b16 a[194:195], v23 offset:6144
v_mfma_f32_16x16x32_bf16 a[32:35], a[212:215], v[232:235], a[32:35]
s_add_u32 s41, s41, 12288
ds_read_b64_tr_b16 a[196:197], v23 offset:12288
ds_read_b64_tr_b16 a[198:199], v23 offset:18432
v_mfma_f32_16x16x32_bf16 a[36:39], a[208:211], v[220:223], a[36:39]
s_add_u32 m0, s27, 12288
v_add_f32 v37, v37, v45
v_cvt_pk_bf16_f32 v204, v44, v45
v_mfma_f32_16x16x32_bf16 a[36:39], a[212:215], v[236:239], a[36:39]
buffer_load_dwordx4 v7, s[12:15], s41 offen offset:0 lds
v_mfma_f32_16x16x32_bf16 a[40:43], a[208:211], v[224:227], a[40:43]
v_exp_f32 v46, v158
v_mfma_f32_16x16x32_bf16 a[40:43], a[212:215], v[240:243], a[40:43]
v_exp_f32 v47, v159
v_mfma_f32_16x16x32_bf16 a[44:47], a[208:211], v[228:231], a[44:47]
v_add_f32 v37, v37, v46
v_add_f32 v37, v37, v47
v_mfma_f32_16x16x32_bf16 a[44:47], a[212:215], v[244:247], a[44:47]
s_waitcnt lgkmcnt(2)
buffer_load_dwordx4 v8, s[12:15], s41 offen offset:1024 lds
v_mfma_f32_16x16x32_bf16 a[48:51], a[192:195], v[216:219], a[48:51]
s_waitcnt lgkmcnt(0)
ds_read_b64_tr_b16 a[200:201], v20 offset:128
ds_read_b64_tr_b16 a[202:203], v20 offset:6272
v_mfma_f32_16x16x32_bf16 a[48:51], a[196:199], v[232:235], a[48:51]
ds_read_b64_tr_b16 a[204:205], v20 offset:12416
ds_read_b64_tr_b16 a[206:207], v20 offset:18560
v_mfma_f32_16x16x32_bf16 a[52:55], a[192:195], v[220:223], a[52:55]
v_exp_f32 v40, v160
v_mfma_f32_16x16x32_bf16 a[52:55], a[196:199], v[236:239], a[52:55]
buffer_load_dwordx4 v9, s[12:15], s41 offen offset:2048 lds
v_mfma_f32_16x16x32_bf16 a[56:59], a[192:195], v[224:227], a[56:59]
v_cvt_pk_bf16_f32 v205, v46, v47
v_add_f32 v38, v38, v40
v_mfma_f32_16x16x32_bf16 a[56:59], a[196:199], v[240:243], a[56:59]
s_add_u32 s41, s41, 12288
v_exp_f32 v41, v161
v_mfma_f32_16x16x32_bf16 a[60:63], a[192:195], v[228:231], a[60:63]
v_add_f32 v38, v38, v41
v_cvt_pk_bf16_f32 v208, v40, v41
v_mfma_f32_16x16x32_bf16 a[60:63], a[196:199], v[244:247], a[60:63]
s_waitcnt lgkmcnt(2)
v_exp_f32 v42, v162
v_mfma_f32_16x16x32_bf16 a[64:67], a[200:203], v[216:219], a[64:67]
s_waitcnt lgkmcnt(0)
ds_read_b64_tr_b16 a[208:209], v21 offset:128
ds_read_b64_tr_b16 a[210:211], v21 offset:6272
v_mfma_f32_16x16x32_bf16 a[64:67], a[204:207], v[232:235], a[64:67]
ds_read_b64_tr_b16 a[212:213], v21 offset:12416
ds_read_b64_tr_b16 a[214:215], v21 offset:18560
v_mfma_f32_16x16x32_bf16 a[68:71], a[200:203], v[220:223], a[68:71]
v_exp_f32 v43, v163
v_mfma_f32_16x16x32_bf16 a[68:71], a[204:207], v[236:239], a[68:71]
v_add_f32 v38, v38, v42
v_add_f32 v38, v38, v43
v_mfma_f32_16x16x32_bf16 a[72:75], a[200:203], v[224:227], a[72:75]
buffer_store_dword v16, off, s[60:63], s59 sc1
v_mfma_f32_16x16x32_bf16 a[72:75], a[204:207], v[240:243], a[72:75]
v_exp_f32 v44, v164
v_mfma_f32_16x16x32_bf16 a[76:79], a[200:203], v[228:231], a[76:79]
v_cvt_pk_bf16_f32 v209, v42, v43
v_add_f32 v39, v39, v44
v_mfma_f32_16x16x32_bf16 a[76:79], a[204:207], v[244:247], a[76:79]
s_waitcnt lgkmcnt(2)
v_exp_f32 v45, v165
v_mfma_f32_16x16x32_bf16 a[80:83], a[208:211], v[216:219], a[80:83]
s_waitcnt lgkmcnt(0)
ds_read_b64_tr_b16 a[192:193], v22 offset:128
ds_read_b64_tr_b16 a[194:195], v22 offset:6272
v_mfma_f32_16x16x32_bf16 a[80:83], a[212:215], v[232:235], a[80:83]
ds_read_b64_tr_b16 a[196:197], v22 offset:12416
ds_read_b64_tr_b16 a[198:199], v22 offset:18560
v_mfma_f32_16x16x32_bf16 a[84:87], a[208:211], v[220:223], a[84:87]
v_add_f32 v39, v39, v45
v_cvt_pk_bf16_f32 v212, v44, v45
v_mfma_f32_16x16x32_bf16 a[84:87], a[212:215], v[236:239], a[84:87]
v_exp_f32 v46, v166
v_mfma_f32_16x16x32_bf16 a[88:91], a[208:211], v[224:227], a[88:91]
v_mfma_f32_16x16x32_bf16 a[88:91], a[212:215], v[240:243], a[88:91]
v_exp_f32 v47, v167
v_mfma_f32_16x16x32_bf16 a[92:95], a[208:211], v[228:231], a[92:95]
v_add_f32 v39, v39, v46
v_add_f32 v39, v39, v47
v_mfma_f32_16x16x32_bf16 a[92:95], a[212:215], v[244:247], a[92:95]
s_waitcnt lgkmcnt(2)
v_exp_f32 v40, v168
v_mfma_f32_16x16x32_bf16 a[96:99], a[192:195], v[216:219], a[96:99]
s_waitcnt lgkmcnt(0)
ds_read_b64_tr_b16 a[200:201], v23 offset:128
ds_read_b64_tr_b16 a[202:203], v23 offset:6272
v_mfma_f32_16x16x32_bf16 a[96:99], a[196:199], v[232:235], a[96:99]
ds_read_b64_tr_b16 a[204:205], v23 offset:12416
ds_read_b64_tr_b16 a[206:207], v23 offset:18560
v_mfma_f32_16x16x32_bf16 a[100:103], a[192:195], v[220:223], a[100:103]
v_cvt_pk_bf16_f32 v213, v46, v47
v_add_f32 v36, v36, v40
v_mfma_f32_16x16x32_bf16 a[100:103], a[196:199], v[236:239], a[100:103]
v_exp_f32 v41, v169
v_mfma_f32_16x16x32_bf16 a[104:107], a[192:195], v[224:227], a[104:107]
v_add_f32 v36, v36, v41
v_cvt_pk_bf16_f32 v202, v40, v41
v_mfma_f32_16x16x32_bf16 a[104:107], a[196:199], v[240:243], a[104:107]
v_exp_f32 v42, v170
v_mfma_f32_16x16x32_bf16 a[108:111], a[192:195], v[228:231], a[108:111]
s_sub_u32 s3, s27, s54
v_exp_f32 v43, v171
v_mfma_f32_16x16x32_bf16 a[108:111], a[196:199], v[244:247], a[108:111]
s_waitcnt lgkmcnt(2)
v_add_f32 v36, v36, v42
v_add_f32 v36, v36, v43
v_mfma_f32_16x16x32_bf16 a[112:115], a[200:203], v[216:219], a[112:115]
s_waitcnt lgkmcnt(0)
ds_read_b64_tr_b16 a[208:209], v20 offset:256
ds_read_b64_tr_b16 a[210:211], v20 offset:6400
v_mfma_f32_16x16x32_bf16 a[112:115], a[204:207], v[232:235], a[112:115]
ds_read_b64_tr_b16 a[212:213], v20 offset:12544
ds_read_b64_tr_b16 a[214:215], v20 offset:18688
v_mfma_f32_16x16x32_bf16 a[116:119], a[200:203], v[220:223], a[116:119]
v_add_u32 v16, s3, v16
v_add_u32 v17, s3, v17
v_mfma_f32_16x16x32_bf16 a[116:119], a[204:207], v[236:239], a[116:119]
v_exp_f32 v44, v172
v_mfma_f32_16x16x32_bf16 a[120:123], a[200:203], v[224:227], a[120:123]
v_cvt_pk_bf16_f32 v203, v42, v43
v_add_f32 v37, v37, v44
v_mfma_f32_16x16x32_bf16 a[120:123], a[204:207], v[240:243], a[120:123]
v_exp_f32 v45, v173
v_mfma_f32_16x16x32_bf16 a[124:127], a[200:203], v[228:231], a[124:127]
v_add_f32 v37, v37, v45
v_cvt_pk_bf16_f32 v206, v44, v45
v_mfma_f32_16x16x32_bf16 a[124:127], a[204:207], v[244:247], a[124:127]
s_waitcnt lgkmcnt(2)
v_exp_f32 v46, v174
v_mfma_f32_16x16x32_bf16 a[128:131], a[208:211], v[216:219], a[128:131]
s_waitcnt lgkmcnt(0)
ds_read_b64_tr_b16 a[192:193], v21 offset:256
ds_read_b64_tr_b16 a[194:195], v21 offset:6400
v_mfma_f32_16x16x32_bf16 a[128:131], a[212:215], v[232:235], a[128:131]
ds_read_b64_tr_b16 a[196:197], v21 offset:12544
ds_read_b64_tr_b16 a[198:199], v21 offset:18688
v_mfma_f32_16x16x32_bf16 a[132:135], a[208:211], v[220:223], a[132:135]
s_mov_b32 s101, s53
v_exp_f32 v47, v175
v_mfma_f32_16x16x32_bf16 a[132:135], a[212:215], v[236:239], a[132:135]
v_add_f32 v37, v37, v46
v_add_f32 v37, v37, v47
v_mfma_f32_16x16x32_bf16 a[136:139], a[208:211], v[224:227], a[136:139]
s_mov_b32 s53, s54
v_exp_f32 v40, v176
v_mfma_f32_16x16x32_bf16 a[136:139], a[212:215], v[240:243], a[136:139]
v_cvt_pk_bf16_f32 v207, v46, v47
v_add_f32 v38, v38, v40
v_mfma_f32_16x16x32_bf16 a[140:143], a[208:211], v[228:231], a[140:143]
s_mov_b32 s54, s27
v_exp_f32 v41, v177
v_mfma_f32_16x16x32_bf16 a[140:143], a[212:215], v[244:247], a[140:143]
s_waitcnt lgkmcnt(2)
v_add_f32 v38, v38, v41
v_cvt_pk_bf16_f32 v210, v40, v41
v_mfma_f32_16x16x32_bf16 a[144:147], a[192:195], v[216:219], a[144:147]
s_waitcnt lgkmcnt(0)
s_mov_b32 s27, s101
ds_read_b64_tr_b16 a[200:201], v22 offset:256
ds_read_b64_tr_b16 a[202:203], v22 offset:6400
v_mfma_f32_16x16x32_bf16 a[144:147], a[196:199], v[232:235], a[144:147]
ds_read_b64_tr_b16 a[204:205], v22 offset:12544
ds_read_b64_tr_b16 a[206:207], v22 offset:18688
v_mfma_f32_16x16x32_bf16 a[148:151], a[192:195], v[220:223], a[148:151]
v_exp_f32 v42, v178
v_mfma_f32_16x16x32_bf16 a[148:151], a[196:199], v[236:239], a[148:151]
v_exp_f32 v43, v179
v_mfma_f32_16x16x32_bf16 a[152:155], a[192:195], v[224:227], a[152:155]
v_add_f32 v38, v38, v42
v_add_f32 v38, v38, v43
v_mfma_f32_16x16x32_bf16 a[152:155], a[196:199], v[240:243], a[152:155]
v_exp_f32 v44, v180
v_mfma_f32_16x16x32_bf16 a[156:159], a[192:195], v[228:231], a[156:159]
v_cvt_pk_bf16_f32 v211, v42, v43
v_add_f32 v39, v39, v44
v_mfma_f32_16x16x32_bf16 a[156:159], a[196:199], v[244:247], a[156:159]
s_waitcnt lgkmcnt(2)
v_exp_f32 v45, v181
v_mfma_f32_16x16x32_bf16 a[160:163], a[200:203], v[216:219], a[160:163]
s_waitcnt lgkmcnt(0)
ds_read_b64_tr_b16 a[208:209], v23 offset:256
ds_read_b64_tr_b16 a[210:211], v23 offset:6400
v_mfma_f32_16x16x32_bf16 a[160:163], a[204:207], v[232:235], a[160:163]
ds_read_b64_tr_b16 a[212:213], v23 offset:12544
ds_read_b64_tr_b16 a[214:215], v23 offset:18688
v_mfma_f32_16x16x32_bf16 a[164:167], a[200:203], v[220:223], a[164:167]
v_add_f32 v39, v39, v45
v_cvt_pk_bf16_f32 v214, v44, v45
v_mfma_f32_16x16x32_bf16 a[164:167], a[204:207], v[236:239], a[164:167]
v_exp_f32 v46, v182
v_mfma_f32_16x16x32_bf16 a[168:171], a[200:203], v[224:227], a[168:171]
v_exp_f32 v47, v183
v_mfma_f32_16x16x32_bf16 a[168:171], a[204:207], v[240:243], a[168:171]
v_add_f32 v39, v39, v46
v_add_f32 v39, v39, v47
v_mfma_f32_16x16x32_bf16 a[172:175], a[200:203], v[228:231], a[172:175]
v_cvt_pk_bf16_f32 v215, v46, v47
v_mfma_f32_16x16x32_bf16 a[172:175], a[204:207], v[244:247], a[172:175]
s_waitcnt lgkmcnt(2)
v_mfma_f32_16x16x32_bf16 a[176:179], a[208:211], v[216:219], a[176:179]
s_waitcnt lgkmcnt(0)
ds_read_b128 a[192:195], v16 offset:0
v_mfma_f32_16x16x32_bf16 a[176:179], a[212:215], v[232:235], a[176:179]
ds_read_b128 a[196:199], v17 offset:0
v_mfma_f32_16x16x32_bf16 a[180:183], a[208:211], v[220:223], a[180:183]
v_mfma_f32_16x16x32_bf16 a[180:183], a[212:215], v[236:239], a[180:183]
v_mfma_f32_16x16x32_bf16 a[184:187], a[208:211], v[224:227], a[184:187]
v_max3_f32 v48, v36, v37, v38
v_max_f32 v48, v48, v39
v_mfma_f32_16x16x32_bf16 a[184:187], a[212:215], v[240:243], a[184:187]
v_cmp_lt_f32 vcc, 0x49800000, v48
v_mfma_f32_16x16x32_bf16 a[188:191], a[208:211], v[228:231], a[188:191]
v_mfma_f32_16x16x32_bf16 a[188:191], a[212:215], v[244:247], a[188:191]
s_cbranch_vccnz L_stub2
L_back2:
s_waitcnt lgkmcnt(1)
v_mfma_f32_16x16x32_bf16 v[120:123], a[192:195], v[64:67], v[248:251]
s_waitcnt lgkmcnt(0)
s_sub_u32 s100, s53, s27
ds_read_b128 a[200:203], v16 offset:128
v_add_f32 v32, v32, v36
v_mfma_f32_16x16x32_bf16 v[120:123], a[196:199], v[80:83], v[120:123]
ds_read_b128 a[204:207], v17 offset:128
v_add_f32 v33, v33, v37
v_mfma_f32_16x16x32_bf16 v[124:127], a[192:195], v[68:71], v[252:255]
v_add_u32 v20, s100, v20
v_add_u32 v21, s100, v21
v_mfma_f32_16x16x32_bf16 v[124:127], a[196:199], v[84:87], v[124:127]
s_add_u32 m0, s53, 73728
v_add_u32 v22, s100, v22
v_add_u32 v23, s100, v23
v_mfma_f32_16x16x32_bf16 v[128:131], a[192:195], v[72:75], v[24:27]
buffer_load_dwordx4 v4, s[8:11], s40 offen offset:0 lds
v_mfma_f32_16x16x32_bf16 v[128:131], a[196:199], v[88:91], v[128:131]
v_add_f32 v34, v34, v38
v_add_f32 v35, v35, v39
v_mfma_f32_16x16x32_bf16 v[132:135], a[192:195], v[76:79], v[12:15]
v_mfma_f32_16x16x32_bf16 v[132:135], a[196:199], v[92:95], v[132:135]
s_waitcnt lgkmcnt(1)
v_mfma_f32_16x16x32_bf16 v[120:123], a[200:203], v[96:99], v[120:123]
s_waitcnt lgkmcnt(0)
ds_read_b128 a[208:211], v16 offset:256
v_mfma_f32_16x16x32_bf16 v[120:123], a[204:207], v[112:115], v[120:123]
ds_read_b128 a[212:215], v17 offset:256
v_mfma_f32_16x16x32_bf16 v[124:127], a[200:203], v[100:103], v[124:127]
buffer_load_dwordx4 v5, s[8:11], s40 offen offset:1024 lds
v_mfma_f32_16x16x32_bf16 v[124:127], a[204:207], v[116:119], v[124:127]
v_mfma_f32_16x16x32_bf16 v[128:131], a[200:203], v[104:107], v[128:131]
v_mfma_f32_16x16x32_bf16 v[128:131], a[204:207], a[216:219], v[128:131]
v_mfma_f32_16x16x32_bf16 v[132:135], a[200:203], v[108:111], v[132:135]
v_mfma_f32_16x16x32_bf16 v[132:135], a[204:207], a[220:223], v[132:135]
s_waitcnt lgkmcnt(1)
ds_read_b128 a[192:195], v16 offset:6144
v_mfma_f32_16x16x32_bf16 v[120:123], a[208:211], a[224:227], v[120:123]
s_waitcnt lgkmcnt(1)
buffer_load_dwordx4 v6, s[8:11], s40 offen offset:2048 lds
v_mfma_f32_16x16x32_bf16 v[120:123], a[212:215], a[240:243], v[120:123]
ds_read_b128 a[196:199], v17 offset:6144
v_mfma_f32_16x16x32_bf16 v[124:127], a[208:211], a[228:231], v[124:127]
s_add_u32 s40, s40, 12288
v_mfma_f32_16x16x32_bf16 v[124:127], a[212:215], a[244:247], v[124:127]
v_mfma_f32_16x16x32_bf16 v[128:131], a[208:211], a[232:235], v[128:131]
v_mfma_f32_16x16x32_bf16 v[128:131], a[212:215], a[248:251], v[128:131]
s_add_u32 m0, s53, 86016
v_mfma_f32_16x16x32_bf16 v[132:135], a[208:211], a[236:239], v[132:135]
buffer_load_dwordx4 v4, s[8:11], s40 offen offset:0 lds
v_mfma_f32_16x16x32_bf16 v[132:135], a[212:215], a[252:255], v[132:135]
s_waitcnt lgkmcnt(1)
v_mfma_f32_16x16x32_bf16 v[136:139], a[192:195], v[64:67], v[248:251]
s_waitcnt lgkmcnt(0)
ds_read_b128 a[200:203], v16 offset:6272
v_mfma_f32_16x16x32_bf16 v[136:139], a[196:199], v[80:83], v[136:139]
ds_read_b128 a[204:207], v17 offset:6272
v_mfma_f32_16x16x32_bf16 v[140:143], a[192:195], v[68:71], v[252:255]
v_exp_f32 v40, v120
v_mfma_f32_16x16x32_bf16 v[140:143], a[196:199], v[84:87], v[140:143]
v_exp_f32 v41, v121
v_mfma_f32_16x16x32_bf16 v[144:147], a[192:195], v[72:75], v[24:27]
buffer_load_dwordx4 v5, s[8:11], s40 offen offset:1024 lds
v_mfma_f32_16x16x32_bf16 v[144:147], a[196:199], v[88:91], v[144:147]
v_add_f32 v36, v40, v41
v_cvt_pk_bf16_f32 v216, v40, v41
v_mfma_f32_16x16x32_bf16 v[148:151], a[192:195], v[76:79], v[12:15]
v_exp_f32 v42, v122
v_mfma_f32_16x16x32_bf16 v[148:151], a[196:199], v[92:95], v[148:151]
s_waitcnt lgkmcnt(1)
v_exp_f32 v43, v123
v_mfma_f32_16x16x32_bf16 v[136:139], a[200:203], v[96:99], v[136:139]
s_waitcnt lgkmcnt(0)
ds_read_b128 a[208:211], v16 offset:6400
v_add_f32 v36, v36, v42
v_mfma_f32_16x16x32_bf16 v[136:139], a[204:207], v[112:115], v[136:139]
ds_read_b128 a[212:215], v17 offset:6400
v_add_f32 v36, v36, v43
v_mfma_f32_16x16x32_bf16 v[140:143], a[200:203], v[100:103], v[140:143]
buffer_load_dwordx4 v6, s[8:11], s40 offen offset:2048 lds
v_mfma_f32_16x16x32_bf16 v[140:143], a[204:207], v[116:119], v[140:143]
v_exp_f32 v44, v124
v_mfma_f32_16x16x32_bf16 v[144:147], a[200:203], v[104:107], v[144:147]
s_add_u32 s40, s40, 12288
v_exp_f32 v45, v125
v_mfma_f32_16x16x32_bf16 v[144:147], a[204:207], a[216:219], v[144:147]
v_cvt_pk_bf16_f32 v217, v42, v43
v_add_f32 v37, v44, v45
v_mfma_f32_16x16x32_bf16 v[148:151], a[200:203], v[108:111], v[148:151]
v_exp_f32 v46, v126
v_mfma_f32_16x16x32_bf16 v[148:151], a[204:207], a[220:223], v[148:151]
s_waitcnt lgkmcnt(1)
v_cvt_pk_bf16_f32 v220, v44, v45
v_add_f32 v37, v37, v46
v_mfma_f32_16x16x32_bf16 v[136:139], a[208:211], a[224:227], v[136:139]
s_waitcnt lgkmcnt(0)
ds_read_b128 a[192:195], v16 offset:12288
v_mfma_f32_16x16x32_bf16 v[136:139], a[212:215], a[240:243], v[136:139]
ds_read_b128 a[196:199], v17 offset:12288
v_mfma_f32_16x16x32_bf16 v[140:143], a[208:211], a[228:231], v[140:143]
v_exp_f32 v47, v127
v_mfma_f32_16x16x32_bf16 v[140:143], a[212:215], a[244:247], v[140:143]
s_mov_b32 m0, s43
v_add_f32 v37, v37, v47
v_cvt_pk_bf16_f32 v221, v46, v47
v_mfma_f32_16x16x32_bf16 v[144:147], a[208:211], a[232:235], v[144:147]
buffer_load_dwordx4 v57, s[64:67], s44 offen lds
v_mfma_f32_16x16x32_bf16 v[144:147], a[212:215], a[248:251], v[144:147]
v_exp_f32 v40, v128
v_mfma_f32_16x16x32_bf16 v[148:151], a[208:211], a[236:239], v[148:151]
s_add_u32 s44, s44, 1024
v_exp_f32 v41, v129
v_mfma_f32_16x16x32_bf16 v[148:151], a[212:215], a[252:255], v[148:151]
s_waitcnt lgkmcnt(1)
v_add_f32 v38, v40, v41
v_cvt_pk_bf16_f32 v224, v40, v41
v_mfma_f32_16x16x32_bf16 v[152:155], a[192:195], v[64:67], v[248:251]
s_waitcnt lgkmcnt(0)
ds_read_b128 a[200:203], v16 offset:12416
v_mfma_f32_16x16x32_bf16 v[152:155], a[196:199], v[80:83], v[152:155]
ds_read_b128 a[204:207], v17 offset:12416
v_mfma_f32_16x16x32_bf16 v[156:159], a[192:195], v[68:71], v[252:255]
v_exp_f32 v42, v130
v_mfma_f32_16x16x32_bf16 v[156:159], a[196:199], v[84:87], v[156:159]
v_exp_f32 v43, v131
v_mfma_f32_16x16x32_bf16 v[160:163], a[192:195], v[72:75], v[24:27]
v_add_f32 v38, v38, v42
v_add_f32 v38, v38, v43
v_mfma_f32_16x16x32_bf16 v[160:163], a[196:199], v[88:91], v[160:163]
v_exp_f32 v44, v132
v_mfma_f32_16x16x32_bf16 v[164:167], a[192:195], v[76:79], v[12:15]
v_exp_f32 v45, v133
v_mfma_f32_16x16x32_bf16 v[164:167], a[196:199], v[92:95], v[164:167]
s_waitcnt lgkmcnt(1)
v_cvt_pk_bf16_f32 v225, v42, v43
v_add_f32 v39, v44, v45
v_mfma_f32_16x16x32_bf16 v[152:155], a[200:203], v[96:99], v[152:155]
s_waitcnt lgkmcnt(0)
ds_read_b128 a[208:211], v16 offset:12544
v_cvt_pk_bf16_f32 v228, v44, v45
v_mfma_f32_16x16x32_bf16 v[152:155], a[204:207], v[112:115], v[152:155]
ds_read_b128 a[212:215], v17 offset:12544
v_mfma_f32_16x16x32_bf16 v[156:159], a[200:203], v[100:103], v[156:159]
v_exp_f32 v46, v134
v_mfma_f32_16x16x32_bf16 v[156:159], a[204:207], v[116:119], v[156:159]
v_exp_f32 v47, v135
v_mfma_f32_16x16x32_bf16 v[160:163], a[200:203], v[104:107], v[160:163]
v_add_f32 v39, v39, v46
v_add_f32 v39, v39, v47
v_mfma_f32_16x16x32_bf16 v[160:163], a[204:207], a[216:219], v[160:163]
v_exp_f32 v40, v136
v_mfma_f32_16x16x32_bf16 v[164:167], a[200:203], v[108:111], v[164:167]
v_cvt_pk_bf16_f32 v229, v46, v47
v_add_f32 v36, v36, v40
v_mfma_f32_16x16x32_bf16 v[164:167], a[204:207], a[220:223], v[164:167]
s_waitcnt lgkmcnt(1)
v_exp_f32 v41, v137
v_mfma_f32_16x16x32_bf16 v[152:155], a[208:211], a[224:227], v[152:155]
s_waitcnt lgkmcnt(0)
ds_read_b128 a[192:195], v16 offset:18432
v_add_f32 v36, v36, v41
v_mfma_f32_16x16x32_bf16 v[152:155], a[212:215], a[240:243], v[152:155]
ds_read_b128 a[196:199], v17 offset:18432
v_cvt_pk_bf16_f32 v218, v40, v41
v_mfma_f32_16x16x32_bf16 v[156:159], a[208:211], a[228:231], v[156:159]
v_exp_f32 v42, v138
v_mfma_f32_16x16x32_bf16 v[156:159], a[212:215], a[244:247], v[156:159]
v_exp_f32 v43, v139
v_mfma_f32_16x16x32_bf16 v[160:163], a[208:211], a[232:235], v[160:163]
v_add_f32 v36, v36, v42
v_add_f32 v36, v36, v43
v_mfma_f32_16x16x32_bf16 v[160:163], a[212:215], a[248:251], v[160:163]
v_exp_f32 v44, v140
v_mfma_f32_16x16x32_bf16 v[164:167], a[208:211], a[236:239], v[164:167]
v_cvt_pk_bf16_f32 v219, v42, v43
v_add_f32 v37, v37, v44
v_mfma_f32_16x16x32_bf16 v[164:167], a[212:215], a[252:255], v[164:167]
s_waitcnt lgkmcnt(1)
v_exp_f32 v45, v141
v_mfma_f32_16x16x32_bf16 v[168:171], a[192:195], v[64:67], v[248:251]
s_waitcnt lgkmcnt(0)
ds_read_b128 a[200:203], v16 offset:18560
v_add_f32 v37, v37, v45
v_mfma_f32_16x16x32_bf16 v[168:171], a[196:199], v[80:83], v[168:171]
ds_read_b128 a[204:207], v17 offset:18560
v_cvt_pk_bf16_f32 v222, v44, v45
v_mfma_f32_16x16x32_bf16 v[172:175], a[192:195], v[68:71], v[252:255]
v_exp_f32 v46, v142
v_mfma_f32_16x16x32_bf16 v[172:175], a[196:199], v[84:87], v[172:175]
v_exp_f32 v47, v143
v_mfma_f32_16x16x32_bf16 v[176:179], a[192:195], v[72:75], v[24:27]
v_add_f32 v37, v37, v46
v_add_f32 v37, v37, v47
v_mfma_f32_16x16x32_bf16 v[176:179], a[196:199], v[88:91], v[176:179]
v_exp_f32 v40, v144
v_mfma_f32_16x16x32_bf16 v[180:183], a[192:195], v[76:79], v[12:15]
v_cvt_pk_bf16_f32 v223, v46, v47
v_add_f32 v38, v38, v40
v_mfma_f32_16x16x32_bf16 v[180:183], a[196:199], v[92:95], v[180:183]
s_waitcnt lgkmcnt(1)
v_exp_f32 v41, v145
v_mfma_f32_16x16x32_bf16 v[168:171], a[200:203], v[96:99], v[168:171]
s_waitcnt lgkmcnt(0)
ds_read_b128 a[208:211], v16 offset:18688
v_add_f32 v38, v38, v41
v_mfma_f32_16x16x32_bf16 v[168:171], a[204:207], v[112:115], v[168:171]
ds_read_b128 a[212:215], v17 offset:18688
v_cvt_pk_bf16_f32 v226, v40, v41
v_mfma_f32_16x16x32_bf16 v[172:175], a[200:203], v[100:103], v[172:175]
v_exp_f32 v42, v146
v_mfma_f32_16x16x32_bf16 v[172:175], a[204:207], v[116:119], v[172:175]
v_exp_f32 v43, v147
v_mfma_f32_16x16x32_bf16 v[176:179], a[200:203], v[104:107], v[176:179]
v_add_f32 v38, v38, v42
v_add_f32 v38, v38, v43
v_mfma_f32_16x16x32_bf16 v[176:179], a[204:207], a[216:219], v[176:179]
v_exp_f32 v44, v148
v_mfma_f32_16x16x32_bf16 v[180:183], a[200:203], v[108:111], v[180:183]
v_cvt_pk_bf16_f32 v227, v42, v43
v_add_f32 v39, v39, v44
v_mfma_f32_16x16x32_bf16 v[180:183], a[204:207], a[220:223], v[180:183]
s_waitcnt lgkmcnt(1)
v_exp_f32 v45, v149
v_mfma_f32_16x16x32_bf16 v[168:171], a[208:211], a[224:227], v[168:171]
s_waitcnt lgkmcnt(0)
ds_read_b64_tr_b16 a[192:193], v20 offset:0
ds_read_b64_tr_b16 a[194:195], v20 offset:6144
v_mfma_f32_16x16x32_bf16 v[168:171], a[212:215], a[240:243], v[168:171]
ds_read_b64_tr_b16 a[196:197], v20 offset:12288
ds_read_b64_tr_b16 a[198:199], v20 offset:18432
v_mfma_f32_16x16x32_bf16 v[172:175], a[208:211], a[228:231], v[172:175]
v_add_f32 v39, v39, v45
v_cvt_pk_bf16_f32 v230, v44, v45
v_mfma_f32_16x16x32_bf16 v[172:175], a[212:215], a[244:247], v[172:175]
v_exp_f32 v46, v150
v_mfma_f32_16x16x32_bf16 v[176:179], a[208:211], a[232:235], v[176:179]
v_exp_f32 v47, v151
v_mfma_f32_16x16x32_bf16 v[176:179], a[212:215], a[248:251], v[176:179]
v_add_f32 v39, v39, v46
v_add_f32 v39, v39, v47
v_mfma_f32_16x16x32_bf16 v[180:183], a[208:211], a[236:239], v[180:183]
v_exp_f32 v40, v152
v_mfma_f32_16x16x32_bf16 v[180:183], a[212:215], a[252:255], v[180:183]
s_waitcnt lgkmcnt(2)
v_cvt_pk_bf16_f32 v231, v46, v47
v_add_f32 v36, v36, v40
v_mfma_f32_16x16x32_bf16 a[0:3], a[192:195], v[184:187], a[0:3]
s_waitcnt lgkmcnt(0)
ds_read_b64_tr_b16 a[200:201], v21 offset:0
ds_read_b64_tr_b16 a[202:203], v21 offset:6144
v_mfma_f32_16x16x32_bf16 a[0:3], a[196:199], v[200:203], a[0:3]
ds_read_b64_tr_b16 a[204:205], v21 offset:12288
ds_read_b64_tr_b16 a[206:207], v21 offset:18432
v_mfma_f32_16x16x32_bf16 a[4:7], a[192:195], v[188:191], a[4:7]
v_exp_f32 v41, v153
v_mfma_f32_16x16x32_bf16 a[4:7], a[196:199], v[204:207], a[4:7]
v_add_f32 v36, v36, v41
v_cvt_pk_bf16_f32 v232, v40, v41
v_mfma_f32_16x16x32_bf16 a[8:11], a[192:195], v[192:195], a[8:11]
s_waitcnt vmcnt(8)
s_barrier
v_mfma_f32_16x16x32_bf16 a[8:11], a[196:199], v[208:211], a[8:11]
v_exp_f32 v42, v154
v_mfma_f32_16x16x32_bf16 a[12:15], a[192:195], v[196:199], a[12:15]
s_add_u32 m0, s27, 0
v_exp_f32 v43, v155
v_mfma_f32_16x16x32_bf16 a[12:15], a[196:199], v[212:215], a[12:15]
s_waitcnt lgkmcnt(2)
buffer_load_dwordx4 v7, s[12:15], s41 offen offset:0 lds
v_mfma_f32_16x16x32_bf16 a[16:19], a[200:203], v[184:187], a[16:19]
s_waitcnt lgkmcnt(0)
ds_read_b64_tr_b16 a[208:209], v22 offset:0
ds_read_b64_tr_b16 a[210:211], v22 offset:6144
v_mfma_f32_16x16x32_bf16 a[16:19], a[204:207], v[200:203], a[16:19]
ds_read_b64_tr_b16 a[212:213], v22 offset:12288
ds_read_b64_tr_b16 a[214:215], v22 offset:18432
v_mfma_f32_16x16x32_bf16 a[20:23], a[200:203], v[188:191], a[20:23]
v_add_f32 v36, v36, v42
v_add_f32 v36, v36, v43
v_mfma_f32_16x16x32_bf16 a[20:23], a[204:207], v[204:207], a[20:23]
buffer_load_dwordx4 v8, s[12:15], s41 offen offset:1024 lds
v_mfma_f32_16x16x32_bf16 a[24:27], a[200:203], v[192:195], a[24:27]
v_exp_f32 v44, v156
v_mfma_f32_16x16x32_bf16 a[24:27], a[204:207], v[208:211], a[24:27]
v_cvt_pk_bf16_f32 v233, v42, v43
v_add_f32 v37, v37, v44
v_mfma_f32_16x16x32_bf16 a[28:31], a[200:203], v[196:199], a[28:31]
v_exp_f32 v45, v157
v_mfma_f32_16x16x32_bf16 a[28:31], a[204:207], v[212:215], a[28:31]
s_waitcnt lgkmcnt(2)
buffer_load_dwordx4 v9, s[12:15], s41 offen offset:2048 lds
v_mfma_f32_16x16x32_bf16 a[32:35], a[208:211], v[184:187], a[32:35]
s_waitcnt lgkmcnt(0)
ds_read_b64_tr_b16 a[192:193], v23 offset:0
ds_read_b64_tr_b16 a[194:195], v23 offset:6144
v_mfma_f32_16x16x32_bf16 a[32:35], a[212:215], v[200:203], a[32:35]
s_add_u32 s41, s41, 12288
ds_read_b64_tr_b16 a[196:197], v23 offset:12288
ds_read_b64_tr_b16 a[198:199], v23 offset:18432
v_mfma_f32_16x16x32_bf16 a[36:39], a[208:211], v[188:191], a[36:39]
s_add_u32 m0, s27, 12288
v_add_f32 v37, v37, v45
v_cvt_pk_bf16_f32 v236, v44, v45
v_mfma_f32_16x16x32_bf16 a[36:39], a[212:215], v[204:207], a[36:39]
buffer_load_dwordx4 v7, s[12:15], s41 offen offset:0 lds
v_mfma_f32_16x16x32_bf16 a[40:43], a[208:211], v[192:195], a[40:43]
v_exp_f32 v46, v158
v_mfma_f32_16x16x32_bf16 a[40:43], a[212:215], v[208:211], a[40:43]
v_exp_f32 v47, v159
v_mfma_f32_16x16x32_bf16 a[44:47], a[208:211], v[196:199], a[44:47]
v_add_f32 v37, v37, v46
v_add_f32 v37, v37, v47
v_mfma_f32_16x16x32_bf16 a[44:47], a[212:215], v[212:215], a[44:47]
s_waitcnt lgkmcnt(2)
buffer_load_dwordx4 v8, s[12:15], s41 offen offset:1024 lds
v_mfma_f32_16x16x32_bf16 a[48:51], a[192:195], v[184:187], a[48:51]
s_waitcnt lgkmcnt(0)
ds_read_b64_tr_b16 a[200:201], v20 offset:128
ds_read_b64_tr_b16 a[202:203], v20 offset:6272
v_mfma_f32_16x16x32_bf16 a[48:51], a[196:199], v[200:203], a[48:51]
ds_read_b64_tr_b16 a[204:205], v20 offset:12416
ds_read_b64_tr_b16 a[206:207], v20 offset:18560
v_mfma_f32_16x16x32_bf16 a[52:55], a[192:195], v[188:191], a[52:55]
v_exp_f32 v40, v160
v_mfma_f32_16x16x32_bf16 a[52:55], a[196:199], v[204:207], a[52:55]
buffer_load_dwordx4 v9, s[12:15], s41 offen offset:2048 lds
v_mfma_f32_16x16x32_bf16 a[56:59], a[192:195], v[192:195], a[56:59]
v_cvt_pk_bf16_f32 v237, v46, v47
v_add_f32 v38, v38, v40
v_mfma_f32_16x16x32_bf16 a[56:59], a[196:199], v[208:211], a[56:59]
s_add_u32 s41, s41, 12288
v_exp_f32 v41, v161
v_mfma_f32_16x16x32_bf16 a[60:63], a[192:195], v[196:199], a[60:63]
v_add_f32 v38, v38, v41
v_cvt_pk_bf16_f32 v240, v40, v41
v_mfma_f32_16x16x32_bf16 a[60:63], a[196:199], v[212:215], a[60:63]
s_waitcnt lgkmcnt(2)
v_exp_f32 v42, v162
v_mfma_f32_16x16x32_bf16 a[64:67], a[200:203], v[184:187], a[64:67]
s_waitcnt lgkmcnt(0)
ds_read_b64_tr_b16 a[208:209], v21 offset:128
ds_read_b64_tr_b16 a[210:211], v21 offset:6272
v_mfma_f32_16x16x32_bf16 a[64:67], a[204:207], v[200:203], a[64:67]
ds_read_b64_tr_b16 a[212:213], v21 offset:12416
ds_read_b64_tr_b16 a[214:215], v21 offset:18560
v_mfma_f32_16x16x32_bf16 a[68:71], a[200:203], v[188:191], a[68:71]
v_exp_f32 v43, v163
v_mfma_f32_16x16x32_bf16 a[68:71], a[204:207], v[204:207], a[68:71]
v_add_f32 v38, v38, v42
v_add_f32 v38, v38, v43
v_mfma_f32_16x16x32_bf16 a[72:75], a[200:203], v[192:195], a[72:75]
v_mfma_f32_16x16x32_bf16 a[72:75], a[204:207], v[208:211], a[72:75]
v_exp_f32 v44, v164
v_mfma_f32_16x16x32_bf16 a[76:79], a[200:203], v[196:199], a[76:79]
v_cvt_pk_bf16_f32 v241, v42, v43
v_add_f32 v39, v39, v44
v_mfma_f32_16x16x32_bf16 a[76:79], a[204:207], v[212:215], a[76:79]
s_waitcnt lgkmcnt(2)
v_exp_f32 v45, v165
v_mfma_f32_16x16x32_bf16 a[80:83], a[208:211], v[184:187], a[80:83]
s_waitcnt lgkmcnt(0)
ds_read_b64_tr_b16 a[192:193], v22 offset:128
ds_read_b64_tr_b16 a[194:195], v22 offset:6272
v_mfma_f32_16x16x32_bf16 a[80:83], a[212:215], v[200:203], a[80:83]
ds_read_b64_tr_b16 a[196:197], v22 offset:12416
ds_read_b64_tr_b16 a[198:199], v22 offset:18560
v_mfma_f32_16x16x32_bf16 a[84:87], a[208:211], v[188:191], a[84:87]
v_add_f32 v39, v39, v45
v_cvt_pk_bf16_f32 v244, v44, v45
v_mfma_f32_16x16x32_bf16 a[84:87], a[212:215], v[204:207], a[84:87]
v_exp_f32 v46, v166
v_mfma_f32_16x16x32_bf16 a[88:91], a[208:211], v[192:195], a[88:91]
v_mfma_f32_16x16x32_bf16 a[88:91], a[212:215], v[208:211], a[88:91]
v_exp_f32 v47, v167
v_mfma_f32_16x16x32_bf16 a[92:95], a[208:211], v[196:199], a[92:95]
v_add_f32 v39, v39, v46
v_add_f32 v39, v39, v47
v_mfma_f32_16x16x32_bf16 a[92:95], a[212:215], v[212:215], a[92:95]
s_waitcnt lgkmcnt(2)
v_exp_f32 v40, v168
v_mfma_f32_16x16x32_bf16 a[96:99], a[192:195], v[184:187], a[96:99]
s_waitcnt lgkmcnt(0)
ds_read_b64_tr_b16 a[200:201], v23 offset:128
ds_read_b64_tr_b16 a[202:203], v23 offset:6272
v_mfma_f32_16x16x32_bf16 a[96:99], a[196:199], v[200:203], a[96:99]
ds_read_b64_tr_b16 a[204:205], v23 offset:12416
ds_read_b64_tr_b16 a[206:207], v23 offset:18560
v_mfma_f32_16x16x32_bf16 a[100:103], a[192:195], v[188:191], a[100:103]
v_cvt_pk_bf16_f32 v245, v46, v47
v_add_f32 v36, v36, v40
v_mfma_f32_16x16x32_bf16 a[100:103], a[196:199], v[204:207], a[100:103]
v_exp_f32 v41, v169
v_mfma_f32_16x16x32_bf16 a[104:107], a[192:195], v[192:195], a[104:107]
v_add_f32 v36, v36, v41
v_cvt_pk_bf16_f32 v234, v40, v41
v_mfma_f32_16x16x32_bf16 a[104:107], a[196:199], v[208:211], a[104:107]
v_exp_f32 v42, v170
v_mfma_f32_16x16x32_bf16 a[108:111], a[192:195], v[196:199], a[108:111]
s_sub_u32 s3, s27, s54
v_exp_f32 v43, v171
v_mfma_f32_16x16x32_bf16 a[108:111], a[196:199], v[212:215], a[108:111]
s_waitcnt lgkmcnt(2)
v_add_f32 v36, v36, v42
v_add_f32 v36, v36, v43
v_mfma_f32_16x16x32_bf16 a[112:115], a[200:203], v[184:187], a[112:115]
s_waitcnt lgkmcnt(0)
ds_read_b64_tr_b16 a[208:209], v20 offset:256
ds_read_b64_tr_b16 a[210:211], v20 offset:6400
v_mfma_f32_16x16x32_bf16 a[112:115], a[204:207], v[200:203], a[112:115]
ds_read_b64_tr_b16 a[212:213], v20 offset:12544
ds_read_b64_tr_b16 a[214:215], v20 offset:18688
v_mfma_f32_16x16x32_bf16 a[116:119], a[200:203], v[188:191], a[116:119]
v_add_u32 v16, s3, v16
v_add_u32 v17, s3, v17
v_mfma_f32_16x16x32_bf16 a[116:119], a[204:207], v[204:207], a[116:119]
v_exp_f32 v44, v172
v_mfma_f32_16x16x32_bf16 a[120:123], a[200:203], v[192:195], a[120:123]
v_cvt_pk_bf16_f32 v235, v42, v43
v_add_f32 v37, v37, v44
v_mfma_f32_16x16x32_bf16 a[120:123], a[204:207], v[208:211], a[120:123]
v_exp_f32 v45, v173
v_mfma_f32_16x16x32_bf16 a[124:127], a[200:203], v[196:199], a[124:127]
v_add_f32 v37, v37, v45
v_cvt_pk_bf16_f32 v238, v44, v45
v_mfma_f32_16x16x32_bf16 a[124:127], a[204:207], v[212:215], a[124:127]
s_waitcnt lgkmcnt(2)
v_exp_f32 v46, v174
v_mfma_f32_16x16x32_bf16 a[128:131], a[208:211], v[184:187], a[128:131]
s_waitcnt lgkmcnt(0)
ds_read_b64_tr_b16 a[192:193], v21 offset:256
ds_read_b64_tr_b16 a[194:195], v21 offset:6400
v_mfma_f32_16x16x32_bf16 a[128:131], a[212:215], v[200:203], a[128:131]
ds_read_b64_tr_b16 a[196:197], v21 offset:12544
ds_read_b64_tr_b16 a[198:199], v21 offset:18688
v_mfma_f32_16x16x32_bf16 a[132:135], a[208:211], v[188:191], a[132:135]
s_mov_b32 s101, s53
v_exp_f32 v47, v175
v_mfma_f32_16x16x32_bf16 a[132:135], a[212:215], v[204:207], a[132:135]
v_add_f32 v37, v37, v46
v_add_f32 v37, v37, v47
v_mfma_f32_16x16x32_bf16 a[136:139], a[208:211], v[192:195], a[136:139]
s_mov_b32 s53, s54
v_exp_f32 v40, v176
v_mfma_f32_16x16x32_bf16 a[136:139], a[212:215], v[208:211], a[136:139]
v_cvt_pk_bf16_f32 v239, v46, v47
v_add_f32 v38, v38, v40
v_mfma_f32_16x16x32_bf16 a[140:143], a[208:211], v[196:199], a[140:143]
s_mov_b32 s54, s27
v_exp_f32 v41, v177
v_mfma_f32_16x16x32_bf16 a[140:143], a[212:215], v[212:215], a[140:143]
s_waitcnt lgkmcnt(2)
v_add_f32 v38, v38, v41
v_cvt_pk_bf16_f32 v242, v40, v41
v_mfma_f32_16x16x32_bf16 a[144:147], a[192:195], v[184:187], a[144:147]
s_waitcnt lgkmcnt(0)
s_mov_b32 s27, s101
ds_read_b64_tr_b16 a[200:201], v22 offset:256
ds_read_b64_tr_b16 a[202:203], v22 offset:6400
v_mfma_f32_16x16x32_bf16 a[144:147], a[196:199], v[200:203], a[144:147]
ds_read_b64_tr_b16 a[204:205], v22 offset:12544
ds_read_b64_tr_b16 a[206:207], v22 offset:18688
v_mfma_f32_16x16x32_bf16 a[148:151], a[192:195], v[188:191], a[148:151]
v_exp_f32 v42, v178
v_mfma_f32_16x16x32_bf16 a[148:151], a[196:199], v[204:207], a[148:151]
v_exp_f32 v43, v179
v_mfma_f32_16x16x32_bf16 a[152:155], a[192:195], v[192:195], a[152:155]
v_add_f32 v38, v38, v42
v_add_f32 v38, v38, v43
v_mfma_f32_16x16x32_bf16 a[152:155], a[196:199], v[208:211], a[152:155]
v_exp_f32 v44, v180
v_mfma_f32_16x16x32_bf16 a[156:159], a[192:195], v[196:199], a[156:159]
v_cvt_pk_bf16_f32 v243, v42, v43
v_add_f32 v39, v39, v44
v_mfma_f32_16x16x32_bf16 a[156:159], a[196:199], v[212:215], a[156:159]
s_waitcnt lgkmcnt(2)
v_exp_f32 v45, v181
v_mfma_f32_16x16x32_bf16 a[160:163], a[200:203], v[184:187], a[160:163]
s_waitcnt lgkmcnt(0)
ds_read_b64_tr_b16 a[208:209], v23 offset:256
ds_read_b64_tr_b16 a[210:211], v23 offset:6400
v_mfma_f32_16x16x32_bf16 a[160:163], a[204:207], v[200:203], a[160:163]
ds_read_b64_tr_b16 a[212:213], v23 offset:12544
ds_read_b64_tr_b16 a[214:215], v23 offset:18688
v_mfma_f32_16x16x32_bf16 a[164:167], a[200:203], v[188:191], a[164:167]
v_add_f32 v39, v39, v45
v_cvt_pk_bf16_f32 v246, v44, v45
v_mfma_f32_16x16x32_bf16 a[164:167], a[204:207], v[204:207], a[164:167]
v_exp_f32 v46, v182
v_mfma_f32_16x16x32_bf16 a[168:171], a[200:203], v[192:195], a[168:171]
v_exp_f32 v47, v183
v_mfma_f32_16x16x32_bf16 a[168:171], a[204:207], v[208:211], a[168:171]
v_add_f32 v39, v39, v46
v_add_f32 v39, v39, v47
v_mfma_f32_16x16x32_bf16 a[172:175], a[200:203], v[196:199], a[172:175]
v_cvt_pk_bf16_f32 v247, v46, v47
v_mfma_f32_16x16x32_bf16 a[172:175], a[204:207], v[212:215], a[172:175]
s_waitcnt lgkmcnt(2)
v_mfma_f32_16x16x32_bf16 a[176:179], a[208:211], v[184:187], a[176:179]
s_waitcnt lgkmcnt(0)
ds_read_b128 a[192:195], v16 offset:0
v_mfma_f32_16x16x32_bf16 a[176:179], a[212:215], v[200:203], a[176:179]
ds_read_b128 a[196:199], v17 offset:0
v_mfma_f32_16x16x32_bf16 a[180:183], a[208:211], v[188:191], a[180:183]
v_mfma_f32_16x16x32_bf16 a[180:183], a[212:215], v[204:207], a[180:183]
v_mfma_f32_16x16x32_bf16 a[184:187], a[208:211], v[192:195], a[184:187]
v_max3_f32 v48, v36, v37, v38
v_max_f32 v48, v48, v39
v_mfma_f32_16x16x32_bf16 a[184:187], a[212:215], v[208:211], a[184:187]
v_cmp_lt_f32 vcc, 0x49800000, v48
v_mfma_f32_16x16x32_bf16 a[188:191], a[208:211], v[196:199], a[188:191]
v_mfma_f32_16x16x32_bf16 a[188:191], a[212:215], v[212:215], a[188:191]
s_cbranch_vccnz L_stub3
L_back3:
s_sub_u32 s45, s45, 1
s_cmp_lg_u32 s45, 0
s_cbranch_scc1 L_at_loop
L_tail0:
s_waitcnt lgkmcnt(1)
v_mfma_f32_16x16x32_bf16 v[120:123], a[192:195], v[64:67], v[248:251]
s_waitcnt lgkmcnt(0)
s_sub_u32 s100, s53, s27
ds_read_b128 a[200:203], v16 offset:128
v_add_f32 v32, v32, v36
s_mov_b32 m0, s43
v_mfma_f32_16x16x32_bf16 v[120:123], a[196:199], v[80:83], v[120:123]
buffer_load_dwordx4 v57, s[64:67], s26 offen lds
ds_read_b128 a[204:207], v17 offset:128
v_add_f32 v33, v33, v37
s_add_u32 s26, s26, 131072
v_mfma_f32_16x16x32_bf16 v[124:127], a[192:195], v[68:71], v[252:255]
v_add_u32 v20, s100, v20
v_add_u32 v21, s100, v21
v_mfma_f32_16x16x32_bf16 v[124:127], a[196:199], v[84:87], v[124:127]
v_add_u32 v22, s100, v22
v_add_u32 v23, s100, v23
v_mfma_f32_16x16x32_bf16 v[128:131], a[192:195], v[72:75], v[24:27]
buffer_load_dwordx4 v57, s[64:67], s26 offen lds
s_add_u32 s26, s26, 131072
v_mfma_f32_16x16x32_bf16 v[128:131], a[196:199], v[88:91], v[128:131]
v_add_f32 v34, v34, v38
v_add_f32 v35, v35, v39
v_mfma_f32_16x16x32_bf16 v[132:135], a[192:195], v[76:79], v[12:15]
buffer_load_dwordx4 v57, s[64:67], s26 offen lds
s_add_u32 s26, s26, 131072
v_mfma_f32_16x16x32_bf16 v[132:135], a[196:199], v[92:95], v[132:135]
s_waitcnt lgkmcnt(1)
buffer_load_dwordx4 v57, s[64:67], s26 offen lds
s_add_u32 s26, s26, 131072
v_mfma_f32_16x16x32_bf16 v[120:123], a[200:203], v[96:99], v[120:123]
s_waitcnt lgkmcnt(0)
ds_read_b128 a[208:211], v16 offset:256
v_mfma_f32_16x16x32_bf16 v[120:123], a[204:207], v[112:115], v[120:123]
ds_read_b128 a[212:215], v17 offset:256
v_mfma_f32_16x16x32_bf16 v[124:127], a[200:203], v[100:103], v[124:127]
buffer_load_dwordx4 v57, s[64:67], s26 offen lds
s_add_u32 s26, s26, 131072
v_mfma_f32_16x16x32_bf16 v[124:127], a[204:207], v[116:119], v[124:127]
v_mfma_f32_16x16x32_bf16 v[128:131], a[200:203], v[104:107], v[128:131]
v_mfma_f32_16x16x32_bf16 v[128:131], a[204:207], a[216:219], v[128:131]
v_mfma_f32_16x16x32_bf16 v[132:135], a[200:203], v[108:111], v[132:135]
v_mfma_f32_16x16x32_bf16 v[132:135], a[204:207], a[220:223], v[132:135]
s_waitcnt lgkmcnt(1)
ds_read_b128 a[192:195], v16 offset:6144
v_mfma_f32_16x16x32_bf16 v[120:123], a[208:211], a[224:227], v[120:123]
s_waitcnt lgkmcnt(1)
v_mfma_f32_16x16x32_bf16 v[120:123], a[212:215], a[240:243], v[120:123]
ds_read_b128 a[196:199], v17 offset:6144
v_mfma_f32_16x16x32_bf16 v[124:127], a[208:211], a[228:231], v[124:127]
v_mfma_f32_16x16x32_bf16 v[124:127], a[212:215], a[244:247], v[124:127]
v_mfma_f32_16x16x32_bf16 v[128:131], a[208:211], a[232:235], v[128:131]
v_mfma_f32_16x16x32_bf16 v[128:131], a[212:215], a[248:251], v[128:131]
v_mfma_f32_16x16x32_bf16 v[132:135], a[208:211], a[236:239], v[132:135]
v_mfma_f32_16x16x32_bf16 v[132:135], a[212:215], a[252:255], v[132:135]
s_waitcnt lgkmcnt(1)
v_mfma_f32_16x16x32_bf16 v[136:139], a[192:195], v[64:67], v[248:251]
s_waitcnt lgkmcnt(0)
ds_read_b128 a[200:203], v16 offset:6272
v_mfma_f32_16x16x32_bf16 v[136:139], a[196:199], v[80:83], v[136:139]
ds_read_b128 a[204:207], v17 offset:6272
v_mfma_f32_16x16x32_bf16 v[140:143], a[192:195], v[68:71], v[252:255]
v_exp_f32 v40, v120
v_mfma_f32_16x16x32_bf16 v[140:143], a[196:199], v[84:87], v[140:143]
v_exp_f32 v41, v121
v_mfma_f32_16x16x32_bf16 v[144:147], a[192:195], v[72:75], v[24:27]
v_mfma_f32_16x16x32_bf16 v[144:147], a[196:199], v[88:91], v[144:147]
v_add_f32 v36, v40, v41
v_cvt_pk_bf16_f32 v184, v40, v41
v_mfma_f32_16x16x32_bf16 v[148:151], a[192:195], v[76:79], v[12:15]
v_exp_f32 v42, v122
v_mfma_f32_16x16x32_bf16 v[148:151], a[196:199], v[92:95], v[148:151]
s_waitcnt lgkmcnt(1)
v_exp_f32 v43, v123
v_mfma_f32_16x16x32_bf16 v[136:139], a[200:203], v[96:99], v[136:139]
s_waitcnt lgkmcnt(0)
ds_read_b128 a[208:211], v16 offset:6400
v_add_f32 v36, v36, v42
v_mfma_f32_16x16x32_bf16 v[136:139], a[204:207], v[112:115], v[136:139]
ds_read_b128 a[212:215], v17 offset:6400
v_add_f32 v36, v36, v43
v_mfma_f32_16x16x32_bf16 v[140:143], a[200:203], v[100:103], v[140:143]
v_mfma_f32_16x16x32_bf16 v[140:143], a[204:207], v[116:119], v[140:143]
v_exp_f32 v44, v124
v_mfma_f32_16x16x32_bf16 v[144:147], a[200:203], v[104:107], v[144:147]
v_exp_f32 v45, v125
v_mfma_f32_16x16x32_bf16 v[144:147], a[204:207], a[216:219], v[144:147]
v_cvt_pk_bf16_f32 v185, v42, v43
v_add_f32 v37, v44, v45
v_mfma_f32_16x16x32_bf16 v[148:151], a[200:203], v[108:111], v[148:151]
v_exp_f32 v46, v126
v_mfma_f32_16x16x32_bf16 v[148:151], a[204:207], a[220:223], v[148:151]
s_waitcnt lgkmcnt(1)
v_cvt_pk_bf16_f32 v188, v44, v45
v_add_f32 v37, v37, v46
v_mfma_f32_16x16x32_bf16 v[136:139], a[208:211], a[224:227], v[136:139]
s_waitcnt lgkmcnt(0)
ds_read_b128 a[192:195], v16 offset:12288
v_mfma_f32_16x16x32_bf16 v[136:139], a[212:215], a[240:243], v[136:139]
ds_read_b128 a[196:199], v17 offset:12288
v_mfma_f32_16x16x32_bf16 v[140:143], a[208:211], a[228:231], v[140:143]
v_exp_f32 v47, v127
v_mfma_f32_16x16x32_bf16 v[140:143], a[212:215], a[244:247], v[140:143]
s_mov_b32 m0, s43
v_add_f32 v37, v37, v47
v_cvt_pk_bf16_f32 v189, v46, v47
v_mfma_f32_16x16x32_bf16 v[144:147], a[208:211], a[232:235], v[144:147]
global_load_lds_dwordx4 v19, s[96:97]
v_mfma_f32_16x16x32_bf16 v[144:147], a[212:215], a[248:251], v[144:147]
v_exp_f32 v40, v128
v_mfma_f32_16x16x32_bf16 v[148:151], a[208:211], a[236:239], v[148:151]
v_exp_f32 v41, v129
v_mfma_f32_16x16x32_bf16 v[148:151], a[212:215], a[252:255], v[148:151]
s_waitcnt lgkmcnt(1)
v_add_f32 v38, v40, v41
v_cvt_pk_bf16_f32 v192, v40, v41
v_mfma_f32_16x16x32_bf16 v[152:155], a[192:195], v[64:67], v[248:251]
s_waitcnt lgkmcnt(0)
ds_read_b128 a[200:203], v16 offset:12416
v_mfma_f32_16x16x32_bf16 v[152:155], a[196:199], v[80:83], v[152:155]
ds_read_b128 a[204:207], v17 offset:12416
v_mfma_f32_16x16x32_bf16 v[156:159], a[192:195], v[68:71], v[252:255]
v_exp_f32 v42, v130
v_mfma_f32_16x16x32_bf16 v[156:159], a[196:199], v[84:87], v[156:159]
v_exp_f32 v43, v131
v_mfma_f32_16x16x32_bf16 v[160:163], a[192:195], v[72:75], v[24:27]
v_add_f32 v38, v38, v42
v_add_f32 v38, v38, v43
v_mfma_f32_16x16x32_bf16 v[160:163], a[196:199], v[88:91], v[160:163]
v_exp_f32 v44, v132
v_mfma_f32_16x16x32_bf16 v[164:167], a[192:195], v[76:79], v[12:15]
v_exp_f32 v45, v133
v_mfma_f32_16x16x32_bf16 v[164:167], a[196:199], v[92:95], v[164:167]
s_waitcnt lgkmcnt(1)
v_cvt_pk_bf16_f32 v193, v42, v43
v_add_f32 v39, v44, v45
v_mfma_f32_16x16x32_bf16 v[152:155], a[200:203], v[96:99], v[152:155]
s_waitcnt lgkmcnt(0)
ds_read_b128 a[208:211], v16 offset:12544
v_cvt_pk_bf16_f32 v196, v44, v45
v_mfma_f32_16x16x32_bf16 v[152:155], a[204:207], v[112:115], v[152:155]
ds_read_b128 a[212:215], v17 offset:12544
v_mfma_f32_16x16x32_bf16 v[156:159], a[200:203], v[100:103], v[156:159]
v_exp_f32 v46, v134
v_mfma_f32_16x16x32_bf16 v[156:159], a[204:207], v[116:119], v[156:159]
v_exp_f32 v47, v135
v_mfma_f32_16x16x32_bf16 v[160:163], a[200:203], v[104:107], v[160:163]
v_add_f32 v39, v39, v46
v_add_f32 v39, v39, v47
v_mfma_f32_16x16x32_bf16 v[160:163], a[204:207], a[216:219], v[160:163]
v_exp_f32 v40, v136
v_mfma_f32_16x16x32_bf16 v[164:167], a[200:203], v[108:111], v[164:167]
v_cvt_pk_bf16_f32 v197, v46, v47
v_add_f32 v36, v36, v40
v_mfma_f32_16x16x32_bf16 v[164:167], a[204:207], a[220:223], v[164:167]
s_waitcnt lgkmcnt(1)
v_exp_f32 v41, v137
v_mfma_f32_16x16x32_bf16 v[152:155], a[208:211], a[224:227], v[152:155]
s_waitcnt lgkmcnt(0)
ds_read_b128 a[192:195], v16 offset:18432
v_add_f32 v36, v36, v41
v_mfma_f32_16x16x32_bf16 v[152:155], a[212:215], a[240:243], v[152:155]
ds_read_b128 a[196:199], v17 offset:18432
v_cvt_pk_bf16_f32 v186, v40, v41
v_mfma_f32_16x16x32_bf16 v[156:159], a[208:211], a[228:231], v[156:159]
v_exp_f32 v42, v138
v_mfma_f32_16x16x32_bf16 v[156:159], a[212:215], a[244:247], v[156:159]
v_exp_f32 v43, v139
v_mfma_f32_16x16x32_bf16 v[160:163], a[208:211], a[232:235], v[160:163]
v_add_f32 v36, v36, v42
v_add_f32 v36, v36, v43
v_mfma_f32_16x16x32_bf16 v[160:163], a[212:215], a[248:251], v[160:163]
v_exp_f32 v44, v140
v_mfma_f32_16x16x32_bf16 v[164:167], a[208:211], a[236:239], v[164:167]
v_cvt_pk_bf16_f32 v187, v42, v43
v_add_f32 v37, v37, v44
v_mfma_f32_16x16x32_bf16 v[164:167], a[212:215], a[252:255], v[164:167]
s_waitcnt lgkmcnt(1)
v_exp_f32 v45, v141
v_mfma_f32_16x16x32_bf16 v[168:171], a[192:195], v[64:67], v[248:251]
s_waitcnt lgkmcnt(0)
ds_read_b128 a[200:203], v16 offset:18560
v_add_f32 v37, v37, v45
v_mfma_f32_16x16x32_bf16 v[168:171], a[196:199], v[80:83], v[168:171]
ds_read_b128 a[204:207], v17 offset:18560
v_cvt_pk_bf16_f32 v190, v44, v45
v_mfma_f32_16x16x32_bf16 v[172:175], a[192:195], v[68:71], v[252:255]
v_exp_f32 v46, v142
v_mfma_f32_16x16x32_bf16 v[172:175], a[196:199], v[84:87], v[172:175]
v_exp_f32 v47, v143
v_mfma_f32_16x16x32_bf16 v[176:179], a[192:195], v[72:75], v[24:27]
v_add_f32 v37, v37, v46
v_add_f32 v37, v37, v47
v_mfma_f32_16x16x32_bf16 v[176:179], a[196:199], v[88:91], v[176:179]
v_exp_f32 v40, v144
v_mfma_f32_16x16x32_bf16 v[180:183], a[192:195], v[76:79], v[12:15]
v_cvt_pk_bf16_f32 v191, v46, v47
v_add_f32 v38, v38, v40
v_mfma_f32_16x16x32_bf16 v[180:183], a[196:199], v[92:95], v[180:183]
s_waitcnt lgkmcnt(1)
v_exp_f32 v41, v145
v_mfma_f32_16x16x32_bf16 v[168:171], a[200:203], v[96:99], v[168:171]
s_waitcnt lgkmcnt(0)
ds_read_b128 a[208:211], v16 offset:18688
v_add_f32 v38, v38, v41
v_mfma_f32_16x16x32_bf16 v[168:171], a[204:207], v[112:115], v[168:171]
ds_read_b128 a[212:215], v17 offset:18688
v_cvt_pk_bf16_f32 v194, v40, v41
v_mfma_f32_16x16x32_bf16 v[172:175], a[200:203], v[100:103], v[172:175]
v_exp_f32 v42, v146
v_mfma_f32_16x16x32_bf16 v[172:175], a[204:207], v[116:119], v[172:175]
v_exp_f32 v43, v147
v_mfma_f32_16x16x32_bf16 v[176:179], a[200:203], v[104:107], v[176:179]
v_add_f32 v38, v38, v42
v_add_f32 v38, v38, v43
v_mfma_f32_16x16x32_bf16 v[176:179], a[204:207], a[216:219], v[176:179]
v_exp_f32 v44, v148
v_mfma_f32_16x16x32_bf16 v[180:183], a[200:203], v[108:111], v[180:183]
v_cvt_pk_bf16_f32 v195, v42, v43
v_add_f32 v39, v39, v44
v_mfma_f32_16x16x32_bf16 v[180:183], a[204:207], a[220:223], v[180:183]
s_waitcnt lgkmcnt(1)
v_exp_f32 v45, v149
v_mfma_f32_16x16x32_bf16 v[168:171], a[208:211], a[224:227], v[168:171]
s_waitcnt lgkmcnt(0)
ds_read_b64_tr_b16 a[192:193], v20 offset:0
ds_read_b64_tr_b16 a[194:195], v20 offset:6144
v_mfma_f32_16x16x32_bf16 v[168:171], a[212:215], a[240:243], v[168:171]
ds_read_b64_tr_b16 a[196:197], v20 offset:12288
ds_read_b64_tr_b16 a[198:199], v20 offset:18432
v_mfma_f32_16x16x32_bf16 v[172:175], a[208:211], a[228:231], v[172:175]
v_add_f32 v39, v39, v45
v_cvt_pk_bf16_f32 v198, v44, v45
v_mfma_f32_16x16x32_bf16 v[172:175], a[212:215], a[244:247], v[172:175]
v_exp_f32 v46, v150
v_mfma_f32_16x16x32_bf16 v[176:179], a[208:211], a[232:235], v[176:179]
v_exp_f32 v47, v151
v_mfma_f32_16x16x32_bf16 v[176:179], a[212:215], a[248:251], v[176:179]
v_add_f32 v39, v39, v46
v_add_f32 v39, v39, v47
v_mfma_f32_16x16x32_bf16 v[180:183], a[208:211], a[236:239], v[180:183]
v_exp_f32 v40, v152
v_mfma_f32_16x16x32_bf16 v[180:183], a[212:215], a[252:255], v[180:183]
s_waitcnt lgkmcnt(2)
v_cvt_pk_bf16_f32 v199, v46, v47
v_add_f32 v36, v36, v40
v_mfma_f32_16x16x32_bf16 a[0:3], a[192:195], v[216:219], a[0:3]
s_waitcnt lgkmcnt(0)
ds_read_b64_tr_b16 a[200:201], v21 offset:0
ds_read_b64_tr_b16 a[202:203], v21 offset:6144
v_mfma_f32_16x16x32_bf16 a[0:3], a[196:199], v[232:235], a[0:3]
ds_read_b64_tr_b16 a[204:205], v21 offset:12288
ds_read_b64_tr_b16 a[206:207], v21 offset:18432
v_mfma_f32_16x16x32_bf16 a[4:7], a[192:195], v[220:223], a[4:7]
v_exp_f32 v41, v153
v_mfma_f32_16x16x32_bf16 a[4:7], a[196:199], v[236:239], a[4:7]
v_add_f32 v36, v36, v41
v_cvt_pk_bf16_f32 v200, v40, v41
v_mfma_f32_16x16x32_bf16 a[8:11], a[192:195], v[224:227], a[8:11]
s_waitcnt vmcnt(6)
s_barrier
v_mfma_f32_16x16x32_bf16 a[8:11], a[196:199], v[240:243], a[8:11]
v_exp_f32 v42, v154
v_mfma_f32_16x16x32_bf16 a[12:15], a[192:195], v[228:231], a[12:15]
s_add_u32 m0, s27, 0
v_exp_f32 v43, v155
v_mfma_f32_16x16x32_bf16 a[12:15], a[196:199], v[244:247], a[12:15]
s_waitcnt lgkmcnt(2)
buffer_load_dwordx4 v7, s[12:15], s41 offen offset:0 lds
v_mfma_f32_16x16x32_bf16 a[16:19], a[200:203], v[216:219], a[16:19]
s_waitcnt lgkmcnt(0)
ds_read_b64_tr_b16 a[208:209], v22 offset:0
ds_read_b64_tr_b16 a[210:211], v22 offset:6144
v_mfma_f32_16x16x32_bf16 a[16:19], a[204:207], v[232:235], a[16:19]
ds_read_b64_tr_b16 a[212:213], v22 offset:12288
ds_read_b64_tr_b16 a[214:215], v22 offset:18432
v_mfma_f32_16x16x32_bf16 a[20:23], a[200:203], v[220:223], a[20:23]
v_add_f32 v36, v36, v42
v_add_f32 v36, v36, v43
v_mfma_f32_16x16x32_bf16 a[20:23], a[204:207], v[236:239], a[20:23]
buffer_load_dwordx4 v8, s[12:15], s41 offen offset:1024 lds
v_mfma_f32_16x16x32_bf16 a[24:27], a[200:203], v[224:227], a[24:27]
v_exp_f32 v44, v156
v_mfma_f32_16x16x32_bf16 a[24:27], a[204:207], v[240:243], a[24:27]
v_cvt_pk_bf16_f32 v201, v42, v43
v_add_f32 v37, v37, v44
v_mfma_f32_16x16x32_bf16 a[28:31], a[200:203], v[228:231], a[28:31]
v_exp_f32 v45, v157
v_mfma_f32_16x16x32_bf16 a[28:31], a[204:207], v[244:247], a[28:31]
s_waitcnt lgkmcnt(2)
buffer_load_dwordx4 v9, s[12:15], s41 offen offset:2048 lds
v_mfma_f32_16x16x32_bf16 a[32:35], a[208:211], v[216:219], a[32:35]
s_waitcnt lgkmcnt(0)
ds_read_b64_tr_b16 a[192:193], v23 offset:0
ds_read_b64_tr_b16 a[194:195], v23 offset:6144
v_mfma_f32_16x16x32_bf16 a[32:35], a[212:215], v[232:235], a[32:35]
s_add_u32 s41, s41, 12288
ds_read_b64_tr_b16 a[196:197], v23 offset:12288
ds_read_b64_tr_b16 a[198:199], v23 offset:18432
v_mfma_f32_16x16x32_bf16 a[36:39], a[208:211], v[220:223], a[36:39]
s_add_u32 m0, s27, 12288
v_add_f32 v37, v37, v45
v_cvt_pk_bf16_f32 v204, v44, v45
v_mfma_f32_16x16x32_bf16 a[36:39], a[212:215], v[236:239], a[36:39]
buffer_load_dwordx4 v7, s[12:15], s41 offen offset:0 lds
v_mfma_f32_16x16x32_bf16 a[40:43], a[208:211], v[224:227], a[40:43]
v_exp_f32 v46, v158
v_mfma_f32_16x16x32_bf16 a[40:43], a[212:215], v[240:243], a[40:43]
v_exp_f32 v47, v159
v_mfma_f32_16x16x32_bf16 a[44:47], a[208:211], v[228:231], a[44:47]
v_add_f32 v37, v37, v46
v_add_f32 v37, v37, v47
v_mfma_f32_16x16x32_bf16 a[44:47], a[212:215], v[244:247], a[44:47]
s_waitcnt lgkmcnt(2)
buffer_load_dwordx4 v8, s[12:15], s41 offen offset:1024 lds
v_mfma_f32_16x16x32_bf16 a[48:51], a[192:195], v[216:219], a[48:51]
s_waitcnt lgkmcnt(0)
ds_read_b64_tr_b16 a[200:201], v20 offset:128
ds_read_b64_tr_b16 a[202:203], v20 offset:6272
v_mfma_f32_16x16x32_bf16 a[48:51], a[196:199], v[232:235], a[48:51]
ds_read_b64_tr_b16 a[204:205], v20 offset:12416
ds_read_b64_tr_b16 a[206:207], v20 offset:18560
v_mfma_f32_16x16x32_bf16 a[52:55], a[192:195], v[220:223], a[52:55]
v_exp_f32 v40, v160
v_mfma_f32_16x16x32_bf16 a[52:55], a[196:199], v[236:239], a[52:55]
buffer_load_dwordx4 v9, s[12:15], s41 offen offset:2048 lds
v_mfma_f32_16x16x32_bf16 a[56:59], a[192:195], v[224:227], a[56:59]
v_cvt_pk_bf16_f32 v205, v46, v47
v_add_f32 v38, v38, v40
v_mfma_f32_16x16x32_bf16 a[56:59], a[196:199], v[240:243], a[56:59]
s_add_u32 s41, s41, 12288
v_exp_f32 v41, v161
v_mfma_f32_16x16x32_bf16 a[60:63], a[192:195], v[228:231], a[60:63]
v_add_f32 v38, v38, v41
v_cvt_pk_bf16_f32 v208, v40, v41
v_mfma_f32_16x16x32_bf16 a[60:63], a[196:199], v[244:247], a[60:63]
s_waitcnt lgkmcnt(2)
v_exp_f32 v42, v162
v_mfma_f32_16x16x32_bf16 a[64:67], a[200:203], v[216:219], a[64:67]
s_waitcnt lgkmcnt(0)
ds_read_b64_tr_b16 a[208:209], v21 offset:128
ds_read_b64_tr_b16 a[210:211], v21 offset:6272
v_mfma_f32_16x16x32_bf16 a[64:67], a[204:207], v[232:235], a[64:67]
ds_read_b64_tr_b16 a[212:213], v21 offset:12416
ds_read_b64_tr_b16 a[214:215], v21 offset:18560
v_mfma_f32_16x16x32_bf16 a[68:71], a[200:203], v[220:223], a[68:71]
v_exp_f32 v43, v163
v_mfma_f32_16x16x32_bf16 a[68:71], a[204:207], v[236:239], a[68:71]
v_add_f32 v38, v38, v42
v_add_f32 v38, v38, v43
v_mfma_f32_16x16x32_bf16 a[72:75], a[200:203], v[224:227], a[72:75]
v_mfma_f32_16x16x32_bf16 a[72:75], a[204:207], v[240:243], a[72:75]
v_exp_f32 v44, v164
v_mfma_f32_16x16x32_bf16 a[76:79], a[200:203], v[228:231], a[76:79]
v_cvt_pk_bf16_f32 v209, v42, v43
v_add_f32 v39, v39, v44
v_mfma_f32_16x16x32_bf16 a[76:79], a[204:207], v[244:247], a[76:79]
s_waitcnt lgkmcnt(2)
v_exp_f32 v45, v165
v_mfma_f32_16x16x32_bf16 a[80:83], a[208:211], v[216:219], a[80:83]
s_waitcnt lgkmcnt(0)
ds_read_b64_tr_b16 a[192:193], v22 offset:128
ds_read_b64_tr_b16 a[194:195], v22 offset:6272
v_mfma_f32_16x16x32_bf16 a[80:83], a[212:215], v[232:235], a[80:83]
ds_read_b64_tr_b16 a[196:197], v22 offset:12416
ds_read_b64_tr_b16 a[198:199], v22 offset:18560
v_mfma_f32_16x16x32_bf16 a[84:87], a[208:211], v[220:223], a[84:87]
v_add_f32 v39, v39, v45
v_cvt_pk_bf16_f32 v212, v44, v45
v_mfma_f32_16x16x32_bf16 a[84:87], a[212:215], v[236:239], a[84:87]
v_exp_f32 v46, v166
v_mfma_f32_16x16x32_bf16 a[88:91], a[208:211], v[224:227], a[88:91]
v_mfma_f32_16x16x32_bf16 a[88:91], a[212:215], v[240:243], a[88:91]
v_exp_f32 v47, v167
v_mfma_f32_16x16x32_bf16 a[92:95], a[208:211], v[228:231], a[92:95]
v_add_f32 v39, v39, v46
v_add_f32 v39, v39, v47
v_mfma_f32_16x16x32_bf16 a[92:95], a[212:215], v[244:247], a[92:95]
s_waitcnt lgkmcnt(2)
v_exp_f32 v40, v168
v_mfma_f32_16x16x32_bf16 a[96:99], a[192:195], v[216:219], a[96:99]
s_waitcnt lgkmcnt(0)
ds_read_b64_tr_b16 a[200:201], v23 offset:128
ds_read_b64_tr_b16 a[202:203], v23 offset:6272
v_mfma_f32_16x16x32_bf16 a[96:99], a[196:199], v[232:235], a[96:99]
ds_read_b64_tr_b16 a[204:205], v23 offset:12416
ds_read_b64_tr_b16 a[206:207], v23 offset:18560
v_mfma_f32_16x16x32_bf16 a[100:103], a[192:195], v[220:223], a[100:103]
v_cvt_pk_bf16_f32 v213, v46, v47
v_add_f32 v36, v36, v40
v_mfma_f32_16x16x32_bf16 a[100:103], a[196:199], v[236:239], a[100:103]
v_exp_f32 v41, v169
v_mfma_f32_16x16x32_bf16 a[104:107], a[192:195], v[224:227], a[104:107]
v_add_f32 v36, v36, v41
v_cvt_pk_bf16_f32 v202, v40, v41
v_mfma_f32_16x16x32_bf16 a[104:107], a[196:199], v[240:243], a[104:107]
v_exp_f32 v42, v170
v_mfma_f32_16x16x32_bf16 a[108:111], a[192:195], v[228:231], a[108:111]
s_sub_u32 s3, s27, s54
v_exp_f32 v43, v171
v_mfma_f32_16x16x32_bf16 a[108:111], a[196:199], v[244:247], a[108:111]
s_waitcnt lgkmcnt(2)
v_add_f32 v36, v36, v42
v_add_f32 v36, v36, v43
v_mfma_f32_16x16x32_bf16 a[112:115], a[200:203], v[216:219], a[112:115]
s_waitcnt lgkmcnt(0)
ds_read_b64_tr_b16 a[208:209], v20 offset:256
ds_read_b64_tr_b16 a[210:211], v20 offset:6400
v_mfma_f32_16x16x32_bf16 a[112:115], a[204:207], v[232:235], a[112:115]
ds_read_b64_tr_b16 a[212:213], v20 offset:12544
ds_read_b64_tr_b16 a[214:215], v20 offset:18688
v_mfma_f32_16x16x32_bf16 a[116:119], a[200:203], v[220:223], a[116:119]
v_add_u32 v16, s3, v16
v_add_u32 v17, s3, v17
v_mfma_f32_16x16x32_bf16 a[116:119], a[204:207], v[236:239], a[116:119]
v_exp_f32 v44, v172
v_mfma_f32_16x16x32_bf16 a[120:123], a[200:203], v[224:227], a[120:123]
v_cvt_pk_bf16_f32 v203, v42, v43
v_add_f32 v37, v37, v44
v_mfma_f32_16x16x32_bf16 a[120:123], a[204:207], v[240:243], a[120:123]
v_exp_f32 v45, v173
v_mfma_f32_16x16x32_bf16 a[124:127], a[200:203], v[228:231], a[124:127]
v_add_f32 v37, v37, v45
v_cvt_pk_bf16_f32 v206, v44, v45
v_mfma_f32_16x16x32_bf16 a[124:127], a[204:207], v[244:247], a[124:127]
s_waitcnt lgkmcnt(2)
v_exp_f32 v46, v174
v_mfma_f32_16x16x32_bf16 a[128:131], a[208:211], v[216:219], a[128:131]
s_waitcnt lgkmcnt(0)
ds_read_b64_tr_b16 a[192:193], v21 offset:256
ds_read_b64_tr_b16 a[194:195], v21 offset:6400
v_mfma_f32_16x16x32_bf16 a[128:131], a[212:215], v[232:235], a[128:131]
ds_read_b64_tr_b16 a[196:197], v21 offset:12544
ds_read_b64_tr_b16 a[198:199], v21 offset:18688
v_mfma_f32_16x16x32_bf16 a[132:135], a[208:211], v[220:223], a[132:135]
s_mov_b32 s101, s53
v_exp_f32 v47, v175
v_mfma_f32_16x16x32_bf16 a[132:135], a[212:215], v[236:239], a[132:135]
v_add_f32 v37, v37, v46
v_add_f32 v37, v37, v47
v_mfma_f32_16x16x32_bf16 a[136:139], a[208:211], v[224:227], a[136:139]
s_mov_b32 s53, s54
v_exp_f32 v40, v176
v_mfma_f32_16x16x32_bf16 a[136:139], a[212:215], v[240:243], a[136:139]
v_cvt_pk_bf16_f32 v207, v46, v47
v_add_f32 v38, v38, v40
v_mfma_f32_16x16x32_bf16 a[140:143], a[208:211], v[228:231], a[140:143]
s_mov_b32 s54, s27
v_exp_f32 v41, v177
v_mfma_f32_16x16x32_bf16 a[140:143], a[212:215], v[244:247], a[140:143]
s_waitcnt lgkmcnt(2)
v_add_f32 v38, v38, v41
v_cvt_pk_bf16_f32 v210, v40, v41
v_mfma_f32_16x16x32_bf16 a[144:147], a[192:195], v[216:219], a[144:147]
s_waitcnt lgkmcnt(0)
s_mov_b32 s27, s101
ds_read_b64_tr_b16 a[200:201], v22 offset:256
ds_read_b64_tr_b16 a[202:203], v22 offset:6400
v_mfma_f32_16x16x32_bf16 a[144:147], a[196:199], v[232:235], a[144:147]
ds_read_b64_tr_b16 a[204:205], v22 offset:12544
ds_read_b64_tr_b16 a[206:207], v22 offset:18688
v_mfma_f32_16x16x32_bf16 a[148:151], a[192:195], v[220:223], a[148:151]
v_exp_f32 v42, v178
v_mfma_f32_16x16x32_bf16 a[148:151], a[196:199], v[236:239], a[148:151]
v_exp_f32 v43, v179
v_mfma_f32_16x16x32_bf16 a[152:155], a[192:195], v[224:227], a[152:155]
v_add_f32 v38, v38, v42
v_add_f32 v38, v38, v43
v_mfma_f32_16x16x32_bf16 a[152:155], a[196:199], v[240:243], a[152:155]
v_exp_f32 v44, v180
v_mfma_f32_16x16x32_bf16 a[156:159], a[192:195], v[228:231], a[156:159]
v_cvt_pk_bf16_f32 v211, v42, v43
v_add_f32 v39, v39, v44
v_mfma_f32_16x16x32_bf16 a[156:159], a[196:199], v[244:247], a[156:159]
s_waitcnt lgkmcnt(2)
v_exp_f32 v45, v181
v_mfma_f32_16x16x32_bf16 a[160:163], a[200:203], v[216:219], a[160:163]
s_waitcnt lgkmcnt(0)
ds_read_b64_tr_b16 a[208:209], v23 offset:256
ds_read_b64_tr_b16 a[210:211], v23 offset:6400
v_mfma_f32_16x16x32_bf16 a[160:163], a[204:207], v[232:235], a[160:163]
ds_read_b64_tr_b16 a[212:213], v23 offset:12544
ds_read_b64_tr_b16 a[214:215], v23 offset:18688
v_mfma_f32_16x16x32_bf16 a[164:167], a[200:203], v[220:223], a[164:167]
v_add_f32 v39, v39, v45
v_cvt_pk_bf16_f32 v214, v44, v45
v_mfma_f32_16x16x32_bf16 a[164:167], a[204:207], v[236:239], a[164:167]
v_exp_f32 v46, v182
v_mfma_f32_16x16x32_bf16 a[168:171], a[200:203], v[224:227], a[168:171]
v_exp_f32 v47, v183
v_mfma_f32_16x16x32_bf16 a[168:171], a[204:207], v[240:243], a[168:171]
v_add_f32 v39, v39, v46
v_add_f32 v39, v39, v47
v_mfma_f32_16x16x32_bf16 a[172:175], a[200:203], v[228:231], a[172:175]
v_cvt_pk_bf16_f32 v215, v46, v47
v_mfma_f32_16x16x32_bf16 a[172:175], a[204:207], v[244:247], a[172:175]
s_waitcnt lgkmcnt(2)
v_mfma_f32_16x16x32_bf16 a[176:179], a[208:211], v[216:219], a[176:179]
s_waitcnt lgkmcnt(0)
ds_read_b128 a[192:195], v16 offset:0
v_mfma_f32_16x16x32_bf16 a[176:179], a[212:215], v[232:235], a[176:179]
ds_read_b128 a[196:199], v17 offset:0
v_mfma_f32_16x16x32_bf16 a[180:183], a[208:211], v[220:223], a[180:183]
v_mfma_f32_16x16x32_bf16 a[180:183], a[212:215], v[236:239], a[180:183]
v_mfma_f32_16x16x32_bf16 a[184:187], a[208:211], v[224:227], a[184:187]
v_max3_f32 v48, v36, v37, v38
v_max_f32 v48, v48, v39
v_mfma_f32_16x16x32_bf16 a[184:187], a[212:215], v[240:243], a[184:187]
v_cmp_lt_f32 vcc, 0x49800000, v48
v_mfma_f32_16x16x32_bf16 a[188:191], a[208:211], v[228:231], a[188:191]
v_mfma_f32_16x16x32_bf16 a[188:191], a[212:215], v[244:247], a[188:191]
s_cbranch_vccnz L_stub30
L_back30:
s_waitcnt lgkmcnt(1)
v_mfma_f32_16x16x32_bf16 v[120:123], a[192:195], v[64:67], v[248:251]
s_waitcnt lgkmcnt(0)
s_sub_u32 s100, s53, s27
ds_read_b128 a[200:203], v16 offset:128
v_add_f32 v32, v32, v36
s_mov_b32 m0, s43
v_mfma_f32_16x16x32_bf16 v[120:123], a[196:199], v[80:83], v[120:123]
buffer_load_dwordx4 v57, s[64:67], s26 offen lds
ds_read_b128 a[204:207], v17 offset:128
v_add_f32 v33, v33, v37
s_add_u32 s26, s26, 131072
v_mfma_f32_16x16x32_bf16 v[124:127], a[192:195], v[68:71], v[252:255]
v_add_u32 v20, s100, v20
v_add_u32 v21, s100, v21
v_mfma_f32_16x16x32_bf16 v[124:127], a[196:199], v[84:87], v[124:127]
v_add_u32 v22, s100, v22
v_add_u32 v23, s100, v23
v_mfma_f32_16x16x32_bf16 v[128:131], a[192:195], v[72:75], v[24:27]
buffer_load_dwordx4 v57, s[64:67], s26 offen lds
s_add_u32 s26, s26, 131072
v_mfma_f32_16x16x32_bf16 v[128:131], a[196:199], v[88:91], v[128:131]
v_add_f32 v34, v34, v38
v_add_f32 v35, v35, v39
v_mfma_f32_16x16x32_bf16 v[132:135], a[192:195], v[76:79], v[12:15]
buffer_load_dwordx4 v57, s[64:67], s26 offen lds
s_add_u32 s26, s26, 131072
v_mfma_f32_16x16x32_bf16 v[132:135], a[196:199], v[92:95], v[132:135]
s_waitcnt lgkmcnt(1)
buffer_load_dwordx4 v57, s[64:67], s26 offen lds
s_add_u32 s26, s26, 131072
v_mfma_f32_16x16x32_bf16 v[120:123], a[200:203], v[96:99], v[120:123]
s_waitcnt lgkmcnt(0)
ds_read_b128 a[208:211], v16 offset:256
v_mfma_f32_16x16x32_bf16 v[120:123], a[204:207], v[112:115], v[120:123]
ds_read_b128 a[212:215], v17 offset:256
v_mfma_f32_16x16x32_bf16 v[124:127], a[200:203], v[100:103], v[124:127]
buffer_load_dword v63, v62, s[60:63], s87 offen sc1
v_mfma_f32_16x16x32_bf16 v[124:127], a[204:207], v[116:119], v[124:127]
v_mfma_f32_16x16x32_bf16 v[128:131], a[200:203], v[104:107], v[128:131]
v_mfma_f32_16x16x32_bf16 v[128:131], a[204:207], a[216:219], v[128:131]
v_mfma_f32_16x16x32_bf16 v[132:135], a[200:203], v[108:111], v[132:135]
v_mfma_f32_16x16x32_bf16 v[132:135], a[204:207], a[220:223], v[132:135]
s_waitcnt lgkmcnt(1)
ds_read_b128 a[192:195], v16 offset:6144
v_mfma_f32_16x16x32_bf16 v[120:123], a[208:211], a[224:227], v[120:123]
s_waitcnt lgkmcnt(1)
v_mfma_f32_16x16x32_bf16 v[120:123], a[212:215], a[240:243], v[120:123]
ds_read_b128 a[196:199], v17 offset:6144
v_mfma_f32_16x16x32_bf16 v[124:127], a[208:211], a[228:231], v[124:127]
v_mfma_f32_16x16x32_bf16 v[124:127], a[212:215], a[244:247], v[124:127]
v_mfma_f32_16x16x32_bf16 v[128:131], a[208:211], a[232:235], v[128:131]
v_mfma_f32_16x16x32_bf16 v[128:131], a[212:215], a[248:251], v[128:131]
v_mfma_f32_16x16x32_bf16 v[132:135], a[208:211], a[236:239], v[132:135]
v_mfma_f32_16x16x32_bf16 v[132:135], a[212:215], a[252:255], v[132:135]
s_waitcnt lgkmcnt(1)
v_mfma_f32_16x16x32_bf16 v[136:139], a[192:195], v[64:67], v[248:251]
s_waitcnt lgkmcnt(0)
ds_read_b128 a[200:203], v16 offset:6272
v_mfma_f32_16x16x32_bf16 v[136:139], a[196:199], v[80:83], v[136:139]
ds_read_b128 a[204:207], v17 offset:6272
v_mfma_f32_16x16x32_bf16 v[140:143], a[192:195], v[68:71], v[252:255]
v_exp_f32 v40, v120
v_mfma_f32_16x16x32_bf16 v[140:143], a[196:199], v[84:87], v[140:143]
v_exp_f32 v41, v121
v_mfma_f32_16x16x32_bf16 v[144:147], a[192:195], v[72:75], v[24:27]
v_mfma_f32_16x16x32_bf16 v[144:147], a[196:199], v[88:91], v[144:147]
v_add_f32 v36, v40, v41
v_cvt_pk_bf16_f32 v216, v40, v41
v_mfma_f32_16x16x32_bf16 v[148:151], a[192:195], v[76:79], v[12:15]
v_exp_f32 v42, v122
v_mfma_f32_16x16x32_bf16 v[148:151], a[196:199], v[92:95], v[148:151]
s_waitcnt lgkmcnt(1)
v_exp_f32 v43, v123
v_mfma_f32_16x16x32_bf16 v[136:139], a[200:203], v[96:99], v[136:139]
s_waitcnt lgkmcnt(0)
ds_read_b128 a[208:211], v16 offset:6400
v_add_f32 v36, v36, v42
v_mfma_f32_16x16x32_bf16 v[136:139], a[204:207], v[112:115], v[136:139]
ds_read_b128 a[212:215], v17 offset:6400
v_add_f32 v36, v36, v43
v_mfma_f32_16x16x32_bf16 v[140:143], a[200:203], v[100:103], v[140:143]
v_mfma_f32_16x16x32_bf16 v[140:143], a[204:207], v[116:119], v[140:143]
v_exp_f32 v44, v124
v_mfma_f32_16x16x32_bf16 v[144:147], a[200:203], v[104:107], v[144:147]
v_exp_f32 v45, v125
v_mfma_f32_16x16x32_bf16 v[144:147], a[204:207], a[216:219], v[144:147]
v_cvt_pk_bf16_f32 v217, v42, v43
v_add_f32 v37, v44, v45
v_mfma_f32_16x16x32_bf16 v[148:151], a[200:203], v[108:111], v[148:151]
v_exp_f32 v46, v126
v_mfma_f32_16x16x32_bf16 v[148:151], a[204:207], a[220:223], v[148:151]
s_waitcnt lgkmcnt(1)
v_cvt_pk_bf16_f32 v220, v44, v45
v_add_f32 v37, v37, v46
v_mfma_f32_16x16x32_bf16 v[136:139], a[208:211], a[224:227], v[136:139]
s_waitcnt lgkmcnt(0)
ds_read_b128 a[192:195], v16 offset:12288
v_mfma_f32_16x16x32_bf16 v[136:139], a[212:215], a[240:243], v[136:139]
ds_read_b128 a[196:199], v17 offset:12288
v_mfma_f32_16x16x32_bf16 v[140:143], a[208:211], a[228:231], v[140:143]
v_exp_f32 v47, v127
v_mfma_f32_16x16x32_bf16 v[140:143], a[212:215], a[244:247], v[140:143]
v_add_f32 v37, v37, v47
v_cvt_pk_bf16_f32 v221, v46, v47
v_mfma_f32_16x16x32_bf16 v[144:147], a[208:211], a[232:235], v[144:147]
v_mfma_f32_16x16x32_bf16 v[144:147], a[212:215], a[248:251], v[144:147]
v_exp_f32 v40, v128
v_mfma_f32_16x16x32_bf16 v[148:151], a[208:211], a[236:239], v[148:151]
v_exp_f32 v41, v129
v_mfma_f32_16x16x32_bf16 v[148:151], a[212:215], a[252:255], v[148:151]
s_waitcnt lgkmcnt(1)
v_add_f32 v38, v40, v41
v_cvt_pk_bf16_f32 v224, v40, v41
v_mfma_f32_16x16x32_bf16 v[152:155], a[192:195], v[64:67], v[248:251]
s_waitcnt lgkmcnt(0)
ds_read_b128 a[200:203], v16 offset:12416
v_mfma_f32_16x16x32_bf16 v[152:155], a[196:199], v[80:83], v[152:155]
ds_read_b128 a[204:207], v17 offset:12416
v_mfma_f32_16x16x32_bf16 v[156:159], a[192:195], v[68:71], v[252:255]
v_exp_f32 v42, v130
v_mfma_f32_16x16x32_bf16 v[156:159], a[196:199], v[84:87], v[156:159]
v_exp_f32 v43, v131
v_mfma_f32_16x16x32_bf16 v[160:163], a[192:195], v[72:75], v[24:27]
v_add_f32 v38, v38, v42
v_add_f32 v38, v38, v43
v_mfma_f32_16x16x32_bf16 v[160:163], a[196:199], v[88:91], v[160:163]
v_exp_f32 v44, v132
v_mfma_f32_16x16x32_bf16 v[164:167], a[192:195], v[76:79], v[12:15]
v_exp_f32 v45, v133
v_mfma_f32_16x16x32_bf16 v[164:167], a[196:199], v[92:95], v[164:167]
s_waitcnt lgkmcnt(1)
v_cvt_pk_bf16_f32 v225, v42, v43
v_add_f32 v39, v44, v45
v_mfma_f32_16x16x32_bf16 v[152:155], a[200:203], v[96:99], v[152:155]
s_waitcnt lgkmcnt(0)
ds_read_b128 a[208:211], v16 offset:12544
v_cvt_pk_bf16_f32 v228, v44, v45
v_mfma_f32_16x16x32_bf16 v[152:155], a[204:207], v[112:115], v[152:155]
ds_read_b128 a[212:215], v17 offset:12544
v_mfma_f32_16x16x32_bf16 v[156:159], a[200:203], v[100:103], v[156:159]
v_exp_f32 v46, v134
v_mfma_f32_16x16x32_bf16 v[156:159], a[204:207], v[116:119], v[156:159]
v_exp_f32 v47, v135
v_mfma_f32_16x16x32_bf16 v[160:163], a[200:203], v[104:107], v[160:163]
v_add_f32 v39, v39, v46
v_add_f32 v39, v39, v47
v_mfma_f32_16x16x32_bf16 v[160:163], a[204:207], a[216:219], v[160:163]
v_exp_f32 v40, v136
v_mfma_f32_16x16x32_bf16 v[164:167], a[200:203], v[108:111], v[164:167]
v_cvt_pk_bf16_f32 v229, v46, v47
v_add_f32 v36, v36, v40
v_mfma_f32_16x16x32_bf16 v[164:167], a[204:207], a[220:223], v[164:167]
s_waitcnt lgkmcnt(1)
v_exp_f32 v41, v137
v_mfma_f32_16x16x32_bf16 v[152:155], a[208:211], a[224:227], v[152:155]
s_waitcnt lgkmcnt(0)
ds_read_b128 a[192:195], v16 offset:18432
v_add_f32 v36, v36, v41
v_mfma_f32_16x16x32_bf16 v[152:155], a[212:215], a[240:243], v[152:155]
ds_read_b128 a[196:199], v17 offset:18432
v_cvt_pk_bf16_f32 v218, v40, v41
v_mfma_f32_16x16x32_bf16 v[156:159], a[208:211], a[228:231], v[156:159]
v_exp_f32 v42, v138
v_mfma_f32_16x16x32_bf16 v[156:159], a[212:215], a[244:247], v[156:159]
v_exp_f32 v43, v139
v_mfma_f32_16x16x32_bf16 v[160:163], a[208:211], a[232:235], v[160:163]
v_add_f32 v36, v36, v42
v_add_f32 v36, v36, v43
v_mfma_f32_16x16x32_bf16 v[160:163], a[212:215], a[248:251], v[160:163]
v_exp_f32 v44, v140
v_mfma_f32_16x16x32_bf16 v[164:167], a[208:211], a[236:239], v[164:167]
v_cvt_pk_bf16_f32 v219, v42, v43
v_add_f32 v37, v37, v44
v_mfma_f32_16x16x32_bf16 v[164:167], a[212:215], a[252:255], v[164:167]
s_waitcnt lgkmcnt(1)
v_exp_f32 v45, v141
v_mfma_f32_16x16x32_bf16 v[168:171], a[192:195], v[64:67], v[248:251]
s_waitcnt lgkmcnt(0)
ds_read_b128 a[200:203], v16 offset:18560
v_add_f32 v37, v37, v45
v_mfma_f32_16x16x32_bf16 v[168:171], a[196:199], v[80:83], v[168:171]
ds_read_b128 a[204:207], v17 offset:18560
v_cvt_pk_bf16_f32 v222, v44, v45
v_mfma_f32_16x16x32_bf16 v[172:175], a[192:195], v[68:71], v[252:255]
v_exp_f32 v46, v142
v_mfma_f32_16x16x32_bf16 v[172:175], a[196:199], v[84:87], v[172:175]
v_exp_f32 v47, v143
v_mfma_f32_16x16x32_bf16 v[176:179], a[192:195], v[72:75], v[24:27]
v_add_f32 v37, v37, v46
v_add_f32 v37, v37, v47
v_mfma_f32_16x16x32_bf16 v[176:179], a[196:199], v[88:91], v[176:179]
v_exp_f32 v40, v144
v_mfma_f32_16x16x32_bf16 v[180:183], a[192:195], v[76:79], v[12:15]
v_cvt_pk_bf16_f32 v223, v46, v47
v_add_f32 v38, v38, v40
v_mfma_f32_16x16x32_bf16 v[180:183], a[196:199], v[92:95], v[180:183]
s_waitcnt lgkmcnt(1)
v_exp_f32 v41, v145
v_mfma_f32_16x16x32_bf16 v[168:171], a[200:203], v[96:99], v[168:171]
s_waitcnt lgkmcnt(0)
ds_read_b128 a[208:211], v16 offset:18688
v_add_f32 v38, v38, v41
v_mfma_f32_16x16x32_bf16 v[168:171], a[204:207], v[112:115], v[168:171]
ds_read_b128 a[212:215], v17 offset:18688
v_cvt_pk_bf16_f32 v226, v40, v41
v_mfma_f32_16x16x32_bf16 v[172:175], a[200:203], v[100:103], v[172:175]
v_exp_f32 v42, v146
v_mfma_f32_16x16x32_bf16 v[172:175], a[204:207], v[116:119], v[172:175]
v_exp_f32 v43, v147
v_mfma_f32_16x16x32_bf16 v[176:179], a[200:203], v[104:107], v[176:179]
v_add_f32 v38, v38, v42
v_add_f32 v38, v38, v43
v_mfma_f32_16x16x32_bf16 v[176:179], a[204:207], a[216:219], v[176:179]
v_exp_f32 v44, v148
v_mfma_f32_16x16x32_bf16 v[180:183], a[200:203], v[108:111], v[180:183]
v_cvt_pk_bf16_f32 v227, v42, v43
v_add_f32 v39, v39, v44
v_mfma_f32_16x16x32_bf16 v[180:183], a[204:207], a[220:223], v[180:183]
s_waitcnt lgkmcnt(1)
v_exp_f32 v45, v149
v_mfma_f32_16x16x32_bf16 v[168:171], a[208:211], a[224:227], v[168:171]
s_waitcnt lgkmcnt(0)
ds_read_b64_tr_b16 a[192:193], v20 offset:0
ds_read_b64_tr_b16 a[194:195], v20 offset:6144
v_mfma_f32_16x16x32_bf16 v[168:171], a[212:215], a[240:243], v[168:171]
ds_read_b64_tr_b16 a[196:197], v20 offset:12288
ds_read_b64_tr_b16 a[198:199], v20 offset:18432
v_mfma_f32_16x16x32_bf16 v[172:175], a[208:211], a[228:231], v[172:175]
v_add_f32 v39, v39, v45
v_cvt_pk_bf16_f32 v230, v44, v45
v_mfma_f32_16x16x32_bf16 v[172:175], a[212:215], a[244:247], v[172:175]
v_exp_f32 v46, v150
v_mfma_f32_16x16x32_bf16 v[176:179], a[208:211], a[232:235], v[176:179]
v_exp_f32 v47, v151
v_mfma_f32_16x16x32_bf16 v[176:179], a[212:215], a[248:251], v[176:179]
v_add_f32 v39, v39, v46
v_add_f32 v39, v39, v47
v_mfma_f32_16x16x32_bf16 v[180:183], a[208:211], a[236:239], v[180:183]
v_exp_f32 v40, v152
v_mfma_f32_16x16x32_bf16 v[180:183], a[212:215], a[252:255], v[180:183]
s_waitcnt lgkmcnt(2)
v_cvt_pk_bf16_f32 v231, v46, v47
v_add_f32 v36, v36, v40
v_mfma_f32_16x16x32_bf16 a[0:3], a[192:195], v[184:187], a[0:3]
s_waitcnt lgkmcnt(0)
ds_read_b64_tr_b16 a[200:201], v21 offset:0
ds_read_b64_tr_b16 a[202:203], v21 offset:6144
v_mfma_f32_16x16x32_bf16 a[0:3], a[196:199], v[200:203], a[0:3]
ds_read_b64_tr_b16 a[204:205], v21 offset:12288
ds_read_b64_tr_b16 a[206:207], v21 offset:18432
v_mfma_f32_16x16x32_bf16 a[4:7], a[192:195], v[188:191], a[4:7]
v_exp_f32 v41, v153
v_mfma_f32_16x16x32_bf16 a[4:7], a[196:199], v[204:207], a[4:7]
v_add_f32 v36, v36, v41
v_cvt_pk_bf16_f32 v232, v40, v41
v_mfma_f32_16x16x32_bf16 a[8:11], a[192:195], v[192:195], a[8:11]
s_waitcnt vmcnt(0)
s_barrier
s_mov_b32 s93, 0x200000
v_cmp_ne_u32 vcc, 0, v63
s_nop 1
s_cmp_eq_u64 vcc, -1
s_cbranch_scc1 L_pd2
L_pl2:
s_sleep 1
buffer_load_dword v63, v62, s[60:63], s87 offen offset:0 sc1
s_waitcnt vmcnt(0)
v_cmp_ne_u32 vcc, 0, v63
s_sub_u32 s93, s93, 1
s_cmp_eq_u64 vcc, -1
s_cbranch_scc1 L_pd2
s_cmp_lg_u32 s93, 0
s_cbranch_scc1 L_pl2
L_pd2:
s_add_u32 m0, s49, 61440
v_mfma_f32_16x16x32_bf16 a[8:11], a[196:199], v[208:211], a[8:11]
v_exp_f32 v42, v154
v_mfma_f32_16x16x32_bf16 a[12:15], a[192:195], v[196:199], a[12:15]
v_exp_f32 v43, v155
v_mfma_f32_16x16x32_bf16 a[12:15], a[196:199], v[212:215], a[12:15]
s_waitcnt lgkmcnt(2)
buffer_load_dwordx4 v49, s[80:83], s92 offen offset:0 lds
v_mfma_f32_16x16x32_bf16 a[16:19], a[200:203], v[184:187], a[16:19]
s_waitcnt lgkmcnt(0)
ds_read_b64_tr_b16 a[208:209], v22 offset:0
ds_read_b64_tr_b16 a[210:211], v22 offset:6144
v_mfma_f32_16x16x32_bf16 a[16:19], a[204:207], v[200:203], a[16:19]
ds_read_b64_tr_b16 a[212:213], v22 offset:12288
ds_read_b64_tr_b16 a[214:215], v22 offset:18432
v_mfma_f32_16x16x32_bf16 a[20:23], a[200:203], v[188:191], a[20:23]
buffer_load_dwordx4 v50, s[80:83], s92 offen offset:1024 lds
v_add_f32 v36, v36, v42
v_add_f32 v36, v36, v43
v_mfma_f32_16x16x32_bf16 a[20:23], a[204:207], v[204:207], a[20:23]
buffer_load_dwordx4 v51, s[80:83], s92 offen offset:2048 lds
v_mfma_f32_16x16x32_bf16 a[24:27], a[200:203], v[192:195], a[24:27]
v_exp_f32 v44, v156
v_mfma_f32_16x16x32_bf16 a[24:27], a[204:207], v[208:211], a[24:27]
buffer_load_dwordx4 v52, s[80:83], s92 offen offset:3072 lds
v_cvt_pk_bf16_f32 v233, v42, v43
v_add_f32 v37, v37, v44
s_add_u32 m0, s49, 65536
v_mfma_f32_16x16x32_bf16 a[28:31], a[200:203], v[196:199], a[28:31]
v_exp_f32 v45, v157
v_mfma_f32_16x16x32_bf16 a[28:31], a[204:207], v[212:215], a[28:31]
s_waitcnt lgkmcnt(2)
buffer_load_dwordx4 v53, s[80:83], s92 offen offset:0 lds
s_add_u32 s92, s92, 81920
v_mfma_f32_16x16x32_bf16 a[32:35], a[208:211], v[184:187], a[32:35]
s_waitcnt lgkmcnt(0)
buffer_load_dwordx4 v[64:67], v60, s[32:35], s52 offen offset:0 sc1
ds_read_b64_tr_b16 a[192:193], v23 offset:0
ds_read_b64_tr_b16 a[194:195], v23 offset:6144
v_mfma_f32_16x16x32_bf16 a[32:35], a[212:215], v[200:203], a[32:35]
ds_read_b64_tr_b16 a[196:197], v23 offset:12288
ds_read_b64_tr_b16 a[198:199], v23 offset:18432
v_mfma_f32_16x16x32_bf16 a[36:39], a[208:211], v[188:191], a[36:39]
v_add_f32 v37, v37, v45
v_cvt_pk_bf16_f32 v236, v44, v45
v_mfma_f32_16x16x32_bf16 a[36:39], a[212:215], v[204:207], a[36:39]
buffer_load_dwordx2 v[68:69], v11, s[32:35], s52 offen offset:1024 sc1
v_mfma_f32_16x16x32_bf16 a[40:43], a[208:211], v[192:195], a[40:43]
v_exp_f32 v46, v158
v_mfma_f32_16x16x32_bf16 a[40:43], a[212:215], v[208:211], a[40:43]
v_exp_f32 v47, v159
v_mfma_f32_16x16x32_bf16 a[44:47], a[208:211], v[196:199], a[44:47]
buffer_load_dwordx2 v[70:71], v11, s[32:35], s52 offen offset:1536 sc1
v_add_f32 v37, v37, v46
v_add_f32 v37, v37, v47
v_mfma_f32_16x16x32_bf16 a[44:47], a[212:215], v[212:215], a[44:47]
s_waitcnt lgkmcnt(2)
buffer_load_dwordx4 v[72:75], v61, s[32:35], s52 offen offset:0 sc1
v_mfma_f32_16x16x32_bf16 a[48:51], a[192:195], v[184:187], a[48:51]
s_waitcnt lgkmcnt(0)
ds_read_b64_tr_b16 a[200:201], v20 offset:128
ds_read_b64_tr_b16 a[202:203], v20 offset:6272
v_mfma_f32_16x16x32_bf16 a[48:51], a[196:199], v[200:203], a[48:51]
buffer_load_dwordx2 v[76:77], v18, s[32:35], s52 offen offset:1024 sc1
ds_read_b64_tr_b16 a[204:205], v20 offset:12416
ds_read_b64_tr_b16 a[206:207], v20 offset:18560
v_mfma_f32_16x16x32_bf16 a[52:55], a[192:195], v[188:191], a[52:55]
v_exp_f32 v40, v160
v_mfma_f32_16x16x32_bf16 a[52:55], a[196:199], v[204:207], a[52:55]
buffer_load_dwordx2 v[78:79], v18, s[32:35], s52 offen offset:1536 sc1
s_add_u32 s52, s52, 2048
s_add_u32 m0, s49, 81920
v_mfma_f32_16x16x32_bf16 a[56:59], a[192:195], v[192:195], a[56:59]
buffer_load_dwordx4 v49, s[80:83], s92 offen offset:0 lds
v_cvt_pk_bf16_f32 v237, v46, v47
v_add_f32 v38, v38, v40
v_mfma_f32_16x16x32_bf16 a[56:59], a[196:199], v[208:211], a[56:59]
v_exp_f32 v41, v161
v_mfma_f32_16x16x32_bf16 a[60:63], a[192:195], v[196:199], a[60:63]
v_add_f32 v38, v38, v41
v_cvt_pk_bf16_f32 v240, v40, v41
v_mfma_f32_16x16x32_bf16 a[60:63], a[196:199], v[212:215], a[60:63]
s_waitcnt lgkmcnt(2)
buffer_load_dwordx4 v50, s[80:83], s92 offen offset:1024 lds
v_exp_f32 v42, v162
v_mfma_f32_16x16x32_bf16 a[64:67], a[200:203], v[184:187], a[64:67]
s_waitcnt lgkmcnt(0)
ds_read_b64_tr_b16 a[208:209], v21 offset:128
ds_read_b64_tr_b16 a[210:211], v21 offset:6272
v_mfma_f32_16x16x32_bf16 a[64:67], a[204:207], v[200:203], a[64:67]
ds_read_b64_tr_b16 a[212:213], v21 offset:12416
ds_read_b64_tr_b16 a[214:215], v21 offset:18560
v_mfma_f32_16x16x32_bf16 a[68:71], a[200:203], v[188:191], a[68:71]
buffer_load_dwordx4 v51, s[80:83], s92 offen offset:2048 lds
v_exp_f32 v43, v163
v_mfma_f32_16x16x32_bf16 a[68:71], a[204:207], v[204:207], a[68:71]
v_add_f32 v38, v38, v42
v_add_f32 v38, v38, v43
v_mfma_f32_16x16x32_bf16 a[72:75], a[200:203], v[192:195], a[72:75]
buffer_load_dwordx4 v52, s[80:83], s92 offen offset:3072 lds
s_add_u32 m0, s49, 86016
v_mfma_f32_16x16x32_bf16 a[72:75], a[204:207], v[208:211], a[72:75]
buffer_load_dwordx4 v53, s[80:83], s92 offen offset:0 lds
v_exp_f32 v44, v164
s_add_u32 s92, s92, 81920
v_mfma_f32_16x16x32_bf16 a[76:79], a[200:203], v[196:199], a[76:79]
v_cvt_pk_bf16_f32 v241, v42, v43
v_add_f32 v39, v39, v44
v_mfma_f32_16x16x32_bf16 a[76:79], a[204:207], v[212:215], a[76:79]
s_waitcnt lgkmcnt(2)
v_exp_f32 v45, v165
v_mfma_f32_16x16x32_bf16 a[80:83], a[208:211], v[184:187], a[80:83]
s_waitcnt lgkmcnt(0)
buffer_load_dwordx4 v[80:83], v60, s[32:35], s52 offen offset:0 sc1
ds_read_b64_tr_b16 a[192:193], v22 offset:128
ds_read_b64_tr_b16 a[194:195], v22 offset:6272
v_mfma_f32_16x16x32_bf16 a[80:83], a[212:215], v[200:203], a[80:83]
ds_read_b64_tr_b16 a[196:197], v22 offset:12416
ds_read_b64_tr_b16 a[198:199], v22 offset:18560
v_mfma_f32_16x16x32_bf16 a[84:87], a[208:211], v[188:191], a[84:87]
v_add_f32 v39, v39, v45
v_cvt_pk_bf16_f32 v244, v44, v45
v_mfma_f32_16x16x32_bf16 a[84:87], a[212:215], v[204:207], a[84:87]
buffer_load_dwordx4 v[84:87], v60, s[32:35], s52 offen offset:1024 sc1
v_exp_f32 v46, v166
v_mfma_f32_16x16x32_bf16 a[88:91], a[208:211], v[192:195], a[88:91]
buffer_load_dwordx4 v[88:91], v61, s[32:35], s52 offen offset:0 sc1
v_mfma_f32_16x16x32_bf16 a[88:91], a[212:215], v[208:211], a[88:91]
v_exp_f32 v47, v167
v_mfma_f32_16x16x32_bf16 a[92:95], a[208:211], v[196:199], a[92:95]
buffer_load_dwordx4 v[92:95], v61, s[32:35], s52 offen offset:1024 sc1
v_add_f32 v39, v39, v46
v_add_f32 v39, v39, v47
s_add_u32 s52, s52, 2048
s_add_u32 m0, s49, 102400
v_mfma_f32_16x16x32_bf16 a[92:95], a[212:215], v[212:215], a[92:95]
s_waitcnt lgkmcnt(2)
v_exp_f32 v40, v168
v_mfma_f32_16x16x32_bf16 a[96:99], a[192:195], v[184:187], a[96:99]
s_waitcnt lgkmcnt(0)
ds_read_b64_tr_b16 a[200:201], v23 offset:128
ds_read_b64_tr_b16 a[202:203], v23 offset:6272
v_mfma_f32_16x16x32_bf16 a[96:99], a[196:199], v[200:203], a[96:99]
buffer_load_dwordx4 v49, s[80:83], s92 offen offset:0 lds
ds_read_b64_tr_b16 a[204:205], v23 offset:12416
ds_read_b64_tr_b16 a[206:207], v23 offset:18560
v_mfma_f32_16x16x32_bf16 a[100:103], a[192:195], v[188:191], a[100:103]
v_cvt_pk_bf16_f32 v245, v46, v47
v_add_f32 v36, v36, v40
v_mfma_f32_16x16x32_bf16 a[100:103], a[196:199], v[204:207], a[100:103]
v_exp_f32 v41, v169
v_mfma_f32_16x16x32_bf16 a[104:107], a[192:195], v[192:195], a[104:107]
buffer_load_dwordx4 v50, s[80:83], s92 offen offset:1024 lds
v_add_f32 v36, v36, v41
v_cvt_pk_bf16_f32 v234, v40, v41
v_mfma_f32_16x16x32_bf16 a[104:107], a[196:199], v[208:211], a[104:107]
v_exp_f32 v42, v170
v_mfma_f32_16x16x32_bf16 a[108:111], a[192:195], v[196:199], a[108:111]
v_exp_f32 v43, v171
v_mfma_f32_16x16x32_bf16 a[108:111], a[196:199], v[212:215], a[108:111]
s_waitcnt lgkmcnt(2)
buffer_load_dwordx4 v51, s[80:83], s92 offen offset:2048 lds
v_add_f32 v36, v36, v42
v_add_f32 v36, v36, v43
v_mfma_f32_16x16x32_bf16 a[112:115], a[200:203], v[184:187], a[112:115]
s_waitcnt lgkmcnt(0)
ds_read_b64_tr_b16 a[208:209], v20 offset:256
ds_read_b64_tr_b16 a[210:211], v20 offset:6400
v_mfma_f32_16x16x32_bf16 a[112:115], a[204:207], v[200:203], a[112:115]
ds_read_b64_tr_b16 a[212:213], v20 offset:12544
ds_read_b64_tr_b16 a[214:215], v20 offset:18688
v_mfma_f32_16x16x32_bf16 a[116:119], a[200:203], v[188:191], a[116:119]
buffer_load_dwordx4 v52, s[80:83], s92 offen offset:3072 lds
s_add_u32 m0, s49, 106496
v_mfma_f32_16x16x32_bf16 a[116:119], a[204:207], v[204:207], a[116:119]
v_exp_f32 v44, v172
v_mfma_f32_16x16x32_bf16 a[120:123], a[200:203], v[192:195], a[120:123]
v_cvt_pk_bf16_f32 v235, v42, v43
v_add_f32 v37, v37, v44
v_mfma_f32_16x16x32_bf16 a[120:123], a[204:207], v[208:211], a[120:123]
buffer_load_dwordx4 v53, s[80:83], s92 offen offset:0 lds
v_exp_f32 v45, v173
s_add_u32 s92, s92, 81920
v_mfma_f32_16x16x32_bf16 a[124:127], a[200:203], v[196:199], a[124:127]
v_add_f32 v37, v37, v45
v_cvt_pk_bf16_f32 v238, v44, v45
v_mfma_f32_16x16x32_bf16 a[124:127], a[204:207], v[212:215], a[124:127]
s_waitcnt lgkmcnt(2)
v_exp_f32 v46, v174
v_mfma_f32_16x16x32_bf16 a[128:131], a[208:211], v[184:187], a[128:131]
s_waitcnt lgkmcnt(0)
buffer_load_dwordx2 v[96:97], v11, s[32:35], s52 offen offset:0 sc1
ds_read_b64_tr_b16 a[192:193], v21 offset:256
ds_read_b64_tr_b16 a[194:195], v21 offset:6400
v_mfma_f32_16x16x32_bf16 a[128:131], a[212:215], v[200:203], a[128:131]
ds_read_b64_tr_b16 a[196:197], v21 offset:12544
ds_read_b64_tr_b16 a[198:199], v21 offset:18688
v_mfma_f32_16x16x32_bf16 a[132:135], a[208:211], v[188:191], a[132:135]
s_mov_b32 s101, s53
v_exp_f32 v47, v175
v_mfma_f32_16x16x32_bf16 a[132:135], a[212:215], v[204:207], a[132:135]
buffer_load_dwordx2 v[98:99], v11, s[32:35], s52 offen offset:512 sc1
v_add_f32 v37, v37, v46
v_add_f32 v37, v37, v47
v_mfma_f32_16x16x32_bf16 a[136:139], a[208:211], v[192:195], a[136:139]
s_mov_b32 s53, s54
v_exp_f32 v40, v176
v_mfma_f32_16x16x32_bf16 a[136:139], a[212:215], v[208:211], a[136:139]
v_cvt_pk_bf16_f32 v239, v46, v47
v_add_f32 v38, v38, v40
v_mfma_f32_16x16x32_bf16 a[140:143], a[208:211], v[196:199], a[140:143]
s_mov_b32 s54, s27
buffer_load_dwordx4 v[100:103], v60, s[32:35], s52 offen offset:1024 sc1
v_exp_f32 v41, v177
v_mfma_f32_16x16x32_bf16 a[140:143], a[212:215], v[212:215], a[140:143]
s_waitcnt lgkmcnt(2)
v_add_f32 v38, v38, v41
v_cvt_pk_bf16_f32 v242, v40, v41
v_mfma_f32_16x16x32_bf16 a[144:147], a[192:195], v[184:187], a[144:147]
s_waitcnt lgkmcnt(0)
s_mov_b32 s27, s101
ds_read_b64_tr_b16 a[200:201], v22 offset:256
ds_read_b64_tr_b16 a[202:203], v22 offset:6400
v_mfma_f32_16x16x32_bf16 a[144:147], a[196:199], v[200:203], a[144:147]
buffer_load_dwordx2 v[104:105], v18, s[32:35], s52 offen offset:0 sc1
ds_read_b64_tr_b16 a[204:205], v22 offset:12544
ds_read_b64_tr_b16 a[206:207], v22 offset:18688
v_mfma_f32_16x16x32_bf16 a[148:151], a[192:195], v[188:191], a[148:151]
v_exp_f32 v42, v178
v_mfma_f32_16x16x32_bf16 a[148:151], a[196:199], v[204:207], a[148:151]
v_exp_f32 v43, v179
v_mfma_f32_16x16x32_bf16 a[152:155], a[192:195], v[192:195], a[152:155]
buffer_load_dwordx2 v[106:107], v18, s[32:35], s52 offen offset:512 sc1
v_add_f32 v38, v38, v42
v_add_f32 v38, v38, v43
v_mfma_f32_16x16x32_bf16 a[152:155], a[196:199], v[208:211], a[152:155]
v_exp_f32 v44, v180
v_mfma_f32_16x16x32_bf16 a[156:159], a[192:195], v[196:199], a[156:159]
v_cvt_pk_bf16_f32 v243, v42, v43
v_add_f32 v39, v39, v44
v_mfma_f32_16x16x32_bf16 a[156:159], a[196:199], v[212:215], a[156:159]
s_waitcnt lgkmcnt(2)
buffer_load_dwordx4 v[108:111], v61, s[32:35], s52 offen offset:1024 sc1
v_exp_f32 v45, v181
s_add_u32 s52, s52, 2048
s_add_u32 m0, s49, 122880
v_mfma_f32_16x16x32_bf16 a[160:163], a[200:203], v[184:187], a[160:163]
s_waitcnt lgkmcnt(0)
ds_read_b64_tr_b16 a[208:209], v23 offset:256
ds_read_b64_tr_b16 a[210:211], v23 offset:6400
v_mfma_f32_16x16x32_bf16 a[160:163], a[204:207], v[200:203], a[160:163]
ds_read_b64_tr_b16 a[212:213], v23 offset:12544
ds_read_b64_tr_b16 a[214:215], v23 offset:18688
v_mfma_f32_16x16x32_bf16 a[164:167], a[200:203], v[188:191], a[164:167]
buffer_load_dwordx4 v49, s[80:83], s92 offen offset:0 lds
v_add_f32 v39, v39, v45
v_cvt_pk_bf16_f32 v246, v44, v45
v_mfma_f32_16x16x32_bf16 a[164:167], a[204:207], v[204:207], a[164:167]
v_exp_f32 v46, v182
v_mfma_f32_16x16x32_bf16 a[168:171], a[200:203], v[192:195], a[168:171]
v_exp_f32 v47, v183
v_mfma_f32_16x16x32_bf16 a[168:171], a[204:207], v[208:211], a[168:171]
buffer_load_dwordx4 v50, s[80:83], s92 offen offset:1024 lds
v_add_f32 v39, v39, v46
v_add_f32 v39, v39, v47
v_mfma_f32_16x16x32_bf16 a[172:175], a[200:203], v[196:199], a[172:175]
v_cvt_pk_bf16_f32 v247, v46, v47
v_mfma_f32_16x16x32_bf16 a[172:175], a[204:207], v[212:215], a[172:175]
s_waitcnt lgkmcnt(2)
buffer_load_dwordx4 v51, s[80:83], s92 offen offset:2048 lds
v_mfma_f32_16x16x32_bf16 a[176:179], a[208:211], v[184:187], a[176:179]
s_waitcnt lgkmcnt(0)
buffer_load_dwordx4 v52, s[80:83], s92 offen offset:3072 lds
s_add_u32 m0, s49, 126976
v_mfma_f32_16x16x32_bf16 a[176:179], a[212:215], v[200:203], a[176:179]
buffer_load_dwordx4 v53, s[80:83], s92 offen offset:0 lds
s_add_u32 s92, s92, 81920
s_add_u32 m0, s49, 143360
v_mfma_f32_16x16x32_bf16 a[180:183], a[208:211], v[188:191], a[180:183]
buffer_load_dwordx4 v49, s[80:83], s92 offen offset:0 lds
v_mfma_f32_16x16x32_bf16 a[180:183], a[212:215], v[204:207], a[180:183]
buffer_load_dwordx4 v50, s[80:83], s92 offen offset:1024 lds
v_mfma_f32_16x16x32_bf16 a[184:187], a[208:211], v[192:195], a[184:187]
v_max3_f32 v48, v36, v37, v38
v_max_f32 v48, v48, v39
v_mfma_f32_16x16x32_bf16 a[184:187], a[212:215], v[208:211], a[184:187]
v_cmp_lt_f32 vcc, 0x49800000, v48
v_mfma_f32_16x16x32_bf16 a[188:191], a[208:211], v[196:199], a[188:191]
buffer_load_dwordx4 v51, s[80:83], s92 offen offset:2048 lds
v_mfma_f32_16x16x32_bf16 a[188:191], a[212:215], v[212:215], a[188:191]
s_cbranch_vccnz L_stub31
L_back31:
buffer_load_dwordx4 v52, s[80:83], s92 offen offset:3072 lds
s_add_u32 m0, s49, 147456
s_nop 0
s_sub_u32 s100, s53, s27
v_add_f32 v32, v32, v36
v_add_f32 v33, v33, v37
v_add_u32 v20, s100, v20
v_add_u32 v21, s100, v21
v_add_u32 v22, s100, v22
v_add_u32 v23, s100, v23
v_add_f32 v34, v34, v38
v_add_f32 v35, v35, v39
s_barrier
ds_read_b64_tr_b16 a[192:193], v20 offset:0
ds_read_b64_tr_b16 a[194:195], v20 offset:6144
ds_read_b64_tr_b16 a[196:197], v20 offset:12288
ds_read_b64_tr_b16 a[198:199], v20 offset:18432
s_waitcnt lgkmcnt(2)
v_mfma_f32_16x16x32_bf16 a[0:3], a[192:195], v[216:219], a[0:3]
s_waitcnt lgkmcnt(0)
ds_read_b64_tr_b16 a[200:201], v21 offset:0
ds_read_b64_tr_b16 a[202:203], v21 offset:6144
v_mfma_f32_16x16x32_bf16 a[0:3], a[196:199], v[232:235], a[0:3]
buffer_load_dwordx4 v53, s[80:83], s92 offen offset:0 lds
ds_read_b64_tr_b16 a[204:205], v21 offset:12288
ds_read_b64_tr_b16 a[206:207], v21 offset:18432
s_add_u32 s92, s92, 81920
v_mfma_f32_16x16x32_bf16 a[4:7], a[192:195], v[220:223], a[4:7]
buffer_load_dwordx4 v[112:115], v60, s[32:35], s52 offen offset:0 sc1
v_mfma_f32_16x16x32_bf16 a[4:7], a[196:199], v[236:239], a[4:7]
buffer_load_dwordx2 v[116:117], v11, s[32:35], s52 offen offset:1024 sc1
v_mfma_f32_16x16x32_bf16 a[8:11], a[192:195], v[224:227], a[8:11]
buffer_load_dwordx2 v[118:119], v11, s[32:35], s52 offen offset:1536 sc1
v_mfma_f32_16x16x32_bf16 a[8:11], a[196:199], v[240:243], a[8:11]
buffer_load_dwordx4 v[120:123], v61, s[32:35], s52 offen offset:0 sc1
v_mfma_f32_16x16x32_bf16 a[12:15], a[192:195], v[228:231], a[12:15]
buffer_load_dwordx2 v[124:125], v18, s[32:35], s52 offen offset:1024 sc1
v_mfma_f32_16x16x32_bf16 a[12:15], a[196:199], v[244:247], a[12:15]
s_waitcnt lgkmcnt(2)
buffer_load_dwordx2 v[126:127], v18, s[32:35], s52 offen offset:1536 sc1
s_add_u32 s52, s52, 2048
v_mfma_f32_16x16x32_bf16 a[16:19], a[200:203], v[216:219], a[16:19]
s_waitcnt lgkmcnt(0)
ds_read_b64_tr_b16 a[208:209], v22 offset:0
ds_read_b64_tr_b16 a[210:211], v22 offset:6144
v_mfma_f32_16x16x32_bf16 a[16:19], a[204:207], v[232:235], a[16:19]
ds_read_b64_tr_b16 a[212:213], v22 offset:12288
ds_read_b64_tr_b16 a[214:215], v22 offset:18432
v_mfma_f32_16x16x32_bf16 a[20:23], a[200:203], v[220:223], a[20:23]
buffer_load_dwordx4 v[128:131], v60, s[32:35], s52 offen offset:0 sc1
v_mfma_f32_16x16x32_bf16 a[20:23], a[204:207], v[236:239], a[20:23]
buffer_load_dwordx4 v[132:135], v60, s[32:35], s52 offen offset:1024 sc1
v_mfma_f32_16x16x32_bf16 a[24:27], a[200:203], v[224:227], a[24:27]
buffer_load_dwordx4 v[136:139], v61, s[32:35], s52 offen offset:0 sc1
v_mfma_f32_16x16x32_bf16 a[24:27], a[204:207], v[240:243], a[24:27]
buffer_load_dwordx4 v[140:143], v61, s[32:35], s52 offen offset:1024 sc1
s_add_u32 s52, s52, 2048
v_mfma_f32_16x16x32_bf16 a[28:31], a[200:203], v[228:231], a[28:31]
v_mov_b32 v40, v32
v_mov_b32 v42, v33
v_mfma_f32_16x16x32_bf16 a[28:31], a[204:207], v[244:247], a[28:31]
s_waitcnt lgkmcnt(2)
v_mov_b32 v44, v34
v_mov_b32 v46, v35
v_mfma_f32_16x16x32_bf16 a[32:35], a[208:211], v[216:219], a[32:35]
s_waitcnt lgkmcnt(0)
ds_read_b64_tr_b16 a[192:193], v23 offset:0
ds_read_b64_tr_b16 a[194:195], v23 offset:6144
v_mfma_f32_16x16x32_bf16 a[32:35], a[212:215], v[232:235], a[32:35]
ds_read_b64_tr_b16 a[196:197], v23 offset:12288
ds_read_b64_tr_b16 a[198:199], v23 offset:18432
v_mfma_f32_16x16x32_bf16 a[36:39], a[208:211], v[220:223], a[36:39]
v_mov_b32 v41, v32
v_mov_b32 v43, v33
v_mfma_f32_16x16x32_bf16 a[36:39], a[212:215], v[236:239], a[36:39]
v_mov_b32 v45, v34
v_mov_b32 v47, v35
v_mfma_f32_16x16x32_bf16 a[40:43], a[208:211], v[224:227], a[40:43]
v_permlane32_swap_b32 v40, v41
v_permlane32_swap_b32 v42, v43
v_mfma_f32_16x16x32_bf16 a[40:43], a[212:215], v[240:243], a[40:43]
v_permlane32_swap_b32 v44, v45
v_permlane32_swap_b32 v46, v47
v_mfma_f32_16x16x32_bf16 a[44:47], a[208:211], v[228:231], a[44:47]
v_add_f32 v32, v40, v41
v_add_f32 v33, v42, v43
v_mfma_f32_16x16x32_bf16 a[44:47], a[212:215], v[244:247], a[44:47]
s_waitcnt lgkmcnt(2)
v_add_f32 v34, v44, v45
v_add_f32 v35, v46, v47
v_mfma_f32_16x16x32_bf16 a[48:51], a[192:195], v[216:219], a[48:51]
s_waitcnt lgkmcnt(0)
ds_read_b64_tr_b16 a[200:201], v20 offset:128
ds_read_b64_tr_b16 a[202:203], v20 offset:6272
v_mfma_f32_16x16x32_bf16 a[48:51], a[196:199], v[232:235], a[48:51]
ds_read_b64_tr_b16 a[204:205], v20 offset:12416
ds_read_b64_tr_b16 a[206:207], v20 offset:18560
v_mfma_f32_16x16x32_bf16 a[52:55], a[192:195], v[220:223], a[52:55]
v_mov_b32 v40, v32
v_mov_b32 v42, v33
v_mfma_f32_16x16x32_bf16 a[52:55], a[196:199], v[236:239], a[52:55]
v_mov_b32 v44, v34
v_mov_b32 v46, v35
v_mfma_f32_16x16x32_bf16 a[56:59], a[192:195], v[224:227], a[56:59]
v_mov_b32 v41, v32
v_mov_b32 v43, v33
v_mfma_f32_16x16x32_bf16 a[56:59], a[196:199], v[240:243], a[56:59]
v_mov_b32 v45, v34
v_mov_b32 v47, v35
v_mfma_f32_16x16x32_bf16 a[60:63], a[192:195], v[228:231], a[60:63]
v_permlane16_swap_b32 v40, v41
v_permlane16_swap_b32 v42, v43
v_mfma_f32_16x16x32_bf16 a[60:63], a[196:199], v[244:247], a[60:63]
s_waitcnt lgkmcnt(2)
v_permlane16_swap_b32 v44, v45
v_permlane16_swap_b32 v46, v47
v_mfma_f32_16x16x32_bf16 a[64:67], a[200:203], v[216:219], a[64:67]
s_waitcnt lgkmcnt(0)
ds_read_b64_tr_b16 a[208:209], v21 offset:128
ds_read_b64_tr_b16 a[210:211], v21 offset:6272
v_mfma_f32_16x16x32_bf16 a[64:67], a[204:207], v[232:235], a[64:67]
ds_read_b64_tr_b16 a[212:213], v21 offset:12416
ds_read_b64_tr_b16 a[214:215], v21 offset:18560
v_mfma_f32_16x16x32_bf16 a[68:71], a[200:203], v[220:223], a[68:71]
v_add_f32 v32, v40, v41
v_add_f32 v33, v42, v43
v_mfma_f32_16x16x32_bf16 a[68:71], a[204:207], v[236:239], a[68:71]
v_add_f32 v34, v44, v45
v_add_f32 v35, v46, v47
v_mfma_f32_16x16x32_bf16 a[72:75], a[200:203], v[224:227], a[72:75]
v_rcp_f32 v36, v32
v_mfma_f32_16x16x32_bf16 a[72:75], a[204:207], v[240:243], a[72:75]
v_rcp_f32 v37, v33
v_mfma_f32_16x16x32_bf16 a[76:79], a[200:203], v[228:231], a[76:79]
v_rcp_f32 v38, v34
v_mfma_f32_16x16x32_bf16 a[76:79], a[204:207], v[244:247], a[76:79]
s_waitcnt lgkmcnt(2)
v_rcp_f32 v39, v35
s_mul_i32 s55, s50, 196608
s_mul_i32 s56, s36, 6144
v_mfma_f32_16x16x32_bf16 a[80:83], a[208:211], v[216:219], a[80:83]
s_waitcnt lgkmcnt(0)
ds_read_b64_tr_b16 a[192:193], v22 offset:128
ds_read_b64_tr_b16 a[194:195], v22 offset:6272
s_add_u32 s55, s55, s56
s_add_u32 s56, s55, 196608
v_mfma_f32_16x16x32_bf16 a[80:83], a[212:215], v[232:235], a[80:83]
ds_read_b64_tr_b16 a[196:197], v22 offset:12416
ds_read_b64_tr_b16 a[198:199], v22 offset:18560
s_add_u32 s57, s56, 196608
s_add_u32 s58, s57, 196608
v_mfma_f32_16x16x32_bf16 a[84:87], a[208:211], v[220:223], a[84:87]
v_and_b32 v56, 12, v62
v_add_u32 v248, 61440, v54
v_mfma_f32_16x16x32_bf16 a[84:87], a[212:215], v[236:239], a[84:87]
v_add_u32 v249, 61440, v55
v_add_u32 v250, 122880, v54
v_mfma_f32_16x16x32_bf16 a[88:91], a[208:211], v[224:227], a[88:91]
v_add_u32 v251, 122880, v55
v_mfma_f32_16x16x32_bf16 a[88:91], a[212:215], v[240:243], a[88:91]
v_mfma_f32_16x16x32_bf16 a[92:95], a[208:211], v[228:231], a[92:95]
v_mfma_f32_16x16x32_bf16 a[92:95], a[212:215], v[244:247], a[92:95]
s_waitcnt lgkmcnt(2)
v_mfma_f32_16x16x32_bf16 a[96:99], a[192:195], v[216:219], a[96:99]
s_waitcnt lgkmcnt(0)
ds_read_b64_tr_b16 a[200:201], v23 offset:128
ds_read_b64_tr_b16 a[202:203], v23 offset:6272
v_mfma_f32_16x16x32_bf16 a[96:99], a[196:199], v[232:235], a[96:99]
ds_read_b64_tr_b16 a[204:205], v23 offset:12416
ds_read_b64_tr_b16 a[206:207], v23 offset:18560
v_mfma_f32_16x16x32_bf16 a[100:103], a[192:195], v[220:223], a[100:103]
v_mfma_f32_16x16x32_bf16 a[100:103], a[196:199], v[236:239], a[100:103]
v_mfma_f32_16x16x32_bf16 a[104:107], a[192:195], v[224:227], a[104:107]
v_mfma_f32_16x16x32_bf16 a[104:107], a[196:199], v[240:243], a[104:107]
v_mfma_f32_16x16x32_bf16 a[108:111], a[192:195], v[228:231], a[108:111]
v_mfma_f32_16x16x32_bf16 a[108:111], a[196:199], v[244:247], a[108:111]
s_waitcnt lgkmcnt(2)
v_mfma_f32_16x16x32_bf16 a[112:115], a[200:203], v[216:219], a[112:115]
s_waitcnt lgkmcnt(0)
ds_read_b64_tr_b16 a[208:209], v20 offset:256
ds_read_b64_tr_b16 a[210:211], v20 offset:6400
v_mfma_f32_16x16x32_bf16 a[112:115], a[204:207], v[232:235], a[112:115]
ds_read_b64_tr_b16 a[212:213], v20 offset:12544
ds_read_b64_tr_b16 a[214:215], v20 offset:18688
v_mfma_f32_16x16x32_bf16 a[116:119], a[200:203], v[220:223], a[116:119]
v_mfma_f32_16x16x32_bf16 a[116:119], a[204:207], v[236:239], a[116:119]
v_mfma_f32_16x16x32_bf16 a[120:123], a[200:203], v[224:227], a[120:123]
v_mfma_f32_16x16x32_bf16 a[120:123], a[204:207], v[240:243], a[120:123]
v_mfma_f32_16x16x32_bf16 a[124:127], a[200:203], v[228:231], a[124:127]
v_mfma_f32_16x16x32_bf16 a[124:127], a[204:207], v[244:247], a[124:127]
s_waitcnt lgkmcnt(2)
v_mfma_f32_16x16x32_bf16 a[128:131], a[208:211], v[216:219], a[128:131]
s_waitcnt lgkmcnt(0)
ds_read_b64_tr_b16 a[192:193], v21 offset:256
ds_read_b64_tr_b16 a[194:195], v21 offset:6400
v_mfma_f32_16x16x32_bf16 a[128:131], a[212:215], v[232:235], a[128:131]
ds_read_b64_tr_b16 a[196:197], v21 offset:12544
ds_read_b64_tr_b16 a[198:199], v21 offset:18688
v_mfma_f32_16x16x32_bf16 a[132:135], a[208:211], v[220:223], a[132:135]
s_mov_b32 s101, s53
v_mfma_f32_16x16x32_bf16 a[132:135], a[212:215], v[236:239], a[132:135]
v_mfma_f32_16x16x32_bf16 a[136:139], a[208:211], v[224:227], a[136:139]
s_mov_b32 s53, s54
v_mfma_f32_16x16x32_bf16 a[136:139], a[212:215], v[240:243], a[136:139]
v_mfma_f32_16x16x32_bf16 a[140:143], a[208:211], v[228:231], a[140:143]
s_mov_b32 s54, s27
v_mfma_f32_16x16x32_bf16 a[140:143], a[212:215], v[244:247], a[140:143]
s_waitcnt lgkmcnt(2)
v_mfma_f32_16x16x32_bf16 a[144:147], a[192:195], v[216:219], a[144:147]
s_waitcnt lgkmcnt(0)
s_mov_b32 s27, s101
ds_read_b64_tr_b16 a[200:201], v22 offset:256
ds_read_b64_tr_b16 a[202:203], v22 offset:6400
v_mfma_f32_16x16x32_bf16 a[144:147], a[196:199], v[232:235], a[144:147]
ds_read_b64_tr_b16 a[204:205], v22 offset:12544
ds_read_b64_tr_b16 a[206:207], v22 offset:18688
v_mfma_f32_16x16x32_bf16 a[148:151], a[192:195], v[220:223], a[148:151]
v_mfma_f32_16x16x32_bf16 a[148:151], a[196:199], v[236:239], a[148:151]
v_mfma_f32_16x16x32_bf16 a[152:155], a[192:195], v[224:227], a[152:155]
v_mfma_f32_16x16x32_bf16 a[152:155], a[196:199], v[240:243], a[152:155]
v_mfma_f32_16x16x32_bf16 a[156:159], a[192:195], v[228:231], a[156:159]
v_mfma_f32_16x16x32_bf16 a[156:159], a[196:199], v[244:247], a[156:159]
s_waitcnt lgkmcnt(2)
v_mfma_f32_16x16x32_bf16 a[160:163], a[200:203], v[216:219], a[160:163]
s_waitcnt lgkmcnt(0)
ds_read_b64_tr_b16 a[208:209], v23 offset:256
ds_read_b64_tr_b16 a[210:211], v23 offset:6400
v_mfma_f32_16x16x32_bf16 a[160:163], a[204:207], v[232:235], a[160:163]
ds_read_b64_tr_b16 a[212:213], v23 offset:12544
ds_read_b64_tr_b16 a[214:215], v23 offset:18688
v_mfma_f32_16x16x32_bf16 a[164:167], a[200:203], v[220:223], a[164:167]
v_mfma_f32_16x16x32_bf16 a[164:167], a[204:207], v[236:239], a[164:167]
v_mfma_f32_16x16x32_bf16 a[168:171], a[200:203], v[224:227], a[168:171]
v_mfma_f32_16x16x32_bf16 a[168:171], a[204:207], v[240:243], a[168:171]
v_mfma_f32_16x16x32_bf16 a[172:175], a[200:203], v[228:231], a[172:175]
v_mfma_f32_16x16x32_bf16 a[172:175], a[204:207], v[244:247], a[172:175]
s_waitcnt lgkmcnt(2)
v_mfma_f32_16x16x32_bf16 a[176:179], a[208:211], v[216:219], a[176:179]
s_waitcnt lgkmcnt(0)
v_mfma_f32_16x16x32_bf16 a[176:179], a[212:215], v[232:235], a[176:179]
v_mfma_f32_16x16x32_bf16 a[180:183], a[208:211], v[220:223], a[180:183]
v_mfma_f32_16x16x32_bf16 a[180:183], a[212:215], v[236:239], a[180:183]
v_mfma_f32_16x16x32_bf16 a[184:187], a[208:211], v[224:227], a[184:187]
v_mfma_f32_16x16x32_bf16 a[184:187], a[212:215], v[240:243], a[184:187]
v_mfma_f32_16x16x32_bf16 a[188:191], a[208:211], v[228:231], a[188:191]
v_mfma_f32_16x16x32_bf16 a[188:191], a[212:215], v[244:247], a[188:191]
s_waitcnt vmcnt(31)
s_memrealtime s[8:9]
s_waitcnt lgkmcnt(0)
s_or_b32 s8, s8, 1
v_mov_b32 v63, s8
buffer_store_dword v63, off, s[60:63], s21 sc1
v_accvgpr_read_b32 v196, a0
v_accvgpr_read_b32 v197, a1
v_accvgpr_read_b32 v198, a2
v_accvgpr_read_b32 v199, a3
v_accvgpr_read_b32 v200, a16
v_accvgpr_read_b32 v201, a17
v_accvgpr_read_b32 v202, a18
v_accvgpr_read_b32 v203, a19
v_pk_mul_f32 v[196:197], v[196:197], v[36:37] op_sel:[0,0] op_sel_hi:[1,0]
v_pk_mul_f32 v[198:199], v[198:199], v[36:37] op_sel:[0,0] op_sel_hi:[1,0]
v_pk_mul_f32 v[200:201], v[200:201], v[36:37] op_sel:[0,0] op_sel_hi:[1,0]
v_pk_mul_f32 v[202:203], v[202:203], v[36:37] op_sel:[0,0] op_sel_hi:[1,0]
v_cvt_pk_bf16_f32 v204, v196, v197
v_cvt_pk_bf16_f32 v205, v198, v199
v_cvt_pk_bf16_f32 v206, v200, v201
v_cvt_pk_bf16_f32 v207, v202, v203
buffer_store_dwordx4 v[204:207], v57, s[28:31], s55 offen offset:0 sc1
v_accvgpr_read_b32 v208, a4
v_accvgpr_read_b32 v209, a5
v_accvgpr_read_b32 v210, a6
v_accvgpr_read_b32 v211, a7
v_accvgpr_read_b32 v212, a20
v_accvgpr_read_b32 v213, a21
v_accvgpr_read_b32 v214, a22
v_accvgpr_read_b32 v215, a23
v_pk_mul_f32 v[208:209], v[208:209], v[36:37] op_sel:[0,1] op_sel_hi:[1,1]
v_pk_mul_f32 v[210:211], v[210:211], v[36:37] op_sel:[0,1] op_sel_hi:[1,1]
v_pk_mul_f32 v[212:213], v[212:213], v[36:37] op_sel:[0,1] op_sel_hi:[1,1]
v_pk_mul_f32 v[214:215], v[214:215], v[36:37] op_sel:[0,1] op_sel_hi:[1,1]
v_cvt_pk_bf16_f32 v216, v208, v209
v_cvt_pk_bf16_f32 v217, v210, v211
v_cvt_pk_bf16_f32 v218, v212, v213
v_cvt_pk_bf16_f32 v219, v214, v215
buffer_store_dwordx4 v[216:219], v57, s[28:31], s56 offen offset:0 sc1
v_accvgpr_read_b32 v220, a8
v_accvgpr_read_b32 v221, a9
v_accvgpr_read_b32 v222, a10
v_accvgpr_read_b32 v223, a11
v_accvgpr_read_b32 v224, a24
v_accvgpr_read_b32 v225, a25
v_accvgpr_read_b32 v226, a26
v_accvgpr_read_b32 v227, a27
v_pk_mul_f32 v[220:221], v[220:221], v[38:39] op_sel:[0,0] op_sel_hi:[1,0]
v_pk_mul_f32 v[222:223], v[222:223], v[38:39] op_sel:[0,0] op_sel_hi:[1,0]
v_pk_mul_f32 v[224:225], v[224:225], v[38:39] op_sel:[0,0] op_sel_hi:[1,0]
v_pk_mul_f32 v[226:227], v[226:227], v[38:39] op_sel:[0,0] op_sel_hi:[1,0]
v_cvt_pk_bf16_f32 v228, v220, v221
v_cvt_pk_bf16_f32 v229, v222, v223
v_cvt_pk_bf16_f32 v230, v224, v225
v_cvt_pk_bf16_f32 v231, v226, v227
buffer_store_dwordx4 v[228:231], v57, s[28:31], s57 offen offset:0 sc1
v_accvgpr_read_b32 v232, a12
v_accvgpr_read_b32 v233, a13
v_accvgpr_read_b32 v234, a14
v_accvgpr_read_b32 v235, a15
v_accvgpr_read_b32 v236, a28
v_accvgpr_read_b32 v237, a29
v_accvgpr_read_b32 v238, a30
v_accvgpr_read_b32 v239, a31
v_pk_mul_f32 v[232:233], v[232:233], v[38:39] op_sel:[0,1] op_sel_hi:[1,1]
v_pk_mul_f32 v[234:235], v[234:235], v[38:39] op_sel:[0,1] op_sel_hi:[1,1]
v_pk_mul_f32 v[236:237], v[236:237], v[38:39] op_sel:[0,1] op_sel_hi:[1,1]
v_pk_mul_f32 v[238:239], v[238:239], v[38:39] op_sel:[0,1] op_sel_hi:[1,1]
v_cvt_pk_bf16_f32 v240, v232, v233
v_cvt_pk_bf16_f32 v241, v234, v235
v_cvt_pk_bf16_f32 v242, v236, v237
v_cvt_pk_bf16_f32 v243, v238, v239
buffer_store_dwordx4 v[240:243], v57, s[28:31], s58 offen offset:0 sc1
v_accvgpr_read_b32 v196, a32
v_accvgpr_read_b32 v197, a33
v_accvgpr_read_b32 v198, a34
v_accvgpr_read_b32 v199, a35
v_accvgpr_read_b32 v200, a48
v_accvgpr_read_b32 v201, a49
v_accvgpr_read_b32 v202, a50
v_accvgpr_read_b32 v203, a51
v_pk_mul_f32 v[196:197], v[196:197], v[36:37] op_sel:[0,0] op_sel_hi:[1,0]
v_pk_mul_f32 v[198:199], v[198:199], v[36:37] op_sel:[0,0] op_sel_hi:[1,0]
v_pk_mul_f32 v[200:201], v[200:201], v[36:37] op_sel:[0,0] op_sel_hi:[1,0]
v_pk_mul_f32 v[202:203], v[202:203], v[36:37] op_sel:[0,0] op_sel_hi:[1,0]
v_cvt_pk_bf16_f32 v204, v196, v197
v_cvt_pk_bf16_f32 v205, v198, v199
v_cvt_pk_bf16_f32 v206, v200, v201
v_cvt_pk_bf16_f32 v207, v202, v203
buffer_store_dwordx4 v[204:207], v57, s[28:31], s55 offen offset:1024 sc1
v_accvgpr_read_b32 v208, a36
v_accvgpr_read_b32 v209, a37
v_accvgpr_read_b32 v210, a38
v_accvgpr_read_b32 v211, a39
v_accvgpr_read_b32 v212, a52
v_accvgpr_read_b32 v213, a53
v_accvgpr_read_b32 v214, a54
v_accvgpr_read_b32 v215, a55
v_pk_mul_f32 v[208:209], v[208:209], v[36:37] op_sel:[0,1] op_sel_hi:[1,1]
v_pk_mul_f32 v[210:211], v[210:211], v[36:37] op_sel:[0,1] op_sel_hi:[1,1]
v_pk_mul_f32 v[212:213], v[212:213], v[36:37] op_sel:[0,1] op_sel_hi:[1,1]
v_pk_mul_f32 v[214:215], v[214:215], v[36:37] op_sel:[0,1] op_sel_hi:[1,1]
v_cvt_pk_bf16_f32 v216, v208, v209
v_cvt_pk_bf16_f32 v217, v210, v211
v_cvt_pk_bf16_f32 v218, v212, v213
v_cvt_pk_bf16_f32 v219, v214, v215
buffer_store_dwordx4 v[216:219], v57, s[28:31], s56 offen offset:1024 sc1
v_accvgpr_read_b32 v220, a40
v_accvgpr_read_b32 v221, a41
v_accvgpr_read_b32 v222, a42
v_accvgpr_read_b32 v223, a43
v_accvgpr_read_b32 v224, a56
v_accvgpr_read_b32 v225, a57
v_accvgpr_read_b32 v226, a58
v_accvgpr_read_b32 v227, a59
v_pk_mul_f32 v[220:221], v[220:221], v[38:39] op_sel:[0,0] op_sel_hi:[1,0]
v_pk_mul_f32 v[222:223], v[222:223], v[38:39] op_sel:[0,0] op_sel_hi:[1,0]
v_pk_mul_f32 v[224:225], v[224:225], v[38:39] op_sel:[0,0] op_sel_hi:[1,0]
v_pk_mul_f32 v[226:227], v[226:227], v[38:39] op_sel:[0,0] op_sel_hi:[1,0]
v_cvt_pk_bf16_f32 v228, v220, v221
v_cvt_pk_bf16_f32 v229, v222, v223
v_cvt_pk_bf16_f32 v230, v224, v225
v_cvt_pk_bf16_f32 v231, v226, v227
buffer_store_dwordx4 v[228:231], v57, s[28:31], s57 offen offset:1024 sc1
v_accvgpr_read_b32 v232, a44
v_accvgpr_read_b32 v233, a45
v_accvgpr_read_b32 v234, a46
v_accvgpr_read_b32 v235, a47
v_accvgpr_read_b32 v236, a60
v_accvgpr_read_b32 v237, a61
v_accvgpr_read_b32 v238, a62
v_accvgpr_read_b32 v239, a63
v_pk_mul_f32 v[232:233], v[232:233], v[38:39] op_sel:[0,1] op_sel_hi:[1,1]
v_pk_mul_f32 v[234:235], v[234:235], v[38:39] op_sel:[0,1] op_sel_hi:[1,1]
v_pk_mul_f32 v[236:237], v[236:237], v[38:39] op_sel:[0,1] op_sel_hi:[1,1]
v_pk_mul_f32 v[238:239], v[238:239], v[38:39] op_sel:[0,1] op_sel_hi:[1,1]
v_cvt_pk_bf16_f32 v240, v232, v233
v_cvt_pk_bf16_f32 v241, v234, v235
v_cvt_pk_bf16_f32 v242, v236, v237
v_cvt_pk_bf16_f32 v243, v238, v239
buffer_store_dwordx4 v[240:243], v57, s[28:31], s58 offen offset:1024 sc1
v_accvgpr_read_b32 v196, a64
v_accvgpr_read_b32 v197, a65
v_accvgpr_read_b32 v198, a66
v_accvgpr_read_b32 v199, a67
v_accvgpr_read_b32 v200, a80
v_accvgpr_read_b32 v201, a81
v_accvgpr_read_b32 v202, a82
v_accvgpr_read_b32 v203, a83
v_pk_mul_f32 v[196:197], v[196:197], v[36:37] op_sel:[0,0] op_sel_hi:[1,0]
v_pk_mul_f32 v[198:199], v[198:199], v[36:37] op_sel:[0,0] op_sel_hi:[1,0]
v_pk_mul_f32 v[200:201], v[200:201], v[36:37] op_sel:[0,0] op_sel_hi:[1,0]
v_pk_mul_f32 v[202:203], v[202:203], v[36:37] op_sel:[0,0] op_sel_hi:[1,0]
v_cvt_pk_bf16_f32 v204, v196, v197
v_cvt_pk_bf16_f32 v205, v198, v199
v_cvt_pk_bf16_f32 v206, v200, v201
v_cvt_pk_bf16_f32 v207, v202, v203
buffer_store_dwordx4 v[204:207], v57, s[28:31], s55 offen offset:2048 sc1
v_accvgpr_read_b32 v208, a68
v_accvgpr_read_b32 v209, a69
v_accvgpr_read_b32 v210, a70
v_accvgpr_read_b32 v211, a71
v_accvgpr_read_b32 v212, a84
v_accvgpr_read_b32 v213, a85
v_accvgpr_read_b32 v214, a86
v_accvgpr_read_b32 v215, a87
v_pk_mul_f32 v[208:209], v[208:209], v[36:37] op_sel:[0,1] op_sel_hi:[1,1]
v_pk_mul_f32 v[210:211], v[210:211], v[36:37] op_sel:[0,1] op_sel_hi:[1,1]
v_pk_mul_f32 v[212:213], v[212:213], v[36:37] op_sel:[0,1] op_sel_hi:[1,1]
v_pk_mul_f32 v[214:215], v[214:215], v[36:37] op_sel:[0,1] op_sel_hi:[1,1]
v_cvt_pk_bf16_f32 v216, v208, v209
v_cvt_pk_bf16_f32 v217, v210, v211
v_cvt_pk_bf16_f32 v218, v212, v213
v_cvt_pk_bf16_f32 v219, v214, v215
buffer_store_dwordx4 v[216:219], v57, s[28:31], s56 offen offset:2048 sc1
v_accvgpr_read_b32 v220, a72
v_accvgpr_read_b32 v221, a73
v_accvgpr_read_b32 v222, a74
v_accvgpr_read_b32 v223, a75
v_accvgpr_read_b32 v224, a88
v_accvgpr_read_b32 v225, a89
v_accvgpr_read_b32 v226, a90
v_accvgpr_read_b32 v227, a91
v_pk_mul_f32 v[220:221], v[220:221], v[38:39] op_sel:[0,0] op_sel_hi:[1,0]
v_pk_mul_f32 v[222:223], v[222:223], v[38:39] op_sel:[0,0] op_sel_hi:[1,0]
v_pk_mul_f32 v[224:225], v[224:225], v[38:39] op_sel:[0,0] op_sel_hi:[1,0]
v_pk_mul_f32 v[226:227], v[226:227], v[38:39] op_sel:[0,0] op_sel_hi:[1,0]
v_cvt_pk_bf16_f32 v228, v220, v221
v_cvt_pk_bf16_f32 v229, v222, v223
v_cvt_pk_bf16_f32 v230, v224, v225
v_cvt_pk_bf16_f32 v231, v226, v227
buffer_store_dwordx4 v[228:231], v57, s[28:31], s57 offen offset:2048 sc1
v_accvgpr_read_b32 v232, a76
v_accvgpr_read_b32 v233, a77
v_accvgpr_read_b32 v234, a78
v_accvgpr_read_b32 v235, a79
v_accvgpr_read_b32 v236, a92
v_accvgpr_read_b32 v237, a93
v_accvgpr_read_b32 v238, a94
v_accvgpr_read_b32 v239, a95
v_pk_mul_f32 v[232:233], v[232:233], v[38:39] op_sel:[0,1] op_sel_hi:[1,1]
v_pk_mul_f32 v[234:235], v[234:235], v[38:39] op_sel:[0,1] op_sel_hi:[1,1]
v_pk_mul_f32 v[236:237], v[236:237], v[38:39] op_sel:[0,1] op_sel_hi:[1,1]
v_pk_mul_f32 v[238:239], v[238:239], v[38:39] op_sel:[0,1] op_sel_hi:[1,1]
v_cvt_pk_bf16_f32 v240, v232, v233
v_cvt_pk_bf16_f32 v241, v234, v235
v_cvt_pk_bf16_f32 v242, v236, v237
v_cvt_pk_bf16_f32 v243, v238, v239
buffer_store_dwordx4 v[240:243], v57, s[28:31], s58 offen offset:2048 sc1
L_epi_j:
s_waitcnt vmcnt(59)
s_barrier
ds_read_b64_tr_b16 a[192:193], v248 offset:0
ds_read_b64_tr_b16 a[194:195], v248 offset:5120
ds_read_b64_tr_b16 a[196:197], v248 offset:10240
ds_read_b64_tr_b16 a[198:199], v248 offset:15360
ds_read_b64_tr_b16 a[200:201], v249 offset:0
ds_read_b64_tr_b16 a[202:203], v249 offset:5120
ds_read_b64_tr_b16 a[204:205], v249 offset:10240
ds_read_b64_tr_b16 a[206:207], v249 offset:15360
s_waitcnt lgkmcnt(6)
v_mfma_f32_16x16x32_bf16 a[0:3], a[192:195], v[64:67], 0
s_waitcnt lgkmcnt(4)
ds_read_b64_tr_b16 a[208:209], v248 offset:64
ds_read_b64_tr_b16 a[210:211], v248 offset:5184
s_add_u32 m0, s49, 0
v_mfma_f32_16x16x32_bf16 a[0:3], a[196:199], v[68:71], a[0:3]
ds_read_b64_tr_b16 a[212:213], v248 offset:10304
ds_read_b64_tr_b16 a[214:215], v248 offset:15424
v_mfma_f32_16x16x32_bf16 a[4:7], a[192:195], v[72:75], 0
buffer_load_dwordx4 v49, s[80:83], s92 offen offset:0 lds
v_mfma_f32_16x16x32_bf16 a[4:7], a[196:199], v[76:79], a[4:7]
s_waitcnt lgkmcnt(6)
buffer_load_dwordx4 v50, s[80:83], s92 offen offset:1024 lds
v_mfma_f32_16x16x32_bf16 a[8:11], a[200:203], v[64:67], 0
s_waitcnt lgkmcnt(4)
ds_read_b64_tr_b16 a[216:217], v249 offset:64
ds_read_b64_tr_b16 a[218:219], v249 offset:5184
v_mfma_f32_16x16x32_bf16 a[8:11], a[204:207], v[68:71], a[8:11]
ds_read_b64_tr_b16 a[220:221], v249 offset:10304
ds_read_b64_tr_b16 a[222:223], v249 offset:15424
v_mfma_f32_16x16x32_bf16 a[12:15], a[200:203], v[72:75], 0
buffer_load_dwordx4 v51, s[80:83], s92 offen offset:2048 lds
v_mfma_f32_16x16x32_bf16 a[12:15], a[204:207], v[76:79], a[12:15]
s_waitcnt lgkmcnt(6)
buffer_load_dwordx4 v52, s[80:83], s92 offen offset:3072 lds
s_add_u32 m0, s49, 4096
v_mfma_f32_16x16x32_bf16 a[16:19], a[208:211], v[64:67], 0
s_waitcnt lgkmcnt(4)
ds_read_b64_tr_b16 a[192:193], v248 offset:128
ds_read_b64_tr_b16 a[194:195], v248 offset:5248
v_mfma_f32_16x16x32_bf16 a[16:19], a[212:215], v[68:71], a[16:19]
ds_read_b64_tr_b16 a[196:197], v248 offset:10368
ds_read_b64_tr_b16 a[198:199], v248 offset:15488
v_mfma_f32_16x16x32_bf16 a[20:23], a[208:211], v[72:75], 0
buffer_load_dwordx4 v53, s[80:83], s92 offen offset:0 lds
s_add_u32 s92, s92, 81920
v_mfma_f32_16x16x32_bf16 a[20:23], a[212:215], v[76:79], a[20:23]
s_waitcnt lgkmcnt(6)
buffer_load_dwordx2 v[144:145], v11, s[32:35], s52 offen offset:0 sc1
v_mfma_f32_16x16x32_bf16 a[24:27], a[216:219], v[64:67], 0
s_waitcnt lgkmcnt(4)
ds_read_b64_tr_b16 a[200:201], v249 offset:128
ds_read_b64_tr_b16 a[202:203], v249 offset:5248
v_mfma_f32_16x16x32_bf16 a[24:27], a[220:223], v[68:71], a[24:27]
ds_read_b64_tr_b16 a[204:205], v249 offset:10368
ds_read_b64_tr_b16 a[206:207], v249 offset:15488
v_mfma_f32_16x16x32_bf16 a[28:31], a[216:219], v[72:75], 0
buffer_load_dwordx2 v[146:147], v11, s[32:35], s52 offen offset:512 sc1
v_mfma_f32_16x16x32_bf16 a[28:31], a[220:223], v[76:79], a[28:31]
s_waitcnt lgkmcnt(6)
buffer_load_dwordx4 v[148:151], v60, s[32:35], s52 offen offset:1024 sc1
v_mfma_f32_16x16x32_bf16 a[32:35], a[192:195], v[64:67], 0
s_waitcnt lgkmcnt(4)
ds_read_b64_tr_b16 a[208:209], v248 offset:192
ds_read_b64_tr_b16 a[210:211], v248 offset:5312
v_mfma_f32_16x16x32_bf16 a[32:35], a[196:199], v[68:71], a[32:35]
ds_read_b64_tr_b16 a[212:213], v248 offset:10432
ds_read_b64_tr_b16 a[214:215], v248 offset:15552
v_mfma_f32_16x16x32_bf16 a[36:39], a[192:195], v[72:75], 0
buffer_load_dwordx2 v[152:153], v18, s[32:35], s52 offen offset:0 sc1
v_mfma_f32_16x16x32_bf16 a[36:39], a[196:199], v[76:79], a[36:39]
s_waitcnt lgkmcnt(6)
buffer_load_dwordx2 v[154:155], v18, s[32:35], s52 offen offset:512 sc1
v_mfma_f32_16x16x32_bf16 a[40:43], a[200:203], v[64:67], 0
s_waitcnt lgkmcnt(4)
ds_read_b64_tr_b16 a[216:217], v249 offset:192
ds_read_b64_tr_b16 a[218:219], v249 offset:5312
v_mfma_f32_16x16x32_bf16 a[40:43], a[204:207], v[68:71], a[40:43]
ds_read_b64_tr_b16 a[220:221], v249 offset:10432
ds_read_b64_tr_b16 a[222:223], v249 offset:15552
v_mfma_f32_16x16x32_bf16 a[44:47], a[200:203], v[72:75], 0
buffer_load_dwordx4 v[156:159], v61, s[32:35], s52 offen offset:1024 sc1
s_add_u32 s52, s52, 2048
v_mfma_f32_16x16x32_bf16 a[44:47], a[204:207], v[76:79], a[44:47]
s_waitcnt lgkmcnt(6)
v_mfma_f32_16x16x32_bf16 a[48:51], a[208:211], v[64:67], 0
s_waitcnt lgkmcnt(4)
ds_read_b64_tr_b16 a[192:193], v248 offset:256
ds_read_b64_tr_b16 a[194:195], v248 offset:5376
v_mfma_f32_16x16x32_bf16 a[48:51], a[212:215], v[68:71], a[48:51]
ds_read_b64_tr_b16 a[196:197], v248 offset:10496
ds_read_b64_tr_b16 a[198:199], v248 offset:15616
v_mfma_f32_16x16x32_bf16 a[52:55], a[208:211], v[72:75], 0
v_mfma_f32_16x16x32_bf16 a[52:55], a[212:215], v[76:79], a[52:55]
s_waitcnt lgkmcnt(6)
v_mfma_f32_16x16x32_bf16 a[56:59], a[216:219], v[64:67], 0
s_waitcnt lgkmcnt(4)
ds_read_b64_tr_b16 a[200:201], v249 offset:256
ds_read_b64_tr_b16 a[202:203], v249 offset:5376
v_mfma_f32_16x16x32_bf16 a[56:59], a[220:223], v[68:71], a[56:59]
ds_read_b64_tr_b16 a[204:205], v249 offset:10496
ds_read_b64_tr_b16 a[206:207], v249 offset:15616
v_mfma_f32_16x16x32_bf16 a[60:63], a[216:219], v[72:75], 0
v_mfma_f32_16x16x32_bf16 a[60:63], a[220:223], v[76:79], a[60:63]
s_waitcnt vmcnt(59)
s_barrier
s_waitcnt lgkmcnt(6)
v_mfma_f32_16x16x32_bf16 a[64:67], a[192:195], v[64:67], 0
s_waitcnt lgkmcnt(4)
ds_read_b64_tr_b16 a[208:209], v248 offset:20480
ds_read_b64_tr_b16 a[210:211], v248 offset:25600
v_mfma_f32_16x16x32_bf16 a[64:67], a[196:199], v[68:71], a[64:67]
ds_read_b64_tr_b16 a[212:213], v248 offset:30720
ds_read_b64_tr_b16 a[214:215], v248 offset:35840
v_mfma_f32_16x16x32_bf16 a[68:71], a[192:195], v[72:75], 0
v_mfma_f32_16x16x32_bf16 a[68:71], a[196:199], v[76:79], a[68:71]
s_waitcnt lgkmcnt(6)
v_mfma_f32_16x16x32_bf16 a[72:75], a[200:203], v[64:67], 0
s_waitcnt lgkmcnt(4)
ds_read_b64_tr_b16 a[216:217], v249 offset:20480
ds_read_b64_tr_b16 a[218:219], v249 offset:25600
v_mfma_f32_16x16x32_bf16 a[72:75], a[204:207], v[68:71], a[72:75]
ds_read_b64_tr_b16 a[220:221], v249 offset:30720
ds_read_b64_tr_b16 a[222:223], v249 offset:35840
v_mfma_f32_16x16x32_bf16 a[76:79], a[200:203], v[72:75], 0
v_mfma_f32_16x16x32_bf16 a[76:79], a[204:207], v[76:79], a[76:79]
s_waitcnt lgkmcnt(6)
v_accvgpr_read_b32 v196, a96
v_accvgpr_read_b32 v197, a97
v_accvgpr_read_b32 v198, a98
v_accvgpr_read_b32 v199, a99
v_accvgpr_read_b32 v200, a112
v_accvgpr_read_b32 v201, a113
v_accvgpr_read_b32 v202, a114
v_accvgpr_read_b32 v203, a115
v_pk_mul_f32 v[196:197], v[196:197], v[36:37] op_sel:[0,0] op_sel_hi:[1,0]
v_pk_mul_f32 v[198:199], v[198:199], v[36:37] op_sel:[0,0] op_sel_hi:[1,0]
v_pk_mul_f32 v[200:201], v[200:201], v[36:37] op_sel:[0,0] op_sel_hi:[1,0]
v_pk_mul_f32 v[202:203], v[202:203], v[36:37] op_sel:[0,0] op_sel_hi:[1,0]
v_cvt_pk_bf16_f32 v204, v196, v197
v_cvt_pk_bf16_f32 v205, v198, v199
v_cvt_pk_bf16_f32 v206, v200, v201
v_cvt_pk_bf16_f32 v207, v202, v203
buffer_store_dwordx4 v[204:207], v57, s[28:31], s55 offen offset:3072 sc1
v_accvgpr_read_b32 v208, a100
v_accvgpr_read_b32 v209, a101
v_accvgpr_read_b32 v210, a102
v_accvgpr_read_b32 v211, a103
v_accvgpr_read_b32 v212, a116
v_accvgpr_read_b32 v213, a117
v_accvgpr_read_b32 v214, a118
v_accvgpr_read_b32 v215, a119
v_pk_mul_f32 v[208:209], v[208:209], v[36:37] op_sel:[0,1] op_sel_hi:[1,1]
v_pk_mul_f32 v[210:211], v[210:211], v[36:37] op_sel:[0,1] op_sel_hi:[1,1]
v_pk_mul_f32 v[212:213], v[212:213], v[36:37] op_sel:[0,1] op_sel_hi:[1,1]
v_pk_mul_f32 v[214:215], v[214:215], v[36:37] op_sel:[0,1] op_sel_hi:[1,1]
v_cvt_pk_bf16_f32 v216, v208, v209
v_cvt_pk_bf16_f32 v217, v210, v211
v_cvt_pk_bf16_f32 v218, v212, v213
v_cvt_pk_bf16_f32 v219, v214, v215
buffer_store_dwordx4 v[216:219], v57, s[28:31], s56 offen offset:3072 sc1
v_accvgpr_read_b32 v220, a104
v_accvgpr_read_b32 v221, a105
v_accvgpr_read_b32 v222, a106
v_accvgpr_read_b32 v223, a107
v_accvgpr_read_b32 v224, a120
v_accvgpr_read_b32 v225, a121
v_accvgpr_read_b32 v226, a122
v_accvgpr_read_b32 v227, a123
v_pk_mul_f32 v[220:221], v[220:221], v[38:39] op_sel:[0,0] op_sel_hi:[1,0]
v_pk_mul_f32 v[222:223], v[222:223], v[38:39] op_sel:[0,0] op_sel_hi:[1,0]
v_pk_mul_f32 v[224:225], v[224:225], v[38:39] op_sel:[0,0] op_sel_hi:[1,0]
v_pk_mul_f32 v[226:227], v[226:227], v[38:39] op_sel:[0,0] op_sel_hi:[1,0]
v_cvt_pk_bf16_f32 v228, v220, v221
v_cvt_pk_bf16_f32 v229, v222, v223
v_cvt_pk_bf16_f32 v230, v224, v225
v_cvt_pk_bf16_f32 v231, v226, v227
buffer_store_dwordx4 v[228:231], v57, s[28:31], s57 offen offset:3072 sc1
v_accvgpr_read_b32 v232, a108
v_accvgpr_read_b32 v233, a109
v_accvgpr_read_b32 v234, a110
v_accvgpr_read_b32 v235, a111
v_accvgpr_read_b32 v236, a124
v_accvgpr_read_b32 v237, a125
v_accvgpr_read_b32 v238, a126
v_accvgpr_read_b32 v239, a127
v_pk_mul_f32 v[232:233], v[232:233], v[38:39] op_sel:[0,1] op_sel_hi:[1,1]
v_pk_mul_f32 v[234:235], v[234:235], v[38:39] op_sel:[0,1] op_sel_hi:[1,1]
v_pk_mul_f32 v[236:237], v[236:237], v[38:39] op_sel:[0,1] op_sel_hi:[1,1]
v_pk_mul_f32 v[238:239], v[238:239], v[38:39] op_sel:[0,1] op_sel_hi:[1,1]
v_cvt_pk_bf16_f32 v240, v232, v233
v_cvt_pk_bf16_f32 v241, v234, v235
v_cvt_pk_bf16_f32 v242, v236, v237
v_cvt_pk_bf16_f32 v243, v238, v239
buffer_store_dwordx4 v[240:243], v57, s[28:31], s58 offen offset:3072 sc1
s_add_u32 s55, s55, 4096
s_add_u32 s56, s56, 4096
s_add_u32 s57, s57, 4096
s_add_u32 s58, s58, 4096
v_accvgpr_read_b32 v196, a128
v_accvgpr_read_b32 v197, a129
v_accvgpr_read_b32 v198, a130
v_accvgpr_read_b32 v199, a131
v_accvgpr_read_b32 v200, a144
v_accvgpr_read_b32 v201, a145
v_accvgpr_read_b32 v202, a146
v_accvgpr_read_b32 v203, a147
v_pk_mul_f32 v[196:197], v[196:197], v[36:37] op_sel:[0,0] op_sel_hi:[1,0]
v_pk_mul_f32 v[198:199], v[198:199], v[36:37] op_sel:[0,0] op_sel_hi:[1,0]
v_pk_mul_f32 v[200:201], v[200:201], v[36:37] op_sel:[0,0] op_sel_hi:[1,0]
v_pk_mul_f32 v[202:203], v[202:203], v[36:37] op_sel:[0,0] op_sel_hi:[1,0]
v_cvt_pk_bf16_f32 v204, v196, v197
v_cvt_pk_bf16_f32 v205, v198, v199
v_cvt_pk_bf16_f32 v206, v200, v201
v_cvt_pk_bf16_f32 v207, v202, v203
buffer_store_dwordx4 v[204:207], v57, s[28:31], s55 offen offset:0 sc1
v_accvgpr_read_b32 v208, a132
v_accvgpr_read_b32 v209, a133
v_accvgpr_read_b32 v210, a134
v_accvgpr_read_b32 v211, a135
v_accvgpr_read_b32 v212, a148
v_accvgpr_read_b32 v213, a149
v_accvgpr_read_b32 v214, a150
v_accvgpr_read_b32 v215, a151
v_pk_mul_f32 v[208:209], v[208:209], v[36:37] op_sel:[0,1] op_sel_hi:[1,1]
v_pk_mul_f32 v[210:211], v[210:211], v[36:37] op_sel:[0,1] op_sel_hi:[1,1]
v_pk_mul_f32 v[212:213], v[212:213], v[36:37] op_sel:[0,1] op_sel_hi:[1,1]
v_pk_mul_f32 v[214:215], v[214:215], v[36:37] op_sel:[0,1] op_sel_hi:[1,1]
v_cvt_pk_bf16_f32 v216, v208, v209
v_cvt_pk_bf16_f32 v217, v210, v211
v_cvt_pk_bf16_f32 v218, v212, v213
v_cvt_pk_bf16_f32 v219, v214, v215
buffer_store_dwordx4 v[216:219], v57, s[28:31], s56 offen offset:0 sc1
v_mfma_f32_16x16x32_bf16 a[0:3], a[208:211], v[80:83], a[0:3]
s_waitcnt lgkmcnt(4)
ds_read_b64_tr_b16 a[192:193], v248 offset:20544
ds_read_b64_tr_b16 a[194:195], v248 offset:25664
v_mfma_f32_16x16x32_bf16 a[0:3], a[212:215], v[84:87], a[0:3]
ds_read_b64_tr_b16 a[196:197], v248 offset:30784
ds_read_b64_tr_b16 a[198:199], v248 offset:35904
v_mfma_f32_16x16x32_bf16 a[4:7], a[208:211], v[88:91], a[4:7]
v_mfma_f32_16x16x32_bf16 a[4:7], a[212:215], v[92:95], a[4:7]
s_waitcnt lgkmcnt(6)
v_mfma_f32_16x16x32_bf16 a[8:11], a[216:219], v[80:83], a[8:11]
s_waitcnt lgkmcnt(4)
ds_read_b64_tr_b16 a[200:201], v249 offset:20544
ds_read_b64_tr_b16 a[202:203], v249 offset:25664
v_mfma_f32_16x16x32_bf16 a[8:11], a[220:223], v[84:87], a[8:11]
ds_read_b64_tr_b16 a[204:205], v249 offset:30784
ds_read_b64_tr_b16 a[206:207], v249 offset:35904
v_mfma_f32_16x16x32_bf16 a[12:15], a[216:219], v[88:91], a[12:15]
v_mfma_f32_16x16x32_bf16 a[12:15], a[220:223], v[92:95], a[12:15]
s_waitcnt lgkmcnt(6)
v_mfma_f32_16x16x32_bf16 a[16:19], a[192:195], v[80:83], a[16:19]
s_waitcnt lgkmcnt(4)
ds_read_b64_tr_b16 a[208:209], v248 offset:20608
ds_read_b64_tr_b16 a[210:211], v248 offset:25728
v_mfma_f32_16x16x32_bf16 a[16:19], a[196:199], v[84:87], a[16:19]
ds_read_b64_tr_b16 a[212:213], v248 offset:30848
ds_read_b64_tr_b16 a[214:215], v248 offset:35968
v_mfma_f32_16x16x32_bf16 a[20:23], a[192:195], v[88:91], a[20:23]
v_mfma_f32_16x16x32_bf16 a[20:23], a[196:199], v[92:95], a[20:23]
s_waitcnt lgkmcnt(6)
v_mfma_f32_16x16x32_bf16 a[24:27], a[200:203], v[80:83], a[24:27]
s_waitcnt lgkmcnt(4)
ds_read_b64_tr_b16 a[216:217], v249 offset:20608
ds_read_b64_tr_b16 a[218:219], v249 offset:25728
v_mfma_f32_16x16x32_bf16 a[24:27], a[204:207], v[84:87], a[24:27]
ds_read_b64_tr_b16 a[220:221], v249 offset:30848
ds_read_b64_tr_b16 a[222:223], v249 offset:35968
v_mfma_f32_16x16x32_bf16 a[28:31], a[200:203], v[88:91], a[28:31]
v_mfma_f32_16x16x32_bf16 a[28:31], a[204:207], v[92:95], a[28:31]
s_waitcnt lgkmcnt(6)
v_mfma_f32_16x16x32_bf16 a[32:35], a[208:211], v[80:83], a[32:35]
s_waitcnt lgkmcnt(4)
ds_read_b64_tr_b16 a[192:193], v248 offset:20672
ds_read_b64_tr_b16 a[194:195], v248 offset:25792
v_mfma_f32_16x16x32_bf16 a[32:35], a[212:215], v[84:87], a[32:35]
ds_read_b64_tr_b16 a[196:197], v248 offset:30912
ds_read_b64_tr_b16 a[198:199], v248 offset:36032
v_mfma_f32_16x16x32_bf16 a[36:39], a[208:211], v[88:91], a[36:39]
v_mfma_f32_16x16x32_bf16 a[36:39], a[212:215], v[92:95], a[36:39]
s_waitcnt lgkmcnt(6)
v_mfma_f32_16x16x32_bf16 a[40:43], a[216:219], v[80:83], a[40:43]
s_waitcnt lgkmcnt(4)
ds_read_b64_tr_b16 a[200:201], v249 offset:20672
ds_read_b64_tr_b16 a[202:203], v249 offset:25792
v_mfma_f32_16x16x32_bf16 a[40:43], a[220:223], v[84:87], a[40:43]
ds_read_b64_tr_b16 a[204:205], v249 offset:30912
ds_read_b64_tr_b16 a[206:207], v249 offset:36032
v_mfma_f32_16x16x32_bf16 a[44:47], a[216:219], v[88:91], a[44:47]
v_mfma_f32_16x16x32_bf16 a[44:47], a[220:223], v[92:95], a[44:47]
s_waitcnt lgkmcnt(6)
v_mfma_f32_16x16x32_bf16 a[48:51], a[192:195], v[80:83], a[48:51]
s_waitcnt lgkmcnt(4)
ds_read_b64_tr_b16 a[208:209], v248 offset:20736
ds_read_b64_tr_b16 a[210:211], v248 offset:25856
v_mfma_f32_16x16x32_bf16 a[48:51], a[196:199], v[84:87], a[48:51]
ds_read_b64_tr_b16 a[212:213], v248 offset:30976
ds_read_b64_tr_b16 a[214:215], v248 offset:36096
v_mfma_f32_16x16x32_bf16 a[52:55], a[192:195], v[88:91], a[52:55]
v_mfma_f32_16x16x32_bf16 a[52:55], a[196:199], v[92:95], a[52:55]
s_waitcnt lgkmcnt(6)
v_mfma_f32_16x16x32_bf16 a[56:59], a[200:203], v[80:83], a[56:59]
s_waitcnt lgkmcnt(4)
ds_read_b64_tr_b16 a[216:217], v249 offset:20736
ds_read_b64_tr_b16 a[218:219], v249 offset:25856
v_mfma_f32_16x16x32_bf16 a[56:59], a[204:207], v[84:87], a[56:59]
ds_read_b64_tr_b16 a[220:221], v249 offset:30976
ds_read_b64_tr_b16 a[222:223], v249 offset:36096
v_mfma_f32_16x16x32_bf16 a[60:63], a[200:203], v[88:91], a[60:63]
v_mfma_f32_16x16x32_bf16 a[60:63], a[204:207], v[92:95], a[60:63]
s_waitcnt vmcnt(56)
s_barrier
s_waitcnt lgkmcnt(6)
v_mfma_f32_16x16x32_bf16 a[64:67], a[208:211], v[80:83], a[64:67]
s_waitcnt lgkmcnt(4)
ds_read_b64_tr_b16 a[192:193], v248 offset:40960
ds_read_b64_tr_b16 a[194:195], v248 offset:46080
v_mfma_f32_16x16x32_bf16 a[64:67], a[212:215], v[84:87], a[64:67]
ds_read_b64_tr_b16 a[196:197], v248 offset:51200
ds_read_b64_tr_b16 a[198:199], v248 offset:56320
v_mfma_f32_16x16x32_bf16 a[68:71], a[208:211], v[88:91], a[68:71]
v_mfma_f32_16x16x32_bf16 a[68:71], a[212:215], v[92:95], a[68:71]
s_waitcnt lgkmcnt(6)
v_mfma_f32_16x16x32_bf16 a[72:75], a[216:219], v[80:83], a[72:75]
s_waitcnt lgkmcnt(4)
ds_read_b64_tr_b16 a[200:201], v249 offset:40960
ds_read_b64_tr_b16 a[202:203], v249 offset:46080
v_mfma_f32_16x16x32_bf16 a[72:75], a[220:223], v[84:87], a[72:75]
ds_read_b64_tr_b16 a[204:205], v249 offset:51200
ds_read_b64_tr_b16 a[206:207], v249 offset:56320
v_mfma_f32_16x16x32_bf16 a[76:79], a[216:219], v[88:91], a[76:79]
v_mfma_f32_16x16x32_bf16 a[76:79], a[220:223], v[92:95], a[76:79]
s_waitcnt lgkmcnt(6) vmcnt(54)
v_accvgpr_read_b32 v220, a136
v_accvgpr_read_b32 v221, a137
v_accvgpr_read_b32 v222, a138
v_accvgpr_read_b32 v223, a139
v_accvgpr_read_b32 v224, a152
v_accvgpr_read_b32 v225, a153
v_accvgpr_read_b32 v226, a154
v_accvgpr_read_b32 v227, a155
v_pk_mul_f32 v[220:221], v[220:221], v[38:39] op_sel:[0,0] op_sel_hi:[1,0]
v_pk_mul_f32 v[222:223], v[222:223], v[38:39] op_sel:[0,0] op_sel_hi:[1,0]
v_pk_mul_f32 v[224:225], v[224:225], v[38:39] op_sel:[0,0] op_sel_hi:[1,0]
v_pk_mul_f32 v[226:227], v[226:227], v[38:39] op_sel:[0,0] op_sel_hi:[1,0]
v_cvt_pk_bf16_f32 v228, v220, v221
v_cvt_pk_bf16_f32 v229, v222, v223
v_cvt_pk_bf16_f32 v230, v224, v225
v_cvt_pk_bf16_f32 v231, v226, v227
buffer_store_dwordx4 v[228:231], v57, s[28:31], s57 offen offset:0 sc1
v_accvgpr_read_b32 v232, a140
v_accvgpr_read_b32 v233, a141
v_accvgpr_read_b32 v234, a142
v_accvgpr_read_b32 v235, a143
v_accvgpr_read_b32 v236, a156
v_accvgpr_read_b32 v237, a157
v_accvgpr_read_b32 v238, a158
v_accvgpr_read_b32 v239, a159
v_pk_mul_f32 v[232:233], v[232:233], v[38:39] op_sel:[0,1] op_sel_hi:[1,1]
v_pk_mul_f32 v[234:235], v[234:235], v[38:39] op_sel:[0,1] op_sel_hi:[1,1]
v_pk_mul_f32 v[236:237], v[236:237], v[38:39] op_sel:[0,1] op_sel_hi:[1,1]
v_pk_mul_f32 v[238:239], v[238:239], v[38:39] op_sel:[0,1] op_sel_hi:[1,1]
v_cvt_pk_bf16_f32 v240, v232, v233
v_cvt_pk_bf16_f32 v241, v234, v235
v_cvt_pk_bf16_f32 v242, v236, v237
v_cvt_pk_bf16_f32 v243, v238, v239
buffer_store_dwordx4 v[240:243], v57, s[28:31], s58 offen offset:0 sc1
v_accvgpr_read_b32 v196, a160
v_accvgpr_read_b32 v197, a161
v_accvgpr_read_b32 v198, a162
v_accvgpr_read_b32 v199, a163
v_accvgpr_read_b32 v200, a176
v_accvgpr_read_b32 v201, a177
v_accvgpr_read_b32 v202, a178
v_accvgpr_read_b32 v203, a179
v_pk_mul_f32 v[196:197], v[196:197], v[36:37] op_sel:[0,0] op_sel_hi:[1,0]
v_pk_mul_f32 v[198:199], v[198:199], v[36:37] op_sel:[0,0] op_sel_hi:[1,0]
v_pk_mul_f32 v[200:201], v[200:201], v[36:37] op_sel:[0,0] op_sel_hi:[1,0]
v_pk_mul_f32 v[202:203], v[202:203], v[36:37] op_sel:[0,0] op_sel_hi:[1,0]
v_cvt_pk_bf16_f32 v204, v196, v197
v_cvt_pk_bf16_f32 v205, v198, v199
v_cvt_pk_bf16_f32 v206, v200, v201
v_cvt_pk_bf16_f32 v207, v202, v203
buffer_store_dwordx4 v[204:207], v57, s[28:31], s55 offen offset:1024 sc1
v_accvgpr_read_b32 v208, a164
v_accvgpr_read_b32 v209, a165
v_accvgpr_read_b32 v210, a166
v_accvgpr_read_b32 v211, a167
v_accvgpr_read_b32 v212, a180
v_accvgpr_read_b32 v213, a181
v_accvgpr_read_b32 v214, a182
v_accvgpr_read_b32 v215, a183
v_pk_mul_f32 v[208:209], v[208:209], v[36:37] op_sel:[0,1] op_sel_hi:[1,1]
v_pk_mul_f32 v[210:211], v[210:211], v[36:37] op_sel:[0,1] op_sel_hi:[1,1]
v_pk_mul_f32 v[212:213], v[212:213], v[36:37] op_sel:[0,1] op_sel_hi:[1,1]
v_pk_mul_f32 v[214:215], v[214:215], v[36:37] op_sel:[0,1] op_sel_hi:[1,1]
v_cvt_pk_bf16_f32 v216, v208, v209
v_cvt_pk_bf16_f32 v217, v210, v211
v_cvt_pk_bf16_f32 v218, v212, v213
v_cvt_pk_bf16_f32 v219, v214, v215
buffer_store_dwordx4 v[216:219], v57, s[28:31], s56 offen offset:1024 sc1
v_accvgpr_read_b32 v220, a168
v_accvgpr_read_b32 v221, a169
v_accvgpr_read_b32 v222, a170
v_accvgpr_read_b32 v223, a171
v_accvgpr_read_b32 v224, a184
v_accvgpr_read_b32 v225, a185
v_accvgpr_read_b32 v226, a186
v_accvgpr_read_b32 v227, a187
v_pk_mul_f32 v[220:221], v[220:221], v[38:39] op_sel:[0,0] op_sel_hi:[1,0]
v_pk_mul_f32 v[222:223], v[222:223], v[38:39] op_sel:[0,0] op_sel_hi:[1,0]
v_pk_mul_f32 v[224:225], v[224:225], v[38:39] op_sel:[0,0] op_sel_hi:[1,0]
v_pk_mul_f32 v[226:227], v[226:227], v[38:39] op_sel:[0,0] op_sel_hi:[1,0]
v_cvt_pk_bf16_f32 v228, v220, v221
v_cvt_pk_bf16_f32 v229, v222, v223
v_cvt_pk_bf16_f32 v230, v224, v225
v_cvt_pk_bf16_f32 v231, v226, v227
buffer_store_dwordx4 v[228:231], v57, s[28:31], s57 offen offset:1024 sc1
v_accvgpr_read_b32 v232, a172
v_accvgpr_read_b32 v233, a173
v_accvgpr_read_b32 v234, a174
v_accvgpr_read_b32 v235, a175
v_accvgpr_read_b32 v236, a188
v_accvgpr_read_b32 v237, a189
v_accvgpr_read_b32 v238, a190
v_accvgpr_read_b32 v239, a191
v_pk_mul_f32 v[232:233], v[232:233], v[38:39] op_sel:[0,1] op_sel_hi:[1,1]
v_pk_mul_f32 v[234:235], v[234:235], v[38:39] op_sel:[0,1] op_sel_hi:[1,1]
v_pk_mul_f32 v[236:237], v[236:237], v[38:39] op_sel:[0,1] op_sel_hi:[1,1]
v_pk_mul_f32 v[238:239], v[238:239], v[38:39] op_sel:[0,1] op_sel_hi:[1,1]
v_cvt_pk_bf16_f32 v240, v232, v233
v_cvt_pk_bf16_f32 v241, v234, v235
v_cvt_pk_bf16_f32 v242, v236, v237
v_cvt_pk_bf16_f32 v243, v238, v239
buffer_store_dwordx4 v[240:243], v57, s[28:31], s58 offen offset:1024 sc1
v_mfma_f32_16x16x32_bf16 a[0:3], a[192:195], v[96:99], a[0:3]
s_waitcnt lgkmcnt(4) vmcnt(59)
ds_read_b64_tr_b16 a[208:209], v248 offset:41024
ds_read_b64_tr_b16 a[210:211], v248 offset:46144
s_add_u32 m0, s49, 20480
v_mfma_f32_16x16x32_bf16 a[0:3], a[196:199], v[100:103], a[0:3]
s_waitcnt vmcnt(57)
ds_read_b64_tr_b16 a[212:213], v248 offset:51264
ds_read_b64_tr_b16 a[214:215], v248 offset:56384
v_mfma_f32_16x16x32_bf16 a[4:7], a[192:195], v[104:107], a[4:7]
s_waitcnt vmcnt(56)
buffer_load_dwordx4 v49, s[64:67], s48 offen offset:0 lds
v_mfma_f32_16x16x32_bf16 a[4:7], a[196:199], v[108:111], a[4:7]
s_waitcnt lgkmcnt(6)
buffer_load_dwordx4 v50, s[64:67], s48 offen offset:1024 lds
v_mfma_f32_16x16x32_bf16 a[8:11], a[200:203], v[96:99], a[8:11]
s_waitcnt lgkmcnt(4)
ds_read_b64_tr_b16 a[216:217], v249 offset:41024
ds_read_b64_tr_b16 a[218:219], v249 offset:46144
v_mfma_f32_16x16x32_bf16 a[8:11], a[204:207], v[100:103], a[8:11]
ds_read_b64_tr_b16 a[220:221], v249 offset:51264
ds_read_b64_tr_b16 a[222:223], v249 offset:56384
v_mfma_f32_16x16x32_bf16 a[12:15], a[200:203], v[104:107], a[12:15]
buffer_load_dwordx4 v51, s[64:67], s48 offen offset:2048 lds
v_mfma_f32_16x16x32_bf16 a[12:15], a[204:207], v[108:111], a[12:15]
s_waitcnt lgkmcnt(6)
buffer_load_dwordx4 v52, s[64:67], s48 offen offset:3072 lds
s_add_u32 m0, s49, 24576
v_mfma_f32_16x16x32_bf16 a[16:19], a[208:211], v[96:99], a[16:19]
s_waitcnt lgkmcnt(4)
ds_read_b64_tr_b16 a[192:193], v248 offset:41088
ds_read_b64_tr_b16 a[194:195], v248 offset:46208
v_mfma_f32_16x16x32_bf16 a[16:19], a[212:215], v[100:103], a[16:19]
ds_read_b64_tr_b16 a[196:197], v248 offset:51328
ds_read_b64_tr_b16 a[198:199], v248 offset:56448
v_mfma_f32_16x16x32_bf16 a[20:23], a[208:211], v[104:107], a[20:23]
buffer_load_dwordx4 v53, s[64:67], s48 offen offset:0 lds
s_add_u32 s48, s48, 81920
s_add_u32 m0, s49, 40960
v_mfma_f32_16x16x32_bf16 a[20:23], a[212:215], v[108:111], a[20:23]
s_waitcnt lgkmcnt(6)
buffer_load_dwordx4 v49, s[64:67], s48 offen offset:0 lds
v_mfma_f32_16x16x32_bf16 a[24:27], a[216:219], v[96:99], a[24:27]
s_waitcnt lgkmcnt(4)
ds_read_b64_tr_b16 a[200:201], v249 offset:41088
ds_read_b64_tr_b16 a[202:203], v249 offset:46208
v_mfma_f32_16x16x32_bf16 a[24:27], a[220:223], v[100:103], a[24:27]
ds_read_b64_tr_b16 a[204:205], v249 offset:51328
ds_read_b64_tr_b16 a[206:207], v249 offset:56448
v_mfma_f32_16x16x32_bf16 a[28:31], a[216:219], v[104:107], a[28:31]
buffer_load_dwordx4 v50, s[64:67], s48 offen offset:1024 lds
v_mfma_f32_16x16x32_bf16 a[28:31], a[220:223], v[108:111], a[28:31]
s_waitcnt vmcnt(59) lgkmcnt(6)
buffer_load_dwordx4 v51, s[64:67], s48 offen offset:2048 lds
v_mfma_f32_16x16x32_bf16 a[32:35], a[192:195], v[96:99], a[32:35]
s_waitcnt lgkmcnt(4)
ds_read_b64_tr_b16 a[208:209], v248 offset:41152
ds_read_b64_tr_b16 a[210:211], v248 offset:46272
v_mfma_f32_16x16x32_bf16 a[32:35], a[196:199], v[100:103], a[32:35]
ds_read_b64_tr_b16 a[212:213], v248 offset:51392
ds_read_b64_tr_b16 a[214:215], v248 offset:56512
v_mfma_f32_16x16x32_bf16 a[36:39], a[192:195], v[104:107], a[36:39]
buffer_load_dwordx4 v52, s[64:67], s48 offen offset:3072 lds
s_add_u32 m0, s49, 45056
v_mfma_f32_16x16x32_bf16 a[36:39], a[196:199], v[108:111], a[36:39]
s_waitcnt lgkmcnt(6)
buffer_load_dwordx4 v53, s[64:67], s48 offen offset:0 lds
s_add_u32 s48, s48, 81920
v_mfma_f32_16x16x32_bf16 a[40:43], a[200:203], v[96:99], a[40:43]
s_waitcnt lgkmcnt(4)
ds_read_b64_tr_b16 a[216:217], v249 offset:41152
ds_read_b64_tr_b16 a[218:219], v249 offset:46272
v_mfma_f32_16x16x32_bf16 a[40:43], a[204:207], v[100:103], a[40:43]
ds_read_b64_tr_b16 a[220:221], v249 offset:51392
ds_read_b64_tr_b16 a[222:223], v249 offset:56512
v_mfma_f32_16x16x32_bf16 a[44:47], a[200:203], v[104:107], a[44:47]
v_mfma_f32_16x16x32_bf16 a[44:47], a[204:207], v[108:111], a[44:47]
s_waitcnt lgkmcnt(6)
v_mfma_f32_16x16x32_bf16 a[48:51], a[208:211], v[96:99], a[48:51]
s_waitcnt lgkmcnt(4)
ds_read_b64_tr_b16 a[192:193], v248 offset:41216
ds_read_b64_tr_b16 a[194:195], v248 offset:46336
v_mfma_f32_16x16x32_bf16 a[48:51], a[212:215], v[100:103], a[48:51]
ds_read_b64_tr_b16 a[196:197], v248 offset:51456
ds_read_b64_tr_b16 a[198:199], v248 offset:56576
v_mfma_f32_16x16x32_bf16 a[52:55], a[208:211], v[104:107], a[52:55]
v_mfma_f32_16x16x32_bf16 a[52:55], a[212:215], v[108:111], a[52:55]
s_waitcnt lgkmcnt(6)
v_mfma_f32_16x16x32_bf16 a[56:59], a[216:219], v[96:99], a[56:59]
s_waitcnt lgkmcnt(4)
ds_read_b64_tr_b16 a[200:201], v249 offset:41216
ds_read_b64_tr_b16 a[202:203], v249 offset:46336
v_mfma_f32_16x16x32_bf16 a[56:59], a[220:223], v[100:103], a[56:59]
ds_read_b64_tr_b16 a[204:205], v249 offset:51456
ds_read_b64_tr_b16 a[206:207], v249 offset:56576
v_mfma_f32_16x16x32_bf16 a[60:63], a[216:219], v[104:107], a[60:63]
v_mfma_f32_16x16x32_bf16 a[60:63], a[220:223], v[108:111], a[60:63]
s_waitcnt vmcnt(61)
s_barrier
s_waitcnt lgkmcnt(6)
v_mfma_f32_16x16x32_bf16 a[64:67], a[192:195], v[96:99], a[64:67]
s_waitcnt lgkmcnt(4)
ds_read_b64_tr_b16 a[208:209], v250 offset:0
ds_read_b64_tr_b16 a[210:211], v250 offset:5120
v_mfma_f32_16x16x32_bf16 a[64:67], a[196:199], v[100:103], a[64:67]
ds_read_b64_tr_b16 a[212:213], v250 offset:10240
ds_read_b64_tr_b16 a[214:215], v250 offset:15360
v_mfma_f32_16x16x32_bf16 a[68:71], a[192:195], v[104:107], a[68:71]
v_mfma_f32_16x16x32_bf16 a[68:71], a[196:199], v[108:111], a[68:71]
s_waitcnt lgkmcnt(6)
v_mfma_f32_16x16x32_bf16 a[72:75], a[200:203], v[96:99], a[72:75]
s_waitcnt lgkmcnt(4)
ds_read_b64_tr_b16 a[216:217], v251 offset:0
ds_read_b64_tr_b16 a[218:219], v251 offset:5120
v_mfma_f32_16x16x32_bf16 a[72:75], a[204:207], v[100:103], a[72:75]
ds_read_b64_tr_b16 a[220:221], v251 offset:10240
ds_read_b64_tr_b16 a[222:223], v251 offset:15360
v_mfma_f32_16x16x32_bf16 a[76:79], a[200:203], v[104:107], a[76:79]
v_mfma_f32_16x16x32_bf16 a[76:79], a[204:207], v[108:111], a[76:79]
s_waitcnt lgkmcnt(6) vmcnt(55)
v_mfma_f32_16x16x32_bf16 a[0:3], a[208:211], v[112:115], a[0:3]
s_waitcnt lgkmcnt(4) vmcnt(53)
ds_read_b64_tr_b16 a[192:193], v250 offset:64
ds_read_b64_tr_b16 a[194:195], v250 offset:5184
s_add_u32 m0, s49, 61440
v_mfma_f32_16x16x32_bf16 a[0:3], a[212:215], v[116:119], a[0:3]
s_waitcnt vmcnt(52)
ds_read_b64_tr_b16 a[196:197], v250 offset:10304
ds_read_b64_tr_b16 a[198:199], v250 offset:15424
v_mfma_f32_16x16x32_bf16 a[4:7], a[208:211], v[120:123], a[4:7]
s_waitcnt vmcnt(50)
buffer_load_dwordx4 v49, s[64:67], s48 offen offset:0 lds
v_mfma_f32_16x16x32_bf16 a[4:7], a[212:215], v[124:127], a[4:7]
s_waitcnt lgkmcnt(6)
buffer_load_dwordx4 v50, s[64:67], s48 offen offset:1024 lds
v_mfma_f32_16x16x32_bf16 a[8:11], a[216:219], v[112:115], a[8:11]
s_waitcnt lgkmcnt(4)
ds_read_b64_tr_b16 a[200:201], v251 offset:64
ds_read_b64_tr_b16 a[202:203], v251 offset:5184
v_mfma_f32_16x16x32_bf16 a[8:11], a[220:223], v[116:119], a[8:11]
ds_read_b64_tr_b16 a[204:205], v251 offset:10304
ds_read_b64_tr_b16 a[206:207], v251 offset:15424
v_mfma_f32_16x16x32_bf16 a[12:15], a[216:219], v[120:123], a[12:15]
buffer_load_dwordx4 v51, s[64:67], s48 offen offset:2048 lds
v_mfma_f32_16x16x32_bf16 a[12:15], a[220:223], v[124:127], a[12:15]
s_waitcnt lgkmcnt(6)
buffer_load_dwordx4 v52, s[64:67], s48 offen offset:3072 lds
s_add_u32 m0, s49, 65536
v_mfma_f32_16x16x32_bf16 a[16:19], a[192:195], v[112:115], a[16:19]
s_waitcnt lgkmcnt(4)
ds_read_b64_tr_b16 a[208:209], v250 offset:128
ds_read_b64_tr_b16 a[210:211], v250 offset:5248
v_mfma_f32_16x16x32_bf16 a[16:19], a[196:199], v[116:119], a[16:19]
ds_read_b64_tr_b16 a[212:213], v250 offset:10368
ds_read_b64_tr_b16 a[214:215], v250 offset:15488
v_mfma_f32_16x16x32_bf16 a[20:23], a[192:195], v[120:123], a[20:23]
buffer_load_dwordx4 v53, s[64:67], s48 offen offset:0 lds
s_add_u32 s48, s48, 81920
v_mfma_f32_16x16x32_bf16 a[20:23], a[196:199], v[124:127], a[20:23]
s_waitcnt lgkmcnt(6)
v_mfma_f32_16x16x32_bf16 a[24:27], a[200:203], v[112:115], a[24:27]
s_waitcnt lgkmcnt(4)
ds_read_b64_tr_b16 a[216:217], v251 offset:128
ds_read_b64_tr_b16 a[218:219], v251 offset:5248
v_mfma_f32_16x16x32_bf16 a[24:27], a[204:207], v[116:119], a[24:27]
ds_read_b64_tr_b16 a[220:221], v251 offset:10368
ds_read_b64_tr_b16 a[222:223], v251 offset:15488
v_mfma_f32_16x16x32_bf16 a[28:31], a[200:203], v[120:123], a[28:31]
v_mfma_f32_16x16x32_bf16 a[28:31], a[204:207], v[124:127], a[28:31]
s_waitcnt lgkmcnt(6)
v_mfma_f32_16x16x32_bf16 a[32:35], a[208:211], v[112:115], a[32:35]
s_waitcnt lgkmcnt(4)
ds_read_b64_tr_b16 a[192:193], v250 offset:192
ds_read_b64_tr_b16 a[194:195], v250 offset:5312
v_mfma_f32_16x16x32_bf16 a[32:35], a[212:215], v[116:119], a[32:35]
ds_read_b64_tr_b16 a[196:197], v250 offset:10432
ds_read_b64_tr_b16 a[198:199], v250 offset:15552
v_mfma_f32_16x16x32_bf16 a[36:39], a[208:211], v[120:123], a[36:39]
v_mfma_f32_16x16x32_bf16 a[36:39], a[212:215], v[124:127], a[36:39]
s_waitcnt lgkmcnt(6)
v_mfma_f32_16x16x32_bf16 a[40:43], a[216:219], v[112:115], a[40:43]
s_waitcnt lgkmcnt(4)
ds_read_b64_tr_b16 a[200:201], v251 offset:192
ds_read_b64_tr_b16 a[202:203], v251 offset:5312
v_mfma_f32_16x16x32_bf16 a[40:43], a[220:223], v[116:119], a[40:43]
ds_read_b64_tr_b16 a[204:205], v251 offset:10432
ds_read_b64_tr_b16 a[206:207], v251 offset:15552
v_mfma_f32_16x16x32_bf16 a[44:47], a[216:219], v[120:123], a[44:47]
v_mfma_f32_16x16x32_bf16 a[44:47], a[220:223], v[124:127], a[44:47]
s_waitcnt lgkmcnt(6)
v_mfma_f32_16x16x32_bf16 a[48:51], a[192:195], v[112:115], a[48:51]
s_waitcnt lgkmcnt(4)
ds_read_b64_tr_b16 a[208:209], v250 offset:256
ds_read_b64_tr_b16 a[210:211], v250 offset:5376
v_mfma_f32_16x16x32_bf16 a[48:51], a[196:199], v[116:119], a[48:51]
ds_read_b64_tr_b16 a[212:213], v250 offset:10496
ds_read_b64_tr_b16 a[214:215], v250 offset:15616
v_mfma_f32_16x16x32_bf16 a[52:55], a[192:195], v[120:123], a[52:55]
v_mfma_f32_16x16x32_bf16 a[52:55], a[196:199], v[124:127], a[52:55]
s_waitcnt lgkmcnt(6)
v_mfma_f32_16x16x32_bf16 a[56:59], a[200:203], v[112:115], a[56:59]
s_waitcnt lgkmcnt(4)
ds_read_b64_tr_b16 a[216:217], v251 offset:256
ds_read_b64_tr_b16 a[218:219], v251 offset:5376
v_mfma_f32_16x16x32_bf16 a[56:59], a[204:207], v[116:119], a[56:59]
ds_read_b64_tr_b16 a[220:221], v251 offset:10496
ds_read_b64_tr_b16 a[222:223], v251 offset:15616
v_mfma_f32_16x16x32_bf16 a[60:63], a[200:203], v[120:123], a[60:63]
v_mfma_f32_16x16x32_bf16 a[60:63], a[204:207], v[124:127], a[60:63]
s_waitcnt vmcnt(61)
s_barrier
s_waitcnt lgkmcnt(6)
v_mfma_f32_16x16x32_bf16 a[64:67], a[208:211], v[112:115], a[64:67]
s_waitcnt lgkmcnt(4)
ds_read_b64_tr_b16 a[192:193], v250 offset:20480
ds_read_b64_tr_b16 a[194:195], v250 offset:25600
v_mfma_f32_16x16x32_bf16 a[64:67], a[212:215], v[116:119], a[64:67]
ds_read_b64_tr_b16 a[196:197], v250 offset:30720
ds_read_b64_tr_b16 a[198:199], v250 offset:35840
v_mfma_f32_16x16x32_bf16 a[68:71], a[208:211], v[120:123], a[68:71]
v_mfma_f32_16x16x32_bf16 a[68:71], a[212:215], v[124:127], a[68:71]
s_waitcnt lgkmcnt(6)
v_mfma_f32_16x16x32_bf16 a[72:75], a[216:219], v[112:115], a[72:75]
s_waitcnt lgkmcnt(4)
ds_read_b64_tr_b16 a[200:201], v251 offset:20480
ds_read_b64_tr_b16 a[202:203], v251 offset:25600
v_mfma_f32_16x16x32_bf16 a[72:75], a[220:223], v[116:119], a[72:75]
ds_read_b64_tr_b16 a[204:205], v251 offset:30720
ds_read_b64_tr_b16 a[206:207], v251 offset:35840
v_mfma_f32_16x16x32_bf16 a[76:79], a[216:219], v[120:123], a[76:79]
v_mfma_f32_16x16x32_bf16 a[76:79], a[220:223], v[124:127], a[76:79]
s_waitcnt lgkmcnt(6) vmcnt(54)
v_mfma_f32_16x16x32_bf16 a[0:3], a[192:195], v[128:131], a[0:3]
s_waitcnt lgkmcnt(4) vmcnt(53)
ds_read_b64_tr_b16 a[208:209], v250 offset:20544
ds_read_b64_tr_b16 a[210:211], v250 offset:25664
s_add_u32 m0, s49, 81920
v_mfma_f32_16x16x32_bf16 a[0:3], a[196:199], v[132:135], a[0:3]
s_waitcnt vmcnt(52)
ds_read_b64_tr_b16 a[212:213], v250 offset:30784
ds_read_b64_tr_b16 a[214:215], v250 offset:35904
v_mfma_f32_16x16x32_bf16 a[4:7], a[192:195], v[136:139], a[4:7]
s_waitcnt vmcnt(51)
buffer_load_dwordx4 v49, s[64:67], s48 offen offset:0 lds
v_mfma_f32_16x16x32_bf16 a[4:7], a[196:199], v[140:143], a[4:7]
s_waitcnt vmcnt(16) lgkmcnt(6)
buffer_store_dword v16, off, s[60:63], s24 sc1
v_mfma_f32_16x16x32_bf16 a[8:11], a[200:203], v[128:131], a[8:11]
s_waitcnt lgkmcnt(4)
ds_read_b64_tr_b16 a[216:217], v251 offset:20544
ds_read_b64_tr_b16 a[218:219], v251 offset:25664
v_mfma_f32_16x16x32_bf16 a[8:11], a[204:207], v[132:135], a[8:11]
ds_read_b64_tr_b16 a[220:221], v251 offset:30784
ds_read_b64_tr_b16 a[222:223], v251 offset:35904
v_mfma_f32_16x16x32_bf16 a[12:15], a[200:203], v[136:139], a[12:15]
buffer_load_dwordx4 v50, s[64:67], s48 offen offset:1024 lds
v_mfma_f32_16x16x32_bf16 a[12:15], a[204:207], v[140:143], a[12:15]
s_waitcnt lgkmcnt(6)
buffer_load_dwordx4 v51, s[64:67], s48 offen offset:2048 lds
v_mfma_f32_16x16x32_bf16 a[16:19], a[208:211], v[128:131], a[16:19]
s_waitcnt lgkmcnt(4)
ds_read_b64_tr_b16 a[192:193], v250 offset:20608
ds_read_b64_tr_b16 a[194:195], v250 offset:25728
v_mfma_f32_16x16x32_bf16 a[16:19], a[212:215], v[132:135], a[16:19]
ds_read_b64_tr_b16 a[196:197], v250 offset:30848
ds_read_b64_tr_b16 a[198:199], v250 offset:35968
v_mfma_f32_16x16x32_bf16 a[20:23], a[208:211], v[136:139], a[20:23]
buffer_load_dwordx4 v52, s[64:67], s48 offen offset:3072 lds
s_add_u32 m0, s49, 86016
v_mfma_f32_16x16x32_bf16 a[20:23], a[212:215], v[140:143], a[20:23]
s_waitcnt lgkmcnt(6)
buffer_load_dwordx4 v53, s[64:67], s48 offen offset:0 lds
s_add_u32 s48, s48, 81920
s_add_u32 m0, s49, 102400
v_mfma_f32_16x16x32_bf16 a[24:27], a[216:219], v[128:131], a[24:27]
s_waitcnt lgkmcnt(4)
ds_read_b64_tr_b16 a[200:201], v251 offset:20608
ds_read_b64_tr_b16 a[202:203], v251 offset:25728
v_mfma_f32_16x16x32_bf16 a[24:27], a[220:223], v[132:135], a[24:27]
ds_read_b64_tr_b16 a[204:205], v251 offset:30848
ds_read_b64_tr_b16 a[206:207], v251 offset:35968
v_mfma_f32_16x16x32_bf16 a[28:31], a[216:219], v[136:139], a[28:31]
buffer_load_dwordx4 v49, s[64:67], s48 offen offset:0 lds
v_mfma_f32_16x16x32_bf16 a[28:31], a[220:223], v[140:143], a[28:31]
s_waitcnt lgkmcnt(6)
buffer_load_dwordx4 v50, s[64:67], s48 offen offset:1024 lds
v_mfma_f32_16x16x32_bf16 a[32:35], a[192:195], v[128:131], a[32:35]
s_waitcnt lgkmcnt(4)
ds_read_b64_tr_b16 a[208:209], v250 offset:20672
ds_read_b64_tr_b16 a[210:211], v250 offset:25792
v_mfma_f32_16x16x32_bf16 a[32:35], a[196:199], v[132:135], a[32:35]
ds_read_b64_tr_b16 a[212:213], v250 offset:30912
ds_read_b64_tr_b16 a[214:215], v250 offset:36032
v_mfma_f32_16x16x32_bf16 a[36:39], a[192:195], v[136:139], a[36:39]
buffer_load_dwordx4 v51, s[64:67], s48 offen offset:2048 lds
v_mfma_f32_16x16x32_bf16 a[36:39], a[196:199], v[140:143], a[36:39]
s_waitcnt lgkmcnt(6)
buffer_load_dwordx4 v52, s[64:67], s48 offen offset:3072 lds
s_add_u32 m0, s49, 106496
v_mfma_f32_16x16x32_bf16 a[40:43], a[200:203], v[128:131], a[40:43]
s_waitcnt lgkmcnt(4)
ds_read_b64_tr_b16 a[216:217], v251 offset:20672
ds_read_b64_tr_b16 a[218:219], v251 offset:25792
v_mfma_f32_16x16x32_bf16 a[40:43], a[204:207], v[132:135], a[40:43]
ds_read_b64_tr_b16 a[220:221], v251 offset:30912
ds_read_b64_tr_b16 a[222:223], v251 offset:36032
v_mfma_f32_16x16x32_bf16 a[44:47], a[200:203], v[136:139], a[44:47]
buffer_load_dwordx4 v53, s[64:67], s48 offen offset:0 lds
s_add_u32 s48, s48, 81920
v_mfma_f32_16x16x32_bf16 a[44:47], a[204:207], v[140:143], a[44:47]
s_waitcnt lgkmcnt(6)
v_mfma_f32_16x16x32_bf16 a[48:51], a[208:211], v[128:131], a[48:51]
s_waitcnt lgkmcnt(4)
ds_read_b64_tr_b16 a[192:193], v250 offset:20736
ds_read_b64_tr_b16 a[194:195], v250 offset:25856
v_mfma_f32_16x16x32_bf16 a[48:51], a[212:215], v[132:135], a[48:51]
ds_read_b64_tr_b16 a[196:197], v250 offset:30976
ds_read_b64_tr_b16 a[198:199], v250 offset:36096
v_mfma_f32_16x16x32_bf16 a[52:55], a[208:211], v[136:139], a[52:55]
v_mfma_f32_16x16x32_bf16 a[52:55], a[212:215], v[140:143], a[52:55]
s_waitcnt lgkmcnt(6)
v_mfma_f32_16x16x32_bf16 a[56:59], a[216:219], v[128:131], a[56:59]
s_waitcnt lgkmcnt(4)
ds_read_b64_tr_b16 a[200:201], v251 offset:20736
ds_read_b64_tr_b16 a[202:203], v251 offset:25856
v_mfma_f32_16x16x32_bf16 a[56:59], a[220:223], v[132:135], a[56:59]
ds_read_b64_tr_b16 a[204:205], v251 offset:30976
ds_read_b64_tr_b16 a[206:207], v251 offset:36096
v_mfma_f32_16x16x32_bf16 a[60:63], a[216:219], v[136:139], a[60:63]
v_mfma_f32_16x16x32_bf16 a[60:63], a[220:223], v[140:143], a[60:63]
s_waitcnt vmcnt(44)
s_barrier
s_waitcnt lgkmcnt(6)
v_mfma_f32_16x16x32_bf16 a[64:67], a[192:195], v[128:131], a[64:67]
s_waitcnt lgkmcnt(4)
ds_read_b64_tr_b16 a[208:209], v54 offset:0
ds_read_b64_tr_b16 a[210:211], v54 offset:5120
v_mfma_f32_16x16x32_bf16 a[64:67], a[196:199], v[132:135], a[64:67]
ds_read_b64_tr_b16 a[212:213], v54 offset:10240
ds_read_b64_tr_b16 a[214:215], v54 offset:15360
v_mfma_f32_16x16x32_bf16 a[68:71], a[192:195], v[136:139], a[68:71]
v_mfma_f32_16x16x32_bf16 a[68:71], a[196:199], v[140:143], a[68:71]
s_waitcnt lgkmcnt(6)
v_mfma_f32_16x16x32_bf16 a[72:75], a[200:203], v[128:131], a[72:75]
s_waitcnt lgkmcnt(4)
ds_read_b64_tr_b16 a[216:217], v55 offset:0
ds_read_b64_tr_b16 a[218:219], v55 offset:5120
v_mfma_f32_16x16x32_bf16 a[72:75], a[204:207], v[132:135], a[72:75]
ds_read_b64_tr_b16 a[220:221], v55 offset:10240
ds_read_b64_tr_b16 a[222:223], v55 offset:15360
v_mfma_f32_16x16x32_bf16 a[76:79], a[200:203], v[136:139], a[76:79]
v_mfma_f32_16x16x32_bf16 a[76:79], a[204:207], v[140:143], a[76:79]
s_waitcnt lgkmcnt(6)
v_mfma_f32_16x16x32_bf16 a[0:3], a[208:211], v[144:147], a[0:3]
s_waitcnt lgkmcnt(4)
ds_read_b64_tr_b16 a[192:193], v54 offset:64
ds_read_b64_tr_b16 a[194:195], v54 offset:5184
s_add_u32 m0, s49, 122880
v_mfma_f32_16x16x32_bf16 a[0:3], a[212:215], v[148:151], a[0:3]
ds_read_b64_tr_b16 a[196:197], v54 offset:10304
ds_read_b64_tr_b16 a[198:199], v54 offset:15424
v_mfma_f32_16x16x32_bf16 a[4:7], a[208:211], v[152:155], a[4:7]
buffer_load_dwordx4 v49, s[64:67], s48 offen offset:0 lds
v_mfma_f32_16x16x32_bf16 a[4:7], a[212:215], v[156:159], a[4:7]
s_waitcnt lgkmcnt(6)
buffer_load_dwordx4 v50, s[64:67], s48 offen offset:1024 lds
v_mfma_f32_16x16x32_bf16 a[8:11], a[216:219], v[144:147], a[8:11]
s_waitcnt lgkmcnt(4)
ds_read_b64_tr_b16 a[200:201], v55 offset:64
ds_read_b64_tr_b16 a[202:203], v55 offset:5184
v_mfma_f32_16x16x32_bf16 a[8:11], a[220:223], v[148:151], a[8:11]
ds_read_b64_tr_b16 a[204:205], v55 offset:10304
ds_read_b64_tr_b16 a[206:207], v55 offset:15424
v_mfma_f32_16x16x32_bf16 a[12:15], a[216:219], v[152:155], a[12:15]
buffer_load_dwordx4 v51, s[64:67], s48 offen offset:2048 lds
v_mfma_f32_16x16x32_bf16 a[12:15], a[220:223], v[156:159], a[12:15]
s_waitcnt lgkmcnt(6)
buffer_load_dwordx4 v52, s[64:67], s48 offen offset:3072 lds
s_add_u32 m0, s49, 126976
v_mfma_f32_16x16x32_bf16 a[16:19], a[192:195], v[144:147], a[16:19]
s_waitcnt lgkmcnt(4)
ds_read_b64_tr_b16 a[208:209], v54 offset:128
ds_read_b64_tr_b16 a[210:211], v54 offset:5248
v_mfma_f32_16x16x32_bf16 a[16:19], a[196:199], v[148:151], a[16:19]
ds_read_b64_tr_b16 a[212:213], v54 offset:10368
ds_read_b64_tr_b16 a[214:215], v54 offset:15488
v_mfma_f32_16x16x32_bf16 a[20:23], a[192:195], v[152:155], a[20:23]
buffer_load_dwordx4 v53, s[64:67], s48 offen offset:0 lds
s_add_u32 s48, s48, 81920
v_mfma_f32_16x16x32_bf16 a[20:23], a[196:199], v[156:159], a[20:23]
s_waitcnt lgkmcnt(6)
v_mfma_f32_16x16x32_bf16 a[24:27], a[200:203], v[144:147], a[24:27]
s_waitcnt lgkmcnt(4)
ds_read_b64_tr_b16 a[216:217], v55 offset:128
ds_read_b64_tr_b16 a[218:219], v55 offset:5248
v_mfma_f32_16x16x32_bf16 a[24:27], a[204:207], v[148:151], a[24:27]
ds_read_b64_tr_b16 a[220:221], v55 offset:10368
ds_read_b64_tr_b16 a[222:223], v55 offset:15488
v_mfma_f32_16x16x32_bf16 a[28:31], a[200:203], v[152:155], a[28:31]
v_mfma_f32_16x16x32_bf16 a[28:31], a[204:207], v[156:159], a[28:31]
s_waitcnt lgkmcnt(6)
v_mfma_f32_16x16x32_bf16 a[32:35], a[208:211], v[144:147], a[32:35]
s_waitcnt lgkmcnt(4)
ds_read_b64_tr_b16 a[192:193], v54 offset:192
ds_read_b64_tr_b16 a[194:195], v54 offset:5312
v_mfma_f32_16x16x32_bf16 a[32:35], a[212:215], v[148:151], a[32:35]
ds_read_b64_tr_b16 a[196:197], v54 offset:10432
ds_read_b64_tr_b16 a[198:199], v54 offset:15552
v_mfma_f32_16x16x32_bf16 a[36:39], a[208:211], v[152:155], a[36:39]
v_mfma_f32_16x16x32_bf16 a[36:39], a[212:215], v[156:159], a[36:39]
s_waitcnt lgkmcnt(6)
v_mfma_f32_16x16x32_bf16 a[40:43], a[216:219], v[144:147], a[40:43]
s_waitcnt lgkmcnt(4)
ds_read_b64_tr_b16 a[200:201], v55 offset:192
ds_read_b64_tr_b16 a[202:203], v55 offset:5312
v_mfma_f32_16x16x32_bf16 a[40:43], a[220:223], v[148:151], a[40:43]
ds_read_b64_tr_b16 a[204:205], v55 offset:10432
ds_read_b64_tr_b16 a[206:207], v55 offset:15552
v_mfma_f32_16x16x32_bf16 a[44:47], a[216:219], v[152:155], a[44:47]
v_mfma_f32_16x16x32_bf16 a[44:47], a[220:223], v[156:159], a[44:47]
s_waitcnt lgkmcnt(6)
v_mfma_f32_16x16x32_bf16 a[48:51], a[192:195], v[144:147], a[48:51]
s_waitcnt lgkmcnt(4)
ds_read_b64_tr_b16 a[208:209], v54 offset:256
ds_read_b64_tr_b16 a[210:211], v54 offset:5376
v_mfma_f32_16x16x32_bf16 a[48:51], a[196:199], v[148:151], a[48:51]
ds_read_b64_tr_b16 a[212:213], v54 offset:10496
ds_read_b64_tr_b16 a[214:215], v54 offset:15616
v_mfma_f32_16x16x32_bf16 a[52:55], a[192:195], v[152:155], a[52:55]
v_mfma_f32_16x16x32_bf16 a[52:55], a[196:199], v[156:159], a[52:55]
s_waitcnt lgkmcnt(6)
v_mfma_f32_16x16x32_bf16 a[56:59], a[200:203], v[144:147], a[56:59]
s_waitcnt lgkmcnt(4)
ds_read_b64_tr_b16 a[216:217], v55 offset:256
ds_read_b64_tr_b16 a[218:219], v55 offset:5376
v_mfma_f32_16x16x32_bf16 a[56:59], a[204:207], v[148:151], a[56:59]
ds_read_b64_tr_b16 a[220:221], v55 offset:10496
ds_read_b64_tr_b16 a[222:223], v55 offset:15616
v_mfma_f32_16x16x32_bf16 a[60:63], a[200:203], v[152:155], a[60:63]
v_mfma_f32_16x16x32_bf16 a[60:63], a[204:207], v[156:159], a[60:63]
s_waitcnt vmcnt(26)
s_barrier
s_waitcnt lgkmcnt(6)
v_mfma_f32_16x16x32_bf16 a[64:67], a[208:211], v[144:147], a[64:67]
s_waitcnt lgkmcnt(4)
ds_read_b64_tr_b16 a[192:193], v54 offset:20480
ds_read_b64_tr_b16 a[194:195], v54 offset:25600
v_mfma_f32_16x16x32_bf16 a[64:67], a[212:215], v[148:151], a[64:67]
ds_read_b64_tr_b16 a[196:197], v54 offset:30720
ds_read_b64_tr_b16 a[198:199], v54 offset:35840
v_mfma_f32_16x16x32_bf16 a[68:71], a[208:211], v[152:155], a[68:71]
v_mfma_f32_16x16x32_bf16 a[68:71], a[212:215], v[156:159], a[68:71]
s_waitcnt lgkmcnt(6)
v_mfma_f32_16x16x32_bf16 a[72:75], a[216:219], v[144:147], a[72:75]
s_waitcnt lgkmcnt(4)
ds_read_b64_tr_b16 a[200:201], v55 offset:20480
ds_read_b64_tr_b16 a[202:203], v55 offset:25600
v_mfma_f32_16x16x32_bf16 a[72:75], a[220:223], v[148:151], a[72:75]
ds_read_b64_tr_b16 a[204:205], v55 offset:30720
ds_read_b64_tr_b16 a[206:207], v55 offset:35840
v_mfma_f32_16x16x32_bf16 a[76:79], a[216:219], v[152:155], a[76:79]
v_mfma_f32_16x16x32_bf16 a[76:79], a[220:223], v[156:159], a[76:79]
s_mov_b32 s93, 0x200000
buffer_load_dword v63, v3, s[60:63], s25 offen offset:0 sc1
s_waitcnt vmcnt(0)
v_cmp_ne_u32 vcc, 0, v63
s_nop 1
s_cmp_eq_u64 vcc, -1
s_cbranch_scc1 L_pd3
L_pl3:
s_sleep 1
buffer_load_dword v63, v3, s[60:63], s25 offen offset:0 sc1
s_waitcnt vmcnt(0)
v_cmp_ne_u32 vcc, 0, v63
s_sub_u32 s93, s93, 1
s_cmp_eq_u64 vcc, -1
s_cbranch_scc1 L_pd3
s_cmp_lg_u32 s93, 0
s_cbranch_scc1 L_pl3
L_pd3:
buffer_load_dwordx4 v[160:163], v58, s[28:31], s51 offen offset:0 sc1
buffer_load_dwordx4 v[164:167], v58, s[28:31], s51 offen offset:1024 sc1
buffer_load_dwordx4 v[168:171], v59, s[28:31], s51 offen offset:0 sc1
buffer_load_dwordx4 v[172:175], v59, s[28:31], s51 offen offset:1024 sc1
s_add_u32 s51, s51, 2048
buffer_load_dwordx4 v[176:179], v58, s[28:31], s51 offen offset:0 sc1
buffer_load_dwordx4 v[180:183], v58, s[28:31], s51 offen offset:1024 sc1
buffer_load_dwordx4 v[184:187], v59, s[28:31], s51 offen offset:0 sc1
buffer_load_dwordx4 v[188:191], v59, s[28:31], s51 offen offset:1024 sc1
s_add_u32 s51, s51, 2048
buffer_load_dwordx4 v[64:67], v58, s[28:31], s51 offen offset:0 sc1
buffer_load_dwordx4 v[68:71], v58, s[28:31], s51 offen offset:1024 sc1
buffer_load_dwordx4 v[72:75], v59, s[28:31], s51 offen offset:0 sc1
buffer_load_dwordx4 v[76:79], v59, s[28:31], s51 offen offset:1024 sc1
s_add_u32 s51, s51, 2048
buffer_load_dwordx4 v[80:83], v58, s[28:31], s51 offen offset:0 sc1
buffer_load_dwordx4 v[84:87], v58, s[28:31], s51 offen offset:1024 sc1
buffer_load_dwordx4 v[88:91], v59, s[28:31], s51 offen offset:0 sc1
buffer_load_dwordx4 v[92:95], v59, s[28:31], s51 offen offset:1024 sc1
s_add_u32 s51, s51, 2048
buffer_load_dwordx4 v[96:99], v58, s[28:31], s51 offen offset:0 sc1
buffer_load_dwordx4 v[100:103], v58, s[28:31], s51 offen offset:1024 sc1
buffer_load_dwordx4 v[104:107], v59, s[28:31], s51 offen offset:0 sc1
buffer_load_dwordx4 v[108:111], v59, s[28:31], s51 offen offset:1024 sc1
s_add_u32 s51, s51, 2048
buffer_load_dwordx4 v[112:115], v58, s[28:31], s51 offen offset:0 sc1
buffer_load_dwordx4 v[116:119], v58, s[28:31], s51 offen offset:1024 sc1
buffer_load_dwordx4 v[120:123], v59, s[28:31], s51 offen offset:0 sc1
buffer_load_dwordx4 v[124:127], v59, s[28:31], s51 offen offset:1024 sc1
s_add_u32 s51, s51, 2048
s_nop 4
s_cmp_eq_u32 s90, 1
s_cbranch_scc1 L_xf1
s_cmp_eq_u32 s90, 2
s_cbranch_scc1 L_xf2
s_cmp_eq_u32 s90, 3
s_cbranch_scc1 L_xf3
s_add_u32 s55, s91, 10240
v_accvgpr_read_b32 v236, a4
v_accvgpr_read_b32 v237, a5
v_accvgpr_read_b32 v238, a6
v_accvgpr_read_b32 v239, a7
v_cvt_pk_bf16_f32 v196, v236, v237
v_cvt_pk_bf16_f32 v197, v238, v239
v_accvgpr_read_b32 v236, a12
v_accvgpr_read_b32 v237, a13
v_accvgpr_read_b32 v238, a14
v_accvgpr_read_b32 v239, a15
v_cvt_pk_bf16_f32 v198, v236, v237
v_cvt_pk_bf16_f32 v199, v238, v239
v_accvgpr_read_b32 v236, a20
v_accvgpr_read_b32 v237, a21
v_accvgpr_read_b32 v238, a22
v_accvgpr_read_b32 v239, a23
v_cvt_pk_bf16_f32 v200, v236, v237
v_cvt_pk_bf16_f32 v201, v238, v239
v_accvgpr_read_b32 v236, a28
v_accvgpr_read_b32 v237, a29
v_accvgpr_read_b32 v238, a30
v_accvgpr_read_b32 v239, a31
v_cvt_pk_bf16_f32 v202, v236, v237
v_cvt_pk_bf16_f32 v203, v238, v239
v_accvgpr_read_b32 v236, a36
v_accvgpr_read_b32 v237, a37
v_accvgpr_read_b32 v238, a38
v_accvgpr_read_b32 v239, a39
v_cvt_pk_bf16_f32 v204, v236, v237
v_cvt_pk_bf16_f32 v205, v238, v239
s_add_u32 s56, s91, 20480
v_accvgpr_read_b32 v236, a40
v_accvgpr_read_b32 v237, a41
v_accvgpr_read_b32 v238, a42
v_accvgpr_read_b32 v239, a43
v_cvt_pk_bf16_f32 v206, v236, v237
v_cvt_pk_bf16_f32 v207, v238, v239
v_accvgpr_read_b32 v236, a48
v_accvgpr_read_b32 v237, a49
v_accvgpr_read_b32 v238, a50
v_accvgpr_read_b32 v239, a51
v_cvt_pk_bf16_f32 v208, v236, v237
v_cvt_pk_bf16_f32 v209, v238, v239
v_accvgpr_read_b32 v236, a56
v_accvgpr_read_b32 v237, a57
v_accvgpr_read_b32 v238, a58
v_accvgpr_read_b32 v239, a59
v_cvt_pk_bf16_f32 v210, v236, v237
v_cvt_pk_bf16_f32 v211, v238, v239
v_accvgpr_read_b32 v236, a64
v_accvgpr_read_b32 v237, a65
v_accvgpr_read_b32 v238, a66
v_accvgpr_read_b32 v239, a67
v_cvt_pk_bf16_f32 v212, v236, v237
v_cvt_pk_bf16_f32 v213, v238, v239
v_accvgpr_read_b32 v236, a72
v_accvgpr_read_b32 v237, a73
v_accvgpr_read_b32 v238, a74
v_accvgpr_read_b32 v239, a75
v_cvt_pk_bf16_f32 v214, v236, v237
v_cvt_pk_bf16_f32 v215, v238, v239
s_add_u32 s57, s91, 30720
v_accvgpr_read_b32 v236, a44
v_accvgpr_read_b32 v237, a45
v_accvgpr_read_b32 v238, a46
v_accvgpr_read_b32 v239, a47
v_cvt_pk_bf16_f32 v216, v236, v237
v_cvt_pk_bf16_f32 v217, v238, v239
v_accvgpr_read_b32 v236, a52
v_accvgpr_read_b32 v237, a53
v_accvgpr_read_b32 v238, a54
v_accvgpr_read_b32 v239, a55
v_cvt_pk_bf16_f32 v218, v236, v237
v_cvt_pk_bf16_f32 v219, v238, v239
v_accvgpr_read_b32 v236, a60
v_accvgpr_read_b32 v237, a61
v_accvgpr_read_b32 v238, a62
v_accvgpr_read_b32 v239, a63
v_cvt_pk_bf16_f32 v220, v236, v237
v_cvt_pk_bf16_f32 v221, v238, v239
v_accvgpr_read_b32 v236, a68
v_accvgpr_read_b32 v237, a69
v_accvgpr_read_b32 v238, a70
v_accvgpr_read_b32 v239, a71
v_cvt_pk_bf16_f32 v222, v236, v237
v_cvt_pk_bf16_f32 v223, v238, v239
v_accvgpr_read_b32 v236, a76
v_accvgpr_read_b32 v237, a77
v_accvgpr_read_b32 v238, a78
v_accvgpr_read_b32 v239, a79
v_cvt_pk_bf16_f32 v224, v236, v237
v_cvt_pk_bf16_f32 v225, v238, v239
v_accvgpr_mov_b32 a160, a0
v_accvgpr_mov_b32 a161, a1
v_accvgpr_mov_b32 a162, a2
v_accvgpr_mov_b32 a163, a3
v_accvgpr_mov_b32 a164, a8
v_accvgpr_mov_b32 a165, a9
v_accvgpr_mov_b32 a166, a10
v_accvgpr_mov_b32 a167, a11
v_accvgpr_mov_b32 a168, a16
v_accvgpr_mov_b32 a169, a17
v_accvgpr_mov_b32 a170, a18
v_accvgpr_mov_b32 a171, a19
v_accvgpr_mov_b32 a172, a24
v_accvgpr_mov_b32 a173, a25
v_accvgpr_mov_b32 a174, a26
v_accvgpr_mov_b32 a175, a27
v_accvgpr_mov_b32 a176, a32
v_accvgpr_mov_b32 a177, a33
v_accvgpr_mov_b32 a178, a34
v_accvgpr_mov_b32 a179, a35
L_xf_j:
s_waitcnt lgkmcnt(6)
s_waitcnt vmcnt(23)
v_mfma_f32_16x16x32_bf16 a[80:83], a[192:195], v[160:163], 0
s_waitcnt lgkmcnt(4) vmcnt(22)
ds_read_b64_tr_b16 a[208:209], v54 offset:20544
ds_read_b64_tr_b16 a[210:211], v54 offset:25664
v_mfma_f32_16x16x32_bf16 a[80:83], a[196:199], v[164:167], a[80:83]
s_waitcnt vmcnt(21)
s_add_u32 m0, s49, 143360
ds_read_b64_tr_b16 a[212:213], v54 offset:30784
ds_read_b64_tr_b16 a[214:215], v54 offset:35904
v_mfma_f32_16x16x32_bf16 a[84:87], a[192:195], v[168:171], 0
s_waitcnt vmcnt(20)
buffer_load_dwordx4 v49, s[64:67], s48 offen offset:0 lds
v_mfma_f32_16x16x32_bf16 a[84:87], a[196:199], v[172:175], a[84:87]
s_waitcnt lgkmcnt(6)
v_mfma_f32_16x16x32_bf16 a[88:91], a[200:203], v[160:163], 0
s_waitcnt lgkmcnt(4)
ds_read_b64_tr_b16 a[216:217], v55 offset:20544
ds_read_b64_tr_b16 a[218:219], v55 offset:25664
v_mfma_f32_16x16x32_bf16 a[88:91], a[204:207], v[164:167], a[88:91]
ds_read_b64_tr_b16 a[220:221], v55 offset:30784
ds_read_b64_tr_b16 a[222:223], v55 offset:35904
v_mfma_f32_16x16x32_bf16 a[92:95], a[200:203], v[168:171], 0
buffer_load_dwordx4 v50, s[64:67], s48 offen offset:1024 lds
v_mfma_f32_16x16x32_bf16 a[92:95], a[204:207], v[172:175], a[92:95]
s_waitcnt lgkmcnt(6)
buffer_store_dwordx4 v[196:199], v57, s[76:79], s55 offen sc1
v_mfma_f32_16x16x32_bf16 a[96:99], a[208:211], v[160:163], 0
s_waitcnt lgkmcnt(4)
ds_read_b64_tr_b16 a[192:193], v54 offset:20608
ds_read_b64_tr_b16 a[194:195], v54 offset:25728
v_mfma_f32_16x16x32_bf16 a[96:99], a[212:215], v[164:167], a[96:99]
ds_read_b64_tr_b16 a[196:197], v54 offset:30848
ds_read_b64_tr_b16 a[198:199], v54 offset:35968
v_mfma_f32_16x16x32_bf16 a[100:103], a[208:211], v[168:171], 0
buffer_load_dwordx4 v51, s[64:67], s48 offen offset:2048 lds
v_mfma_f32_16x16x32_bf16 a[100:103], a[212:215], v[172:175], a[100:103]
s_waitcnt lgkmcnt(6)
buffer_store_dwordx4 v[200:203], v57, s[76:79], s55 offen offset:1024 sc1
v_mfma_f32_16x16x32_bf16 a[104:107], a[216:219], v[160:163], 0
s_waitcnt lgkmcnt(4)
ds_read_b64_tr_b16 a[200:201], v55 offset:20608
ds_read_b64_tr_b16 a[202:203], v55 offset:25728
v_mfma_f32_16x16x32_bf16 a[104:107], a[220:223], v[164:167], a[104:107]
ds_read_b64_tr_b16 a[204:205], v55 offset:30848
ds_read_b64_tr_b16 a[206:207], v55 offset:35968
v_mfma_f32_16x16x32_bf16 a[108:111], a[216:219], v[168:171], 0
buffer_load_dwordx4 v52, s[64:67], s48 offen offset:3072 lds
v_mfma_f32_16x16x32_bf16 a[108:111], a[220:223], v[172:175], a[108:111]
s_waitcnt lgkmcnt(6)
buffer_store_dwordx2 v[204:205], v10, s[76:79], s55 offen offset:2048 sc1
v_mfma_f32_16x16x32_bf16 a[112:115], a[192:195], v[160:163], 0
s_waitcnt lgkmcnt(4)
ds_read_b64_tr_b16 a[208:209], v54 offset:20672
ds_read_b64_tr_b16 a[210:211], v54 offset:25792
v_mfma_f32_16x16x32_bf16 a[112:115], a[196:199], v[164:167], a[112:115]
s_add_u32 m0, s49, 147456
ds_read_b64_tr_b16 a[212:213], v54 offset:30912
ds_read_b64_tr_b16 a[214:215], v54 offset:36032
v_mfma_f32_16x16x32_bf16 a[116:119], a[192:195], v[168:171], 0
buffer_load_dwordx4 v53, s[64:67], s48 offen offset:0 lds
v_mfma_f32_16x16x32_bf16 a[116:119], a[196:199], v[172:175], a[116:119]
s_waitcnt lgkmcnt(6)
v_mfma_f32_16x16x32_bf16 a[120:123], a[200:203], v[160:163], 0
s_waitcnt lgkmcnt(4)
ds_read_b64_tr_b16 a[216:217], v55 offset:20672
ds_read_b64_tr_b16 a[218:219], v55 offset:25792
v_mfma_f32_16x16x32_bf16 a[120:123], a[204:207], v[164:167], a[120:123]
ds_read_b64_tr_b16 a[220:221], v55 offset:30912
ds_read_b64_tr_b16 a[222:223], v55 offset:36032
v_mfma_f32_16x16x32_bf16 a[124:127], a[200:203], v[168:171], 0
buffer_load_dwordx4 v[128:131], v58, s[28:31], s51 offen offset:0 sc1
v_mfma_f32_16x16x32_bf16 a[124:127], a[204:207], v[172:175], a[124:127]
s_waitcnt lgkmcnt(6)
v_mfma_f32_16x16x32_bf16 a[128:131], a[208:211], v[160:163], 0
s_waitcnt lgkmcnt(4)
ds_read_b64_tr_b16 a[192:193], v54 offset:20736
ds_read_b64_tr_b16 a[194:195], v54 offset:25856
v_mfma_f32_16x16x32_bf16 a[128:131], a[212:215], v[164:167], a[128:131]
ds_read_b64_tr_b16 a[196:197], v54 offset:30976
ds_read_b64_tr_b16 a[198:199], v54 offset:36096
v_mfma_f32_16x16x32_bf16 a[132:135], a[208:211], v[168:171], 0
buffer_load_dwordx4 v[132:135], v58, s[28:31], s51 offen offset:1024 sc1
v_mfma_f32_16x16x32_bf16 a[132:135], a[212:215], v[172:175], a[132:135]
s_waitcnt lgkmcnt(6)
v_mfma_f32_16x16x32_bf16 a[136:139], a[216:219], v[160:163], 0
s_waitcnt lgkmcnt(4)
ds_read_b64_tr_b16 a[200:201], v55 offset:20736
ds_read_b64_tr_b16 a[202:203], v55 offset:25856
v_mfma_f32_16x16x32_bf16 a[136:139], a[220:223], v[164:167], a[136:139]
ds_read_b64_tr_b16 a[204:205], v55 offset:30976
ds_read_b64_tr_b16 a[206:207], v55 offset:36096
v_mfma_f32_16x16x32_bf16 a[140:143], a[216:219], v[168:171], 0
buffer_load_dwordx4 v[136:139], v59, s[28:31], s51 offen offset:0 sc1
v_mfma_f32_16x16x32_bf16 a[140:143], a[220:223], v[172:175], a[140:143]
s_waitcnt vmcnt(57)
s_barrier
s_waitcnt lgkmcnt(6)
v_mfma_f32_16x16x32_bf16 a[144:147], a[192:195], v[160:163], 0
s_waitcnt lgkmcnt(4)
ds_read_b64_tr_b16 a[208:209], v54 offset:40960
ds_read_b64_tr_b16 a[210:211], v54 offset:46080
v_mfma_f32_16x16x32_bf16 a[144:147], a[196:199], v[164:167], a[144:147]
ds_read_b64_tr_b16 a[212:213], v54 offset:51200
ds_read_b64_tr_b16 a[214:215], v54 offset:56320
v_mfma_f32_16x16x32_bf16 a[148:151], a[192:195], v[168:171], 0
buffer_load_dwordx4 v[140:143], v59, s[28:31], s51 offen offset:1024 sc1
v_mfma_f32_16x16x32_bf16 a[148:151], a[196:199], v[172:175], a[148:151]
s_waitcnt lgkmcnt(6)
v_mfma_f32_16x16x32_bf16 a[152:155], a[200:203], v[160:163], 0
s_waitcnt lgkmcnt(4)
ds_read_b64_tr_b16 a[216:217], v55 offset:40960
ds_read_b64_tr_b16 a[218:219], v55 offset:46080
v_mfma_f32_16x16x32_bf16 a[152:155], a[204:207], v[164:167], a[152:155]
s_add_u32 s51, s51, 2048
ds_read_b64_tr_b16 a[220:221], v55 offset:51200
ds_read_b64_tr_b16 a[222:223], v55 offset:56320
v_mfma_f32_16x16x32_bf16 a[156:159], a[200:203], v[168:171], 0
s_add_u32 s48, s48, 81920
v_mfma_f32_16x16x32_bf16 a[156:159], a[204:207], v[172:175], a[156:159]
s_waitcnt lgkmcnt(6) vmcnt(31)
v_mfma_f32_16x16x32_bf16 a[80:83], a[208:211], v[176:179], a[80:83]
s_waitcnt lgkmcnt(4) vmcnt(30)
ds_read_b64_tr_b16 a[192:193], v54 offset:41024
ds_read_b64_tr_b16 a[194:195], v54 offset:46144
v_mfma_f32_16x16x32_bf16 a[80:83], a[212:215], v[180:183], a[80:83]
s_waitcnt vmcnt(29)
s_add_u32 m0, s49, 0
ds_read_b64_tr_b16 a[196:197], v54 offset:51264
ds_read_b64_tr_b16 a[198:199], v54 offset:56384
v_mfma_f32_16x16x32_bf16 a[84:87], a[208:211], v[184:187], a[84:87]
s_waitcnt vmcnt(28)
buffer_load_dwordx4 v49, s[64:67], s48 offen offset:0 lds
v_mfma_f32_16x16x32_bf16 a[84:87], a[212:215], v[188:191], a[84:87]
s_waitcnt lgkmcnt(6)
v_mfma_f32_16x16x32_bf16 a[88:91], a[216:219], v[176:179], a[88:91]
s_waitcnt lgkmcnt(4)
ds_read_b64_tr_b16 a[200:201], v55 offset:41024
ds_read_b64_tr_b16 a[202:203], v55 offset:46144
v_mfma_f32_16x16x32_bf16 a[88:91], a[220:223], v[180:183], a[88:91]
ds_read_b64_tr_b16 a[204:205], v55 offset:51264
ds_read_b64_tr_b16 a[206:207], v55 offset:56384
v_mfma_f32_16x16x32_bf16 a[92:95], a[216:219], v[184:187], a[92:95]
buffer_load_dwordx4 v50, s[64:67], s48 offen offset:1024 lds
v_mfma_f32_16x16x32_bf16 a[92:95], a[220:223], v[188:191], a[92:95]
s_waitcnt lgkmcnt(6)
buffer_store_dwordx4 v[206:209], v57, s[76:79], s56 offen sc1
v_mfma_f32_16x16x32_bf16 a[96:99], a[192:195], v[176:179], a[96:99]
s_waitcnt lgkmcnt(4)
ds_read_b64_tr_b16 a[208:209], v54 offset:41088
ds_read_b64_tr_b16 a[210:211], v54 offset:46208
v_mfma_f32_16x16x32_bf16 a[96:99], a[196:199], v[180:183], a[96:99]
ds_read_b64_tr_b16 a[212:213], v54 offset:51328
ds_read_b64_tr_b16 a[214:215], v54 offset:56448
v_mfma_f32_16x16x32_bf16 a[100:103], a[192:195], v[184:187], a[100:103]
buffer_load_dwordx4 v51, s[64:67], s48 offen offset:2048 lds
v_mfma_f32_16x16x32_bf16 a[100:103], a[196:199], v[188:191], a[100:103]
s_waitcnt lgkmcnt(6)
buffer_store_dwordx4 v[210:213], v57, s[76:79], s56 offen offset:1024 sc1
v_mfma_f32_16x16x32_bf16 a[104:107], a[200:203], v[176:179], a[104:107]
s_waitcnt lgkmcnt(4)
ds_read_b64_tr_b16 a[216:217], v55 offset:41088
ds_read_b64_tr_b16 a[218:219], v55 offset:46208
v_mfma_f32_16x16x32_bf16 a[104:107], a[204:207], v[180:183], a[104:107]
ds_read_b64_tr_b16 a[220:221], v55 offset:51328
ds_read_b64_tr_b16 a[222:223], v55 offset:56448
v_mfma_f32_16x16x32_bf16 a[108:111], a[200:203], v[184:187], a[108:111]
buffer_load_dwordx4 v52, s[64:67], s48 offen offset:3072 lds
v_mfma_f32_16x16x32_bf16 a[108:111], a[204:207], v[188:191], a[108:111]
s_waitcnt lgkmcnt(6)
buffer_store_dwordx2 v[214:215], v10, s[76:79], s56 offen offset:2048 sc1
v_mfma_f32_16x16x32_bf16 a[112:115], a[208:211], v[176:179], a[112:115]
s_waitcnt lgkmcnt(4)
ds_read_b64_tr_b16 a[192:193], v54 offset:41152
ds_read_b64_tr_b16 a[194:195], v54 offset:46272
v_mfma_f32_16x16x32_bf16 a[112:115], a[212:215], v[180:183], a[112:115]
s_add_u32 m0, s49, 4096
ds_read_b64_tr_b16 a[196:197], v54 offset:51392
ds_read_b64_tr_b16 a[198:199], v54 offset:56512
v_mfma_f32_16x16x32_bf16 a[116:119], a[208:211], v[184:187], a[116:119]
buffer_load_dwordx4 v53, s[64:67], s48 offen offset:0 lds
v_mfma_f32_16x16x32_bf16 a[116:119], a[212:215], v[188:191], a[116:119]
s_waitcnt lgkmcnt(6)
v_mfma_f32_16x16x32_bf16 a[120:123], a[216:219], v[176:179], a[120:123]
s_waitcnt lgkmcnt(4)
ds_read_b64_tr_b16 a[200:201], v55 offset:41152
ds_read_b64_tr_b16 a[202:203], v55 offset:46272
v_mfma_f32_16x16x32_bf16 a[120:123], a[220:223], v[180:183], a[120:123]
ds_read_b64_tr_b16 a[204:205], v55 offset:51392
ds_read_b64_tr_b16 a[206:207], v55 offset:56512
v_mfma_f32_16x16x32_bf16 a[124:127], a[216:219], v[184:187], a[124:127]
buffer_load_dwordx4 v[144:147], v58, s[28:31], s51 offen offset:0 sc1
v_mfma_f32_16x16x32_bf16 a[124:127], a[220:223], v[188:191], a[124:127]
s_waitcnt lgkmcnt(6)
v_mfma_f32_16x16x32_bf16 a[128:131], a[192:195], v[176:179], a[128:131]
s_waitcnt lgkmcnt(4)
ds_read_b64_tr_b16 a[208:209], v54 offset:41216
ds_read_b64_tr_b16 a[210:211], v54 offset:46336
v_mfma_f32_16x16x32_bf16 a[128:131], a[196:199], v[180:183], a[128:131]
ds_read_b64_tr_b16 a[212:213], v54 offset:51456
ds_read_b64_tr_b16 a[214:215], v54 offset:56576
v_mfma_f32_16x16x32_bf16 a[132:135], a[192:195], v[184:187], a[132:135]
buffer_load_dwordx4 v[148:151], v58, s[28:31], s51 offen offset:1024 sc1
v_mfma_f32_16x16x32_bf16 a[132:135], a[196:199], v[188:191], a[132:135]
s_waitcnt lgkmcnt(6)
v_mfma_f32_16x16x32_bf16 a[136:139], a[200:203], v[176:179], a[136:139]
s_waitcnt lgkmcnt(4)
ds_read_b64_tr_b16 a[216:217], v55 offset:41216
ds_read_b64_tr_b16 a[218:219], v55 offset:46336
v_mfma_f32_16x16x32_bf16 a[136:139], a[204:207], v[180:183], a[136:139]
ds_read_b64_tr_b16 a[220:221], v55 offset:51456
ds_read_b64_tr_b16 a[222:223], v55 offset:56576
v_mfma_f32_16x16x32_bf16 a[140:143], a[200:203], v[184:187], a[140:143]
buffer_load_dwordx4 v[152:155], v59, s[28:31], s51 offen offset:0 sc1
v_mfma_f32_16x16x32_bf16 a[140:143], a[204:207], v[188:191], a[140:143]
s_waitcnt vmcnt(63)
s_barrier
s_waitcnt lgkmcnt(6)
v_mfma_f32_16x16x32_bf16 a[144:147], a[208:211], v[176:179], a[144:147]
s_waitcnt lgkmcnt(4)
ds_read_b64_tr_b16 a[192:193], v248 offset:0
ds_read_b64_tr_b16 a[194:195], v248 offset:5120
v_mfma_f32_16x16x32_bf16 a[144:147], a[212:215], v[180:183], a[144:147]
ds_read_b64_tr_b16 a[196:197], v248 offset:10240
ds_read_b64_tr_b16 a[198:199], v248 offset:15360
v_mfma_f32_16x16x32_bf16 a[148:151], a[208:211], v[184:187], a[148:151]
buffer_load_dwordx4 v[156:159], v59, s[28:31], s51 offen offset:1024 sc1
v_mfma_f32_16x16x32_bf16 a[148:151], a[212:215], v[188:191], a[148:151]
s_waitcnt lgkmcnt(6)
buffer_load_dword v63, v28, s[60:63], s25 offen sc1
v_mfma_f32_16x16x32_bf16 a[152:155], a[216:219], v[176:179], a[152:155]
s_waitcnt lgkmcnt(4)
ds_read_b64_tr_b16 a[200:201], v249 offset:0
ds_read_b64_tr_b16 a[202:203], v249 offset:5120
v_mfma_f32_16x16x32_bf16 a[152:155], a[220:223], v[180:183], a[152:155]
s_add_u32 s51, s51, 2048
ds_read_b64_tr_b16 a[204:205], v249 offset:10240
ds_read_b64_tr_b16 a[206:207], v249 offset:15360
v_mfma_f32_16x16x32_bf16 a[156:159], a[216:219], v[184:187], a[156:159]
s_add_u32 s48, s48, 81920
v_mfma_f32_16x16x32_bf16 a[156:159], a[220:223], v[188:191], a[156:159]
s_waitcnt lgkmcnt(6) vmcnt(40)
v_mfma_f32_16x16x32_bf16 a[80:83], a[192:195], v[64:67], a[80:83]
s_waitcnt lgkmcnt(4) vmcnt(39)
ds_read_b64_tr_b16 a[208:209], v248 offset:64
ds_read_b64_tr_b16 a[210:211], v248 offset:5184
v_mfma_f32_16x16x32_bf16 a[80:83], a[196:199], v[68:71], a[80:83]
s_waitcnt vmcnt(38)
s_add_u32 m0, s49, 20480
ds_read_b64_tr_b16 a[212:213], v248 offset:10304
ds_read_b64_tr_b16 a[214:215], v248 offset:15424
v_mfma_f32_16x16x32_bf16 a[84:87], a[192:195], v[72:75], a[84:87]
s_waitcnt vmcnt(37)
buffer_load_dwordx4 v49, s[64:67], s48 offen offset:0 lds
v_mfma_f32_16x16x32_bf16 a[84:87], a[196:199], v[76:79], a[84:87]
s_waitcnt lgkmcnt(6)
v_mfma_f32_16x16x32_bf16 a[88:91], a[200:203], v[64:67], a[88:91]
s_waitcnt lgkmcnt(4)
ds_read_b64_tr_b16 a[216:217], v249 offset:64
ds_read_b64_tr_b16 a[218:219], v249 offset:5184
v_mfma_f32_16x16x32_bf16 a[88:91], a[204:207], v[68:71], a[88:91]
ds_read_b64_tr_b16 a[220:221], v249 offset:10304
ds_read_b64_tr_b16 a[222:223], v249 offset:15424
v_mfma_f32_16x16x32_bf16 a[92:95], a[200:203], v[72:75], a[92:95]
buffer_load_dwordx4 v50, s[64:67], s48 offen offset:1024 lds
v_mfma_f32_16x16x32_bf16 a[92:95], a[204:207], v[76:79], a[92:95]
s_waitcnt lgkmcnt(6)
buffer_store_dwordx4 v[216:219], v57, s[76:79], s57 offen sc1
v_mfma_f32_16x16x32_bf16 a[96:99], a[208:211], v[64:67], a[96:99]
s_waitcnt lgkmcnt(4)
ds_read_b64_tr_b16 a[192:193], v248 offset:128
ds_read_b64_tr_b16 a[194:195], v248 offset:5248
v_mfma_f32_16x16x32_bf16 a[96:99], a[212:215], v[68:71], a[96:99]
ds_read_b64_tr_b16 a[196:197], v248 offset:10368
ds_read_b64_tr_b16 a[198:199], v248 offset:15488
v_mfma_f32_16x16x32_bf16 a[100:103], a[208:211], v[72:75], a[100:103]
buffer_load_dwordx4 v51, s[64:67], s48 offen offset:2048 lds
v_mfma_f32_16x16x32_bf16 a[100:103], a[212:215], v[76:79], a[100:103]
s_waitcnt lgkmcnt(6)
buffer_store_dwordx4 v[220:223], v57, s[76:79], s57 offen offset:1024 sc1
v_mfma_f32_16x16x32_bf16 a[104:107], a[216:219], v[64:67], a[104:107]
s_waitcnt lgkmcnt(4)
ds_read_b64_tr_b16 a[200:201], v249 offset:128
ds_read_b64_tr_b16 a[202:203], v249 offset:5248
v_mfma_f32_16x16x32_bf16 a[104:107], a[220:223], v[68:71], a[104:107]
ds_read_b64_tr_b16 a[204:205], v249 offset:10368
ds_read_b64_tr_b16 a[206:207], v249 offset:15488
v_mfma_f32_16x16x32_bf16 a[108:111], a[216:219], v[72:75], a[108:111]
buffer_load_dwordx4 v52, s[64:67], s48 offen offset:3072 lds
v_mfma_f32_16x16x32_bf16 a[108:111], a[220:223], v[76:79], a[108:111]
s_waitcnt lgkmcnt(6)
buffer_store_dwordx2 v[224:225], v10, s[76:79], s57 offen offset:2048 sc1
v_mfma_f32_16x16x32_bf16 a[112:115], a[192:195], v[64:67], a[112:115]
s_waitcnt lgkmcnt(4)
ds_read_b64_tr_b16 a[208:209], v248 offset:192
ds_read_b64_tr_b16 a[210:211], v248 offset:5312
v_mfma_f32_16x16x32_bf16 a[112:115], a[196:199], v[68:71], a[112:115]
s_add_u32 m0, s49, 24576
ds_read_b64_tr_b16 a[212:213], v248 offset:10432
ds_read_b64_tr_b16 a[214:215], v248 offset:15552
v_mfma_f32_16x16x32_bf16 a[116:119], a[192:195], v[72:75], a[116:119]
buffer_load_dwordx4 v53, s[64:67], s48 offen offset:0 lds
v_mfma_f32_16x16x32_bf16 a[116:119], a[196:199], v[76:79], a[116:119]
s_waitcnt lgkmcnt(6)
v_mfma_f32_16x16x32_bf16 a[120:123], a[200:203], v[64:67], a[120:123]
s_waitcnt lgkmcnt(4)
ds_read_b64_tr_b16 a[216:217], v249 offset:192
ds_read_b64_tr_b16 a[218:219], v249 offset:5312
v_mfma_f32_16x16x32_bf16 a[120:123], a[204:207], v[68:71], a[120:123]
ds_read_b64_tr_b16 a[220:221], v249 offset:10432
ds_read_b64_tr_b16 a[222:223], v249 offset:15552
v_mfma_f32_16x16x32_bf16 a[124:127], a[200:203], v[72:75], a[124:127]
buffer_load_dwordx4 v[160:163], v58, s[28:31], s51 offen offset:0 sc1
v_mfma_f32_16x16x32_bf16 a[124:127], a[204:207], v[76:79], a[124:127]
s_waitcnt lgkmcnt(6)
v_mfma_f32_16x16x32_bf16 a[128:131], a[208:211], v[64:67], a[128:131]
s_waitcnt lgkmcnt(4)
ds_read_b64_tr_b16 a[192:193], v248 offset:256
ds_read_b64_tr_b16 a[194:195], v248 offset:5376
v_mfma_f32_16x16x32_bf16 a[128:131], a[212:215], v[68:71], a[128:131]
ds_read_b64_tr_b16 a[196:197], v248 offset:10496
ds_read_b64_tr_b16 a[198:199], v248 offset:15616
v_mfma_f32_16x16x32_bf16 a[132:135], a[208:211], v[72:75], a[132:135]
buffer_load_dwordx4 v[164:167], v58, s[28:31], s51 offen offset:1024 sc1
v_mfma_f32_16x16x32_bf16 a[132:135], a[212:215], v[76:79], a[132:135]
s_waitcnt lgkmcnt(6)
v_mfma_f32_16x16x32_bf16 a[136:139], a[216:219], v[64:67], a[136:139]
s_waitcnt lgkmcnt(4)
ds_read_b64_tr_b16 a[200:201], v249 offset:256
ds_read_b64_tr_b16 a[202:203], v249 offset:5376
v_mfma_f32_16x16x32_bf16 a[136:139], a[220:223], v[68:71], a[136:139]
ds_read_b64_tr_b16 a[204:205], v249 offset:10496
ds_read_b64_tr_b16 a[206:207], v249 offset:15616
v_mfma_f32_16x16x32_bf16 a[140:143], a[216:219], v[72:75], a[140:143]
buffer_load_dwordx4 v[168:171], v59, s[28:31], s51 offen offset:0 sc1
v_mfma_f32_16x16x32_bf16 a[140:143], a[220:223], v[76:79], a[140:143]
s_waitcnt vmcnt(63)
s_barrier
s_waitcnt lgkmcnt(6)
v_mfma_f32_16x16x32_bf16 a[144:147], a[192:195], v[64:67], a[144:147]
s_waitcnt lgkmcnt(4)
ds_read_b64_tr_b16 a[208:209], v248 offset:20480
ds_read_b64_tr_b16 a[210:211], v248 offset:25600
v_mfma_f32_16x16x32_bf16 a[144:147], a[196:199], v[68:71], a[144:147]
ds_read_b64_tr_b16 a[212:213], v248 offset:30720
ds_read_b64_tr_b16 a[214:215], v248 offset:35840
v_mfma_f32_16x16x32_bf16 a[148:151], a[192:195], v[72:75], a[148:151]
buffer_load_dwordx4 v[172:175], v59, s[28:31], s51 offen offset:1024 sc1
v_mfma_f32_16x16x32_bf16 a[148:151], a[196:199], v[76:79], a[148:151]
s_waitcnt lgkmcnt(6)
v_mfma_f32_16x16x32_bf16 a[152:155], a[200:203], v[64:67], a[152:155]
s_waitcnt lgkmcnt(4)
ds_read_b64_tr_b16 a[216:217], v249 offset:20480
ds_read_b64_tr_b16 a[218:219], v249 offset:25600
v_mfma_f32_16x16x32_bf16 a[152:155], a[204:207], v[68:71], a[152:155]
s_add_u32 s51, s51, 2048
ds_read_b64_tr_b16 a[220:221], v249 offset:30720
ds_read_b64_tr_b16 a[222:223], v249 offset:35840
v_mfma_f32_16x16x32_bf16 a[156:159], a[200:203], v[72:75], a[156:159]
s_add_u32 s48, s48, 81920
v_mfma_f32_16x16x32_bf16 a[156:159], a[204:207], v[76:79], a[156:159]
s_waitcnt lgkmcnt(6) vmcnt(48)
buffer_load_dword v14, v62, s[60:63], 0 offen offset:2048 sc1
v_mfma_f32_16x16x32_bf16 a[80:83], a[208:211], v[80:83], a[80:83]
s_waitcnt lgkmcnt(4) vmcnt(48)
ds_read_b64_tr_b16 a[192:193], v248 offset:20544
ds_read_b64_tr_b16 a[194:195], v248 offset:25664
v_mfma_f32_16x16x32_bf16 a[80:83], a[212:215], v[84:87], a[80:83]
s_waitcnt vmcnt(47)
s_add_u32 m0, s49, 40960
ds_read_b64_tr_b16 a[196:197], v248 offset:30784
ds_read_b64_tr_b16 a[198:199], v248 offset:35904
v_mfma_f32_16x16x32_bf16 a[84:87], a[208:211], v[88:91], a[84:87]
s_waitcnt vmcnt(46)
buffer_load_dwordx4 v49, s[64:67], s48 offen offset:0 lds
v_mfma_f32_16x16x32_bf16 a[84:87], a[212:215], v[92:95], a[84:87]
s_waitcnt lgkmcnt(6)
v_mfma_f32_16x16x32_bf16 a[88:91], a[216:219], v[80:83], a[88:91]
s_waitcnt lgkmcnt(4)
ds_read_b64_tr_b16 a[200:201], v249 offset:20544
ds_read_b64_tr_b16 a[202:203], v249 offset:25664
v_mfma_f32_16x16x32_bf16 a[88:91], a[220:223], v[84:87], a[88:91]
ds_read_b64_tr_b16 a[204:205], v249 offset:30784
ds_read_b64_tr_b16 a[206:207], v249 offset:35904
v_mfma_f32_16x16x32_bf16 a[92:95], a[216:219], v[88:91], a[92:95]
buffer_load_dwordx4 v50, s[64:67], s48 offen offset:1024 lds
v_mfma_f32_16x16x32_bf16 a[92:95], a[220:223], v[92:95], a[92:95]
s_waitcnt lgkmcnt(6)
v_mfma_f32_16x16x32_bf16 a[96:99], a[192:195], v[80:83], a[96:99]
s_waitcnt lgkmcnt(4)
ds_read_b64_tr_b16 a[208:209], v248 offset:20608
ds_read_b64_tr_b16 a[210:211], v248 offset:25728
v_mfma_f32_16x16x32_bf16 a[96:99], a[196:199], v[84:87], a[96:99]
ds_read_b64_tr_b16 a[212:213], v248 offset:30848
ds_read_b64_tr_b16 a[214:215], v248 offset:35968
v_mfma_f32_16x16x32_bf16 a[100:103], a[192:195], v[88:91], a[100:103]
buffer_load_dwordx4 v51, s[64:67], s48 offen offset:2048 lds
v_mfma_f32_16x16x32_bf16 a[100:103], a[196:199], v[92:95], a[100:103]
s_waitcnt lgkmcnt(6)
v_mfma_f32_16x16x32_bf16 a[104:107], a[200:203], v[80:83], a[104:107]
s_waitcnt lgkmcnt(4)
ds_read_b64_tr_b16 a[216:217], v249 offset:20608
ds_read_b64_tr_b16 a[218:219], v249 offset:25728
v_mfma_f32_16x16x32_bf16 a[104:107], a[204:207], v[84:87], a[104:107]
ds_read_b64_tr_b16 a[220:221], v249 offset:30848
ds_read_b64_tr_b16 a[222:223], v249 offset:35968
v_mfma_f32_16x16x32_bf16 a[108:111], a[200:203], v[88:91], a[108:111]
buffer_load_dwordx4 v52, s[64:67], s48 offen offset:3072 lds
v_mfma_f32_16x16x32_bf16 a[108:111], a[204:207], v[92:95], a[108:111]
s_waitcnt lgkmcnt(6)
v_mfma_f32_16x16x32_bf16 a[112:115], a[208:211], v[80:83], a[112:115]
s_waitcnt lgkmcnt(4)
ds_read_b64_tr_b16 a[192:193], v248 offset:20672
ds_read_b64_tr_b16 a[194:195], v248 offset:25792
v_mfma_f32_16x16x32_bf16 a[112:115], a[212:215], v[84:87], a[112:115]
s_add_u32 m0, s49, 45056
ds_read_b64_tr_b16 a[196:197], v248 offset:30912
ds_read_b64_tr_b16 a[198:199], v248 offset:36032
v_mfma_f32_16x16x32_bf16 a[116:119], a[208:211], v[88:91], a[116:119]
buffer_load_dwordx4 v53, s[64:67], s48 offen offset:0 lds
v_mfma_f32_16x16x32_bf16 a[116:119], a[212:215], v[92:95], a[116:119]
s_waitcnt lgkmcnt(6)
v_mfma_f32_16x16x32_bf16 a[120:123], a[216:219], v[80:83], a[120:123]
s_waitcnt lgkmcnt(4)
ds_read_b64_tr_b16 a[200:201], v249 offset:20672
ds_read_b64_tr_b16 a[202:203], v249 offset:25792
v_mfma_f32_16x16x32_bf16 a[120:123], a[220:223], v[84:87], a[120:123]
ds_read_b64_tr_b16 a[204:205], v249 offset:30912
ds_read_b64_tr_b16 a[206:207], v249 offset:36032
v_mfma_f32_16x16x32_bf16 a[124:127], a[216:219], v[88:91], a[124:127]
buffer_load_dwordx4 v[176:179], v58, s[28:31], s51 offen offset:0 sc1
v_mfma_f32_16x16x32_bf16 a[124:127], a[220:223], v[92:95], a[124:127]
s_waitcnt lgkmcnt(6)
v_mfma_f32_16x16x32_bf16 a[128:131], a[192:195], v[80:83], a[128:131]
s_waitcnt lgkmcnt(4)
ds_read_b64_tr_b16 a[208:209], v248 offset:20736
ds_read_b64_tr_b16 a[210:211], v248 offset:25856
v_mfma_f32_16x16x32_bf16 a[128:131], a[196:199], v[84:87], a[128:131]
ds_read_b64_tr_b16 a[212:213], v248 offset:30976
ds_read_b64_tr_b16 a[214:215], v248 offset:36096
v_mfma_f32_16x16x32_bf16 a[132:135], a[192:195], v[88:91], a[132:135]
buffer_load_dwordx4 v[180:183], v58, s[28:31], s51 offen offset:1024 sc1
v_mfma_f32_16x16x32_bf16 a[132:135], a[196:199], v[92:95], a[132:135]
s_waitcnt lgkmcnt(6)
v_mfma_f32_16x16x32_bf16 a[136:139], a[200:203], v[80:83], a[136:139]
s_waitcnt lgkmcnt(4)
ds_read_b64_tr_b16 a[216:217], v249 offset:20736
ds_read_b64_tr_b16 a[218:219], v249 offset:25856
v_mfma_f32_16x16x32_bf16 a[136:139], a[204:207], v[84:87], a[136:139]
ds_read_b64_tr_b16 a[220:221], v249 offset:30976
ds_read_b64_tr_b16 a[222:223], v249 offset:36096
v_mfma_f32_16x16x32_bf16 a[140:143], a[200:203], v[88:91], a[140:143]
buffer_load_dwordx4 v[184:187], v59, s[28:31], s51 offen offset:0 sc1
v_mfma_f32_16x16x32_bf16 a[140:143], a[204:207], v[92:95], a[140:143]
s_waitcnt vmcnt(63)
s_barrier
s_waitcnt lgkmcnt(6)
v_mfma_f32_16x16x32_bf16 a[144:147], a[208:211], v[80:83], a[144:147]
s_waitcnt lgkmcnt(4)
ds_read_b64_tr_b16 a[192:193], v248 offset:40960
ds_read_b64_tr_b16 a[194:195], v248 offset:46080
v_mfma_f32_16x16x32_bf16 a[144:147], a[212:215], v[84:87], a[144:147]
ds_read_b64_tr_b16 a[196:197], v248 offset:51200
ds_read_b64_tr_b16 a[198:199], v248 offset:56320
v_mfma_f32_16x16x32_bf16 a[148:151], a[208:211], v[88:91], a[148:151]
buffer_load_dwordx4 v[188:191], v59, s[28:31], s51 offen offset:1024 sc1
v_mfma_f32_16x16x32_bf16 a[148:151], a[212:215], v[92:95], a[148:151]
s_waitcnt lgkmcnt(6)
v_mfma_f32_16x16x32_bf16 a[152:155], a[216:219], v[80:83], a[152:155]
s_waitcnt lgkmcnt(4)
ds_read_b64_tr_b16 a[200:201], v249 offset:40960
ds_read_b64_tr_b16 a[202:203], v249 offset:46080
v_mfma_f32_16x16x32_bf16 a[152:155], a[220:223], v[84:87], a[152:155]
s_add_u32 s51, s51, 2048
ds_read_b64_tr_b16 a[204:205], v249 offset:51200
ds_read_b64_tr_b16 a[206:207], v249 offset:56320
v_mfma_f32_16x16x32_bf16 a[156:159], a[216:219], v[88:91], a[156:159]
s_add_u32 s48, s48, 81920
v_mfma_f32_16x16x32_bf16 a[156:159], a[220:223], v[92:95], a[156:159]
s_waitcnt lgkmcnt(6) vmcnt(54)
v_mfma_f32_16x16x32_bf16 a[80:83], a[192:195], v[96:99], a[80:83]
s_waitcnt lgkmcnt(4) vmcnt(53)
ds_read_b64_tr_b16 a[208:209], v248 offset:41024
ds_read_b64_tr_b16 a[210:211], v248 offset:46144
v_mfma_f32_16x16x32_bf16 a[80:83], a[196:199], v[100:103], a[80:83]
s_waitcnt vmcnt(52)
s_add_u32 m0, s49, 61440
ds_read_b64_tr_b16 a[212:213], v248 offset:51264
ds_read_b64_tr_b16 a[214:215], v248 offset:56384
v_mfma_f32_16x16x32_bf16 a[84:87], a[192:195], v[104:107], a[84:87]
s_waitcnt vmcnt(51)
buffer_load_dwordx4 v49, s[64:67], s48 offen offset:0 lds
v_mfma_f32_16x16x32_bf16 a[84:87], a[196:199], v[108:111], a[84:87]
s_waitcnt lgkmcnt(6)
v_mfma_f32_16x16x32_bf16 a[88:91], a[200:203], v[96:99], a[88:91]
s_waitcnt lgkmcnt(4)
ds_read_b64_tr_b16 a[216:217], v249 offset:41024
ds_read_b64_tr_b16 a[218:219], v249 offset:46144
v_mfma_f32_16x16x32_bf16 a[88:91], a[204:207], v[100:103], a[88:91]
ds_read_b64_tr_b16 a[220:221], v249 offset:51264
ds_read_b64_tr_b16 a[222:223], v249 offset:56384
v_mfma_f32_16x16x32_bf16 a[92:95], a[200:203], v[104:107], a[92:95]
buffer_load_dwordx4 v50, s[64:67], s48 offen offset:1024 lds
v_mfma_f32_16x16x32_bf16 a[92:95], a[204:207], v[108:111], a[92:95]
s_waitcnt lgkmcnt(6)
v_mfma_f32_16x16x32_bf16 a[96:99], a[208:211], v[96:99], a[96:99]
s_waitcnt lgkmcnt(4)
ds_read_b64_tr_b16 a[192:193], v248 offset:41088
ds_read_b64_tr_b16 a[194:195], v248 offset:46208
v_mfma_f32_16x16x32_bf16 a[96:99], a[212:215], v[100:103], a[96:99]
ds_read_b64_tr_b16 a[196:197], v248 offset:51328
ds_read_b64_tr_b16 a[198:199], v248 offset:56448
v_mfma_f32_16x16x32_bf16 a[100:103], a[208:211], v[104:107], a[100:103]
buffer_load_dwordx4 v51, s[64:67], s48 offen offset:2048 lds
v_mfma_f32_16x16x32_bf16 a[100:103], a[212:215], v[108:111], a[100:103]
s_waitcnt lgkmcnt(6)
v_mfma_f32_16x16x32_bf16 a[104:107], a[216:219], v[96:99], a[104:107]
s_waitcnt lgkmcnt(4)
ds_read_b64_tr_b16 a[200:201], v249 offset:41088
ds_read_b64_tr_b16 a[202:203], v249 offset:46208
v_mfma_f32_16x16x32_bf16 a[104:107], a[220:223], v[100:103], a[104:107]
ds_read_b64_tr_b16 a[204:205], v249 offset:51328
ds_read_b64_tr_b16 a[206:207], v249 offset:56448
v_mfma_f32_16x16x32_bf16 a[108:111], a[216:219], v[104:107], a[108:111]
buffer_load_dwordx4 v52, s[64:67], s48 offen offset:3072 lds
v_mfma_f32_16x16x32_bf16 a[108:111], a[220:223], v[108:111], a[108:111]
s_waitcnt lgkmcnt(6)
v_mfma_f32_16x16x32_bf16 a[112:115], a[192:195], v[96:99], a[112:115]
s_waitcnt lgkmcnt(4)
ds_read_b64_tr_b16 a[208:209], v248 offset:41152
ds_read_b64_tr_b16 a[210:211], v248 offset:46272
v_mfma_f32_16x16x32_bf16 a[112:115], a[196:199], v[100:103], a[112:115]
s_add_u32 m0, s49, 65536
ds_read_b64_tr_b16 a[212:213], v248 offset:51392
ds_read_b64_tr_b16 a[214:215], v248 offset:56512
v_mfma_f32_16x16x32_bf16 a[116:119], a[192:195], v[104:107], a[116:119]
buffer_load_dwordx4 v53, s[64:67], s48 offen offset:0 lds
v_mfma_f32_16x16x32_bf16 a[116:119], a[196:199], v[108:111], a[116:119]
s_waitcnt lgkmcnt(6)
v_mfma_f32_16x16x32_bf16 a[120:123], a[200:203], v[96:99], a[120:123]
s_waitcnt lgkmcnt(4)
ds_read_b64_tr_b16 a[216:217], v249 offset:41152
ds_read_b64_tr_b16 a[218:219], v249 offset:46272
v_mfma_f32_16x16x32_bf16 a[120:123], a[204:207], v[100:103], a[120:123]
ds_read_b64_tr_b16 a[220:221], v249 offset:51392
ds_read_b64_tr_b16 a[222:223], v249 offset:56512
v_mfma_f32_16x16x32_bf16 a[124:127], a[200:203], v[104:107], a[124:127]
buffer_load_dwordx4 v[64:67], v58, s[28:31], s51 offen offset:0 sc1
v_mfma_f32_16x16x32_bf16 a[124:127], a[204:207], v[108:111], a[124:127]
s_waitcnt lgkmcnt(6)
v_mfma_f32_16x16x32_bf16 a[128:131], a[208:211], v[96:99], a[128:131]
s_waitcnt lgkmcnt(4)
ds_read_b64_tr_b16 a[192:193], v248 offset:41216
ds_read_b64_tr_b16 a[194:195], v248 offset:46336
v_mfma_f32_16x16x32_bf16 a[128:131], a[212:215], v[100:103], a[128:131]
ds_read_b64_tr_b16 a[196:197], v248 offset:51456
ds_read_b64_tr_b16 a[198:199], v248 offset:56576
v_mfma_f32_16x16x32_bf16 a[132:135], a[208:211], v[104:107], a[132:135]
buffer_load_dwordx4 v[68:71], v58, s[28:31], s51 offen offset:1024 sc1
v_mfma_f32_16x16x32_bf16 a[132:135], a[212:215], v[108:111], a[132:135]
s_waitcnt lgkmcnt(6)
v_mfma_f32_16x16x32_bf16 a[136:139], a[216:219], v[96:99], a[136:139]
s_waitcnt lgkmcnt(4)
ds_read_b64_tr_b16 a[200:201], v249 offset:41216
ds_read_b64_tr_b16 a[202:203], v249 offset:46336
v_mfma_f32_16x16x32_bf16 a[136:139], a[220:223], v[100:103], a[136:139]
ds_read_b64_tr_b16 a[204:205], v249 offset:51456
ds_read_b64_tr_b16 a[206:207], v249 offset:56576
v_mfma_f32_16x16x32_bf16 a[140:143], a[216:219], v[104:107], a[140:143]
buffer_load_dwordx4 v[72:75], v59, s[28:31], s51 offen offset:0 sc1
v_mfma_f32_16x16x32_bf16 a[140:143], a[220:223], v[108:111], a[140:143]
s_waitcnt vmcnt(63)
s_barrier
s_waitcnt lgkmcnt(6)
v_mfma_f32_16x16x32_bf16 a[144:147], a[192:195], v[96:99], a[144:147]
s_waitcnt lgkmcnt(4)
ds_read_b64_tr_b16 a[208:209], v250 offset:0
ds_read_b64_tr_b16 a[210:211], v250 offset:5120
v_mfma_f32_16x16x32_bf16 a[144:147], a[196:199], v[100:103], a[144:147]
ds_read_b64_tr_b16 a[212:213], v250 offset:10240
ds_read_b64_tr_b16 a[214:215], v250 offset:15360
v_mfma_f32_16x16x32_bf16 a[148:151], a[192:195], v[104:107], a[148:151]
buffer_load_dwordx4 v[76:79], v59, s[28:31], s51 offen offset:1024 sc1
v_mfma_f32_16x16x32_bf16 a[148:151], a[196:199], v[108:111], a[148:151]
s_waitcnt lgkmcnt(6)
v_mfma_f32_16x16x32_bf16 a[152:155], a[200:203], v[96:99], a[152:155]
s_waitcnt lgkmcnt(4)
ds_read_b64_tr_b16 a[216:217], v251 offset:0
ds_read_b64_tr_b16 a[218:219], v251 offset:5120
v_mfma_f32_16x16x32_bf16 a[152:155], a[204:207], v[100:103], a[152:155]
s_add_u32 s51, s51, 2048
ds_read_b64_tr_b16 a[220:221], v251 offset:10240
ds_read_b64_tr_b16 a[222:223], v251 offset:15360
v_mfma_f32_16x16x32_bf16 a[156:159], a[200:203], v[104:107], a[156:159]
s_add_u32 s48, s48, 81920
v_mfma_f32_16x16x32_bf16 a[156:159], a[204:207], v[108:111], a[156:159]
s_waitcnt lgkmcnt(6) vmcnt(59)
v_mfma_f32_16x16x32_bf16 a[80:83], a[208:211], v[112:115], a[80:83]
s_waitcnt lgkmcnt(4) vmcnt(58)
ds_read_b64_tr_b16 a[192:193], v250 offset:64
ds_read_b64_tr_b16 a[194:195], v250 offset:5184
v_mfma_f32_16x16x32_bf16 a[80:83], a[212:215], v[116:119], a[80:83]
s_waitcnt vmcnt(57)
s_add_u32 m0, s49, 81920
ds_read_b64_tr_b16 a[196:197], v250 offset:10304
ds_read_b64_tr_b16 a[198:199], v250 offset:15424
v_mfma_f32_16x16x32_bf16 a[84:87], a[208:211], v[120:123], a[84:87]
s_waitcnt vmcnt(56)
buffer_load_dwordx4 v49, s[64:67], s48 offen offset:0 lds
v_mfma_f32_16x16x32_bf16 a[84:87], a[212:215], v[124:127], a[84:87]
s_waitcnt lgkmcnt(6)
v_mfma_f32_16x16x32_bf16 a[88:91], a[216:219], v[112:115], a[88:91]
s_waitcnt lgkmcnt(4)
ds_read_b64_tr_b16 a[200:201], v251 offset:64
ds_read_b64_tr_b16 a[202:203], v251 offset:5184
v_mfma_f32_16x16x32_bf16 a[88:91], a[220:223], v[116:119], a[88:91]
ds_read_b64_tr_b16 a[204:205], v251 offset:10304
ds_read_b64_tr_b16 a[206:207], v251 offset:15424
v_mfma_f32_16x16x32_bf16 a[92:95], a[216:219], v[120:123], a[92:95]
buffer_load_dwordx4 v50, s[64:67], s48 offen offset:1024 lds
v_mfma_f32_16x16x32_bf16 a[92:95], a[220:223], v[124:127], a[92:95]
s_waitcnt lgkmcnt(6)
v_mfma_f32_16x16x32_bf16 a[96:99], a[192:195], v[112:115], a[96:99]
s_waitcnt lgkmcnt(4)
ds_read_b64_tr_b16 a[208:209], v250 offset:128
ds_read_b64_tr_b16 a[210:211], v250 offset:5248
v_mfma_f32_16x16x32_bf16 a[96:99], a[196:199], v[116:119], a[96:99]
ds_read_b64_tr_b16 a[212:213], v250 offset:10368
ds_read_b64_tr_b16 a[214:215], v250 offset:15488
v_mfma_f32_16x16x32_bf16 a[100:103], a[192:195], v[120:123], a[100:103]
buffer_load_dwordx4 v51, s[64:67], s48 offen offset:2048 lds
v_mfma_f32_16x16x32_bf16 a[100:103], a[196:199], v[124:127], a[100:103]
s_waitcnt lgkmcnt(6)
v_mfma_f32_16x16x32_bf16 a[104:107], a[200:203], v[112:115], a[104:107]
s_waitcnt lgkmcnt(4)
ds_read_b64_tr_b16 a[216:217], v251 offset:128
ds_read_b64_tr_b16 a[218:219], v251 offset:5248
v_mfma_f32_16x16x32_bf16 a[104:107], a[204:207], v[116:119], a[104:107]
ds_read_b64_tr_b16 a[220:221], v251 offset:10368
ds_read_b64_tr_b16 a[222:223], v251 offset:15488
v_mfma_f32_16x16x32_bf16 a[108:111], a[200:203], v[120:123], a[108:111]
buffer_load_dwordx4 v52, s[64:67], s48 offen offset:3072 lds
v_mfma_f32_16x16x32_bf16 a[108:111], a[204:207], v[124:127], a[108:111]
s_waitcnt lgkmcnt(6)
v_mfma_f32_16x16x32_bf16 a[112:115], a[208:211], v[112:115], a[112:115]
s_waitcnt lgkmcnt(4)
ds_read_b64_tr_b16 a[192:193], v250 offset:192
ds_read_b64_tr_b16 a[194:195], v250 offset:5312
v_mfma_f32_16x16x32_bf16 a[112:115], a[212:215], v[116:119], a[112:115]
s_add_u32 m0, s49, 86016
ds_read_b64_tr_b16 a[196:197], v250 offset:10432
ds_read_b64_tr_b16 a[198:199], v250 offset:15552
v_mfma_f32_16x16x32_bf16 a[116:119], a[208:211], v[120:123], a[116:119]
buffer_load_dwordx4 v53, s[64:67], s48 offen offset:0 lds
v_mfma_f32_16x16x32_bf16 a[116:119], a[212:215], v[124:127], a[116:119]
s_waitcnt lgkmcnt(6)
v_mfma_f32_16x16x32_bf16 a[120:123], a[216:219], v[112:115], a[120:123]
s_waitcnt lgkmcnt(4)
ds_read_b64_tr_b16 a[200:201], v251 offset:192
ds_read_b64_tr_b16 a[202:203], v251 offset:5312
v_mfma_f32_16x16x32_bf16 a[120:123], a[220:223], v[116:119], a[120:123]
ds_read_b64_tr_b16 a[204:205], v251 offset:10432
ds_read_b64_tr_b16 a[206:207], v251 offset:15552
v_mfma_f32_16x16x32_bf16 a[124:127], a[216:219], v[120:123], a[124:127]
buffer_load_dwordx4 v[80:83], v58, s[28:31], s51 offen offset:0 sc1
v_mfma_f32_16x16x32_bf16 a[124:127], a[220:223], v[124:127], a[124:127]
s_waitcnt lgkmcnt(6)
v_mfma_f32_16x16x32_bf16 a[128:131], a[192:195], v[112:115], a[128:131]
s_waitcnt lgkmcnt(4)
ds_read_b64_tr_b16 a[208:209], v250 offset:256
ds_read_b64_tr_b16 a[210:211], v250 offset:5376
v_mfma_f32_16x16x32_bf16 a[128:131], a[196:199], v[116:119], a[128:131]
ds_read_b64_tr_b16 a[212:213], v250 offset:10496
ds_read_b64_tr_b16 a[214:215], v250 offset:15616
v_mfma_f32_16x16x32_bf16 a[132:135], a[192:195], v[120:123], a[132:135]
buffer_load_dwordx4 v[84:87], v58, s[28:31], s51 offen offset:1024 sc1
v_mfma_f32_16x16x32_bf16 a[132:135], a[196:199], v[124:127], a[132:135]
s_waitcnt lgkmcnt(6)
v_mfma_f32_16x16x32_bf16 a[136:139], a[200:203], v[112:115], a[136:139]
s_waitcnt lgkmcnt(4)
ds_read_b64_tr_b16 a[216:217], v251 offset:256
ds_read_b64_tr_b16 a[218:219], v251 offset:5376
v_mfma_f32_16x16x32_bf16 a[136:139], a[204:207], v[116:119], a[136:139]
ds_read_b64_tr_b16 a[220:221], v251 offset:10496
ds_read_b64_tr_b16 a[222:223], v251 offset:15616
v_mfma_f32_16x16x32_bf16 a[140:143], a[200:203], v[120:123], a[140:143]
s_waitcnt vmcnt(59)
buffer_load_dwordx4 v[88:91], v59, s[28:31], s51 offen offset:0 sc1
v_mfma_f32_16x16x32_bf16 a[140:143], a[204:207], v[124:127], a[140:143]
s_waitcnt vmcnt(56)
s_barrier
s_waitcnt lgkmcnt(6)
v_mfma_f32_16x16x32_bf16 a[144:147], a[208:211], v[112:115], a[144:147]
s_waitcnt lgkmcnt(4)
ds_read_b64_tr_b16 a[192:193], v250 offset:20480
ds_read_b64_tr_b16 a[194:195], v250 offset:25600
v_mfma_f32_16x16x32_bf16 a[144:147], a[212:215], v[116:119], a[144:147]
ds_read_b64_tr_b16 a[196:197], v250 offset:30720
ds_read_b64_tr_b16 a[198:199], v250 offset:35840
v_mfma_f32_16x16x32_bf16 a[148:151], a[208:211], v[120:123], a[148:151]
buffer_load_dwordx4 v[92:95], v59, s[28:31], s51 offen offset:1024 sc1
v_mfma_f32_16x16x32_bf16 a[148:151], a[212:215], v[124:127], a[148:151]
s_waitcnt lgkmcnt(6)
v_mfma_f32_16x16x32_bf16 a[152:155], a[216:219], v[112:115], a[152:155]
s_waitcnt lgkmcnt(4)
ds_read_b64_tr_b16 a[200:201], v251 offset:20480
ds_read_b64_tr_b16 a[202:203], v251 offset:25600
v_mfma_f32_16x16x32_bf16 a[152:155], a[220:223], v[116:119], a[152:155]
s_add_u32 s51, s51, s19
ds_read_b64_tr_b16 a[204:205], v251 offset:30720
ds_read_b64_tr_b16 a[206:207], v251 offset:35840
v_mfma_f32_16x16x32_bf16 a[156:159], a[216:219], v[120:123], a[156:159]
s_add_u32 s48, s48, s22
v_mfma_f32_16x16x32_bf16 a[156:159], a[220:223], v[124:127], a[156:159]
s_waitcnt lgkmcnt(6) vmcnt(56)
v_mfma_f32_16x16x32_bf16 a[80:83], a[192:195], v[128:131], a[80:83]
s_waitcnt lgkmcnt(4) vmcnt(55)
ds_read_b64_tr_b16 a[208:209], v250 offset:20544
ds_read_b64_tr_b16 a[210:211], v250 offset:25664
v_mfma_f32_16x16x32_bf16 a[80:83], a[196:199], v[132:135], a[80:83]
s_waitcnt vmcnt(54)
s_add_u32 m0, s49, 102400
ds_read_b64_tr_b16 a[212:213], v250 offset:30784
ds_read_b64_tr_b16 a[214:215], v250 offset:35904
v_mfma_f32_16x16x32_bf16 a[84:87], a[192:195], v[136:139], a[84:87]
s_waitcnt vmcnt(53)
buffer_load_dwordx4 v49, s[64:67], s48 offen offset:0 lds
v_mfma_f32_16x16x32_bf16 a[84:87], a[196:199], v[140:143], a[84:87]
s_waitcnt lgkmcnt(6)
v_mfma_f32_16x16x32_bf16 a[88:91], a[200:203], v[128:131], a[88:91]
s_waitcnt lgkmcnt(4)
ds_read_b64_tr_b16 a[216:217], v251 offset:20544
ds_read_b64_tr_b16 a[218:219], v251 offset:25664
v_mfma_f32_16x16x32_bf16 a[88:91], a[204:207], v[132:135], a[88:91]
ds_read_b64_tr_b16 a[220:221], v251 offset:30784
ds_read_b64_tr_b16 a[222:223], v251 offset:35904
v_mfma_f32_16x16x32_bf16 a[92:95], a[200:203], v[136:139], a[92:95]
buffer_load_dwordx4 v50, s[64:67], s48 offen offset:1024 lds
v_mfma_f32_16x16x32_bf16 a[92:95], a[204:207], v[140:143], a[92:95]
s_waitcnt lgkmcnt(6)
v_mfma_f32_16x16x32_bf16 a[96:99], a[208:211], v[128:131], a[96:99]
s_waitcnt lgkmcnt(4)
ds_read_b64_tr_b16 a[192:193], v250 offset:20608
ds_read_b64_tr_b16 a[194:195], v250 offset:25728
v_mfma_f32_16x16x32_bf16 a[96:99], a[212:215], v[132:135], a[96:99]
ds_read_b64_tr_b16 a[196:197], v250 offset:30848
ds_read_b64_tr_b16 a[198:199], v250 offset:35968
v_mfma_f32_16x16x32_bf16 a[100:103], a[208:211], v[136:139], a[100:103]
buffer_load_dwordx4 v51, s[64:67], s48 offen offset:2048 lds
v_mfma_f32_16x16x32_bf16 a[100:103], a[212:215], v[140:143], a[100:103]
s_waitcnt lgkmcnt(6)
v_mfma_f32_16x16x32_bf16 a[104:107], a[216:219], v[128:131], a[104:107]
s_waitcnt lgkmcnt(4)
ds_read_b64_tr_b16 a[200:201], v251 offset:20608
ds_read_b64_tr_b16 a[202:203], v251 offset:25728
v_mfma_f32_16x16x32_bf16 a[104:107], a[220:223], v[132:135], a[104:107]
ds_read_b64_tr_b16 a[204:205], v251 offset:30848
ds_read_b64_tr_b16 a[206:207], v251 offset:35968
v_mfma_f32_16x16x32_bf16 a[108:111], a[216:219], v[136:139], a[108:111]
buffer_load_dwordx4 v52, s[64:67], s48 offen offset:3072 lds
v_mfma_f32_16x16x32_bf16 a[108:111], a[220:223], v[140:143], a[108:111]
s_waitcnt lgkmcnt(6)
v_mfma_f32_16x16x32_bf16 a[112:115], a[192:195], v[128:131], a[112:115]
s_waitcnt lgkmcnt(4)
ds_read_b64_tr_b16 a[208:209], v250 offset:20672
ds_read_b64_tr_b16 a[210:211], v250 offset:25792
v_mfma_f32_16x16x32_bf16 a[112:115], a[196:199], v[132:135], a[112:115]
s_add_u32 m0, s49, 106496
ds_read_b64_tr_b16 a[212:213], v250 offset:30912
ds_read_b64_tr_b16 a[214:215], v250 offset:36032
v_mfma_f32_16x16x32_bf16 a[116:119], a[192:195], v[136:139], a[116:119]
buffer_load_dwordx4 v53, s[64:67], s48 offen offset:0 lds
v_mfma_f32_16x16x32_bf16 a[116:119], a[196:199], v[140:143], a[116:119]
s_waitcnt vmcnt(45)
v_cmp_eq_u32 vcc, 0, v63
s_nop 1
s_cbranch_vccnz L_of2
L_of2_b:
s_waitcnt lgkmcnt(6)
v_mfma_f32_16x16x32_bf16 a[120:123], a[200:203], v[128:131], a[120:123]
s_waitcnt lgkmcnt(4)
ds_read_b64_tr_b16 a[216:217], v251 offset:20672
ds_read_b64_tr_b16 a[218:219], v251 offset:25792
v_mfma_f32_16x16x32_bf16 a[120:123], a[204:207], v[132:135], a[120:123]
ds_read_b64_tr_b16 a[220:221], v251 offset:30912
ds_read_b64_tr_b16 a[222:223], v251 offset:36032
v_mfma_f32_16x16x32_bf16 a[124:127], a[200:203], v[136:139], a[124:127]
buffer_load_dwordx4 v[96:99], v58, s[28:31], s51 offen offset:0 sc1
v_mfma_f32_16x16x32_bf16 a[124:127], a[204:207], v[140:143], a[124:127]
s_waitcnt lgkmcnt(6)
v_mfma_f32_16x16x32_bf16 a[128:131], a[208:211], v[128:131], a[128:131]
s_waitcnt lgkmcnt(4)
ds_read_b64_tr_b16 a[192:193], v250 offset:20736
ds_read_b64_tr_b16 a[194:195], v250 offset:25856
v_mfma_f32_16x16x32_bf16 a[128:131], a[212:215], v[132:135], a[128:131]
ds_read_b64_tr_b16 a[196:197], v250 offset:30976
ds_read_b64_tr_b16 a[198:199], v250 offset:36096
v_mfma_f32_16x16x32_bf16 a[132:135], a[208:211], v[136:139], a[132:135]
buffer_load_dwordx4 v[100:103], v58, s[28:31], s51 offen offset:1024 sc1
v_mfma_f32_16x16x32_bf16 a[132:135], a[212:215], v[140:143], a[132:135]
s_waitcnt lgkmcnt(6)
v_mfma_f32_16x16x32_bf16 a[136:139], a[216:219], v[128:131], a[136:139]
s_waitcnt lgkmcnt(4)
ds_read_b64_tr_b16 a[200:201], v251 offset:20736
ds_read_b64_tr_b16 a[202:203], v251 offset:25856
v_mfma_f32_16x16x32_bf16 a[136:139], a[220:223], v[132:135], a[136:139]
ds_read_b64_tr_b16 a[204:205], v251 offset:30976
ds_read_b64_tr_b16 a[206:207], v251 offset:36096
v_mfma_f32_16x16x32_bf16 a[140:143], a[216:219], v[136:139], a[140:143]
buffer_load_dwordx4 v[104:107], v59, s[28:31], s51 offen offset:0 sc1
v_mfma_f32_16x16x32_bf16 a[140:143], a[220:223], v[140:143], a[140:143]
s_waitcnt vmcnt(53)
s_barrier
s_waitcnt lgkmcnt(6)
v_mfma_f32_16x16x32_bf16 a[144:147], a[192:195], v[128:131], a[144:147]
s_waitcnt lgkmcnt(4)
ds_read_b64_tr_b16 a[208:209], v54 offset:0
ds_read_b64_tr_b16 a[210:211], v54 offset:5120
v_mfma_f32_16x16x32_bf16 a[144:147], a[196:199], v[132:135], a[144:147]
ds_read_b64_tr_b16 a[212:213], v54 offset:10240
ds_read_b64_tr_b16 a[214:215], v54 offset:15360
v_mfma_f32_16x16x32_bf16 a[148:151], a[192:195], v[136:139], a[148:151]
buffer_load_dwordx4 v[108:111], v59, s[28:31], s51 offen offset:1024 sc1
v_mfma_f32_16x16x32_bf16 a[148:151], a[196:199], v[140:143], a[148:151]
s_waitcnt lgkmcnt(6)
v_mfma_f32_16x16x32_bf16 a[152:155], a[200:203], v[128:131], a[152:155]
s_waitcnt lgkmcnt(4)
ds_read_b64_tr_b16 a[216:217], v55 offset:0
ds_read_b64_tr_b16 a[218:219], v55 offset:5120
v_mfma_f32_16x16x32_bf16 a[152:155], a[204:207], v[132:135], a[152:155]
s_add_u32 s51, s51, 2048
ds_read_b64_tr_b16 a[220:221], v55 offset:10240
ds_read_b64_tr_b16 a[222:223], v55 offset:15360
v_mfma_f32_16x16x32_bf16 a[156:159], a[200:203], v[136:139], a[156:159]
s_add_u32 s48, s48, 81920
v_mfma_f32_16x16x32_bf16 a[156:159], a[204:207], v[140:143], a[156:159]
s_waitcnt lgkmcnt(6)
v_mfma_f32_16x16x32_bf16 a[80:83], a[208:211], v[144:147], a[80:83]
s_waitcnt lgkmcnt(4)
ds_read_b64_tr_b16 a[192:193], v54 offset:64
ds_read_b64_tr_b16 a[194:195], v54 offset:5184
v_mfma_f32_16x16x32_bf16 a[80:83], a[212:215], v[148:151], a[80:83]
s_add_u32 m0, s49, 122880
ds_read_b64_tr_b16 a[196:197], v54 offset:10304
ds_read_b64_tr_b16 a[198:199], v54 offset:15424
v_mfma_f32_16x16x32_bf16 a[84:87], a[208:211], v[152:155], a[84:87]
buffer_load_dwordx4 v49, s[64:67], s48 offen offset:0 lds
v_mfma_f32_16x16x32_bf16 a[84:87], a[212:215], v[156:159], a[84:87]
s_waitcnt lgkmcnt(6)
v_mfma_f32_16x16x32_bf16 a[88:91], a[216:219], v[144:147], a[88:91]
s_waitcnt lgkmcnt(4)
ds_read_b64_tr_b16 a[200:201], v55 offset:64
ds_read_b64_tr_b16 a[202:203], v55 offset:5184
v_mfma_f32_16x16x32_bf16 a[88:91], a[220:223], v[148:151], a[88:91]
ds_read_b64_tr_b16 a[204:205], v55 offset:10304
ds_read_b64_tr_b16 a[206:207], v55 offset:15424
v_mfma_f32_16x16x32_bf16 a[92:95], a[216:219], v[152:155], a[92:95]
buffer_load_dwordx4 v50, s[64:67], s48 offen offset:1024 lds
v_mfma_f32_16x16x32_bf16 a[92:95], a[220:223], v[156:159], a[92:95]
s_waitcnt lgkmcnt(6)
v_mfma_f32_16x16x32_bf16 a[96:99], a[192:195], v[144:147], a[96:99]
s_waitcnt lgkmcnt(4)
ds_read_b64_tr_b16 a[208:209], v54 offset:128
ds_read_b64_tr_b16 a[210:211], v54 offset:5248
v_mfma_f32_16x16x32_bf16 a[96:99], a[196:199], v[148:151], a[96:99]
ds_read_b64_tr_b16 a[212:213], v54 offset:10368
ds_read_b64_tr_b16 a[214:215], v54 offset:15488
v_mfma_f32_16x16x32_bf16 a[100:103], a[192:195], v[152:155], a[100:103]
buffer_load_dwordx4 v51, s[64:67], s48 offen offset:2048 lds
v_mfma_f32_16x16x32_bf16 a[100:103], a[196:199], v[156:159], a[100:103]
s_waitcnt lgkmcnt(6)
v_mfma_f32_16x16x32_bf16 a[104:107], a[200:203], v[144:147], a[104:107]
s_waitcnt lgkmcnt(4)
ds_read_b64_tr_b16 a[216:217], v55 offset:128
ds_read_b64_tr_b16 a[218:219], v55 offset:5248
v_mfma_f32_16x16x32_bf16 a[104:107], a[204:207], v[148:151], a[104:107]
ds_read_b64_tr_b16 a[220:221], v55 offset:10368
ds_read_b64_tr_b16 a[222:223], v55 offset:15488
v_mfma_f32_16x16x32_bf16 a[108:111], a[200:203], v[152:155], a[108:111]
buffer_load_dwordx4 v52, s[64:67], s48 offen offset:3072 lds
v_mfma_f32_16x16x32_bf16 a[108:111], a[204:207], v[156:159], a[108:111]
s_waitcnt lgkmcnt(6)
v_mfma_f32_16x16x32_bf16 a[112:115], a[208:211], v[144:147], a[112:115]
s_waitcnt lgkmcnt(4)
ds_read_b64_tr_b16 a[192:193], v54 offset:192
ds_read_b64_tr_b16 a[194:195], v54 offset:5312
v_mfma_f32_16x16x32_bf16 a[112:115], a[212:215], v[148:151], a[112:115]
s_add_u32 m0, s49, 126976
ds_read_b64_tr_b16 a[196:197], v54 offset:10432
ds_read_b64_tr_b16 a[198:199], v54 offset:15552
v_mfma_f32_16x16x32_bf16 a[116:119], a[208:211], v[152:155], a[116:119]
buffer_load_dwordx4 v53, s[64:67], s48 offen offset:0 lds
v_mfma_f32_16x16x32_bf16 a[116:119], a[212:215], v[156:159], a[116:119]
s_waitcnt lgkmcnt(6)
v_mfma_f32_16x16x32_bf16 a[120:123], a[216:219], v[144:147], a[120:123]
s_waitcnt lgkmcnt(4)
ds_read_b64_tr_b16 a[200:201], v55 offset:192
ds_read_b64_tr_b16 a[202:203], v55 offset:5312
v_mfma_f32_16x16x32_bf16 a[120:123], a[220:223], v[148:151], a[120:123]
ds_read_b64_tr_b16 a[204:205], v55 offset:10432
ds_read_b64_tr_b16 a[206:207], v55 offset:15552
v_mfma_f32_16x16x32_bf16 a[124:127], a[216:219], v[152:155], a[124:127]
buffer_load_dwordx4 v[112:115], v58, s[28:31], s51 offen offset:0 sc1
v_mfma_f32_16x16x32_bf16 a[124:127], a[220:223], v[156:159], a[124:127]
s_waitcnt lgkmcnt(6)
v_mfma_f32_16x16x32_bf16 a[128:131], a[192:195], v[144:147], a[128:131]
s_waitcnt lgkmcnt(4)
ds_read_b64_tr_b16 a[208:209], v54 offset:256
ds_read_b64_tr_b16 a[210:211], v54 offset:5376
v_mfma_f32_16x16x32_bf16 a[128:131], a[196:199], v[148:151], a[128:131]
ds_read_b64_tr_b16 a[212:213], v54 offset:10496
ds_read_b64_tr_b16 a[214:215], v54 offset:15616
v_mfma_f32_16x16x32_bf16 a[132:135], a[192:195], v[152:155], a[132:135]
buffer_load_dwordx4 v[116:119], v58, s[28:31], s51 offen offset:1024 sc1
v_mfma_f32_16x16x32_bf16 a[132:135], a[196:199], v[156:159], a[132:135]
s_waitcnt lgkmcnt(6)
v_mfma_f32_16x16x32_bf16 a[136:139], a[200:203], v[144:147], a[136:139]
s_waitcnt lgkmcnt(4)
ds_read_b64_tr_b16 a[216:217], v55 offset:256
ds_read_b64_tr_b16 a[218:219], v55 offset:5376
v_mfma_f32_16x16x32_bf16 a[136:139], a[204:207], v[148:151], a[136:139]
ds_read_b64_tr_b16 a[220:221], v55 offset:10496
ds_read_b64_tr_b16 a[222:223], v55 offset:15616
v_mfma_f32_16x16x32_bf16 a[140:143], a[200:203], v[152:155], a[140:143]
buffer_load_dwordx4 v[120:123], v59, s[28:31], s51 offen offset:0 sc1
v_mfma_f32_16x16x32_bf16 a[140:143], a[204:207], v[156:159], a[140:143]
s_waitcnt vmcnt(49)
s_barrier
s_waitcnt lgkmcnt(6)
v_mfma_f32_16x16x32_bf16 a[144:147], a[208:211], v[144:147], a[144:147]
s_waitcnt lgkmcnt(4)
ds_read_b64_tr_b16 a[192:193], v54 offset:20480
ds_read_b64_tr_b16 a[194:195], v54 offset:25600
v_mfma_f32_16x16x32_bf16 a[144:147], a[212:215], v[148:151], a[144:147]
ds_read_b64_tr_b16 a[196:197], v54 offset:30720
ds_read_b64_tr_b16 a[198:199], v54 offset:35840
v_mfma_f32_16x16x32_bf16 a[148:151], a[208:211], v[152:155], a[148:151]
buffer_load_dwordx4 v[124:127], v59, s[28:31], s51 offen offset:1024 sc1
v_mfma_f32_16x16x32_bf16 a[148:151], a[212:215], v[156:159], a[148:151]
s_waitcnt lgkmcnt(6)
v_mfma_f32_16x16x32_bf16 a[152:155], a[216:219], v[144:147], a[152:155]
s_waitcnt lgkmcnt(4)
ds_read_b64_tr_b16 a[200:201], v55 offset:20480
ds_read_b64_tr_b16 a[202:203], v55 offset:25600
v_mfma_f32_16x16x32_bf16 a[152:155], a[220:223], v[148:151], a[152:155]
s_add_u32 s51, s51, 2048
ds_read_b64_tr_b16 a[204:205], v55 offset:30720
ds_read_b64_tr_b16 a[206:207], v55 offset:35840
v_mfma_f32_16x16x32_bf16 a[156:159], a[216:219], v[152:155], a[156:159]
s_add_u32 s48, s48, 81920
v_mfma_f32_16x16x32_bf16 a[156:159], a[220:223], v[156:159], a[156:159]
s_waitcnt vmcnt(45)
v_cmp_eq_u32 vcc, 0, v14
s_nop 1
s_cbranch_vccnz L_tb
L_tb_b:
s_waitcnt lgkmcnt(6)
v_mfma_f32_16x16x32_bf16 a[80:83], a[192:195], v[160:163], a[80:83]
s_waitcnt lgkmcnt(4)
ds_read_b64_tr_b16 a[208:209], v54 offset:20544
ds_read_b64_tr_b16 a[210:211], v54 offset:25664
s_and_b32 s8, s2, 7
s_xor_b32 s9, s8, 1
v_mfma_f32_16x16x32_bf16 a[80:83], a[196:199], v[164:167], a[80:83]
s_add_u32 m0, s49, 143360
ds_read_b64_tr_b16 a[212:213], v54 offset:30784
ds_read_b64_tr_b16 a[214:215], v54 offset:35904
s_xor_b32 s10, s8, 4
s_xor_b32 s11, s8, 5
v_mfma_f32_16x16x32_bf16 a[84:87], a[192:195], v[168:171], a[84:87]
buffer_load_dwordx4 v49, s[64:67], s48 offen offset:0 lds
v_mfma_f32_16x16x32_bf16 a[84:87], a[196:199], v[172:175], a[84:87]
s_waitcnt lgkmcnt(6)
v_readlane_b32 s12, v14, s8
v_readlane_b32 s13, v14, s9
v_mfma_f32_16x16x32_bf16 a[88:91], a[200:203], v[160:163], a[88:91]
s_waitcnt lgkmcnt(4)
ds_read_b64_tr_b16 a[216:217], v55 offset:20544
ds_read_b64_tr_b16 a[218:219], v55 offset:25664
v_mfma_f32_16x16x32_bf16 a[88:91], a[204:207], v[164:167], a[88:91]
ds_read_b64_tr_b16 a[220:221], v55 offset:30784
ds_read_b64_tr_b16 a[222:223], v55 offset:35904
v_mfma_f32_16x16x32_bf16 a[92:95], a[200:203], v[168:171], a[92:95]
buffer_load_dwordx4 v50, s[64:67], s48 offen offset:1024 lds
v_mfma_f32_16x16x32_bf16 a[92:95], a[204:207], v[172:175], a[92:95]
s_waitcnt vmcnt(53) lgkmcnt(6)
buffer_store_dword v16, off, s[60:63], s89 sc1
v_mfma_f32_16x16x32_bf16 a[96:99], a[208:211], v[160:163], a[96:99]
s_waitcnt lgkmcnt(4)
ds_read_b64_tr_b16 a[192:193], v54 offset:20608
ds_read_b64_tr_b16 a[194:195], v54 offset:25728
v_mfma_f32_16x16x32_bf16 a[96:99], a[212:215], v[164:167], a[96:99]
ds_read_b64_tr_b16 a[196:197], v54 offset:30848
ds_read_b64_tr_b16 a[198:199], v54 offset:35968
v_mfma_f32_16x16x32_bf16 a[100:103], a[208:211], v[168:171], a[100:103]
buffer_load_dwordx4 v51, s[64:67], s48 offen offset:2048 lds
v_mfma_f32_16x16x32_bf16 a[100:103], a[212:215], v[172:175], a[100:103]
s_waitcnt lgkmcnt(6)
v_readlane_b32 s14, v14, s10
v_readlane_b32 s15, v14, s11
s_nop 2
s_sub_u32 s13, s13, s12
s_lshl_b32 s13, s13, 3
v_mfma_f32_16x16x32_bf16 a[104:107], a[216:219], v[160:163], a[104:107]
s_waitcnt lgkmcnt(4)
ds_read_b64_tr_b16 a[200:201], v55 offset:20608
ds_read_b64_tr_b16 a[202:203], v55 offset:25728
s_add_u32 s13, s13, s9
s_sub_u32 s14, s14, s12
v_mfma_f32_16x16x32_bf16 a[104:107], a[220:223], v[164:167], a[104:107]
ds_read_b64_tr_b16 a[204:205], v55 offset:30848
ds_read_b64_tr_b16 a[206:207], v55 offset:35968
s_lshl_b32 s14, s14, 3
s_add_u32 s14, s14, s10
v_mfma_f32_16x16x32_bf16 a[108:111], a[216:219], v[168:171], a[108:111]
buffer_load_dwordx4 v52, s[64:67], s48 offen offset:3072 lds
s_sub_u32 s15, s15, s12
s_lshl_b32 s15, s15, 3
v_mfma_f32_16x16x32_bf16 a[108:111], a[220:223], v[172:175], a[108:111]
s_waitcnt lgkmcnt(6)
s_add_u32 s15, s15, s11
s_mov_b32 s12, s8
v_mfma_f32_16x16x32_bf16 a[112:115], a[192:195], v[160:163], a[112:115]
s_waitcnt lgkmcnt(4)
ds_read_b64_tr_b16 a[208:209], v54 offset:20672
ds_read_b64_tr_b16 a[210:211], v54 offset:25792
s_mov_b32 s40, 0
s_cmp_lt_i32 s13, s12
s_addc_u32 s40, s40, 0
v_mfma_f32_16x16x32_bf16 a[112:115], a[196:199], v[164:167], a[112:115]
s_add_u32 m0, s49, 147456
ds_read_b64_tr_b16 a[212:213], v54 offset:30912
ds_read_b64_tr_b16 a[214:215], v54 offset:36032
s_cmp_lt_i32 s14, s12
s_addc_u32 s40, s40, 0
s_cmp_lt_i32 s15, s12
s_addc_u32 s40, s40, 0
v_mfma_f32_16x16x32_bf16 a[116:119], a[192:195], v[168:171], a[116:119]
buffer_load_dwordx4 v53, s[64:67], s48 offen offset:0 lds
s_mov_b32 s41, 0
s_cmp_lt_i32 s12, s13
s_addc_u32 s41, s41, 0
v_mfma_f32_16x16x32_bf16 a[116:119], a[196:199], v[172:175], a[116:119]
s_waitcnt lgkmcnt(6)
s_cmp_lt_i32 s14, s13
s_addc_u32 s41, s41, 0
s_cmp_lt_i32 s15, s13
s_addc_u32 s41, s41, 0
v_mfma_f32_16x16x32_bf16 a[120:123], a[200:203], v[160:163], a[120:123]
s_waitcnt lgkmcnt(4)
ds_read_b64_tr_b16 a[216:217], v55 offset:20672
ds_read_b64_tr_b16 a[218:219], v55 offset:25792
s_mov_b32 s42, 0
s_cmp_lt_i32 s12, s14
s_addc_u32 s42, s42, 0
v_mfma_f32_16x16x32_bf16 a[120:123], a[204:207], v[164:167], a[120:123]
ds_read_b64_tr_b16 a[220:221], v55 offset:30912
ds_read_b64_tr_b16 a[222:223], v55 offset:36032
s_cmp_lt_i32 s13, s14
s_addc_u32 s42, s42, 0
s_cmp_lt_i32 s15, s14
s_addc_u32 s42, s42, 0
v_mfma_f32_16x16x32_bf16 a[124:127], a[200:203], v[168:171], a[124:127]
buffer_load_dwordx4 v[128:131], v58, s[28:31], s51 offen offset:0 sc1
s_mov_b32 s43, 0
s_cmp_lt_i32 s12, s15
s_addc_u32 s43, s43, 0
v_mfma_f32_16x16x32_bf16 a[124:127], a[204:207], v[172:175], a[124:127]
s_waitcnt lgkmcnt(6)
s_cmp_lt_i32 s13, s15
s_addc_u32 s43, s43, 0
s_cmp_lt_i32 s14, s15
s_addc_u32 s43, s43, 0
v_mfma_f32_16x16x32_bf16 a[128:131], a[208:211], v[160:163], a[128:131]
s_waitcnt lgkmcnt(4)
ds_read_b64_tr_b16 a[192:193], v54 offset:20736
ds_read_b64_tr_b16 a[194:195], v54 offset:25856
s_sub_u32 s44, 3, s40
s_mov_b32 s17, s13
v_mfma_f32_16x16x32_bf16 a[128:131], a[212:215], v[164:167], a[128:131]
ds_read_b64_tr_b16 a[196:197], v54 offset:30976
ds_read_b64_tr_b16 a[198:199], v54 offset:36096
s_cmp_eq_u32 s42, s44
s_cselect_b32 s17, s14, s17
s_cmp_eq_u32 s43, s44
s_cselect_b32 s17, s15, s17
v_mfma_f32_16x16x32_bf16 a[132:135], a[208:211], v[168:171], a[132:135]
buffer_load_dwordx4 v[132:135], v58, s[28:31], s51 offen offset:1024 sc1
s_ashr_i32 s18, s17, 3
s_abs_i32 s18, s18
v_mfma_f32_16x16x32_bf16 a[132:135], a[212:215], v[172:175], a[132:135]
s_waitcnt lgkmcnt(6)
s_min_u32 s18, s18, 2000
s_mul_i32 s18, s18, 697
v_mfma_f32_16x16x32_bf16 a[136:139], a[216:219], v[160:163], a[136:139]
s_waitcnt lgkmcnt(4)
ds_read_b64_tr_b16 a[200:201], v55 offset:20736
ds_read_b64_tr_b16 a[202:203], v55 offset:25856
s_add_u32 s18, s18, 32768
s_lshr_b32 s18, s18, 16
v_mfma_f32_16x16x32_bf16 a[136:139], a[220:223], v[164:167], a[136:139]
ds_read_b64_tr_b16 a[204:205], v55 offset:30976
ds_read_b64_tr_b16 a[206:207], v55 offset:36096
s_min_u32 s18, s18, 6
s_and_b32 s17, s17, 7
v_mfma_f32_16x16x32_bf16 a[140:143], a[216:219], v[168:171], a[140:143]
buffer_load_dwordx4 v[136:139], v59, s[28:31], s51 offen offset:0 sc1
s_xor_b32 s17, s17, 2
s_xor_b32 s16, s8, 2
v_mfma_f32_16x16x32_bf16 a[140:143], a[220:223], v[172:175], a[140:143]
s_waitcnt vmcnt(49)
s_barrier
s_sub_u32 s16, s17, s16
s_mul_i32 s16, s16, 12
s_waitcnt lgkmcnt(6)
v_mfma_f32_16x16x32_bf16 a[144:147], a[192:195], v[160:163], a[144:147]
s_waitcnt lgkmcnt(4)
ds_read_b64_tr_b16 a[208:209], v54 offset:40960
ds_read_b64_tr_b16 a[210:211], v54 offset:46080
s_add_u32 s16, s16, 1
s_sub_u32 s16, s16, s18
v_mfma_f32_16x16x32_bf16 a[144:147], a[196:199], v[164:167], a[144:147]
ds_read_b64_tr_b16 a[212:213], v54 offset:51200
ds_read_b64_tr_b16 a[214:215], v54 offset:56320
s_mul_i32 s23, s16, 81920
s_lshl_b32 s16, s16, 11
v_mfma_f32_16x16x32_bf16 a[148:151], a[192:195], v[168:171], a[148:151]
buffer_load_dwordx4 v[140:143], v59, s[28:31], s51 offen offset:1024 sc1
s_sub_u32 s20, 30, s18
s_add_u32 s41, 30, s18
v_mfma_f32_16x16x32_bf16 a[148:151], a[196:199], v[172:175], a[148:151]
s_waitcnt lgkmcnt(6)
s_cmp_lt_u32 s40, 2
s_cselect_b32 s20, s41, s20
s_lshr_b32 s41, s17, 1
v_mfma_f32_16x16x32_bf16 a[152:155], a[200:203], v[160:163], a[152:155]
s_waitcnt lgkmcnt(4)
ds_read_b64_tr_b16 a[216:217], v55 offset:40960
ds_read_b64_tr_b16 a[218:219], v55 offset:46080
s_lshl_b32 s41, s41, 7
s_and_b32 s17, s17, 1
v_mfma_f32_16x16x32_bf16 a[152:155], a[204:207], v[164:167], a[152:155]
s_add_u32 s51, s51, 2048
ds_read_b64_tr_b16 a[220:221], v55 offset:51200
ds_read_b64_tr_b16 a[222:223], v55 offset:56320
s_lshl_b32 s17, s17, 5
s_add_u32 s41, s41, s17
v_mfma_f32_16x16x32_bf16 a[156:159], a[200:203], v[168:171], a[156:159]
s_add_u32 s48, s48, 81920
s_add_u32 s41, s41, 16
v_add_u32 v29, s41, v56
s_cmp_gt_u32 s20, 30
s_cselect_b64 vcc, -1, 0
s_nop 1
v_cndmask_b32 v29, v3, v29, vcc
v_mfma_f32_16x16x32_bf16 a[156:159], a[204:207], v[172:175], a[156:159]
s_waitcnt lgkmcnt(6) vmcnt(49)
v_mfma_f32_16x16x32_bf16 a[80:83], a[208:211], v[176:179], a[80:83]
s_waitcnt lgkmcnt(4) vmcnt(48)
ds_read_b64_tr_b16 a[192:193], v54 offset:41024
ds_read_b64_tr_b16 a[194:195], v54 offset:46144
v_mfma_f32_16x16x32_bf16 a[80:83], a[212:215], v[180:183], a[80:83]
s_waitcnt vmcnt(47)
s_add_u32 m0, s49, 0
ds_read_b64_tr_b16 a[196:197], v54 offset:51264
ds_read_b64_tr_b16 a[198:199], v54 offset:56384
v_mfma_f32_16x16x32_bf16 a[84:87], a[208:211], v[184:187], a[84:87]
s_waitcnt vmcnt(46)
buffer_load_dwordx4 v49, s[64:67], s48 offen offset:0 lds
v_mfma_f32_16x16x32_bf16 a[84:87], a[212:215], v[188:191], a[84:87]
s_waitcnt lgkmcnt(6)
v_mfma_f32_16x16x32_bf16 a[88:91], a[216:219], v[176:179], a[88:91]
s_waitcnt lgkmcnt(4)
ds_read_b64_tr_b16 a[200:201], v55 offset:41024
ds_read_b64_tr_b16 a[202:203], v55 offset:46144
v_mfma_f32_16x16x32_bf16 a[88:91], a[220:223], v[180:183], a[88:91]
ds_read_b64_tr_b16 a[204:205], v55 offset:51264
ds_read_b64_tr_b16 a[206:207], v55 offset:56384
v_mfma_f32_16x16x32_bf16 a[92:95], a[216:219], v[184:187], a[92:95]
buffer_load_dwordx4 v50, s[64:67], s48 offen offset:1024 lds
v_mfma_f32_16x16x32_bf16 a[92:95], a[220:223], v[188:191], a[92:95]
s_waitcnt lgkmcnt(6)
v_mfma_f32_16x16x32_bf16 a[96:99], a[192:195], v[176:179], a[96:99]
s_waitcnt lgkmcnt(4)
ds_read_b64_tr_b16 a[208:209], v54 offset:41088
ds_read_b64_tr_b16 a[210:211], v54 offset:46208
v_mfma_f32_16x16x32_bf16 a[96:99], a[196:199], v[180:183], a[96:99]
ds_read_b64_tr_b16 a[212:213], v54 offset:51328
ds_read_b64_tr_b16 a[214:215], v54 offset:56448
v_mfma_f32_16x16x32_bf16 a[100:103], a[192:195], v[184:187], a[100:103]
buffer_load_dwordx4 v51, s[64:67], s48 offen offset:2048 lds
v_mfma_f32_16x16x32_bf16 a[100:103], a[196:199], v[188:191], a[100:103]
s_waitcnt lgkmcnt(6)
v_mfma_f32_16x16x32_bf16 a[104:107], a[200:203], v[176:179], a[104:107]
s_waitcnt lgkmcnt(4)
ds_read_b64_tr_b16 a[216:217], v55 offset:41088
ds_read_b64_tr_b16 a[218:219], v55 offset:46208
v_mfma_f32_16x16x32_bf16 a[104:107], a[204:207], v[180:183], a[104:107]
ds_read_b64_tr_b16 a[220:221], v55 offset:51328
ds_read_b64_tr_b16 a[222:223], v55 offset:56448
v_mfma_f32_16x16x32_bf16 a[108:111], a[200:203], v[184:187], a[108:111]
buffer_load_dwordx4 v52, s[64:67], s48 offen offset:3072 lds
v_mfma_f32_16x16x32_bf16 a[108:111], a[204:207], v[188:191], a[108:111]
s_waitcnt lgkmcnt(6)
v_mfma_f32_16x16x32_bf16 a[112:115], a[208:211], v[176:179], a[112:115]
s_waitcnt lgkmcnt(4)
ds_read_b64_tr_b16 a[192:193], v54 offset:41152
ds_read_b64_tr_b16 a[194:195], v54 offset:46272
v_mfma_f32_16x16x32_bf16 a[112:115], a[212:215], v[180:183], a[112:115]
s_add_u32 m0, s49, 4096
ds_read_b64_tr_b16 a[196:197], v54 offset:51392
ds_read_b64_tr_b16 a[198:199], v54 offset:56512
v_mfma_f32_16x16x32_bf16 a[116:119], a[208:211], v[184:187], a[116:119]
buffer_load_dwordx4 v53, s[64:67], s48 offen offset:0 lds
v_mfma_f32_16x16x32_bf16 a[116:119], a[212:215], v[188:191], a[116:119]
s_waitcnt lgkmcnt(6)
v_mfma_f32_16x16x32_bf16 a[120:123], a[216:219], v[176:179], a[120:123]
s_waitcnt lgkmcnt(4)
ds_read_b64_tr_b16 a[200:201], v55 offset:41152
ds_read_b64_tr_b16 a[202:203], v55 offset:46272
v_mfma_f32_16x16x32_bf16 a[120:123], a[220:223], v[180:183], a[120:123]
ds_read_b64_tr_b16 a[204:205], v55 offset:51392
ds_read_b64_tr_b16 a[206:207], v55 offset:56512
v_mfma_f32_16x16x32_bf16 a[124:127], a[216:219], v[184:187], a[124:127]
buffer_load_dwordx4 v[144:147], v58, s[28:31], s51 offen offset:0 sc1
v_mfma_f32_16x16x32_bf16 a[124:127], a[220:223], v[188:191], a[124:127]
s_waitcnt lgkmcnt(6)
v_mfma_f32_16x16x32_bf16 a[128:131], a[192:195], v[176:179], a[128:131]
s_waitcnt lgkmcnt(4)
ds_read_b64_tr_b16 a[208:209], v54 offset:41216
ds_read_b64_tr_b16 a[210:211], v54 offset:46336
v_mfma_f32_16x16x32_bf16 a[128:131], a[196:199], v[180:183], a[128:131]
ds_read_b64_tr_b16 a[212:213], v54 offset:51456
ds_read_b64_tr_b16 a[214:215], v54 offset:56576
v_mfma_f32_16x16x32_bf16 a[132:135], a[192:195], v[184:187], a[132:135]
buffer_load_dwordx4 v[148:151], v58, s[28:31], s51 offen offset:1024 sc1
v_mfma_f32_16x16x32_bf16 a[132:135], a[196:199], v[188:191], a[132:135]
s_waitcnt lgkmcnt(6)
v_mfma_f32_16x16x32_bf16 a[136:139], a[200:203], v[176:179], a[136:139]
s_waitcnt lgkmcnt(4)
ds_read_b64_tr_b16 a[216:217], v55 offset:41216
ds_read_b64_tr_b16 a[218:219], v55 offset:46336
v_mfma_f32_16x16x32_bf16 a[136:139], a[204:207], v[180:183], a[136:139]
ds_read_b64_tr_b16 a[220:221], v55 offset:51456
ds_read_b64_tr_b16 a[222:223], v55 offset:56576
v_mfma_f32_16x16x32_bf16 a[140:143], a[200:203], v[184:187], a[140:143]
buffer_load_dwordx4 v[152:155], v59, s[28:31], s51 offen offset:0 sc1
v_mfma_f32_16x16x32_bf16 a[140:143], a[204:207], v[188:191], a[140:143]
s_waitcnt vmcnt(49)
s_barrier
s_waitcnt lgkmcnt(6)
v_mfma_f32_16x16x32_bf16 a[144:147], a[208:211], v[176:179], a[144:147]
s_waitcnt lgkmcnt(4)
ds_read_b64_tr_b16 a[192:193], v248 offset:0
ds_read_b64_tr_b16 a[194:195], v248 offset:5120
v_mfma_f32_16x16x32_bf16 a[144:147], a[212:215], v[180:183], a[144:147]
ds_read_b64_tr_b16 a[196:197], v248 offset:10240
ds_read_b64_tr_b16 a[198:199], v248 offset:15360
v_mfma_f32_16x16x32_bf16 a[148:151], a[208:211], v[184:187], a[148:151]
buffer_load_dwordx4 v[156:159], v59, s[28:31], s51 offen offset:1024 sc1
v_mfma_f32_16x16x32_bf16 a[148:151], a[212:215], v[188:191], a[148:151]
s_waitcnt lgkmcnt(6)
v_mfma_f32_16x16x32_bf16 a[152:155], a[216:219], v[176:179], a[152:155]
s_waitcnt lgkmcnt(4)
ds_read_b64_tr_b16 a[200:201], v249 offset:0
ds_read_b64_tr_b16 a[202:203], v249 offset:5120
v_mfma_f32_16x16x32_bf16 a[152:155], a[220:223], v[180:183], a[152:155]
s_add_u32 s51, s51, 2048
ds_read_b64_tr_b16 a[204:205], v249 offset:10240
ds_read_b64_tr_b16 a[206:207], v249 offset:15360
v_mfma_f32_16x16x32_bf16 a[156:159], a[216:219], v[184:187], a[156:159]
s_add_u32 s48, s48, 81920
v_mfma_f32_16x16x32_bf16 a[156:159], a[220:223], v[188:191], a[156:159]
s_waitcnt lgkmcnt(6) vmcnt(49)
v_mfma_f32_16x16x32_bf16 a[80:83], a[192:195], v[64:67], a[80:83]
s_waitcnt lgkmcnt(4) vmcnt(48)
ds_read_b64_tr_b16 a[208:209], v248 offset:64
ds_read_b64_tr_b16 a[210:211], v248 offset:5184
v_mfma_f32_16x16x32_bf16 a[80:83], a[196:199], v[68:71], a[80:83]
s_waitcnt vmcnt(47)
s_add_u32 m0, s49, 20480
ds_read_b64_tr_b16 a[212:213], v248 offset:10304
ds_read_b64_tr_b16 a[214:215], v248 offset:15424
v_mfma_f32_16x16x32_bf16 a[84:87], a[192:195], v[72:75], a[84:87]
s_waitcnt vmcnt(46)
buffer_load_dwordx4 v49, s[64:67], s48 offen offset:0 lds
v_mfma_f32_16x16x32_bf16 a[84:87], a[196:199], v[76:79], a[84:87]
s_waitcnt lgkmcnt(6)
v_mfma_f32_16x16x32_bf16 a[88:91], a[200:203], v[64:67], a[88:91]
s_waitcnt lgkmcnt(4)
ds_read_b64_tr_b16 a[216:217], v249 offset:64
ds_read_b64_tr_b16 a[218:219], v249 offset:5184
v_mfma_f32_16x16x32_bf16 a[88:91], a[204:207], v[68:71], a[88:91]
ds_read_b64_tr_b16 a[220:221], v249 offset:10304
ds_read_b64_tr_b16 a[222:223], v249 offset:15424
v_mfma_f32_16x16x32_bf16 a[92:95], a[200:203], v[72:75], a[92:95]
buffer_load_dwordx4 v50, s[64:67], s48 offen offset:1024 lds
v_mfma_f32_16x16x32_bf16 a[92:95], a[204:207], v[76:79], a[92:95]
s_waitcnt lgkmcnt(6)
v_mfma_f32_16x16x32_bf16 a[96:99], a[208:211], v[64:67], a[96:99]
s_waitcnt lgkmcnt(4)
ds_read_b64_tr_b16 a[192:193], v248 offset:128
ds_read_b64_tr_b16 a[194:195], v248 offset:5248
v_mfma_f32_16x16x32_bf16 a[96:99], a[212:215], v[68:71], a[96:99]
ds_read_b64_tr_b16 a[196:197], v248 offset:10368
ds_read_b64_tr_b16 a[198:199], v248 offset:15488
v_mfma_f32_16x16x32_bf16 a[100:103], a[208:211], v[72:75], a[100:103]
buffer_load_dwordx4 v51, s[64:67], s48 offen offset:2048 lds
v_mfma_f32_16x16x32_bf16 a[100:103], a[212:215], v[76:79], a[100:103]
s_waitcnt lgkmcnt(6)
v_mfma_f32_16x16x32_bf16 a[104:107], a[216:219], v[64:67], a[104:107]
s_waitcnt lgkmcnt(4)
ds_read_b64_tr_b16 a[200:201], v249 offset:128
ds_read_b64_tr_b16 a[202:203], v249 offset:5248
v_mfma_f32_16x16x32_bf16 a[104:107], a[220:223], v[68:71], a[104:107]
ds_read_b64_tr_b16 a[204:205], v249 offset:10368
ds_read_b64_tr_b16 a[206:207], v249 offset:15488
v_mfma_f32_16x16x32_bf16 a[108:111], a[216:219], v[72:75], a[108:111]
buffer_load_dwordx4 v52, s[64:67], s48 offen offset:3072 lds
v_mfma_f32_16x16x32_bf16 a[108:111], a[220:223], v[76:79], a[108:111]
s_waitcnt lgkmcnt(6)
v_mfma_f32_16x16x32_bf16 a[112:115], a[192:195], v[64:67], a[112:115]
s_waitcnt lgkmcnt(4)
ds_read_b64_tr_b16 a[208:209], v248 offset:192
ds_read_b64_tr_b16 a[210:211], v248 offset:5312
v_mfma_f32_16x16x32_bf16 a[112:115], a[196:199], v[68:71], a[112:115]
s_add_u32 m0, s49, 24576
ds_read_b64_tr_b16 a[212:213], v248 offset:10432
ds_read_b64_tr_b16 a[214:215], v248 offset:15552
v_mfma_f32_16x16x32_bf16 a[116:119], a[192:195], v[72:75], a[116:119]
buffer_load_dwordx4 v53, s[64:67], s48 offen offset:0 lds
v_mfma_f32_16x16x32_bf16 a[116:119], a[196:199], v[76:79], a[116:119]
s_waitcnt lgkmcnt(6)
v_mfma_f32_16x16x32_bf16 a[120:123], a[200:203], v[64:67], a[120:123]
s_waitcnt lgkmcnt(4)
ds_read_b64_tr_b16 a[216:217], v249 offset:192
ds_read_b64_tr_b16 a[218:219], v249 offset:5312
v_mfma_f32_16x16x32_bf16 a[120:123], a[204:207], v[68:71], a[120:123]
ds_read_b64_tr_b16 a[220:221], v249 offset:10432
ds_read_b64_tr_b16 a[222:223], v249 offset:15552
v_mfma_f32_16x16x32_bf16 a[124:127], a[200:203], v[72:75], a[124:127]
buffer_load_dwordx4 v[160:163], v58, s[28:31], s51 offen offset:0 sc1
v_mfma_f32_16x16x32_bf16 a[124:127], a[204:207], v[76:79], a[124:127]
s_waitcnt lgkmcnt(6)
v_mfma_f32_16x16x32_bf16 a[128:131], a[208:211], v[64:67], a[128:131]
s_waitcnt lgkmcnt(4)
ds_read_b64_tr_b16 a[192:193], v248 offset:256
ds_read_b64_tr_b16 a[194:195], v248 offset:5376
v_mfma_f32_16x16x32_bf16 a[128:131], a[212:215], v[68:71], a[128:131]
ds_read_b64_tr_b16 a[196:197], v248 offset:10496
ds_read_b64_tr_b16 a[198:199], v248 offset:15616
v_mfma_f32_16x16x32_bf16 a[132:135], a[208:211], v[72:75], a[132:135]
buffer_load_dwordx4 v[164:167], v58, s[28:31], s51 offen offset:1024 sc1
v_mfma_f32_16x16x32_bf16 a[132:135], a[212:215], v[76:79], a[132:135]
s_waitcnt lgkmcnt(6)
v_mfma_f32_16x16x32_bf16 a[136:139], a[216:219], v[64:67], a[136:139]
s_waitcnt lgkmcnt(4)
ds_read_b64_tr_b16 a[200:201], v249 offset:256
ds_read_b64_tr_b16 a[202:203], v249 offset:5376
v_mfma_f32_16x16x32_bf16 a[136:139], a[220:223], v[68:71], a[136:139]
ds_read_b64_tr_b16 a[204:205], v249 offset:10496
ds_read_b64_tr_b16 a[206:207], v249 offset:15616
v_mfma_f32_16x16x32_bf16 a[140:143], a[216:219], v[72:75], a[140:143]
buffer_load_dwordx4 v[168:171], v59, s[28:31], s51 offen offset:0 sc1
v_mfma_f32_16x16x32_bf16 a[140:143], a[220:223], v[76:79], a[140:143]
s_waitcnt vmcnt(49)
s_barrier
s_waitcnt lgkmcnt(6)
v_mfma_f32_16x16x32_bf16 a[144:147], a[192:195], v[64:67], a[144:147]
s_waitcnt lgkmcnt(4)
ds_read_b64_tr_b16 a[208:209], v248 offset:20480
ds_read_b64_tr_b16 a[210:211], v248 offset:25600
v_mfma_f32_16x16x32_bf16 a[144:147], a[196:199], v[68:71], a[144:147]
ds_read_b64_tr_b16 a[212:213], v248 offset:30720
ds_read_b64_tr_b16 a[214:215], v248 offset:35840
v_mfma_f32_16x16x32_bf16 a[148:151], a[192:195], v[72:75], a[148:151]
buffer_load_dwordx4 v[172:175], v59, s[28:31], s51 offen offset:1024 sc1
v_mfma_f32_16x16x32_bf16 a[148:151], a[196:199], v[76:79], a[148:151]
s_waitcnt lgkmcnt(6)
v_mfma_f32_16x16x32_bf16 a[152:155], a[200:203], v[64:67], a[152:155]
s_waitcnt lgkmcnt(4)
ds_read_b64_tr_b16 a[216:217], v249 offset:20480
ds_read_b64_tr_b16 a[218:219], v249 offset:25600
v_mfma_f32_16x16x32_bf16 a[152:155], a[204:207], v[68:71], a[152:155]
s_add_u32 s51, s51, 2048
ds_read_b64_tr_b16 a[220:221], v249 offset:30720
ds_read_b64_tr_b16 a[222:223], v249 offset:35840
v_mfma_f32_16x16x32_bf16 a[156:159], a[200:203], v[72:75], a[156:159]
s_add_u32 s48, s48, 81920
v_mfma_f32_16x16x32_bf16 a[156:159], a[204:207], v[76:79], a[156:159]
s_waitcnt lgkmcnt(6) vmcnt(49)
v_mfma_f32_16x16x32_bf16 a[80:83], a[208:211], v[80:83], a[80:83]
s_waitcnt lgkmcnt(4) vmcnt(48)
ds_read_b64_tr_b16 a[192:193], v248 offset:20544
ds_read_b64_tr_b16 a[194:195], v248 offset:25664
v_mfma_f32_16x16x32_bf16 a[80:83], a[212:215], v[84:87], a[80:83]
s_waitcnt vmcnt(47)
s_add_u32 m0, s49, 40960
ds_read_b64_tr_b16 a[196:197], v248 offset:30784
ds_read_b64_tr_b16 a[198:199], v248 offset:35904
v_mfma_f32_16x16x32_bf16 a[84:87], a[208:211], v[88:91], a[84:87]
s_waitcnt vmcnt(46)
buffer_load_dwordx4 v49, s[64:67], s48 offen offset:0 lds
v_mfma_f32_16x16x32_bf16 a[84:87], a[212:215], v[92:95], a[84:87]
s_waitcnt lgkmcnt(6)
v_mfma_f32_16x16x32_bf16 a[88:91], a[216:219], v[80:83], a[88:91]
s_waitcnt lgkmcnt(4)
ds_read_b64_tr_b16 a[200:201], v249 offset:20544
ds_read_b64_tr_b16 a[202:203], v249 offset:25664
v_mfma_f32_16x16x32_bf16 a[88:91], a[220:223], v[84:87], a[88:91]
ds_read_b64_tr_b16 a[204:205], v249 offset:30784
ds_read_b64_tr_b16 a[206:207], v249 offset:35904
v_mfma_f32_16x16x32_bf16 a[92:95], a[216:219], v[88:91], a[92:95]
buffer_load_dwordx4 v50, s[64:67], s48 offen offset:1024 lds
v_mfma_f32_16x16x32_bf16 a[92:95], a[220:223], v[92:95], a[92:95]
s_waitcnt lgkmcnt(6)
v_mfma_f32_16x16x32_bf16 a[96:99], a[192:195], v[80:83], a[96:99]
s_waitcnt lgkmcnt(4)
ds_read_b64_tr_b16 a[208:209], v248 offset:20608
ds_read_b64_tr_b16 a[210:211], v248 offset:25728
v_mfma_f32_16x16x32_bf16 a[96:99], a[196:199], v[84:87], a[96:99]
ds_read_b64_tr_b16 a[212:213], v248 offset:30848
ds_read_b64_tr_b16 a[214:215], v248 offset:35968
v_mfma_f32_16x16x32_bf16 a[100:103], a[192:195], v[88:91], a[100:103]
buffer_load_dwordx4 v51, s[64:67], s48 offen offset:2048 lds
v_mfma_f32_16x16x32_bf16 a[100:103], a[196:199], v[92:95], a[100:103]
s_waitcnt lgkmcnt(6)
v_mfma_f32_16x16x32_bf16 a[104:107], a[200:203], v[80:83], a[104:107]
s_waitcnt lgkmcnt(4)
ds_read_b64_tr_b16 a[216:217], v249 offset:20608
ds_read_b64_tr_b16 a[218:219], v249 offset:25728
v_mfma_f32_16x16x32_bf16 a[104:107], a[204:207], v[84:87], a[104:107]
ds_read_b64_tr_b16 a[220:221], v249 offset:30848
ds_read_b64_tr_b16 a[222:223], v249 offset:35968
v_mfma_f32_16x16x32_bf16 a[108:111], a[200:203], v[88:91], a[108:111]
buffer_load_dwordx4 v52, s[64:67], s48 offen offset:3072 lds
v_mfma_f32_16x16x32_bf16 a[108:111], a[204:207], v[92:95], a[108:111]
s_waitcnt lgkmcnt(6)
v_mfma_f32_16x16x32_bf16 a[112:115], a[208:211], v[80:83], a[112:115]
s_waitcnt lgkmcnt(4)
ds_read_b64_tr_b16 a[192:193], v248 offset:20672
ds_read_b64_tr_b16 a[194:195], v248 offset:25792
v_mfma_f32_16x16x32_bf16 a[112:115], a[212:215], v[84:87], a[112:115]
s_add_u32 m0, s49, 45056
ds_read_b64_tr_b16 a[196:197], v248 offset:30912
ds_read_b64_tr_b16 a[198:199], v248 offset:36032
v_mfma_f32_16x16x32_bf16 a[116:119], a[208:211], v[88:91], a[116:119]
buffer_load_dwordx4 v53, s[64:67], s48 offen offset:0 lds
v_mfma_f32_16x16x32_bf16 a[116:119], a[212:215], v[92:95], a[116:119]
s_waitcnt lgkmcnt(6)
v_mfma_f32_16x16x32_bf16 a[120:123], a[216:219], v[80:83], a[120:123]
s_waitcnt lgkmcnt(4)
ds_read_b64_tr_b16 a[200:201], v249 offset:20672
ds_read_b64_tr_b16 a[202:203], v249 offset:25792
v_mfma_f32_16x16x32_bf16 a[120:123], a[220:223], v[84:87], a[120:123]
ds_read_b64_tr_b16 a[204:205], v249 offset:30912
ds_read_b64_tr_b16 a[206:207], v249 offset:36032
v_mfma_f32_16x16x32_bf16 a[124:127], a[216:219], v[88:91], a[124:127]
buffer_load_dwordx4 v[176:179], v58, s[28:31], s51 offen offset:0 sc1
v_mfma_f32_16x16x32_bf16 a[124:127], a[220:223], v[92:95], a[124:127]
s_waitcnt lgkmcnt(6)
v_mfma_f32_16x16x32_bf16 a[128:131], a[192:195], v[80:83], a[128:131]
s_waitcnt lgkmcnt(4)
ds_read_b64_tr_b16 a[208:209], v248 offset:20736
ds_read_b64_tr_b16 a[210:211], v248 offset:25856
v_mfma_f32_16x16x32_bf16 a[128:131], a[196:199], v[84:87], a[128:131]
ds_read_b64_tr_b16 a[212:213], v248 offset:30976
ds_read_b64_tr_b16 a[214:215], v248 offset:36096
v_mfma_f32_16x16x32_bf16 a[132:135], a[192:195], v[88:91], a[132:135]
buffer_load_dwordx4 v[180:183], v58, s[28:31], s51 offen offset:1024 sc1
v_mfma_f32_16x16x32_bf16 a[132:135], a[196:199], v[92:95], a[132:135]
s_waitcnt lgkmcnt(6)
v_mfma_f32_16x16x32_bf16 a[136:139], a[200:203], v[80:83], a[136:139]
s_waitcnt lgkmcnt(4)
ds_read_b64_tr_b16 a[216:217], v249 offset:20736
ds_read_b64_tr_b16 a[218:219], v249 offset:25856
v_mfma_f32_16x16x32_bf16 a[136:139], a[204:207], v[84:87], a[136:139]
ds_read_b64_tr_b16 a[220:221], v249 offset:30976
ds_read_b64_tr_b16 a[222:223], v249 offset:36096
v_mfma_f32_16x16x32_bf16 a[140:143], a[200:203], v[88:91], a[140:143]
buffer_load_dwordx4 v[184:187], v59, s[28:31], s51 offen offset:0 sc1
v_mfma_f32_16x16x32_bf16 a[140:143], a[204:207], v[92:95], a[140:143]
s_waitcnt vmcnt(49)
s_barrier
s_waitcnt lgkmcnt(6)
v_mfma_f32_16x16x32_bf16 a[144:147], a[208:211], v[80:83], a[144:147]
s_waitcnt lgkmcnt(4)
ds_read_b64_tr_b16 a[192:193], v248 offset:40960
ds_read_b64_tr_b16 a[194:195], v248 offset:46080
v_mfma_f32_16x16x32_bf16 a[144:147], a[212:215], v[84:87], a[144:147]
ds_read_b64_tr_b16 a[196:197], v248 offset:51200
ds_read_b64_tr_b16 a[198:199], v248 offset:56320
v_mfma_f32_16x16x32_bf16 a[148:151], a[208:211], v[88:91], a[148:151]
buffer_load_dwordx4 v[188:191], v59, s[28:31], s51 offen offset:1024 sc1
v_mfma_f32_16x16x32_bf16 a[148:151], a[212:215], v[92:95], a[148:151]
s_waitcnt lgkmcnt(6)
v_mfma_f32_16x16x32_bf16 a[152:155], a[216:219], v[80:83], a[152:155]
s_waitcnt lgkmcnt(4)
ds_read_b64_tr_b16 a[200:201], v249 offset:40960
ds_read_b64_tr_b16 a[202:203], v249 offset:46080
v_mfma_f32_16x16x32_bf16 a[152:155], a[220:223], v[84:87], a[152:155]
s_add_u32 s51, s51, 2048
ds_read_b64_tr_b16 a[204:205], v249 offset:51200
ds_read_b64_tr_b16 a[206:207], v249 offset:56320
v_mfma_f32_16x16x32_bf16 a[156:159], a[216:219], v[88:91], a[156:159]
s_add_u32 s48, s48, 81920
v_mfma_f32_16x16x32_bf16 a[156:159], a[220:223], v[92:95], a[156:159]
s_waitcnt lgkmcnt(6) vmcnt(49)
v_mfma_f32_16x16x32_bf16 a[80:83], a[192:195], v[96:99], a[80:83]
s_waitcnt lgkmcnt(4) vmcnt(48)
ds_read_b64_tr_b16 a[208:209], v248 offset:41024
ds_read_b64_tr_b16 a[210:211], v248 offset:46144
s_cmp_eq_u32 s20, 24
s_cselect_b32 s30, 0, s30
s_cselect_b32 s66, 0, s66
v_mfma_f32_16x16x32_bf16 a[80:83], a[196:199], v[100:103], a[80:83]
s_waitcnt vmcnt(47)
s_add_u32 m0, s49, 61440
ds_read_b64_tr_b16 a[212:213], v248 offset:51264
ds_read_b64_tr_b16 a[214:215], v248 offset:56384
v_mfma_f32_16x16x32_bf16 a[84:87], a[192:195], v[104:107], a[84:87]
s_waitcnt vmcnt(46)
buffer_load_dwordx4 v49, s[64:67], s48 offen offset:0 lds
v_mfma_f32_16x16x32_bf16 a[84:87], a[196:199], v[108:111], a[84:87]
s_waitcnt lgkmcnt(6)
v_mfma_f32_16x16x32_bf16 a[88:91], a[200:203], v[96:99], a[88:91]
s_waitcnt lgkmcnt(4)
ds_read_b64_tr_b16 a[216:217], v249 offset:41024
ds_read_b64_tr_b16 a[218:219], v249 offset:46144
v_mfma_f32_16x16x32_bf16 a[88:91], a[204:207], v[100:103], a[88:91]
ds_read_b64_tr_b16 a[220:221], v249 offset:51264
ds_read_b64_tr_b16 a[222:223], v249 offset:56384
v_mfma_f32_16x16x32_bf16 a[92:95], a[200:203], v[104:107], a[92:95]
buffer_load_dwordx4 v50, s[64:67], s48 offen offset:1024 lds
v_mfma_f32_16x16x32_bf16 a[92:95], a[204:207], v[108:111], a[92:95]
s_waitcnt lgkmcnt(6)
v_mfma_f32_16x16x32_bf16 a[96:99], a[208:211], v[96:99], a[96:99]
s_waitcnt lgkmcnt(4)
ds_read_b64_tr_b16 a[192:193], v248 offset:41088
ds_read_b64_tr_b16 a[194:195], v248 offset:46208
v_mfma_f32_16x16x32_bf16 a[96:99], a[212:215], v[100:103], a[96:99]
ds_read_b64_tr_b16 a[196:197], v248 offset:51328
ds_read_b64_tr_b16 a[198:199], v248 offset:56448
v_mfma_f32_16x16x32_bf16 a[100:103], a[208:211], v[104:107], a[100:103]
buffer_load_dwordx4 v51, s[64:67], s48 offen offset:2048 lds
v_mfma_f32_16x16x32_bf16 a[100:103], a[212:215], v[108:111], a[100:103]
s_waitcnt lgkmcnt(6)
v_mfma_f32_16x16x32_bf16 a[104:107], a[216:219], v[96:99], a[104:107]
s_waitcnt lgkmcnt(4)
ds_read_b64_tr_b16 a[200:201], v249 offset:41088
ds_read_b64_tr_b16 a[202:203], v249 offset:46208
v_mfma_f32_16x16x32_bf16 a[104:107], a[220:223], v[100:103], a[104:107]
ds_read_b64_tr_b16 a[204:205], v249 offset:51328
ds_read_b64_tr_b16 a[206:207], v249 offset:56448
v_mfma_f32_16x16x32_bf16 a[108:111], a[216:219], v[104:107], a[108:111]
buffer_load_dwordx4 v52, s[64:67], s48 offen offset:3072 lds
v_mfma_f32_16x16x32_bf16 a[108:111], a[220:223], v[108:111], a[108:111]
s_waitcnt lgkmcnt(6)
v_mfma_f32_16x16x32_bf16 a[112:115], a[192:195], v[96:99], a[112:115]
s_waitcnt lgkmcnt(4)
ds_read_b64_tr_b16 a[208:209], v248 offset:41152
ds_read_b64_tr_b16 a[210:211], v248 offset:46272
v_mfma_f32_16x16x32_bf16 a[112:115], a[196:199], v[100:103], a[112:115]
s_add_u32 m0, s49, 65536
ds_read_b64_tr_b16 a[212:213], v248 offset:51392
ds_read_b64_tr_b16 a[214:215], v248 offset:56512
v_mfma_f32_16x16x32_bf16 a[116:119], a[192:195], v[104:107], a[116:119]
buffer_load_dwordx4 v53, s[64:67], s48 offen offset:0 lds
v_mfma_f32_16x16x32_bf16 a[116:119], a[196:199], v[108:111], a[116:119]
s_waitcnt lgkmcnt(6)
v_mfma_f32_16x16x32_bf16 a[120:123], a[200:203], v[96:99], a[120:123]
s_waitcnt lgkmcnt(4)
ds_read_b64_tr_b16 a[216:217], v249 offset:41152
ds_read_b64_tr_b16 a[218:219], v249 offset:46272
v_mfma_f32_16x16x32_bf16 a[120:123], a[204:207], v[100:103], a[120:123]
ds_read_b64_tr_b16 a[220:221], v249 offset:51392
ds_read_b64_tr_b16 a[222:223], v249 offset:56512
v_mfma_f32_16x16x32_bf16 a[124:127], a[200:203], v[104:107], a[124:127]
buffer_load_dwordx4 v[64:67], v58, s[28:31], s51 offen offset:0 sc1
v_mfma_f32_16x16x32_bf16 a[124:127], a[204:207], v[108:111], a[124:127]
s_waitcnt lgkmcnt(6)
v_mfma_f32_16x16x32_bf16 a[128:131], a[208:211], v[96:99], a[128:131]
s_waitcnt lgkmcnt(4)
ds_read_b64_tr_b16 a[192:193], v248 offset:41216
ds_read_b64_tr_b16 a[194:195], v248 offset:46336
v_mfma_f32_16x16x32_bf16 a[128:131], a[212:215], v[100:103], a[128:131]
ds_read_b64_tr_b16 a[196:197], v248 offset:51456
ds_read_b64_tr_b16 a[198:199], v248 offset:56576
v_mfma_f32_16x16x32_bf16 a[132:135], a[208:211], v[104:107], a[132:135]
buffer_load_dwordx4 v[68:71], v58, s[28:31], s51 offen offset:1024 sc1
v_mfma_f32_16x16x32_bf16 a[132:135], a[212:215], v[108:111], a[132:135]
s_waitcnt lgkmcnt(6)
v_mfma_f32_16x16x32_bf16 a[136:139], a[216:219], v[96:99], a[136:139]
s_waitcnt lgkmcnt(4)
ds_read_b64_tr_b16 a[200:201], v249 offset:41216
ds_read_b64_tr_b16 a[202:203], v249 offset:46336
v_mfma_f32_16x16x32_bf16 a[136:139], a[220:223], v[100:103], a[136:139]
ds_read_b64_tr_b16 a[204:205], v249 offset:51456
ds_read_b64_tr_b16 a[206:207], v249 offset:56576
v_mfma_f32_16x16x32_bf16 a[140:143], a[216:219], v[104:107], a[140:143]
buffer_load_dwordx4 v[72:75], v59, s[28:31], s51 offen offset:0 sc1
v_mfma_f32_16x16x32_bf16 a[140:143], a[220:223], v[108:111], a[140:143]
s_waitcnt vmcnt(49)
s_barrier
s_waitcnt lgkmcnt(6)
v_mfma_f32_16x16x32_bf16 a[144:147], a[192:195], v[96:99], a[144:147]
s_waitcnt lgkmcnt(4)
ds_read_b64_tr_b16 a[208:209], v250 offset:0
ds_read_b64_tr_b16 a[210:211], v250 offset:5120
v_mfma_f32_16x16x32_bf16 a[144:147], a[196:199], v[100:103], a[144:147]
ds_read_b64_tr_b16 a[212:213], v250 offset:10240
ds_read_b64_tr_b16 a[214:215], v250 offset:15360
v_mfma_f32_16x16x32_bf16 a[148:151], a[192:195], v[104:107], a[148:151]
buffer_load_dwordx4 v[76:79], v59, s[28:31], s51 offen offset:1024 sc1
v_mfma_f32_16x16x32_bf16 a[148:151], a[196:199], v[108:111], a[148:151]
s_waitcnt lgkmcnt(6)
buffer_load_dword v15, v29, s[60:63], s25 offen sc1
v_mfma_f32_16x16x32_bf16 a[152:155], a[200:203], v[96:99], a[152:155]
s_waitcnt lgkmcnt(4)
ds_read_b64_tr_b16 a[216:217], v251 offset:0
ds_read_b64_tr_b16 a[218:219], v251 offset:5120
v_mfma_f32_16x16x32_bf16 a[152:155], a[204:207], v[100:103], a[152:155]
s_add_u32 s51, s51, 2048
ds_read_b64_tr_b16 a[220:221], v251 offset:10240
ds_read_b64_tr_b16 a[222:223], v251 offset:15360
v_mfma_f32_16x16x32_bf16 a[156:159], a[200:203], v[104:107], a[156:159]
s_add_u32 s48, s48, 81920
v_mfma_f32_16x16x32_bf16 a[156:159], a[204:207], v[108:111], a[156:159]
s_waitcnt lgkmcnt(6) vmcnt(50)
v_mfma_f32_16x16x32_bf16 a[80:83], a[208:211], v[112:115], a[80:83]
s_waitcnt lgkmcnt(4) vmcnt(49)
ds_read_b64_tr_b16 a[192:193], v250 offset:64
ds_read_b64_tr_b16 a[194:195], v250 offset:5184
s_cmp_eq_u32 s20, 25
s_cselect_b32 s30, 0, s30
s_cselect_b32 s66, 0, s66
v_mfma_f32_16x16x32_bf16 a[80:83], a[212:215], v[116:119], a[80:83]
s_waitcnt vmcnt(48)
s_add_u32 m0, s49, 81920
ds_read_b64_tr_b16 a[196:197], v250 offset:10304
ds_read_b64_tr_b16 a[198:199], v250 offset:15424
s_mov_b32 s94, 0xffff0000
s_mov_b32 s95, 0xbfb8aa3b
v_mfma_f32_16x16x32_bf16 a[84:87], a[208:211], v[120:123], a[84:87]
s_waitcnt vmcnt(47)
buffer_load_dwordx4 v49, s[64:67], s48 offen offset:0 lds
s_add_u32 s89, s89, 16384
s_add_u32 s55, s91, 10485760
v_mfma_f32_16x16x32_bf16 a[84:87], a[212:215], v[124:127], a[84:87]
s_waitcnt lgkmcnt(6)
s_cmp_eq_u32 s90, 0
s_cselect_b32 s55, 0x7ff00000, s55
s_add_u32 s56, s91, 10496000
v_mfma_f32_16x16x32_bf16 a[88:91], a[216:219], v[112:115], a[88:91]
s_waitcnt lgkmcnt(4)
ds_read_b64_tr_b16 a[200:201], v251 offset:64
ds_read_b64_tr_b16 a[202:203], v251 offset:5184
s_cmp_eq_u32 s90, 1
s_cselect_b32 s56, 0x7ff00000, s56
s_add_u32 s57, s91, 10506240
v_mfma_f32_16x16x32_bf16 a[88:91], a[220:223], v[116:119], a[88:91]
ds_read_b64_tr_b16 a[204:205], v251 offset:10304
ds_read_b64_tr_b16 a[206:207], v251 offset:15424
s_cmp_eq_u32 s90, 2
s_cselect_b32 s57, 0x7ff00000, s57
s_add_u32 s58, s91, 10516480
v_mfma_f32_16x16x32_bf16 a[92:95], a[216:219], v[120:123], a[92:95]
buffer_load_dwordx4 v50, s[64:67], s48 offen offset:1024 lds
s_cmp_eq_u32 s90, 3
s_cselect_b32 s58, 0x7ff00000, s58
v_mfma_f32_16x16x32_bf16 a[92:95], a[220:223], v[124:127], a[92:95]
s_waitcnt lgkmcnt(6)
v_mfma_f32_16x16x32_bf16 a[96:99], a[192:195], v[112:115], a[96:99]
s_waitcnt lgkmcnt(4)
ds_read_b64_tr_b16 a[208:209], v250 offset:128
ds_read_b64_tr_b16 a[210:211], v250 offset:5248
v_mfma_f32_16x16x32_bf16 a[96:99], a[196:199], v[116:119], a[96:99]
ds_read_b64_tr_b16 a[212:213], v250 offset:10368
ds_read_b64_tr_b16 a[214:215], v250 offset:15488
v_mfma_f32_16x16x32_bf16 a[100:103], a[192:195], v[120:123], a[100:103]
buffer_load_dwordx4 v51, s[64:67], s48 offen offset:2048 lds
v_mfma_f32_16x16x32_bf16 a[100:103], a[196:199], v[124:127], a[100:103]
s_waitcnt lgkmcnt(6)
v_mfma_f32_16x16x32_bf16 a[104:107], a[200:203], v[112:115], a[104:107]
s_waitcnt lgkmcnt(4)
ds_read_b64_tr_b16 a[216:217], v251 offset:128
ds_read_b64_tr_b16 a[218:219], v251 offset:5248
v_mfma_f32_16x16x32_bf16 a[104:107], a[204:207], v[116:119], a[104:107]
ds_read_b64_tr_b16 a[220:221], v251 offset:10368
ds_read_b64_tr_b16 a[222:223], v251 offset:15488
v_mfma_f32_16x16x32_bf16 a[108:111], a[200:203], v[120:123], a[108:111]
buffer_load_dwordx4 v52, s[64:67], s48 offen offset:3072 lds
v_mfma_f32_16x16x32_bf16 a[108:111], a[204:207], v[124:127], a[108:111]
s_waitcnt lgkmcnt(6)
v_mfma_f32_16x16x32_bf16 a[112:115], a[208:211], v[112:115], a[112:115]
s_waitcnt lgkmcnt(4)
ds_read_b64_tr_b16 a[192:193], v250 offset:192
ds_read_b64_tr_b16 a[194:195], v250 offset:5312
v_mfma_f32_16x16x32_bf16 a[112:115], a[212:215], v[116:119], a[112:115]
s_add_u32 m0, s49, 86016
ds_read_b64_tr_b16 a[196:197], v250 offset:10432
ds_read_b64_tr_b16 a[198:199], v250 offset:15552
v_mfma_f32_16x16x32_bf16 a[116:119], a[208:211], v[120:123], a[116:119]
buffer_load_dwordx4 v53, s[64:67], s48 offen offset:0 lds
v_mfma_f32_16x16x32_bf16 a[116:119], a[212:215], v[124:127], a[116:119]
s_waitcnt lgkmcnt(6)
v_mfma_f32_16x16x32_bf16 a[120:123], a[216:219], v[112:115], a[120:123]
s_waitcnt lgkmcnt(4)
ds_read_b64_tr_b16 a[200:201], v251 offset:192
ds_read_b64_tr_b16 a[202:203], v251 offset:5312
v_mfma_f32_16x16x32_bf16 a[120:123], a[220:223], v[116:119], a[120:123]
ds_read_b64_tr_b16 a[204:205], v251 offset:10432
ds_read_b64_tr_b16 a[206:207], v251 offset:15552
v_mfma_f32_16x16x32_bf16 a[124:127], a[216:219], v[120:123], a[124:127]
buffer_load_dwordx4 v[80:83], v58, s[28:31], s51 offen offset:0 sc1
v_mfma_f32_16x16x32_bf16 a[124:127], a[220:223], v[124:127], a[124:127]
s_waitcnt lgkmcnt(6)
v_mfma_f32_16x16x32_bf16 a[128:131], a[192:195], v[112:115], a[128:131]
s_waitcnt lgkmcnt(4)
ds_read_b64_tr_b16 a[208:209], v250 offset:256
ds_read_b64_tr_b16 a[210:211], v250 offset:5376
v_mfma_f32_16x16x32_bf16 a[128:131], a[196:199], v[116:119], a[128:131]
ds_read_b64_tr_b16 a[212:213], v250 offset:10496
ds_read_b64_tr_b16 a[214:215], v250 offset:15616
v_mfma_f32_16x16x32_bf16 a[132:135], a[192:195], v[120:123], a[132:135]
buffer_load_dwordx4 v[84:87], v58, s[28:31], s51 offen offset:1024 sc1
v_mfma_f32_16x16x32_bf16 a[132:135], a[196:199], v[124:127], a[132:135]
s_waitcnt lgkmcnt(6)
v_mfma_f32_16x16x32_bf16 a[136:139], a[200:203], v[112:115], a[136:139]
s_waitcnt lgkmcnt(4)
ds_read_b64_tr_b16 a[216:217], v251 offset:256
ds_read_b64_tr_b16 a[218:219], v251 offset:5376
v_mfma_f32_16x16x32_bf16 a[136:139], a[204:207], v[116:119], a[136:139]
ds_read_b64_tr_b16 a[220:221], v251 offset:10496
ds_read_b64_tr_b16 a[222:223], v251 offset:15616
v_mfma_f32_16x16x32_bf16 a[140:143], a[200:203], v[120:123], a[140:143]
buffer_load_dwordx4 v[88:91], v59, s[28:31], s51 offen offset:0 sc1
v_mfma_f32_16x16x32_bf16 a[140:143], a[204:207], v[124:127], a[140:143]
s_waitcnt vmcnt(49)
s_barrier
s_waitcnt lgkmcnt(6)
v_mfma_f32_16x16x32_bf16 a[144:147], a[208:211], v[112:115], a[144:147]
s_waitcnt lgkmcnt(4)
ds_read_b64_tr_b16 a[192:193], v250 offset:20480
ds_read_b64_tr_b16 a[194:195], v250 offset:25600
v_mfma_f32_16x16x32_bf16 a[144:147], a[212:215], v[116:119], a[144:147]
ds_read_b64_tr_b16 a[196:197], v250 offset:30720
ds_read_b64_tr_b16 a[198:199], v250 offset:35840
v_mfma_f32_16x16x32_bf16 a[148:151], a[208:211], v[120:123], a[148:151]
buffer_load_dwordx4 v[92:95], v59, s[28:31], s51 offen offset:1024 sc1
v_mfma_f32_16x16x32_bf16 a[148:151], a[212:215], v[124:127], a[148:151]
s_waitcnt lgkmcnt(6)
v_mfma_f32_16x16x32_bf16 a[152:155], a[216:219], v[112:115], a[152:155]
s_waitcnt lgkmcnt(4)
ds_read_b64_tr_b16 a[200:201], v251 offset:20480
ds_read_b64_tr_b16 a[202:203], v251 offset:25600
v_mfma_f32_16x16x32_bf16 a[152:155], a[220:223], v[116:119], a[152:155]
s_add_u32 s51, s51, 2048
ds_read_b64_tr_b16 a[204:205], v251 offset:30720
ds_read_b64_tr_b16 a[206:207], v251 offset:35840
v_mfma_f32_16x16x32_bf16 a[156:159], a[216:219], v[120:123], a[156:159]
s_add_u32 s48, s48, 81920
v_mfma_f32_16x16x32_bf16 a[156:159], a[220:223], v[124:127], a[156:159]
s_waitcnt lgkmcnt(6) vmcnt(49)
v_mfma_f32_16x16x32_bf16 a[80:83], a[192:195], v[128:131], a[80:83]
s_waitcnt lgkmcnt(4) vmcnt(48)
ds_read_b64_tr_b16 a[208:209], v250 offset:20544
ds_read_b64_tr_b16 a[210:211], v250 offset:25664
s_cmp_eq_u32 s20, 26
s_cselect_b32 s30, 0, s30
s_cselect_b32 s66, 0, s66
v_mfma_f32_16x16x32_bf16 a[80:83], a[196:199], v[132:135], a[80:83]
s_waitcnt vmcnt(47)
s_add_u32 m0, s49, 102400
ds_read_b64_tr_b16 a[212:213], v250 offset:30784
ds_read_b64_tr_b16 a[214:215], v250 offset:35904
v_mfma_f32_16x16x32_bf16 a[84:87], a[192:195], v[136:139], a[84:87]
s_waitcnt vmcnt(46)
buffer_load_dwordx4 v49, s[64:67], s48 offen offset:0 lds
v_mfma_f32_16x16x32_bf16 a[84:87], a[196:199], v[140:143], a[84:87]
s_waitcnt lgkmcnt(6)
buffer_load_dwordx2 v[226:227], v30, s[68:71], 0 offen offset:0
v_mfma_f32_16x16x32_bf16 a[88:91], a[200:203], v[128:131], a[88:91]
s_waitcnt lgkmcnt(4)
ds_read_b64_tr_b16 a[216:217], v251 offset:20544
ds_read_b64_tr_b16 a[218:219], v251 offset:25664
v_mfma_f32_16x16x32_bf16 a[88:91], a[204:207], v[132:135], a[88:91]
ds_read_b64_tr_b16 a[220:221], v251 offset:30784
ds_read_b64_tr_b16 a[222:223], v251 offset:35904
v_mfma_f32_16x16x32_bf16 a[92:95], a[200:203], v[136:139], a[92:95]
buffer_load_dwordx4 v50, s[64:67], s48 offen offset:1024 lds
v_mfma_f32_16x16x32_bf16 a[92:95], a[204:207], v[140:143], a[92:95]
s_waitcnt lgkmcnt(6)
buffer_load_dwordx2 v[228:229], v30, s[68:71], 0 offen offset:32
v_mfma_f32_16x16x32_bf16 a[96:99], a[208:211], v[128:131], a[96:99]
s_waitcnt lgkmcnt(4)
ds_read_b64_tr_b16 a[192:193], v250 offset:20608
ds_read_b64_tr_b16 a[194:195], v250 offset:25728
v_mfma_f32_16x16x32_bf16 a[96:99], a[212:215], v[132:135], a[96:99]
ds_read_b64_tr_b16 a[196:197], v250 offset:30848
ds_read_b64_tr_b16 a[198:199], v250 offset:35968
v_mfma_f32_16x16x32_bf16 a[100:103], a[208:211], v[136:139], a[100:103]
buffer_load_dwordx4 v51, s[64:67], s48 offen offset:2048 lds
v_mfma_f32_16x16x32_bf16 a[100:103], a[212:215], v[140:143], a[100:103]
s_waitcnt lgkmcnt(6)
buffer_load_dwordx2 v[230:231], v30, s[68:71], 0 offen offset:64
v_mfma_f32_16x16x32_bf16 a[104:107], a[216:219], v[128:131], a[104:107]
s_waitcnt lgkmcnt(4)
ds_read_b64_tr_b16 a[200:201], v251 offset:20608
ds_read_b64_tr_b16 a[202:203], v251 offset:25728
v_mfma_f32_16x16x32_bf16 a[104:107], a[220:223], v[132:135], a[104:107]
ds_read_b64_tr_b16 a[204:205], v251 offset:30848
ds_read_b64_tr_b16 a[206:207], v251 offset:35968
v_mfma_f32_16x16x32_bf16 a[108:111], a[216:219], v[136:139], a[108:111]
buffer_load_dwordx4 v52, s[64:67], s48 offen offset:3072 lds
v_mfma_f32_16x16x32_bf16 a[108:111], a[220:223], v[140:143], a[108:111]
s_waitcnt lgkmcnt(6)
buffer_load_dwordx2 v[232:233], v30, s[68:71], 0 offen offset:96
v_mfma_f32_16x16x32_bf16 a[112:115], a[192:195], v[128:131], a[112:115]
s_waitcnt lgkmcnt(4)
ds_read_b64_tr_b16 a[208:209], v250 offset:20672
ds_read_b64_tr_b16 a[210:211], v250 offset:25792
v_mfma_f32_16x16x32_bf16 a[112:115], a[196:199], v[132:135], a[112:115]
s_add_u32 m0, s49, 106496
ds_read_b64_tr_b16 a[212:213], v250 offset:30912
ds_read_b64_tr_b16 a[214:215], v250 offset:36032
v_mfma_f32_16x16x32_bf16 a[116:119], a[192:195], v[136:139], a[116:119]
buffer_load_dwordx4 v53, s[64:67], s48 offen offset:0 lds
v_mfma_f32_16x16x32_bf16 a[116:119], a[196:199], v[140:143], a[116:119]
s_waitcnt lgkmcnt(6)
buffer_load_dwordx2 v[234:235], v30, s[68:71], 0 offen offset:128
v_mfma_f32_16x16x32_bf16 a[120:123], a[200:203], v[128:131], a[120:123]
s_waitcnt lgkmcnt(4)
ds_read_b64_tr_b16 a[216:217], v251 offset:20672
ds_read_b64_tr_b16 a[218:219], v251 offset:25792
v_mfma_f32_16x16x32_bf16 a[120:123], a[204:207], v[132:135], a[120:123]
ds_read_b64_tr_b16 a[220:221], v251 offset:30912
ds_read_b64_tr_b16 a[222:223], v251 offset:36032
v_mfma_f32_16x16x32_bf16 a[124:127], a[200:203], v[136:139], a[124:127]
buffer_load_dwordx4 v[96:99], v58, s[28:31], s51 offen offset:0 sc1
v_mfma_f32_16x16x32_bf16 a[124:127], a[204:207], v[140:143], a[124:127]
s_waitcnt lgkmcnt(6)
v_mfma_f32_16x16x32_bf16 a[128:131], a[208:211], v[128:131], a[128:131]
s_waitcnt lgkmcnt(4)
ds_read_b64_tr_b16 a[192:193], v250 offset:20736
ds_read_b64_tr_b16 a[194:195], v250 offset:25856
v_mfma_f32_16x16x32_bf16 a[128:131], a[212:215], v[132:135], a[128:131]
ds_read_b64_tr_b16 a[196:197], v250 offset:30976
ds_read_b64_tr_b16 a[198:199], v250 offset:36096
v_mfma_f32_16x16x32_bf16 a[132:135], a[208:211], v[136:139], a[132:135]
buffer_load_dwordx4 v[100:103], v58, s[28:31], s51 offen offset:1024 sc1
v_mfma_f32_16x16x32_bf16 a[132:135], a[212:215], v[140:143], a[132:135]
s_waitcnt lgkmcnt(6)
v_mfma_f32_16x16x32_bf16 a[136:139], a[216:219], v[128:131], a[136:139]
s_waitcnt lgkmcnt(4)
ds_read_b64_tr_b16 a[200:201], v251 offset:20736
ds_read_b64_tr_b16 a[202:203], v251 offset:25856
v_mfma_f32_16x16x32_bf16 a[136:139], a[220:223], v[132:135], a[136:139]
ds_read_b64_tr_b16 a[204:205], v251 offset:30976
ds_read_b64_tr_b16 a[206:207], v251 offset:36096
v_mfma_f32_16x16x32_bf16 a[140:143], a[216:219], v[136:139], a[140:143]
buffer_load_dwordx4 v[104:107], v59, s[28:31], s51 offen offset:0 sc1
v_mfma_f32_16x16x32_bf16 a[140:143], a[220:223], v[140:143], a[140:143]
s_waitcnt vmcnt(54)
s_barrier
s_waitcnt lgkmcnt(6)
v_mfma_f32_16x16x32_bf16 a[144:147], a[192:195], v[128:131], a[144:147]
s_waitcnt lgkmcnt(4)
ds_read_b64_tr_b16 a[208:209], v54 offset:0
ds_read_b64_tr_b16 a[210:211], v54 offset:5120
v_mfma_f32_16x16x32_bf16 a[144:147], a[196:199], v[132:135], a[144:147]
ds_read_b64_tr_b16 a[212:213], v54 offset:10240
ds_read_b64_tr_b16 a[214:215], v54 offset:15360
v_mfma_f32_16x16x32_bf16 a[148:151], a[192:195], v[136:139], a[148:151]
buffer_load_dwordx4 v[108:111], v59, s[28:31], s51 offen offset:1024 sc1
v_mfma_f32_16x16x32_bf16 a[148:151], a[196:199], v[140:143], a[148:151]
s_waitcnt lgkmcnt(6)
v_mfma_f32_16x16x32_bf16 a[152:155], a[200:203], v[128:131], a[152:155]
s_waitcnt lgkmcnt(4)
ds_read_b64_tr_b16 a[216:217], v55 offset:0
ds_read_b64_tr_b16 a[218:219], v55 offset:5120
v_mfma_f32_16x16x32_bf16 a[152:155], a[204:207], v[132:135], a[152:155]
s_add_u32 s51, s51, 2048
ds_read_b64_tr_b16 a[220:221], v55 offset:10240
ds_read_b64_tr_b16 a[222:223], v55 offset:15360
v_mfma_f32_16x16x32_bf16 a[156:159], a[200:203], v[136:139], a[156:159]
s_add_u32 s48, s48, 81920
v_mfma_f32_16x16x32_bf16 a[156:159], a[204:207], v[140:143], a[156:159]
s_waitcnt lgkmcnt(6) vmcnt(54)
v_mfma_f32_16x16x32_bf16 a[80:83], a[208:211], v[144:147], a[80:83]
s_waitcnt lgkmcnt(4) vmcnt(53)
ds_read_b64_tr_b16 a[192:193], v54 offset:64
ds_read_b64_tr_b16 a[194:195], v54 offset:5184
s_cmp_eq_u32 s20, 27
s_cselect_b32 s30, 0, s30
s_cselect_b32 s66, 0, s66
v_mfma_f32_16x16x32_bf16 a[80:83], a[212:215], v[148:151], a[80:83]
s_waitcnt vmcnt(52)
s_add_u32 m0, s49, 122880
ds_read_b64_tr_b16 a[196:197], v54 offset:10304
ds_read_b64_tr_b16 a[198:199], v54 offset:15424
v_mfma_f32_16x16x32_bf16 a[84:87], a[208:211], v[152:155], a[84:87]
s_waitcnt vmcnt(51)
buffer_load_dwordx4 v49, s[64:67], s48 offen offset:0 lds
v_mfma_f32_16x16x32_bf16 a[84:87], a[212:215], v[156:159], a[84:87]
s_waitcnt lgkmcnt(6)
v_mfma_f32_16x16x32_bf16 a[88:91], a[216:219], v[144:147], a[88:91]
s_waitcnt lgkmcnt(4)
ds_read_b64_tr_b16 a[200:201], v55 offset:64
ds_read_b64_tr_b16 a[202:203], v55 offset:5184
v_mfma_f32_16x16x32_bf16 a[88:91], a[220:223], v[148:151], a[88:91]
ds_read_b64_tr_b16 a[204:205], v55 offset:10304
ds_read_b64_tr_b16 a[206:207], v55 offset:15424
v_mfma_f32_16x16x32_bf16 a[92:95], a[216:219], v[152:155], a[92:95]
buffer_load_dwordx4 v50, s[64:67], s48 offen offset:1024 lds
v_mfma_f32_16x16x32_bf16 a[92:95], a[220:223], v[156:159], a[92:95]
s_waitcnt lgkmcnt(6)
v_mfma_f32_16x16x32_bf16 a[96:99], a[192:195], v[144:147], a[96:99]
s_waitcnt lgkmcnt(4)
ds_read_b64_tr_b16 a[208:209], v54 offset:128
ds_read_b64_tr_b16 a[210:211], v54 offset:5248
v_mfma_f32_16x16x32_bf16 a[96:99], a[196:199], v[148:151], a[96:99]
ds_read_b64_tr_b16 a[212:213], v54 offset:10368
ds_read_b64_tr_b16 a[214:215], v54 offset:15488
v_mfma_f32_16x16x32_bf16 a[100:103], a[192:195], v[152:155], a[100:103]
buffer_load_dwordx4 v51, s[64:67], s48 offen offset:2048 lds
v_mfma_f32_16x16x32_bf16 a[100:103], a[196:199], v[156:159], a[100:103]
s_waitcnt lgkmcnt(6)
v_mfma_f32_16x16x32_bf16 a[104:107], a[200:203], v[144:147], a[104:107]
s_waitcnt lgkmcnt(4)
ds_read_b64_tr_b16 a[216:217], v55 offset:128
ds_read_b64_tr_b16 a[218:219], v55 offset:5248
v_mfma_f32_16x16x32_bf16 a[104:107], a[204:207], v[148:151], a[104:107]
ds_read_b64_tr_b16 a[220:221], v55 offset:10368
ds_read_b64_tr_b16 a[222:223], v55 offset:15488
v_mfma_f32_16x16x32_bf16 a[108:111], a[200:203], v[152:155], a[108:111]
buffer_load_dwordx4 v52, s[64:67], s48 offen offset:3072 lds
v_mfma_f32_16x16x32_bf16 a[108:111], a[204:207], v[156:159], a[108:111]
s_waitcnt lgkmcnt(6)
v_mfma_f32_16x16x32_bf16 a[112:115], a[208:211], v[144:147], a[112:115]
s_waitcnt lgkmcnt(4)
ds_read_b64_tr_b16 a[192:193], v54 offset:192
ds_read_b64_tr_b16 a[194:195], v54 offset:5312
v_mfma_f32_16x16x32_bf16 a[112:115], a[212:215], v[148:151], a[112:115]
s_add_u32 m0, s49, 126976
ds_read_b64_tr_b16 a[196:197], v54 offset:10432
ds_read_b64_tr_b16 a[198:199], v54 offset:15552
v_mfma_f32_16x16x32_bf16 a[116:119], a[208:211], v[152:155], a[116:119]
buffer_load_dwordx4 v53, s[64:67], s48 offen offset:0 lds
v_mfma_f32_16x16x32_bf16 a[116:119], a[212:215], v[156:159], a[116:119]
s_waitcnt lgkmcnt(6)
v_mfma_f32_16x16x32_bf16 a[120:123], a[216:219], v[144:147], a[120:123]
s_waitcnt lgkmcnt(4)
ds_read_b64_tr_b16 a[200:201], v55 offset:192
ds_read_b64_tr_b16 a[202:203], v55 offset:5312
v_mfma_f32_16x16x32_bf16 a[120:123], a[220:223], v[148:151], a[120:123]
ds_read_b64_tr_b16 a[204:205], v55 offset:10432
ds_read_b64_tr_b16 a[206:207], v55 offset:15552
v_mfma_f32_16x16x32_bf16 a[124:127], a[216:219], v[152:155], a[124:127]
buffer_load_dwordx4 v[112:115], v58, s[28:31], s51 offen offset:0 sc1
v_mfma_f32_16x16x32_bf16 a[124:127], a[220:223], v[156:159], a[124:127]
s_waitcnt lgkmcnt(6)
v_mfma_f32_16x16x32_bf16 a[128:131], a[192:195], v[144:147], a[128:131]
s_waitcnt lgkmcnt(4)
ds_read_b64_tr_b16 a[208:209], v54 offset:256
ds_read_b64_tr_b16 a[210:211], v54 offset:5376
v_mfma_f32_16x16x32_bf16 a[128:131], a[196:199], v[148:151], a[128:131]
ds_read_b64_tr_b16 a[212:213], v54 offset:10496
ds_read_b64_tr_b16 a[214:215], v54 offset:15616
v_mfma_f32_16x16x32_bf16 a[132:135], a[192:195], v[152:155], a[132:135]
buffer_load_dwordx4 v[116:119], v58, s[28:31], s51 offen offset:1024 sc1
v_mfma_f32_16x16x32_bf16 a[132:135], a[196:199], v[156:159], a[132:135]
s_waitcnt lgkmcnt(6)
v_mfma_f32_16x16x32_bf16 a[136:139], a[200:203], v[144:147], a[136:139]
s_waitcnt lgkmcnt(4)
ds_read_b64_tr_b16 a[216:217], v55 offset:256
ds_read_b64_tr_b16 a[218:219], v55 offset:5376
v_mfma_f32_16x16x32_bf16 a[136:139], a[204:207], v[148:151], a[136:139]
ds_read_b64_tr_b16 a[220:221], v55 offset:10496
ds_read_b64_tr_b16 a[222:223], v55 offset:15616
v_mfma_f32_16x16x32_bf16 a[140:143], a[200:203], v[152:155], a[140:143]
buffer_load_dwordx4 v[120:123], v59, s[28:31], s51 offen offset:0 sc1
v_mfma_f32_16x16x32_bf16 a[140:143], a[204:207], v[156:159], a[140:143]
s_waitcnt vmcnt(54)
s_barrier
s_waitcnt lgkmcnt(6)
v_mfma_f32_16x16x32_bf16 a[144:147], a[208:211], v[144:147], a[144:147]
s_waitcnt lgkmcnt(4)
ds_read_b64_tr_b16 a[192:193], v54 offset:20480
ds_read_b64_tr_b16 a[194:195], v54 offset:25600
v_mfma_f32_16x16x32_bf16 a[144:147], a[212:215], v[148:151], a[144:147]
ds_read_b64_tr_b16 a[196:197], v54 offset:30720
ds_read_b64_tr_b16 a[198:199], v54 offset:35840
v_mfma_f32_16x16x32_bf16 a[148:151], a[208:211], v[152:155], a[148:151]
buffer_load_dwordx4 v[124:127], v59, s[28:31], s51 offen offset:1024 sc1
v_mfma_f32_16x16x32_bf16 a[148:151], a[212:215], v[156:159], a[148:151]
s_waitcnt lgkmcnt(6)
v_mfma_f32_16x16x32_bf16 a[152:155], a[216:219], v[144:147], a[152:155]
s_waitcnt lgkmcnt(4)
ds_read_b64_tr_b16 a[200:201], v55 offset:20480
ds_read_b64_tr_b16 a[202:203], v55 offset:25600
v_mfma_f32_16x16x32_bf16 a[152:155], a[220:223], v[148:151], a[152:155]
s_add_u32 s51, s51, 2048
ds_read_b64_tr_b16 a[204:205], v55 offset:30720
ds_read_b64_tr_b16 a[206:207], v55 offset:35840
v_mfma_f32_16x16x32_bf16 a[156:159], a[216:219], v[152:155], a[156:159]
s_add_u32 s48, s48, 81920
v_mfma_f32_16x16x32_bf16 a[156:159], a[220:223], v[156:159], a[156:159]
s_waitcnt lgkmcnt(6) vmcnt(54)
v_mfma_f32_16x16x32_bf16 a[80:83], a[192:195], v[160:163], a[80:83]
s_waitcnt lgkmcnt(4) vmcnt(53)
ds_read_b64_tr_b16 a[208:209], v54 offset:20544
ds_read_b64_tr_b16 a[210:211], v54 offset:25664
s_cmp_eq_u32 s20, 28
s_cselect_b32 s30, 0, s30
s_cselect_b32 s66, 0, s66
v_mfma_f32_16x16x32_bf16 a[80:83], a[196:199], v[164:167], a[80:83]
s_waitcnt vmcnt(52)
s_add_u32 m0, s49, 143360
ds_read_b64_tr_b16 a[212:213], v54 offset:30784
ds_read_b64_tr_b16 a[214:215], v54 offset:35904
v_mfma_f32_16x16x32_bf16 a[84:87], a[192:195], v[168:171], a[84:87]
s_waitcnt vmcnt(51)
buffer_load_dwordx4 v49, s[64:67], s48 offen offset:0 lds
v_mfma_f32_16x16x32_bf16 a[84:87], a[196:199], v[172:175], a[84:87]
s_waitcnt lgkmcnt(6)
v_mfma_f32_16x16x32_bf16 a[88:91], a[200:203], v[160:163], a[88:91]
s_waitcnt lgkmcnt(4)
ds_read_b64_tr_b16 a[216:217], v55 offset:20544
ds_read_b64_tr_b16 a[218:219], v55 offset:25664
v_mfma_f32_16x16x32_bf16 a[88:91], a[204:207], v[164:167], a[88:91]
ds_read_b64_tr_b16 a[220:221], v55 offset:30784
ds_read_b64_tr_b16 a[222:223], v55 offset:35904
v_mfma_f32_16x16x32_bf16 a[92:95], a[200:203], v[168:171], a[92:95]
buffer_load_dwordx4 v50, s[64:67], s48 offen offset:1024 lds
v_mfma_f32_16x16x32_bf16 a[92:95], a[204:207], v[172:175], a[92:95]
s_waitcnt lgkmcnt(6)
v_mfma_f32_16x16x32_bf16 a[96:99], a[208:211], v[160:163], a[96:99]
s_waitcnt lgkmcnt(4)
ds_read_b64_tr_b16 a[192:193], v54 offset:20608
ds_read_b64_tr_b16 a[194:195], v54 offset:25728
v_mfma_f32_16x16x32_bf16 a[96:99], a[212:215], v[164:167], a[96:99]
ds_read_b64_tr_b16 a[196:197], v54 offset:30848
ds_read_b64_tr_b16 a[198:199], v54 offset:35968
v_mfma_f32_16x16x32_bf16 a[100:103], a[208:211], v[168:171], a[100:103]
buffer_load_dwordx4 v51, s[64:67], s48 offen offset:2048 lds
v_mfma_f32_16x16x32_bf16 a[100:103], a[212:215], v[172:175], a[100:103]
s_waitcnt lgkmcnt(6)
v_mfma_f32_16x16x32_bf16 a[104:107], a[216:219], v[160:163], a[104:107]
s_waitcnt lgkmcnt(4)
ds_read_b64_tr_b16 a[200:201], v55 offset:20608
ds_read_b64_tr_b16 a[202:203], v55 offset:25728
v_mfma_f32_16x16x32_bf16 a[104:107], a[220:223], v[164:167], a[104:107]
ds_read_b64_tr_b16 a[204:205], v55 offset:30848
ds_read_b64_tr_b16 a[206:207], v55 offset:35968
v_mfma_f32_16x16x32_bf16 a[108:111], a[216:219], v[168:171], a[108:111]
buffer_load_dwordx4 v52, s[64:67], s48 offen offset:3072 lds
v_mfma_f32_16x16x32_bf16 a[108:111], a[220:223], v[172:175], a[108:111]
s_waitcnt lgkmcnt(6)
v_mfma_f32_16x16x32_bf16 a[112:115], a[192:195], v[160:163], a[112:115]
s_waitcnt lgkmcnt(4)
ds_read_b64_tr_b16 a[208:209], v54 offset:20672
ds_read_b64_tr_b16 a[210:211], v54 offset:25792
v_mfma_f32_16x16x32_bf16 a[112:115], a[196:199], v[164:167], a[112:115]
s_add_u32 m0, s49, 147456
ds_read_b64_tr_b16 a[212:213], v54 offset:30912
ds_read_b64_tr_b16 a[214:215], v54 offset:36032
v_mfma_f32_16x16x32_bf16 a[116:119], a[192:195], v[168:171], a[116:119]
buffer_load_dwordx4 v53, s[64:67], s48 offen offset:0 lds
v_mfma_f32_16x16x32_bf16 a[116:119], a[196:199], v[172:175], a[116:119]
s_waitcnt lgkmcnt(6)
v_mfma_f32_16x16x32_bf16 a[120:123], a[200:203], v[160:163], a[120:123]
s_waitcnt lgkmcnt(4)
ds_read_b64_tr_b16 a[216:217], v55 offset:20672
ds_read_b64_tr_b16 a[218:219], v55 offset:25792
v_mfma_f32_16x16x32_bf16 a[120:123], a[204:207], v[164:167], a[120:123]
ds_read_b64_tr_b16 a[220:221], v55 offset:30912
ds_read_b64_tr_b16 a[222:223], v55 offset:36032
v_mfma_f32_16x16x32_bf16 a[124:127], a[200:203], v[168:171], a[124:127]
buffer_load_dwordx4 v[128:131], v58, s[28:31], s51 offen offset:0 sc1
v_mfma_f32_16x16x32_bf16 a[124:127], a[204:207], v[172:175], a[124:127]
s_waitcnt lgkmcnt(6)
v_mfma_f32_16x16x32_bf16 a[128:131], a[208:211], v[160:163], a[128:131]
s_waitcnt lgkmcnt(4)
ds_read_b64_tr_b16 a[192:193], v54 offset:20736
ds_read_b64_tr_b16 a[194:195], v54 offset:25856
v_mfma_f32_16x16x32_bf16 a[128:131], a[212:215], v[164:167], a[128:131]
ds_read_b64_tr_b16 a[196:197], v54 offset:30976
ds_read_b64_tr_b16 a[198:199], v54 offset:36096
v_mfma_f32_16x16x32_bf16 a[132:135], a[208:211], v[168:171], a[132:135]
buffer_load_dwordx4 v[132:135], v58, s[28:31], s51 offen offset:1024 sc1
v_mfma_f32_16x16x32_bf16 a[132:135], a[212:215], v[172:175], a[132:135]
s_waitcnt lgkmcnt(6)
v_mfma_f32_16x16x32_bf16 a[136:139], a[216:219], v[160:163], a[136:139]
s_waitcnt lgkmcnt(4)
ds_read_b64_tr_b16 a[200:201], v55 offset:20736
ds_read_b64_tr_b16 a[202:203], v55 offset:25856
v_mfma_f32_16x16x32_bf16 a[136:139], a[220:223], v[164:167], a[136:139]
ds_read_b64_tr_b16 a[204:205], v55 offset:30976
ds_read_b64_tr_b16 a[206:207], v55 offset:36096
v_mfma_f32_16x16x32_bf16 a[140:143], a[216:219], v[168:171], a[140:143]
buffer_load_dwordx4 v[136:139], v59, s[28:31], s51 offen offset:0 sc1
v_mfma_f32_16x16x32_bf16 a[140:143], a[220:223], v[172:175], a[140:143]
s_waitcnt vmcnt(54)
s_barrier
s_waitcnt lgkmcnt(6)
v_mfma_f32_16x16x32_bf16 a[144:147], a[192:195], v[160:163], a[144:147]
s_waitcnt lgkmcnt(4)
ds_read_b64_tr_b16 a[208:209], v54 offset:40960
ds_read_b64_tr_b16 a[210:211], v54 offset:46080
v_mfma_f32_16x16x32_bf16 a[144:147], a[196:199], v[164:167], a[144:147]
ds_read_b64_tr_b16 a[212:213], v54 offset:51200
ds_read_b64_tr_b16 a[214:215], v54 offset:56320
v_mfma_f32_16x16x32_bf16 a[148:151], a[192:195], v[168:171], a[148:151]
buffer_load_dwordx4 v[140:143], v59, s[28:31], s51 offen offset:1024 sc1
v_mfma_f32_16x16x32_bf16 a[148:151], a[196:199], v[172:175], a[148:151]
s_waitcnt lgkmcnt(6)
v_mfma_f32_16x16x32_bf16 a[152:155], a[200:203], v[160:163], a[152:155]
s_waitcnt lgkmcnt(4)
ds_read_b64_tr_b16 a[216:217], v55 offset:40960
ds_read_b64_tr_b16 a[218:219], v55 offset:46080
v_mfma_f32_16x16x32_bf16 a[152:155], a[204:207], v[164:167], a[152:155]
s_add_u32 s51, s51, 2048
ds_read_b64_tr_b16 a[220:221], v55 offset:51200
ds_read_b64_tr_b16 a[222:223], v55 offset:56320
v_mfma_f32_16x16x32_bf16 a[156:159], a[200:203], v[168:171], a[156:159]
s_add_u32 s48, s48, 81920
v_mfma_f32_16x16x32_bf16 a[156:159], a[204:207], v[172:175], a[156:159]
s_waitcnt lgkmcnt(6) vmcnt(54)
buffer_load_dword v63, v56, s[60:63], s88 offen sc1
v_mfma_f32_16x16x32_bf16 a[80:83], a[208:211], v[176:179], a[80:83]
s_waitcnt lgkmcnt(4) vmcnt(54)
ds_read_b64_tr_b16 a[192:193], v54 offset:41024
ds_read_b64_tr_b16 a[194:195], v54 offset:46144
s_cmp_eq_u32 s20, 29
s_cselect_b32 s30, 0, s30
s_cselect_b32 s66, 0, s66
v_mfma_f32_16x16x32_bf16 a[80:83], a[212:215], v[180:183], a[80:83]
s_waitcnt vmcnt(53)
s_add_u32 m0, s49, 0
ds_read_b64_tr_b16 a[196:197], v54 offset:51264
ds_read_b64_tr_b16 a[198:199], v54 offset:56384
v_mfma_f32_16x16x32_bf16 a[84:87], a[208:211], v[184:187], a[84:87]
s_waitcnt vmcnt(52)
buffer_load_dwordx4 v49, s[64:67], s48 offen offset:0 lds
v_mfma_f32_16x16x32_bf16 a[84:87], a[212:215], v[188:191], a[84:87]
s_waitcnt lgkmcnt(6)
v_mfma_f32_16x16x32_bf16 a[88:91], a[216:219], v[176:179], a[88:91]
s_waitcnt lgkmcnt(4)
ds_read_b64_tr_b16 a[200:201], v55 offset:41024
ds_read_b64_tr_b16 a[202:203], v55 offset:46144
v_mfma_f32_16x16x32_bf16 a[88:91], a[220:223], v[180:183], a[88:91]
ds_read_b64_tr_b16 a[204:205], v55 offset:51264
ds_read_b64_tr_b16 a[206:207], v55 offset:56384
v_mfma_f32_16x16x32_bf16 a[92:95], a[216:219], v[184:187], a[92:95]
buffer_load_dwordx4 v50, s[64:67], s48 offen offset:1024 lds
v_mfma_f32_16x16x32_bf16 a[92:95], a[220:223], v[188:191], a[92:95]
s_waitcnt lgkmcnt(6)
v_mfma_f32_16x16x32_bf16 a[96:99], a[192:195], v[176:179], a[96:99]
s_waitcnt lgkmcnt(4)
ds_read_b64_tr_b16 a[208:209], v54 offset:41088
ds_read_b64_tr_b16 a[210:211], v54 offset:46208
v_mfma_f32_16x16x32_bf16 a[96:99], a[196:199], v[180:183], a[96:99]
ds_read_b64_tr_b16 a[212:213], v54 offset:51328
ds_read_b64_tr_b16 a[214:215], v54 offset:56448
v_mfma_f32_16x16x32_bf16 a[100:103], a[192:195], v[184:187], a[100:103]
buffer_load_dwordx4 v51, s[64:67], s48 offen offset:2048 lds
v_mfma_f32_16x16x32_bf16 a[100:103], a[196:199], v[188:191], a[100:103]
s_waitcnt lgkmcnt(6)
v_mfma_f32_16x16x32_bf16 a[104:107], a[200:203], v[176:179], a[104:107]
s_waitcnt lgkmcnt(4)
ds_read_b64_tr_b16 a[216:217], v55 offset:41088
ds_read_b64_tr_b16 a[218:219], v55 offset:46208
v_mfma_f32_16x16x32_bf16 a[104:107], a[204:207], v[180:183], a[104:107]
ds_read_b64_tr_b16 a[220:221], v55 offset:51328
ds_read_b64_tr_b16 a[222:223], v55 offset:56448
v_mfma_f32_16x16x32_bf16 a[108:111], a[200:203], v[184:187], a[108:111]
buffer_load_dwordx4 v52, s[64:67], s48 offen offset:3072 lds
v_mfma_f32_16x16x32_bf16 a[108:111], a[204:207], v[188:191], a[108:111]
s_waitcnt lgkmcnt(6)
v_mfma_f32_16x16x32_bf16 a[112:115], a[208:211], v[176:179], a[112:115]
s_waitcnt lgkmcnt(4)
ds_read_b64_tr_b16 a[192:193], v54 offset:41152
ds_read_b64_tr_b16 a[194:195], v54 offset:46272
v_mfma_f32_16x16x32_bf16 a[112:115], a[212:215], v[180:183], a[112:115]
s_add_u32 m0, s49, 4096
ds_read_b64_tr_b16 a[196:197], v54 offset:51392
ds_read_b64_tr_b16 a[198:199], v54 offset:56512
v_mfma_f32_16x16x32_bf16 a[116:119], a[208:211], v[184:187], a[116:119]
buffer_load_dwordx4 v53, s[64:67], s48 offen offset:0 lds
v_mfma_f32_16x16x32_bf16 a[116:119], a[212:215], v[188:191], a[116:119]
s_waitcnt lgkmcnt(6)
v_mfma_f32_16x16x32_bf16 a[120:123], a[216:219], v[176:179], a[120:123]
s_waitcnt lgkmcnt(4)
ds_read_b64_tr_b16 a[200:201], v55 offset:41152
ds_read_b64_tr_b16 a[202:203], v55 offset:46272
v_mfma_f32_16x16x32_bf16 a[120:123], a[220:223], v[180:183], a[120:123]
ds_read_b64_tr_b16 a[204:205], v55 offset:51392
ds_read_b64_tr_b16 a[206:207], v55 offset:56512
v_mfma_f32_16x16x32_bf16 a[124:127], a[216:219], v[184:187], a[124:127]
buffer_load_dwordx4 v[144:147], v58, s[28:31], s51 offen offset:0 sc1
v_mfma_f32_16x16x32_bf16 a[124:127], a[220:223], v[188:191], a[124:127]
s_waitcnt lgkmcnt(6)
v_mfma_f32_16x16x32_bf16 a[128:131], a[192:195], v[176:179], a[128:131]
s_waitcnt lgkmcnt(4)
ds_read_b64_tr_b16 a[208:209], v54 offset:41216
ds_read_b64_tr_b16 a[210:211], v54 offset:46336
v_mfma_f32_16x16x32_bf16 a[128:131], a[196:199], v[180:183], a[128:131]
ds_read_b64_tr_b16 a[212:213], v54 offset:51456
ds_read_b64_tr_b16 a[214:215], v54 offset:56576
v_mfma_f32_16x16x32_bf16 a[132:135], a[192:195], v[184:187], a[132:135]
buffer_load_dwordx4 v[148:151], v58, s[28:31], s51 offen offset:1024 sc1
v_mfma_f32_16x16x32_bf16 a[132:135], a[196:199], v[188:191], a[132:135]
s_waitcnt lgkmcnt(6)
v_mfma_f32_16x16x32_bf16 a[136:139], a[200:203], v[176:179], a[136:139]
s_waitcnt lgkmcnt(4)
ds_read_b64_tr_b16 a[216:217], v55 offset:41216
ds_read_b64_tr_b16 a[218:219], v55 offset:46336
v_mfma_f32_16x16x32_bf16 a[136:139], a[204:207], v[180:183], a[136:139]
ds_read_b64_tr_b16 a[220:221], v55 offset:51456
ds_read_b64_tr_b16 a[222:223], v55 offset:56576
v_mfma_f32_16x16x32_bf16 a[140:143], a[200:203], v[184:187], a[140:143]
buffer_load_dwordx4 v[152:155], v59, s[28:31], s51 offen offset:0 sc1
v_mfma_f32_16x16x32_bf16 a[140:143], a[204:207], v[188:191], a[140:143]
s_waitcnt vmcnt(55)
s_barrier
s_waitcnt lgkmcnt(6)
v_mfma_f32_16x16x32_bf16 a[144:147], a[208:211], v[176:179], a[144:147]
s_waitcnt lgkmcnt(4)
ds_read_b64_tr_b16 a[192:193], v248 offset:0
ds_read_b64_tr_b16 a[194:195], v248 offset:5120
v_mfma_f32_16x16x32_bf16 a[144:147], a[212:215], v[180:183], a[144:147]
ds_read_b64_tr_b16 a[196:197], v248 offset:10240
ds_read_b64_tr_b16 a[198:199], v248 offset:15360
v_mfma_f32_16x16x32_bf16 a[148:151], a[208:211], v[184:187], a[148:151]
buffer_load_dwordx4 v[156:159], v59, s[28:31], s51 offen offset:1024 sc1
v_mfma_f32_16x16x32_bf16 a[148:151], a[212:215], v[188:191], a[148:151]
s_waitcnt lgkmcnt(6)
v_mfma_f32_16x16x32_bf16 a[152:155], a[216:219], v[176:179], a[152:155]
s_waitcnt lgkmcnt(4)
ds_read_b64_tr_b16 a[200:201], v249 offset:0
ds_read_b64_tr_b16 a[202:203], v249 offset:5120
v_mfma_f32_16x16x32_bf16 a[152:155], a[220:223], v[180:183], a[152:155]
s_add_u32 s51, s51, s16
ds_read_b64_tr_b16 a[204:205], v249 offset:10240
ds_read_b64_tr_b16 a[206:207], v249 offset:15360
v_mfma_f32_16x16x32_bf16 a[156:159], a[216:219], v[184:187], a[156:159]
s_add_u32 s48, s48, s23
v_mfma_f32_16x16x32_bf16 a[156:159], a[220:223], v[188:191], a[156:159]
s_cmp_eq_u32 s20, 24
s_cbranch_scc1 L_p2_short
s_waitcnt lgkmcnt(6)
s_waitcnt vmcnt(55)
v_mfma_f32_16x16x32_bf16 a[80:83], a[192:195], v[64:67], a[80:83]
s_waitcnt lgkmcnt(4) vmcnt(54)
ds_read_b64_tr_b16 a[208:209], v248 offset:64
ds_read_b64_tr_b16 a[210:211], v248 offset:5184
s_cmp_eq_u32 s20, 30
s_cselect_b32 s30, 0, s30
s_cselect_b32 s66, 0, s66
v_mfma_f32_16x16x32_bf16 a[80:83], a[196:199], v[68:71], a[80:83]
s_waitcnt vmcnt(53)
s_add_u32 m0, s49, 20480
ds_read_b64_tr_b16 a[212:213], v248 offset:10304
ds_read_b64_tr_b16 a[214:215], v248 offset:15424
v_mfma_f32_16x16x32_bf16 a[84:87], a[192:195], v[72:75], a[84:87]
s_waitcnt vmcnt(52)
buffer_load_dwordx4 v49, s[64:67], s48 offen offset:0 lds
v_mfma_f32_16x16x32_bf16 a[84:87], a[196:199], v[76:79], a[84:87]
s_waitcnt lgkmcnt(6)
v_mfma_f32_16x16x32_bf16 a[88:91], a[200:203], v[64:67], a[88:91]
s_waitcnt lgkmcnt(4)
ds_read_b64_tr_b16 a[216:217], v249 offset:64
ds_read_b64_tr_b16 a[218:219], v249 offset:5184
v_mfma_f32_16x16x32_bf16 a[88:91], a[204:207], v[68:71], a[88:91]
ds_read_b64_tr_b16 a[220:221], v249 offset:10304
ds_read_b64_tr_b16 a[222:223], v249 offset:15424
v_mfma_f32_16x16x32_bf16 a[92:95], a[200:203], v[72:75], a[92:95]
buffer_load_dwordx4 v50, s[64:67], s48 offen offset:1024 lds
v_mfma_f32_16x16x32_bf16 a[92:95], a[204:207], v[76:79], a[92:95]
s_waitcnt lgkmcnt(6)
v_mfma_f32_16x16x32_bf16 a[96:99], a[208:211], v[64:67], a[96:99]
s_waitcnt lgkmcnt(4)
ds_read_b64_tr_b16 a[192:193], v248 offset:128
ds_read_b64_tr_b16 a[194:195], v248 offset:5248
v_mfma_f32_16x16x32_bf16 a[96:99], a[212:215], v[68:71], a[96:99]
ds_read_b64_tr_b16 a[196:197], v248 offset:10368
ds_read_b64_tr_b16 a[198:199], v248 offset:15488
v_mfma_f32_16x16x32_bf16 a[100:103], a[208:211], v[72:75], a[100:103]
buffer_load_dwordx4 v51, s[64:67], s48 offen offset:2048 lds
v_mfma_f32_16x16x32_bf16 a[100:103], a[212:215], v[76:79], a[100:103]
s_waitcnt lgkmcnt(6)
v_mfma_f32_16x16x32_bf16 a[104:107], a[216:219], v[64:67], a[104:107]
s_waitcnt lgkmcnt(4)
ds_read_b64_tr_b16 a[200:201], v249 offset:128
ds_read_b64_tr_b16 a[202:203], v249 offset:5248
v_mfma_f32_16x16x32_bf16 a[104:107], a[220:223], v[68:71], a[104:107]
ds_read_b64_tr_b16 a[204:205], v249 offset:10368
ds_read_b64_tr_b16 a[206:207], v249 offset:15488
v_mfma_f32_16x16x32_bf16 a[108:111], a[216:219], v[72:75], a[108:111]
buffer_load_dwordx4 v52, s[64:67], s48 offen offset:3072 lds
v_mfma_f32_16x16x32_bf16 a[108:111], a[220:223], v[76:79], a[108:111]
s_waitcnt lgkmcnt(6)
v_mfma_f32_16x16x32_bf16 a[112:115], a[192:195], v[64:67], a[112:115]
s_waitcnt lgkmcnt(4)
ds_read_b64_tr_b16 a[208:209], v248 offset:192
ds_read_b64_tr_b16 a[210:211], v248 offset:5312
v_mfma_f32_16x16x32_bf16 a[112:115], a[196:199], v[68:71], a[112:115]
s_add_u32 m0, s49, 24576
ds_read_b64_tr_b16 a[212:213], v248 offset:10432
ds_read_b64_tr_b16 a[214:215], v248 offset:15552
v_mfma_f32_16x16x32_bf16 a[116:119], a[192:195], v[72:75], a[116:119]
buffer_load_dwordx4 v53, s[64:67], s48 offen offset:0 lds
v_mfma_f32_16x16x32_bf16 a[116:119], a[196:199], v[76:79], a[116:119]
s_waitcnt vmcnt(56)
v_cmp_eq_u32 vcc, 0, v15
s_nop 1
s_cbranch_vccnz L_of3
L_of3_b:
s_waitcnt lgkmcnt(6)
v_mfma_f32_16x16x32_bf16 a[120:123], a[200:203], v[64:67], a[120:123]
s_waitcnt lgkmcnt(4)
ds_read_b64_tr_b16 a[216:217], v249 offset:192
ds_read_b64_tr_b16 a[218:219], v249 offset:5312
v_mfma_f32_16x16x32_bf16 a[120:123], a[204:207], v[68:71], a[120:123]
ds_read_b64_tr_b16 a[220:221], v249 offset:10432
ds_read_b64_tr_b16 a[222:223], v249 offset:15552
v_mfma_f32_16x16x32_bf16 a[124:127], a[200:203], v[72:75], a[124:127]
buffer_load_dwordx4 v[160:163], v58, s[28:31], s51 offen offset:0 sc1
v_mfma_f32_16x16x32_bf16 a[124:127], a[204:207], v[76:79], a[124:127]
s_waitcnt lgkmcnt(6)
v_mfma_f32_16x16x32_bf16 a[128:131], a[208:211], v[64:67], a[128:131]
s_waitcnt lgkmcnt(4)
ds_read_b64_tr_b16 a[192:193], v248 offset:256
ds_read_b64_tr_b16 a[194:195], v248 offset:5376
v_mfma_f32_16x16x32_bf16 a[128:131], a[212:215], v[68:71], a[128:131]
ds_read_b64_tr_b16 a[196:197], v248 offset:10496
ds_read_b64_tr_b16 a[198:199], v248 offset:15616
v_mfma_f32_16x16x32_bf16 a[132:135], a[208:211], v[72:75], a[132:135]
buffer_load_dwordx4 v[164:167], v58, s[28:31], s51 offen offset:1024 sc1
v_mfma_f32_16x16x32_bf16 a[132:135], a[212:215], v[76:79], a[132:135]
s_waitcnt lgkmcnt(6)
v_mfma_f32_16x16x32_bf16 a[136:139], a[216:219], v[64:67], a[136:139]
s_waitcnt lgkmcnt(4)
ds_read_b64_tr_b16 a[200:201], v249 offset:256
ds_read_b64_tr_b16 a[202:203], v249 offset:5376
v_mfma_f32_16x16x32_bf16 a[136:139], a[220:223], v[68:71], a[136:139]
ds_read_b64_tr_b16 a[204:205], v249 offset:10496
ds_read_b64_tr_b16 a[206:207], v249 offset:15616
v_mfma_f32_16x16x32_bf16 a[140:143], a[216:219], v[72:75], a[140:143]
buffer_load_dwordx4 v[168:171], v59, s[28:31], s51 offen offset:0 sc1
v_mfma_f32_16x16x32_bf16 a[140:143], a[220:223], v[76:79], a[140:143]
s_waitcnt vmcnt(54)
s_barrier
s_waitcnt lgkmcnt(6)
v_mfma_f32_16x16x32_bf16 a[144:147], a[192:195], v[64:67], a[144:147]
s_waitcnt lgkmcnt(4)
ds_read_b64_tr_b16 a[208:209], v248 offset:20480
ds_read_b64_tr_b16 a[210:211], v248 offset:25600
v_mfma_f32_16x16x32_bf16 a[144:147], a[196:199], v[68:71], a[144:147]
ds_read_b64_tr_b16 a[212:213], v248 offset:30720
ds_read_b64_tr_b16 a[214:215], v248 offset:35840
v_mfma_f32_16x16x32_bf16 a[148:151], a[192:195], v[72:75], a[148:151]
buffer_load_dwordx4 v[172:175], v59, s[28:31], s51 offen offset:1024 sc1
v_mfma_f32_16x16x32_bf16 a[148:151], a[196:199], v[76:79], a[148:151]
s_waitcnt lgkmcnt(6)
v_mfma_f32_16x16x32_bf16 a[152:155], a[200:203], v[64:67], a[152:155]
s_waitcnt lgkmcnt(4)
ds_read_b64_tr_b16 a[216:217], v249 offset:20480
ds_read_b64_tr_b16 a[218:219], v249 offset:25600
v_mfma_f32_16x16x32_bf16 a[152:155], a[204:207], v[68:71], a[152:155]
s_add_u32 s51, s51, 2048
ds_read_b64_tr_b16 a[220:221], v249 offset:30720
ds_read_b64_tr_b16 a[222:223], v249 offset:35840
v_mfma_f32_16x16x32_bf16 a[156:159], a[200:203], v[72:75], a[156:159]
s_add_u32 s48, s48, 81920
v_mfma_f32_16x16x32_bf16 a[156:159], a[204:207], v[76:79], a[156:159]
s_cmp_eq_u32 s20, 25
s_cbranch_scc1 L_p2_short
s_waitcnt lgkmcnt(6)
s_waitcnt vmcnt(54)
v_mfma_f32_16x16x32_bf16 a[80:83], a[208:211], v[80:83], a[80:83]
s_waitcnt lgkmcnt(4) vmcnt(53)
ds_read_b64_tr_b16 a[192:193], v248 offset:20544
ds_read_b64_tr_b16 a[194:195], v248 offset:25664
s_cmp_eq_u32 s20, 31
s_cselect_b32 s30, 0, s30
s_cselect_b32 s66, 0, s66
v_mfma_f32_16x16x32_bf16 a[80:83], a[212:215], v[84:87], a[80:83]
s_waitcnt vmcnt(52)
s_add_u32 m0, s49, 40960
ds_read_b64_tr_b16 a[196:197], v248 offset:30784
ds_read_b64_tr_b16 a[198:199], v248 offset:35904
v_mfma_f32_16x16x32_bf16 a[84:87], a[208:211], v[88:91], a[84:87]
s_waitcnt vmcnt(51)
buffer_load_dwordx4 v49, s[64:67], s48 offen offset:0 lds
v_mfma_f32_16x16x32_bf16 a[84:87], a[212:215], v[92:95], a[84:87]
s_waitcnt lgkmcnt(6)
v_mfma_f32_16x16x32_bf16 a[88:91], a[216:219], v[80:83], a[88:91]
s_waitcnt lgkmcnt(4)
ds_read_b64_tr_b16 a[200:201], v249 offset:20544
ds_read_b64_tr_b16 a[202:203], v249 offset:25664
v_mfma_f32_16x16x32_bf16 a[88:91], a[220:223], v[84:87], a[88:91]
ds_read_b64_tr_b16 a[204:205], v249 offset:30784
ds_read_b64_tr_b16 a[206:207], v249 offset:35904
v_mfma_f32_16x16x32_bf16 a[92:95], a[216:219], v[88:91], a[92:95]
buffer_load_dwordx4 v50, s[64:67], s48 offen offset:1024 lds
v_mfma_f32_16x16x32_bf16 a[92:95], a[220:223], v[92:95], a[92:95]
s_waitcnt lgkmcnt(6)
v_mfma_f32_16x16x32_bf16 a[96:99], a[192:195], v[80:83], a[96:99]
s_waitcnt lgkmcnt(4)
ds_read_b64_tr_b16 a[208:209], v248 offset:20608
ds_read_b64_tr_b16 a[210:211], v248 offset:25728
v_mfma_f32_16x16x32_bf16 a[96:99], a[196:199], v[84:87], a[96:99]
ds_read_b64_tr_b16 a[212:213], v248 offset:30848
ds_read_b64_tr_b16 a[214:215], v248 offset:35968
v_mfma_f32_16x16x32_bf16 a[100:103], a[192:195], v[88:91], a[100:103]
buffer_load_dwordx4 v51, s[64:67], s48 offen offset:2048 lds
v_mfma_f32_16x16x32_bf16 a[100:103], a[196:199], v[92:95], a[100:103]
s_waitcnt lgkmcnt(6)
v_mfma_f32_16x16x32_bf16 a[104:107], a[200:203], v[80:83], a[104:107]
s_waitcnt lgkmcnt(4)
ds_read_b64_tr_b16 a[216:217], v249 offset:20608
ds_read_b64_tr_b16 a[218:219], v249 offset:25728
v_mfma_f32_16x16x32_bf16 a[104:107], a[204:207], v[84:87], a[104:107]
ds_read_b64_tr_b16 a[220:221], v249 offset:30848
ds_read_b64_tr_b16 a[222:223], v249 offset:35968
v_mfma_f32_16x16x32_bf16 a[108:111], a[200:203], v[88:91], a[108:111]
buffer_load_dwordx4 v52, s[64:67], s48 offen offset:3072 lds
v_mfma_f32_16x16x32_bf16 a[108:111], a[204:207], v[92:95], a[108:111]
s_waitcnt lgkmcnt(6)
v_mfma_f32_16x16x32_bf16 a[112:115], a[208:211], v[80:83], a[112:115]
s_waitcnt lgkmcnt(4)
ds_read_b64_tr_b16 a[192:193], v248 offset:20672
ds_read_b64_tr_b16 a[194:195], v248 offset:25792
v_mfma_f32_16x16x32_bf16 a[112:115], a[212:215], v[84:87], a[112:115]
s_add_u32 m0, s49, 45056
ds_read_b64_tr_b16 a[196:197], v248 offset:30912
ds_read_b64_tr_b16 a[198:199], v248 offset:36032
v_mfma_f32_16x16x32_bf16 a[116:119], a[208:211], v[88:91], a[116:119]
buffer_load_dwordx4 v53, s[64:67], s48 offen offset:0 lds
v_mfma_f32_16x16x32_bf16 a[116:119], a[212:215], v[92:95], a[116:119]
s_waitcnt lgkmcnt(6)
v_mfma_f32_16x16x32_bf16 a[120:123], a[216:219], v[80:83], a[120:123]
s_waitcnt lgkmcnt(4)
ds_read_b64_tr_b16 a[200:201], v249 offset:20672
ds_read_b64_tr_b16 a[202:203], v249 offset:25792
v_mfma_f32_16x16x32_bf16 a[120:123], a[220:223], v[84:87], a[120:123]
ds_read_b64_tr_b16 a[204:205], v249 offset:30912
ds_read_b64_tr_b16 a[206:207], v249 offset:36032
v_mfma_f32_16x16x32_bf16 a[124:127], a[216:219], v[88:91], a[124:127]
buffer_load_dwordx4 v[176:179], v58, s[28:31], s51 offen offset:0 sc1
v_mfma_f32_16x16x32_bf16 a[124:127], a[220:223], v[92:95], a[124:127]
s_waitcnt lgkmcnt(6)
v_mfma_f32_16x16x32_bf16 a[128:131], a[192:195], v[80:83], a[128:131]
s_waitcnt lgkmcnt(4)
ds_read_b64_tr_b16 a[208:209], v248 offset:20736
ds_read_b64_tr_b16 a[210:211], v248 offset:25856
v_mfma_f32_16x16x32_bf16 a[128:131], a[196:199], v[84:87], a[128:131]
ds_read_b64_tr_b16 a[212:213], v248 offset:30976
ds_read_b64_tr_b16 a[214:215], v248 offset:36096
v_mfma_f32_16x16x32_bf16 a[132:135], a[192:195], v[88:91], a[132:135]
buffer_load_dwordx4 v[180:183], v58, s[28:31], s51 offen offset:1024 sc1
v_mfma_f32_16x16x32_bf16 a[132:135], a[196:199], v[92:95], a[132:135]
s_waitcnt lgkmcnt(6)
v_mfma_f32_16x16x32_bf16 a[136:139], a[200:203], v[80:83], a[136:139]
s_waitcnt lgkmcnt(4)
ds_read_b64_tr_b16 a[216:217], v249 offset:20736
ds_read_b64_tr_b16 a[218:219], v249 offset:25856
v_mfma_f32_16x16x32_bf16 a[136:139], a[204:207], v[84:87], a[136:139]
ds_read_b64_tr_b16 a[220:221], v249 offset:30976
ds_read_b64_tr_b16 a[222:223], v249 offset:36096
v_mfma_f32_16x16x32_bf16 a[140:143], a[200:203], v[88:91], a[140:143]
buffer_load_dwordx4 v[184:187], v59, s[28:31], s51 offen offset:0 sc1
v_mfma_f32_16x16x32_bf16 a[140:143], a[204:207], v[92:95], a[140:143]
s_waitcnt vmcnt(50)
s_barrier
s_waitcnt lgkmcnt(6)
v_mfma_f32_16x16x32_bf16 a[144:147], a[208:211], v[80:83], a[144:147]
s_waitcnt lgkmcnt(4)
ds_read_b64_tr_b16 a[192:193], v248 offset:40960
ds_read_b64_tr_b16 a[194:195], v248 offset:46080
v_mfma_f32_16x16x32_bf16 a[144:147], a[212:215], v[84:87], a[144:147]
ds_read_b64_tr_b16 a[196:197], v248 offset:51200
ds_read_b64_tr_b16 a[198:199], v248 offset:56320
v_mfma_f32_16x16x32_bf16 a[148:151], a[208:211], v[88:91], a[148:151]
buffer_load_dwordx4 v[188:191], v59, s[28:31], s51 offen offset:1024 sc1
v_mfma_f32_16x16x32_bf16 a[148:151], a[212:215], v[92:95], a[148:151]
s_waitcnt lgkmcnt(6)
v_mfma_f32_16x16x32_bf16 a[152:155], a[216:219], v[80:83], a[152:155]
s_waitcnt lgkmcnt(4)
ds_read_b64_tr_b16 a[200:201], v249 offset:40960
ds_read_b64_tr_b16 a[202:203], v249 offset:46080
v_mfma_f32_16x16x32_bf16 a[152:155], a[220:223], v[84:87], a[152:155]
s_add_u32 s51, s51, 2048
ds_read_b64_tr_b16 a[204:205], v249 offset:51200
ds_read_b64_tr_b16 a[206:207], v249 offset:56320
v_mfma_f32_16x16x32_bf16 a[156:159], a[216:219], v[88:91], a[156:159]
s_add_u32 s48, s48, 81920
v_mfma_f32_16x16x32_bf16 a[156:159], a[220:223], v[92:95], a[156:159]
s_cmp_eq_u32 s20, 26
s_cbranch_scc1 L_p2_short
s_waitcnt lgkmcnt(6)
s_waitcnt vmcnt(49)
v_mfma_f32_16x16x32_bf16 a[80:83], a[192:195], v[96:99], a[80:83]
s_waitcnt lgkmcnt(4) vmcnt(48)
ds_read_b64_tr_b16 a[208:209], v248 offset:41024
ds_read_b64_tr_b16 a[210:211], v248 offset:46144
s_cmp_eq_u32 s20, 32
s_cselect_b32 s30, 0, s30
s_cselect_b32 s66, 0, s66
v_mfma_f32_16x16x32_bf16 a[80:83], a[196:199], v[100:103], a[80:83]
s_waitcnt vmcnt(47)
s_add_u32 m0, s49, 61440
ds_read_b64_tr_b16 a[212:213], v248 offset:51264
ds_read_b64_tr_b16 a[214:215], v248 offset:56384
v_mfma_f32_16x16x32_bf16 a[84:87], a[192:195], v[104:107], a[84:87]
s_waitcnt vmcnt(46)
buffer_load_dwordx4 v49, s[64:67], s48 offen offset:0 lds
v_mfma_f32_16x16x32_bf16 a[84:87], a[196:199], v[108:111], a[84:87]
s_waitcnt lgkmcnt(6)
v_mfma_f32_16x16x32_bf16 a[88:91], a[200:203], v[96:99], a[88:91]
s_waitcnt lgkmcnt(4)
ds_read_b64_tr_b16 a[216:217], v249 offset:41024
ds_read_b64_tr_b16 a[218:219], v249 offset:46144
v_mfma_f32_16x16x32_bf16 a[88:91], a[204:207], v[100:103], a[88:91]
ds_read_b64_tr_b16 a[220:221], v249 offset:51264
ds_read_b64_tr_b16 a[222:223], v249 offset:56384
v_mfma_f32_16x16x32_bf16 a[92:95], a[200:203], v[104:107], a[92:95]
buffer_load_dwordx4 v50, s[64:67], s48 offen offset:1024 lds
v_mfma_f32_16x16x32_bf16 a[92:95], a[204:207], v[108:111], a[92:95]
s_waitcnt lgkmcnt(6)
v_mfma_f32_16x16x32_bf16 a[96:99], a[208:211], v[96:99], a[96:99]
s_waitcnt lgkmcnt(4)
ds_read_b64_tr_b16 a[192:193], v248 offset:41088
ds_read_b64_tr_b16 a[194:195], v248 offset:46208
v_mfma_f32_16x16x32_bf16 a[96:99], a[212:215], v[100:103], a[96:99]
ds_read_b64_tr_b16 a[196:197], v248 offset:51328
ds_read_b64_tr_b16 a[198:199], v248 offset:56448
v_mfma_f32_16x16x32_bf16 a[100:103], a[208:211], v[104:107], a[100:103]
buffer_load_dwordx4 v51, s[64:67], s48 offen offset:2048 lds
v_mfma_f32_16x16x32_bf16 a[100:103], a[212:215], v[108:111], a[100:103]
s_waitcnt lgkmcnt(6)
v_mfma_f32_16x16x32_bf16 a[104:107], a[216:219], v[96:99], a[104:107]
s_waitcnt lgkmcnt(4)
ds_read_b64_tr_b16 a[200:201], v249 offset:41088
ds_read_b64_tr_b16 a[202:203], v249 offset:46208
v_mfma_f32_16x16x32_bf16 a[104:107], a[220:223], v[100:103], a[104:107]
ds_read_b64_tr_b16 a[204:205], v249 offset:51328
ds_read_b64_tr_b16 a[206:207], v249 offset:56448
v_mfma_f32_16x16x32_bf16 a[108:111], a[216:219], v[104:107], a[108:111]
buffer_load_dwordx4 v52, s[64:67], s48 offen offset:3072 lds
v_mfma_f32_16x16x32_bf16 a[108:111], a[220:223], v[108:111], a[108:111]
s_waitcnt lgkmcnt(6)
v_mfma_f32_16x16x32_bf16 a[112:115], a[192:195], v[96:99], a[112:115]
s_waitcnt lgkmcnt(4)
ds_read_b64_tr_b16 a[208:209], v248 offset:41152
ds_read_b64_tr_b16 a[210:211], v248 offset:46272
v_mfma_f32_16x16x32_bf16 a[112:115], a[196:199], v[100:103], a[112:115]
s_add_u32 m0, s49, 65536
ds_read_b64_tr_b16 a[212:213], v248 offset:51392
ds_read_b64_tr_b16 a[214:215], v248 offset:56512
v_mfma_f32_16x16x32_bf16 a[116:119], a[192:195], v[104:107], a[116:119]
buffer_load_dwordx4 v53, s[64:67], s48 offen offset:0 lds
v_mfma_f32_16x16x32_bf16 a[116:119], a[196:199], v[108:111], a[116:119]
s_waitcnt lgkmcnt(6)
v_mfma_f32_16x16x32_bf16 a[120:123], a[200:203], v[96:99], a[120:123]
s_waitcnt lgkmcnt(4)
ds_read_b64_tr_b16 a[216:217], v249 offset:41152
ds_read_b64_tr_b16 a[218:219], v249 offset:46272
v_mfma_f32_16x16x32_bf16 a[120:123], a[204:207], v[100:103], a[120:123]
ds_read_b64_tr_b16 a[220:221], v249 offset:51392
ds_read_b64_tr_b16 a[222:223], v249 offset:56512
v_mfma_f32_16x16x32_bf16 a[124:127], a[200:203], v[104:107], a[124:127]
buffer_load_dwordx4 v[64:67], v58, s[28:31], s51 offen offset:0 sc1
v_mfma_f32_16x16x32_bf16 a[124:127], a[204:207], v[108:111], a[124:127]
s_waitcnt lgkmcnt(6)
v_mfma_f32_16x16x32_bf16 a[128:131], a[208:211], v[96:99], a[128:131]
s_waitcnt lgkmcnt(4)
ds_read_b64_tr_b16 a[192:193], v248 offset:41216
ds_read_b64_tr_b16 a[194:195], v248 offset:46336
v_mfma_f32_16x16x32_bf16 a[128:131], a[212:215], v[100:103], a[128:131]
ds_read_b64_tr_b16 a[196:197], v248 offset:51456
ds_read_b64_tr_b16 a[198:199], v248 offset:56576
v_mfma_f32_16x16x32_bf16 a[132:135], a[208:211], v[104:107], a[132:135]
buffer_load_dwordx4 v[68:71], v58, s[28:31], s51 offen offset:1024 sc1
v_mfma_f32_16x16x32_bf16 a[132:135], a[212:215], v[108:111], a[132:135]
s_waitcnt lgkmcnt(6)
v_mfma_f32_16x16x32_bf16 a[136:139], a[216:219], v[96:99], a[136:139]
s_waitcnt lgkmcnt(4)
ds_read_b64_tr_b16 a[200:201], v249 offset:41216
ds_read_b64_tr_b16 a[202:203], v249 offset:46336
v_mfma_f32_16x16x32_bf16 a[136:139], a[220:223], v[100:103], a[136:139]
ds_read_b64_tr_b16 a[204:205], v249 offset:51456
ds_read_b64_tr_b16 a[206:207], v249 offset:56576
v_mfma_f32_16x16x32_bf16 a[140:143], a[216:219], v[104:107], a[140:143]
buffer_load_dwordx4 v[72:75], v59, s[28:31], s51 offen offset:0 sc1
v_mfma_f32_16x16x32_bf16 a[140:143], a[220:223], v[108:111], a[140:143]
s_waitcnt vmcnt(49)
s_barrier
s_waitcnt lgkmcnt(6)
v_mfma_f32_16x16x32_bf16 a[144:147], a[192:195], v[96:99], a[144:147]
s_waitcnt lgkmcnt(4)
ds_read_b64_tr_b16 a[208:209], v250 offset:0
ds_read_b64_tr_b16 a[210:211], v250 offset:5120
v_mfma_f32_16x16x32_bf16 a[144:147], a[196:199], v[100:103], a[144:147]
ds_read_b64_tr_b16 a[212:213], v250 offset:10240
ds_read_b64_tr_b16 a[214:215], v250 offset:15360
v_mfma_f32_16x16x32_bf16 a[148:151], a[192:195], v[104:107], a[148:151]
buffer_load_dwordx4 v[76:79], v59, s[28:31], s51 offen offset:1024 sc1
v_mfma_f32_16x16x32_bf16 a[148:151], a[196:199], v[108:111], a[148:151]
s_waitcnt lgkmcnt(6)
v_mfma_f32_16x16x32_bf16 a[152:155], a[200:203], v[96:99], a[152:155]
s_waitcnt lgkmcnt(4)
ds_read_b64_tr_b16 a[216:217], v251 offset:0
ds_read_b64_tr_b16 a[218:219], v251 offset:5120
v_mfma_f32_16x16x32_bf16 a[152:155], a[204:207], v[100:103], a[152:155]
s_add_u32 s51, s51, 2048
ds_read_b64_tr_b16 a[220:221], v251 offset:10240
ds_read_b64_tr_b16 a[222:223], v251 offset:15360
v_mfma_f32_16x16x32_bf16 a[156:159], a[200:203], v[104:107], a[156:159]
s_add_u32 s48, s48, 81920
v_mfma_f32_16x16x32_bf16 a[156:159], a[204:207], v[108:111], a[156:159]
s_cmp_eq_u32 s20, 27
s_cbranch_scc1 L_p2_short
s_waitcnt lgkmcnt(6)
s_waitcnt vmcnt(49)
v_mfma_f32_16x16x32_bf16 a[80:83], a[208:211], v[112:115], a[80:83]
s_waitcnt lgkmcnt(4) vmcnt(48)
ds_read_b64_tr_b16 a[192:193], v250 offset:64
ds_read_b64_tr_b16 a[194:195], v250 offset:5184
s_cmp_eq_u32 s20, 33
s_cselect_b32 s30, 0, s30
s_cselect_b32 s66, 0, s66
v_mfma_f32_16x16x32_bf16 a[80:83], a[212:215], v[116:119], a[80:83]
s_waitcnt vmcnt(47)
s_add_u32 m0, s49, 81920
ds_read_b64_tr_b16 a[196:197], v250 offset:10304
ds_read_b64_tr_b16 a[198:199], v250 offset:15424
v_mfma_f32_16x16x32_bf16 a[84:87], a[208:211], v[120:123], a[84:87]
s_waitcnt vmcnt(46)
buffer_load_dwordx4 v49, s[64:67], s48 offen offset:0 lds
v_mfma_f32_16x16x32_bf16 a[84:87], a[212:215], v[124:127], a[84:87]
s_waitcnt lgkmcnt(6)
v_mfma_f32_16x16x32_bf16 a[88:91], a[216:219], v[112:115], a[88:91]
s_waitcnt lgkmcnt(4)
ds_read_b64_tr_b16 a[200:201], v251 offset:64
ds_read_b64_tr_b16 a[202:203], v251 offset:5184
v_mfma_f32_16x16x32_bf16 a[88:91], a[220:223], v[116:119], a[88:91]
ds_read_b64_tr_b16 a[204:205], v251 offset:10304
ds_read_b64_tr_b16 a[206:207], v251 offset:15424
v_mfma_f32_16x16x32_bf16 a[92:95], a[216:219], v[120:123], a[92:95]
buffer_load_dwordx4 v50, s[64:67], s48 offen offset:1024 lds
v_mfma_f32_16x16x32_bf16 a[92:95], a[220:223], v[124:127], a[92:95]
s_waitcnt lgkmcnt(6)
v_mfma_f32_16x16x32_bf16 a[96:99], a[192:195], v[112:115], a[96:99]
s_waitcnt lgkmcnt(4)
ds_read_b64_tr_b16 a[208:209], v250 offset:128
ds_read_b64_tr_b16 a[210:211], v250 offset:5248
v_mfma_f32_16x16x32_bf16 a[96:99], a[196:199], v[116:119], a[96:99]
ds_read_b64_tr_b16 a[212:213], v250 offset:10368
ds_read_b64_tr_b16 a[214:215], v250 offset:15488
v_mfma_f32_16x16x32_bf16 a[100:103], a[192:195], v[120:123], a[100:103]
buffer_load_dwordx4 v51, s[64:67], s48 offen offset:2048 lds
v_mfma_f32_16x16x32_bf16 a[100:103], a[196:199], v[124:127], a[100:103]
s_waitcnt lgkmcnt(6)
v_mfma_f32_16x16x32_bf16 a[104:107], a[200:203], v[112:115], a[104:107]
s_waitcnt lgkmcnt(4)
ds_read_b64_tr_b16 a[216:217], v251 offset:128
ds_read_b64_tr_b16 a[218:219], v251 offset:5248
v_mfma_f32_16x16x32_bf16 a[104:107], a[204:207], v[116:119], a[104:107]
ds_read_b64_tr_b16 a[220:221], v251 offset:10368
ds_read_b64_tr_b16 a[222:223], v251 offset:15488
v_mfma_f32_16x16x32_bf16 a[108:111], a[200:203], v[120:123], a[108:111]
buffer_load_dwordx4 v52, s[64:67], s48 offen offset:3072 lds
v_mfma_f32_16x16x32_bf16 a[108:111], a[204:207], v[124:127], a[108:111]
s_waitcnt lgkmcnt(6)
v_mfma_f32_16x16x32_bf16 a[112:115], a[208:211], v[112:115], a[112:115]
s_waitcnt lgkmcnt(4)
ds_read_b64_tr_b16 a[192:193], v250 offset:192
ds_read_b64_tr_b16 a[194:195], v250 offset:5312
v_mfma_f32_16x16x32_bf16 a[112:115], a[212:215], v[116:119], a[112:115]
s_add_u32 m0, s49, 86016
ds_read_b64_tr_b16 a[196:197], v250 offset:10432
ds_read_b64_tr_b16 a[198:199], v250 offset:15552
v_mfma_f32_16x16x32_bf16 a[116:119], a[208:211], v[120:123], a[116:119]
buffer_load_dwordx4 v53, s[64:67], s48 offen offset:0 lds
v_mfma_f32_16x16x32_bf16 a[116:119], a[212:215], v[124:127], a[116:119]
s_waitcnt lgkmcnt(6)
v_mfma_f32_16x16x32_bf16 a[120:123], a[216:219], v[112:115], a[120:123]
s_waitcnt lgkmcnt(4)
ds_read_b64_tr_b16 a[200:201], v251 offset:192
ds_read_b64_tr_b16 a[202:203], v251 offset:5312
v_mfma_f32_16x16x32_bf16 a[120:123], a[220:223], v[116:119], a[120:123]
ds_read_b64_tr_b16 a[204:205], v251 offset:10432
ds_read_b64_tr_b16 a[206:207], v251 offset:15552
v_mfma_f32_16x16x32_bf16 a[124:127], a[216:219], v[120:123], a[124:127]
buffer_load_dwordx4 v[80:83], v58, s[28:31], s51 offen offset:0 sc1
v_mfma_f32_16x16x32_bf16 a[124:127], a[220:223], v[124:127], a[124:127]
s_waitcnt lgkmcnt(6)
v_mfma_f32_16x16x32_bf16 a[128:131], a[192:195], v[112:115], a[128:131]
s_waitcnt lgkmcnt(4)
ds_read_b64_tr_b16 a[208:209], v250 offset:256
ds_read_b64_tr_b16 a[210:211], v250 offset:5376
v_mfma_f32_16x16x32_bf16 a[128:131], a[196:199], v[116:119], a[128:131]
ds_read_b64_tr_b16 a[212:213], v250 offset:10496
ds_read_b64_tr_b16 a[214:215], v250 offset:15616
v_mfma_f32_16x16x32_bf16 a[132:135], a[192:195], v[120:123], a[132:135]
buffer_load_dwordx4 v[84:87], v58, s[28:31], s51 offen offset:1024 sc1
v_mfma_f32_16x16x32_bf16 a[132:135], a[196:199], v[124:127], a[132:135]
s_waitcnt lgkmcnt(6)
v_mfma_f32_16x16x32_bf16 a[136:139], a[200:203], v[112:115], a[136:139]
s_waitcnt lgkmcnt(4)
ds_read_b64_tr_b16 a[216:217], v251 offset:256
ds_read_b64_tr_b16 a[218:219], v251 offset:5376
v_mfma_f32_16x16x32_bf16 a[136:139], a[204:207], v[116:119], a[136:139]
ds_read_b64_tr_b16 a[220:221], v251 offset:10496
ds_read_b64_tr_b16 a[222:223], v251 offset:15616
v_mfma_f32_16x16x32_bf16 a[140:143], a[200:203], v[120:123], a[140:143]
buffer_load_dwordx4 v[88:91], v59, s[28:31], s51 offen offset:0 sc1
v_mfma_f32_16x16x32_bf16 a[140:143], a[204:207], v[124:127], a[140:143]
s_waitcnt vmcnt(49)
s_barrier
s_waitcnt lgkmcnt(6)
v_mfma_f32_16x16x32_bf16 a[144:147], a[208:211], v[112:115], a[144:147]
s_waitcnt lgkmcnt(4)
ds_read_b64_tr_b16 a[192:193], v250 offset:20480
ds_read_b64_tr_b16 a[194:195], v250 offset:25600
v_mfma_f32_16x16x32_bf16 a[144:147], a[212:215], v[116:119], a[144:147]
ds_read_b64_tr_b16 a[196:197], v250 offset:30720
ds_read_b64_tr_b16 a[198:199], v250 offset:35840
v_mfma_f32_16x16x32_bf16 a[148:151], a[208:211], v[120:123], a[148:151]
buffer_load_dwordx4 v[92:95], v59, s[28:31], s51 offen offset:1024 sc1
v_mfma_f32_16x16x32_bf16 a[148:151], a[212:215], v[124:127], a[148:151]
s_waitcnt lgkmcnt(6)
v_mfma_f32_16x16x32_bf16 a[152:155], a[216:219], v[112:115], a[152:155]
s_waitcnt lgkmcnt(4)
ds_read_b64_tr_b16 a[200:201], v251 offset:20480
ds_read_b64_tr_b16 a[202:203], v251 offset:25600
v_mfma_f32_16x16x32_bf16 a[152:155], a[220:223], v[116:119], a[152:155]
s_add_u32 s51, s51, 2048
ds_read_b64_tr_b16 a[204:205], v251 offset:30720
ds_read_b64_tr_b16 a[206:207], v251 offset:35840
v_mfma_f32_16x16x32_bf16 a[156:159], a[216:219], v[120:123], a[156:159]
s_add_u32 s48, s48, 81920
v_mfma_f32_16x16x32_bf16 a[156:159], a[220:223], v[124:127], a[156:159]
s_cmp_eq_u32 s20, 28
s_cbranch_scc1 L_p2_short
s_waitcnt lgkmcnt(6)
s_waitcnt vmcnt(49)
v_mfma_f32_16x16x32_bf16 a[80:83], a[192:195], v[128:131], a[80:83]
s_waitcnt lgkmcnt(4) vmcnt(48)
ds_read_b64_tr_b16 a[208:209], v250 offset:20544
ds_read_b64_tr_b16 a[210:211], v250 offset:25664
s_cmp_eq_u32 s20, 34
s_cselect_b32 s30, 0, s30
s_cselect_b32 s66, 0, s66
v_mfma_f32_16x16x32_bf16 a[80:83], a[196:199], v[132:135], a[80:83]
s_waitcnt vmcnt(47)
s_add_u32 m0, s49, 102400
ds_read_b64_tr_b16 a[212:213], v250 offset:30784
ds_read_b64_tr_b16 a[214:215], v250 offset:35904
v_mfma_f32_16x16x32_bf16 a[84:87], a[192:195], v[136:139], a[84:87]
s_waitcnt vmcnt(46)
buffer_load_dwordx4 v49, s[64:67], s48 offen offset:0 lds
v_mfma_f32_16x16x32_bf16 a[84:87], a[196:199], v[140:143], a[84:87]
s_waitcnt lgkmcnt(6)
v_mfma_f32_16x16x32_bf16 a[88:91], a[200:203], v[128:131], a[88:91]
s_waitcnt lgkmcnt(4)
ds_read_b64_tr_b16 a[216:217], v251 offset:20544
ds_read_b64_tr_b16 a[218:219], v251 offset:25664
v_mfma_f32_16x16x32_bf16 a[88:91], a[204:207], v[132:135], a[88:91]
ds_read_b64_tr_b16 a[220:221], v251 offset:30784
ds_read_b64_tr_b16 a[222:223], v251 offset:35904
v_mfma_f32_16x16x32_bf16 a[92:95], a[200:203], v[136:139], a[92:95]
buffer_load_dwordx4 v50, s[64:67], s48 offen offset:1024 lds
v_mfma_f32_16x16x32_bf16 a[92:95], a[204:207], v[140:143], a[92:95]
s_waitcnt lgkmcnt(6)
v_mfma_f32_16x16x32_bf16 a[96:99], a[208:211], v[128:131], a[96:99]
s_waitcnt lgkmcnt(4)
ds_read_b64_tr_b16 a[192:193], v250 offset:20608
ds_read_b64_tr_b16 a[194:195], v250 offset:25728
v_mfma_f32_16x16x32_bf16 a[96:99], a[212:215], v[132:135], a[96:99]
ds_read_b64_tr_b16 a[196:197], v250 offset:30848
ds_read_b64_tr_b16 a[198:199], v250 offset:35968
v_mfma_f32_16x16x32_bf16 a[100:103], a[208:211], v[136:139], a[100:103]
buffer_load_dwordx4 v51, s[64:67], s48 offen offset:2048 lds
v_mfma_f32_16x16x32_bf16 a[100:103], a[212:215], v[140:143], a[100:103]
s_waitcnt lgkmcnt(6)
v_mfma_f32_16x16x32_bf16 a[104:107], a[216:219], v[128:131], a[104:107]
s_waitcnt lgkmcnt(4)
ds_read_b64_tr_b16 a[200:201], v251 offset:20608
ds_read_b64_tr_b16 a[202:203], v251 offset:25728
v_mfma_f32_16x16x32_bf16 a[104:107], a[220:223], v[132:135], a[104:107]
ds_read_b64_tr_b16 a[204:205], v251 offset:30848
ds_read_b64_tr_b16 a[206:207], v251 offset:35968
v_mfma_f32_16x16x32_bf16 a[108:111], a[216:219], v[136:139], a[108:111]
buffer_load_dwordx4 v52, s[64:67], s48 offen offset:3072 lds
v_mfma_f32_16x16x32_bf16 a[108:111], a[220:223], v[140:143], a[108:111]
s_waitcnt lgkmcnt(6)
v_mfma_f32_16x16x32_bf16 a[112:115], a[192:195], v[128:131], a[112:115]
s_waitcnt lgkmcnt(4)
ds_read_b64_tr_b16 a[208:209], v250 offset:20672
ds_read_b64_tr_b16 a[210:211], v250 offset:25792
v_mfma_f32_16x16x32_bf16 a[112:115], a[196:199], v[132:135], a[112:115]
s_add_u32 m0, s49, 106496
ds_read_b64_tr_b16 a[212:213], v250 offset:30912
ds_read_b64_tr_b16 a[214:215], v250 offset:36032
v_mfma_f32_16x16x32_bf16 a[116:119], a[192:195], v[136:139], a[116:119]
buffer_load_dwordx4 v53, s[64:67], s48 offen offset:0 lds
v_mfma_f32_16x16x32_bf16 a[116:119], a[196:199], v[140:143], a[116:119]
s_waitcnt lgkmcnt(6)
v_mfma_f32_16x16x32_bf16 a[120:123], a[200:203], v[128:131], a[120:123]
s_waitcnt lgkmcnt(4)
ds_read_b64_tr_b16 a[216:217], v251 offset:20672
ds_read_b64_tr_b16 a[218:219], v251 offset:25792
v_mfma_f32_16x16x32_bf16 a[120:123], a[204:207], v[132:135], a[120:123]
ds_read_b64_tr_b16 a[220:221], v251 offset:30912
ds_read_b64_tr_b16 a[222:223], v251 offset:36032
v_mfma_f32_16x16x32_bf16 a[124:127], a[200:203], v[136:139], a[124:127]
buffer_load_dwordx4 v[96:99], v58, s[28:31], s51 offen offset:0 sc1
v_mfma_f32_16x16x32_bf16 a[124:127], a[204:207], v[140:143], a[124:127]
s_waitcnt lgkmcnt(6)
v_mfma_f32_16x16x32_bf16 a[128:131], a[208:211], v[128:131], a[128:131]
s_waitcnt lgkmcnt(4)
ds_read_b64_tr_b16 a[192:193], v250 offset:20736
ds_read_b64_tr_b16 a[194:195], v250 offset:25856
v_mfma_f32_16x16x32_bf16 a[128:131], a[212:215], v[132:135], a[128:131]
ds_read_b64_tr_b16 a[196:197], v250 offset:30976
ds_read_b64_tr_b16 a[198:199], v250 offset:36096
v_mfma_f32_16x16x32_bf16 a[132:135], a[208:211], v[136:139], a[132:135]
buffer_load_dwordx4 v[100:103], v58, s[28:31], s51 offen offset:1024 sc1
v_mfma_f32_16x16x32_bf16 a[132:135], a[212:215], v[140:143], a[132:135]
s_waitcnt lgkmcnt(6)
v_mfma_f32_16x16x32_bf16 a[136:139], a[216:219], v[128:131], a[136:139]
s_waitcnt lgkmcnt(4)
ds_read_b64_tr_b16 a[200:201], v251 offset:20736
ds_read_b64_tr_b16 a[202:203], v251 offset:25856
v_mfma_f32_16x16x32_bf16 a[136:139], a[220:223], v[132:135], a[136:139]
ds_read_b64_tr_b16 a[204:205], v251 offset:30976
ds_read_b64_tr_b16 a[206:207], v251 offset:36096
v_mfma_f32_16x16x32_bf16 a[140:143], a[216:219], v[136:139], a[140:143]
buffer_load_dwordx4 v[104:107], v59, s[28:31], s51 offen offset:0 sc1
v_mfma_f32_16x16x32_bf16 a[140:143], a[220:223], v[140:143], a[140:143]
s_waitcnt vmcnt(48)
s_barrier
s_waitcnt lgkmcnt(6)
v_mfma_f32_16x16x32_bf16 a[144:147], a[192:195], v[128:131], a[144:147]
s_waitcnt lgkmcnt(4)
ds_read_b64_tr_b16 a[208:209], v54 offset:0
ds_read_b64_tr_b16 a[210:211], v54 offset:5120
v_mfma_f32_16x16x32_bf16 a[144:147], a[196:199], v[132:135], a[144:147]
ds_read_b64_tr_b16 a[212:213], v54 offset:10240
ds_read_b64_tr_b16 a[214:215], v54 offset:15360
v_mfma_f32_16x16x32_bf16 a[148:151], a[192:195], v[136:139], a[148:151]
buffer_load_dwordx4 v[108:111], v59, s[28:31], s51 offen offset:1024 sc1
v_mfma_f32_16x16x32_bf16 a[148:151], a[196:199], v[140:143], a[148:151]
s_waitcnt lgkmcnt(6)
v_mfma_f32_16x16x32_bf16 a[152:155], a[200:203], v[128:131], a[152:155]
s_waitcnt lgkmcnt(4)
ds_read_b64_tr_b16 a[216:217], v55 offset:0
ds_read_b64_tr_b16 a[218:219], v55 offset:5120
v_mfma_f32_16x16x32_bf16 a[152:155], a[204:207], v[132:135], a[152:155]
s_add_u32 s51, s51, 2048
ds_read_b64_tr_b16 a[220:221], v55 offset:10240
ds_read_b64_tr_b16 a[222:223], v55 offset:15360
v_mfma_f32_16x16x32_bf16 a[156:159], a[200:203], v[136:139], a[156:159]
s_add_u32 s48, s48, 81920
v_mfma_f32_16x16x32_bf16 a[156:159], a[204:207], v[140:143], a[156:159]
s_cmp_eq_u32 s20, 29
s_cbranch_scc1 L_p2_short
s_waitcnt lgkmcnt(6)
s_waitcnt vmcnt(48)
v_mfma_f32_16x16x32_bf16 a[80:83], a[208:211], v[144:147], a[80:83]
s_waitcnt lgkmcnt(4) vmcnt(47)
ds_read_b64_tr_b16 a[192:193], v54 offset:64
ds_read_b64_tr_b16 a[194:195], v54 offset:5184
s_cmp_eq_u32 s20, 35
s_cselect_b32 s30, 0, s30
s_cselect_b32 s66, 0, s66
v_mfma_f32_16x16x32_bf16 a[80:83], a[212:215], v[148:151], a[80:83]
s_waitcnt vmcnt(46)
s_add_u32 m0, s49, 122880
ds_read_b64_tr_b16 a[196:197], v54 offset:10304
ds_read_b64_tr_b16 a[198:199], v54 offset:15424
v_mfma_f32_16x16x32_bf16 a[84:87], a[208:211], v[152:155], a[84:87]
s_waitcnt vmcnt(45)
buffer_load_dwordx4 v49, s[64:67], s48 offen offset:0 lds
v_mfma_f32_16x16x32_bf16 a[84:87], a[212:215], v[156:159], a[84:87]
s_waitcnt lgkmcnt(6)
v_mfma_f32_16x16x32_bf16 a[88:91], a[216:219], v[144:147], a[88:91]
s_waitcnt lgkmcnt(4)
ds_read_b64_tr_b16 a[200:201], v55 offset:64
ds_read_b64_tr_b16 a[202:203], v55 offset:5184
v_mfma_f32_16x16x32_bf16 a[88:91], a[220:223], v[148:151], a[88:91]
ds_read_b64_tr_b16 a[204:205], v55 offset:10304
ds_read_b64_tr_b16 a[206:207], v55 offset:15424
v_mfma_f32_16x16x32_bf16 a[92:95], a[216:219], v[152:155], a[92:95]
buffer_load_dwordx4 v50, s[64:67], s48 offen offset:1024 lds
v_mfma_f32_16x16x32_bf16 a[92:95], a[220:223], v[156:159], a[92:95]
s_waitcnt lgkmcnt(6)
v_mfma_f32_16x16x32_bf16 a[96:99], a[192:195], v[144:147], a[96:99]
s_waitcnt lgkmcnt(4)
ds_read_b64_tr_b16 a[208:209], v54 offset:128
ds_read_b64_tr_b16 a[210:211], v54 offset:5248
v_mfma_f32_16x16x32_bf16 a[96:99], a[196:199], v[148:151], a[96:99]
ds_read_b64_tr_b16 a[212:213], v54 offset:10368
ds_read_b64_tr_b16 a[214:215], v54 offset:15488
v_mfma_f32_16x16x32_bf16 a[100:103], a[192:195], v[152:155], a[100:103]
buffer_load_dwordx4 v51, s[64:67], s48 offen offset:2048 lds
v_mfma_f32_16x16x32_bf16 a[100:103], a[196:199], v[156:159], a[100:103]
s_waitcnt lgkmcnt(6)
v_mfma_f32_16x16x32_bf16 a[104:107], a[200:203], v[144:147], a[104:107]
s_waitcnt lgkmcnt(4)
ds_read_b64_tr_b16 a[216:217], v55 offset:128
ds_read_b64_tr_b16 a[218:219], v55 offset:5248
v_mfma_f32_16x16x32_bf16 a[104:107], a[204:207], v[148:151], a[104:107]
ds_read_b64_tr_b16 a[220:221], v55 offset:10368
ds_read_b64_tr_b16 a[222:223], v55 offset:15488
v_mfma_f32_16x16x32_bf16 a[108:111], a[200:203], v[152:155], a[108:111]
buffer_load_dwordx4 v52, s[64:67], s48 offen offset:3072 lds
v_mfma_f32_16x16x32_bf16 a[108:111], a[204:207], v[156:159], a[108:111]
s_waitcnt lgkmcnt(6)
v_mfma_f32_16x16x32_bf16 a[112:115], a[208:211], v[144:147], a[112:115]
s_waitcnt lgkmcnt(4)
ds_read_b64_tr_b16 a[192:193], v54 offset:192
ds_read_b64_tr_b16 a[194:195], v54 offset:5312
v_mfma_f32_16x16x32_bf16 a[112:115], a[212:215], v[148:151], a[112:115]
s_add_u32 m0, s49, 126976
ds_read_b64_tr_b16 a[196:197], v54 offset:10432
ds_read_b64_tr_b16 a[198:199], v54 offset:15552
v_mfma_f32_16x16x32_bf16 a[116:119], a[208:211], v[152:155], a[116:119]
buffer_load_dwordx4 v53, s[64:67], s48 offen offset:0 lds
v_mfma_f32_16x16x32_bf16 a[116:119], a[212:215], v[156:159], a[116:119]
s_waitcnt lgkmcnt(6)
v_mfma_f32_16x16x32_bf16 a[120:123], a[216:219], v[144:147], a[120:123]
s_waitcnt lgkmcnt(4)
ds_read_b64_tr_b16 a[200:201], v55 offset:192
ds_read_b64_tr_b16 a[202:203], v55 offset:5312
v_mfma_f32_16x16x32_bf16 a[120:123], a[220:223], v[148:151], a[120:123]
ds_read_b64_tr_b16 a[204:205], v55 offset:10432
ds_read_b64_tr_b16 a[206:207], v55 offset:15552
v_mfma_f32_16x16x32_bf16 a[124:127], a[216:219], v[152:155], a[124:127]
buffer_load_dwordx4 v[112:115], v58, s[28:31], s51 offen offset:0 sc1
v_mfma_f32_16x16x32_bf16 a[124:127], a[220:223], v[156:159], a[124:127]
s_waitcnt lgkmcnt(6)
v_mfma_f32_16x16x32_bf16 a[128:131], a[192:195], v[144:147], a[128:131]
s_waitcnt lgkmcnt(4)
ds_read_b64_tr_b16 a[208:209], v54 offset:256
ds_read_b64_tr_b16 a[210:211], v54 offset:5376
v_mfma_f32_16x16x32_bf16 a[128:131], a[196:199], v[148:151], a[128:131]
ds_read_b64_tr_b16 a[212:213], v54 offset:10496
ds_read_b64_tr_b16 a[214:215], v54 offset:15616
v_mfma_f32_16x16x32_bf16 a[132:135], a[192:195], v[152:155], a[132:135]
buffer_load_dwordx4 v[116:119], v58, s[28:31], s51 offen offset:1024 sc1
v_mfma_f32_16x16x32_bf16 a[132:135], a[196:199], v[156:159], a[132:135]
s_waitcnt lgkmcnt(6)
v_mfma_f32_16x16x32_bf16 a[136:139], a[200:203], v[144:147], a[136:139]
s_waitcnt lgkmcnt(4)
ds_read_b64_tr_b16 a[216:217], v55 offset:256
ds_read_b64_tr_b16 a[218:219], v55 offset:5376
v_mfma_f32_16x16x32_bf16 a[136:139], a[204:207], v[148:151], a[136:139]
ds_read_b64_tr_b16 a[220:221], v55 offset:10496
ds_read_b64_tr_b16 a[222:223], v55 offset:15616
v_mfma_f32_16x16x32_bf16 a[140:143], a[200:203], v[152:155], a[140:143]
buffer_load_dwordx4 v[120:123], v59, s[28:31], s51 offen offset:0 sc1
v_mfma_f32_16x16x32_bf16 a[140:143], a[204:207], v[156:159], a[140:143]
s_waitcnt vmcnt(48)
s_barrier
s_waitcnt lgkmcnt(6)
v_mfma_f32_16x16x32_bf16 a[144:147], a[208:211], v[144:147], a[144:147]
s_waitcnt lgkmcnt(4)
ds_read_b64_tr_b16 a[192:193], v54 offset:20480
ds_read_b64_tr_b16 a[194:195], v54 offset:25600
v_mfma_f32_16x16x32_bf16 a[144:147], a[212:215], v[148:151], a[144:147]
ds_read_b64_tr_b16 a[196:197], v54 offset:30720
ds_read_b64_tr_b16 a[198:199], v54 offset:35840
v_mfma_f32_16x16x32_bf16 a[148:151], a[208:211], v[152:155], a[148:151]
buffer_load_dwordx4 v[124:127], v59, s[28:31], s51 offen offset:1024 sc1
v_mfma_f32_16x16x32_bf16 a[148:151], a[212:215], v[156:159], a[148:151]
s_waitcnt lgkmcnt(6)
v_mfma_f32_16x16x32_bf16 a[152:155], a[216:219], v[144:147], a[152:155]
s_waitcnt lgkmcnt(4)
ds_read_b64_tr_b16 a[200:201], v55 offset:20480
ds_read_b64_tr_b16 a[202:203], v55 offset:25600
v_mfma_f32_16x16x32_bf16 a[152:155], a[220:223], v[148:151], a[152:155]
s_add_u32 s51, s51, 2048
ds_read_b64_tr_b16 a[204:205], v55 offset:30720
ds_read_b64_tr_b16 a[206:207], v55 offset:35840
v_mfma_f32_16x16x32_bf16 a[156:159], a[216:219], v[152:155], a[156:159]
s_add_u32 s48, s48, 81920
v_mfma_f32_16x16x32_bf16 a[156:159], a[220:223], v[156:159], a[156:159]
s_cmp_eq_u32 s20, 30
s_cbranch_scc1 L_p2_short
s_waitcnt lgkmcnt(6)
s_waitcnt vmcnt(48)
v_mfma_f32_16x16x32_bf16 a[80:83], a[192:195], v[160:163], a[80:83]
s_waitcnt lgkmcnt(4) vmcnt(47)
ds_read_b64_tr_b16 a[208:209], v54 offset:20544
ds_read_b64_tr_b16 a[210:211], v54 offset:25664
v_mfma_f32_16x16x32_bf16 a[80:83], a[196:199], v[164:167], a[80:83]
s_waitcnt vmcnt(46)
ds_read_b64_tr_b16 a[212:213], v54 offset:30784
ds_read_b64_tr_b16 a[214:215], v54 offset:35904
v_mfma_f32_16x16x32_bf16 a[84:87], a[192:195], v[168:171], a[84:87]
s_waitcnt vmcnt(45)
v_mfma_f32_16x16x32_bf16 a[84:87], a[196:199], v[172:175], a[84:87]
s_waitcnt lgkmcnt(6)
v_mfma_f32_16x16x32_bf16 a[88:91], a[200:203], v[160:163], a[88:91]
s_waitcnt lgkmcnt(4)
ds_read_b64_tr_b16 a[216:217], v55 offset:20544
ds_read_b64_tr_b16 a[218:219], v55 offset:25664
v_mfma_f32_16x16x32_bf16 a[88:91], a[204:207], v[164:167], a[88:91]
ds_read_b64_tr_b16 a[220:221], v55 offset:30784
ds_read_b64_tr_b16 a[222:223], v55 offset:35904
v_mfma_f32_16x16x32_bf16 a[92:95], a[200:203], v[168:171], a[92:95]
v_mfma_f32_16x16x32_bf16 a[92:95], a[204:207], v[172:175], a[92:95]
s_waitcnt lgkmcnt(6)
v_mfma_f32_16x16x32_bf16 a[96:99], a[208:211], v[160:163], a[96:99]
s_waitcnt lgkmcnt(4)
ds_read_b64_tr_b16 a[192:193], v54 offset:20608
ds_read_b64_tr_b16 a[194:195], v54 offset:25728
v_mfma_f32_16x16x32_bf16 a[96:99], a[212:215], v[164:167], a[96:99]
ds_read_b64_tr_b16 a[196:197], v54 offset:30848
ds_read_b64_tr_b16 a[198:199], v54 offset:35968
v_mfma_f32_16x16x32_bf16 a[100:103], a[208:211], v[168:171], a[100:103]
v_mfma_f32_16x16x32_bf16 a[100:103], a[212:215], v[172:175], a[100:103]
s_waitcnt lgkmcnt(6)
v_mfma_f32_16x16x32_bf16 a[104:107], a[216:219], v[160:163], a[104:107]
s_waitcnt lgkmcnt(4)
ds_read_b64_tr_b16 a[200:201], v55 offset:20608
ds_read_b64_tr_b16 a[202:203], v55 offset:25728
v_mfma_f32_16x16x32_bf16 a[104:107], a[220:223], v[164:167], a[104:107]
ds_read_b64_tr_b16 a[204:205], v55 offset:30848
ds_read_b64_tr_b16 a[206:207], v55 offset:35968
v_mfma_f32_16x16x32_bf16 a[108:111], a[216:219], v[168:171], a[108:111]
v_mfma_f32_16x16x32_bf16 a[108:111], a[220:223], v[172:175], a[108:111]
s_waitcnt lgkmcnt(6)
v_mfma_f32_16x16x32_bf16 a[112:115], a[192:195], v[160:163], a[112:115]
s_waitcnt lgkmcnt(4)
ds_read_b64_tr_b16 a[208:209], v54 offset:20672
ds_read_b64_tr_b16 a[210:211], v54 offset:25792
v_mfma_f32_16x16x32_bf16 a[112:115], a[196:199], v[164:167], a[112:115]
ds_read_b64_tr_b16 a[212:213], v54 offset:30912
ds_read_b64_tr_b16 a[214:215], v54 offset:36032
v_mfma_f32_16x16x32_bf16 a[116:119], a[192:195], v[168:171], a[116:119]
v_mfma_f32_16x16x32_bf16 a[116:119], a[196:199], v[172:175], a[116:119]
s_waitcnt lgkmcnt(6)
v_mfma_f32_16x16x32_bf16 a[120:123], a[200:203], v[160:163], a[120:123]
s_waitcnt lgkmcnt(4)
ds_read_b64_tr_b16 a[216:217], v55 offset:20672
ds_read_b64_tr_b16 a[218:219], v55 offset:25792
v_mfma_f32_16x16x32_bf16 a[120:123], a[204:207], v[164:167], a[120:123]
ds_read_b64_tr_b16 a[220:221], v55 offset:30912
ds_read_b64_tr_b16 a[222:223], v55 offset:36032
v_mfma_f32_16x16x32_bf16 a[124:127], a[200:203], v[168:171], a[124:127]
v_mfma_f32_16x16x32_bf16 a[124:127], a[204:207], v[172:175], a[124:127]
s_waitcnt lgkmcnt(6)
v_mfma_f32_16x16x32_bf16 a[128:131], a[208:211], v[160:163], a[128:131]
s_waitcnt lgkmcnt(4)
ds_read_b64_tr_b16 a[192:193], v54 offset:20736
ds_read_b64_tr_b16 a[194:195], v54 offset:25856
v_mfma_f32_16x16x32_bf16 a[128:131], a[212:215], v[164:167], a[128:131]
ds_read_b64_tr_b16 a[196:197], v54 offset:30976
ds_read_b64_tr_b16 a[198:199], v54 offset:36096
v_mfma_f32_16x16x32_bf16 a[132:135], a[208:211], v[168:171], a[132:135]
v_mfma_f32_16x16x32_bf16 a[132:135], a[212:215], v[172:175], a[132:135]
s_waitcnt lgkmcnt(6)
v_mfma_f32_16x16x32_bf16 a[136:139], a[216:219], v[160:163], a[136:139]
s_waitcnt lgkmcnt(4)
ds_read_b64_tr_b16 a[200:201], v55 offset:20736
ds_read_b64_tr_b16 a[202:203], v55 offset:25856
v_mfma_f32_16x16x32_bf16 a[136:139], a[220:223], v[164:167], a[136:139]
ds_read_b64_tr_b16 a[204:205], v55 offset:30976
ds_read_b64_tr_b16 a[206:207], v55 offset:36096
v_mfma_f32_16x16x32_bf16 a[140:143], a[216:219], v[168:171], a[140:143]
v_mfma_f32_16x16x32_bf16 a[140:143], a[220:223], v[172:175], a[140:143]
s_waitcnt vmcnt(40)
s_barrier
s_waitcnt lgkmcnt(6)
v_mfma_f32_16x16x32_bf16 a[144:147], a[192:195], v[160:163], a[144:147]
s_waitcnt lgkmcnt(4)
ds_read_b64_tr_b16 a[208:209], v54 offset:40960
ds_read_b64_tr_b16 a[210:211], v54 offset:46080
v_mfma_f32_16x16x32_bf16 a[144:147], a[196:199], v[164:167], a[144:147]
ds_read_b64_tr_b16 a[212:213], v54 offset:51200
ds_read_b64_tr_b16 a[214:215], v54 offset:56320
v_mfma_f32_16x16x32_bf16 a[148:151], a[192:195], v[168:171], a[148:151]
v_mfma_f32_16x16x32_bf16 a[148:151], a[196:199], v[172:175], a[148:151]
s_waitcnt lgkmcnt(6)
v_mfma_f32_16x16x32_bf16 a[152:155], a[200:203], v[160:163], a[152:155]
s_waitcnt lgkmcnt(4)
ds_read_b64_tr_b16 a[216:217], v55 offset:40960
ds_read_b64_tr_b16 a[218:219], v55 offset:46080
v_mfma_f32_16x16x32_bf16 a[152:155], a[204:207], v[164:167], a[152:155]
ds_read_b64_tr_b16 a[220:221], v55 offset:51200
ds_read_b64_tr_b16 a[222:223], v55 offset:56320
v_mfma_f32_16x16x32_bf16 a[156:159], a[200:203], v[168:171], a[156:159]
v_mfma_f32_16x16x32_bf16 a[156:159], a[204:207], v[172:175], a[156:159]
s_cmp_eq_u32 s20, 31
s_cbranch_scc1 L_p2_short
s_waitcnt lgkmcnt(6)
s_waitcnt vmcnt(39)
v_mfma_f32_16x16x32_bf16 a[80:83], a[208:211], v[176:179], a[80:83]
s_waitcnt lgkmcnt(4) vmcnt(38)
ds_read_b64_tr_b16 a[192:193], v54 offset:41024
ds_read_b64_tr_b16 a[194:195], v54 offset:46144
v_mfma_f32_16x16x32_bf16 a[80:83], a[212:215], v[180:183], a[80:83]
s_waitcnt vmcnt(37)
ds_read_b64_tr_b16 a[196:197], v54 offset:51264
ds_read_b64_tr_b16 a[198:199], v54 offset:56384
v_mfma_f32_16x16x32_bf16 a[84:87], a[208:211], v[184:187], a[84:87]
s_waitcnt vmcnt(36)
v_mfma_f32_16x16x32_bf16 a[84:87], a[212:215], v[188:191], a[84:87]
s_waitcnt lgkmcnt(6)
v_mfma_f32_16x16x32_bf16 a[88:91], a[216:219], v[176:179], a[88:91]
s_waitcnt lgkmcnt(4)
ds_read_b64_tr_b16 a[200:201], v55 offset:41024
ds_read_b64_tr_b16 a[202:203], v55 offset:46144
v_mfma_f32_16x16x32_bf16 a[88:91], a[220:223], v[180:183], a[88:91]
ds_read_b64_tr_b16 a[204:205], v55 offset:51264
ds_read_b64_tr_b16 a[206:207], v55 offset:56384
v_mfma_f32_16x16x32_bf16 a[92:95], a[216:219], v[184:187], a[92:95]
v_mfma_f32_16x16x32_bf16 a[92:95], a[220:223], v[188:191], a[92:95]
s_waitcnt lgkmcnt(6)
v_mfma_f32_16x16x32_bf16 a[96:99], a[192:195], v[176:179], a[96:99]
s_waitcnt lgkmcnt(4)
ds_read_b64_tr_b16 a[208:209], v54 offset:41088
ds_read_b64_tr_b16 a[210:211], v54 offset:46208
v_mfma_f32_16x16x32_bf16 a[96:99], a[196:199], v[180:183], a[96:99]
ds_read_b64_tr_b16 a[212:213], v54 offset:51328
ds_read_b64_tr_b16 a[214:215], v54 offset:56448
v_mfma_f32_16x16x32_bf16 a[100:103], a[192:195], v[184:187], a[100:103]
v_mfma_f32_16x16x32_bf16 a[100:103], a[196:199], v[188:191], a[100:103]
s_waitcnt lgkmcnt(6)
v_mfma_f32_16x16x32_bf16 a[104:107], a[200:203], v[176:179], a[104:107]
s_waitcnt lgkmcnt(4)
ds_read_b64_tr_b16 a[216:217], v55 offset:41088
ds_read_b64_tr_b16 a[218:219], v55 offset:46208
v_mfma_f32_16x16x32_bf16 a[104:107], a[204:207], v[180:183], a[104:107]
ds_read_b64_tr_b16 a[220:221], v55 offset:51328
ds_read_b64_tr_b16 a[222:223], v55 offset:56448
v_mfma_f32_16x16x32_bf16 a[108:111], a[200:203], v[184:187], a[108:111]
v_mfma_f32_16x16x32_bf16 a[108:111], a[204:207], v[188:191], a[108:111]
s_waitcnt lgkmcnt(6)
v_mfma_f32_16x16x32_bf16 a[112:115], a[208:211], v[176:179], a[112:115]
s_waitcnt lgkmcnt(4)
ds_read_b64_tr_b16 a[192:193], v54 offset:41152
ds_read_b64_tr_b16 a[194:195], v54 offset:46272
v_mfma_f32_16x16x32_bf16 a[112:115], a[212:215], v[180:183], a[112:115]
ds_read_b64_tr_b16 a[196:197], v54 offset:51392
ds_read_b64_tr_b16 a[198:199], v54 offset:56512
v_mfma_f32_16x16x32_bf16 a[116:119], a[208:211], v[184:187], a[116:119]
v_mfma_f32_16x16x32_bf16 a[116:119], a[212:215], v[188:191], a[116:119]
s_waitcnt lgkmcnt(6)
v_mfma_f32_16x16x32_bf16 a[120:123], a[216:219], v[176:179], a[120:123]
s_waitcnt lgkmcnt(4)
ds_read_b64_tr_b16 a[200:201], v55 offset:41152
ds_read_b64_tr_b16 a[202:203], v55 offset:46272
v_mfma_f32_16x16x32_bf16 a[120:123], a[220:223], v[180:183], a[120:123]
ds_read_b64_tr_b16 a[204:205], v55 offset:51392
ds_read_b64_tr_b16 a[206:207], v55 offset:56512
v_mfma_f32_16x16x32_bf16 a[124:127], a[216:219], v[184:187], a[124:127]
v_mfma_f32_16x16x32_bf16 a[124:127], a[220:223], v[188:191], a[124:127]
s_waitcnt lgkmcnt(6)
v_mfma_f32_16x16x32_bf16 a[128:131], a[192:195], v[176:179], a[128:131]
s_waitcnt lgkmcnt(4)
ds_read_b64_tr_b16 a[208:209], v54 offset:41216
ds_read_b64_tr_b16 a[210:211], v54 offset:46336
v_mfma_f32_16x16x32_bf16 a[128:131], a[196:199], v[180:183], a[128:131]
ds_read_b64_tr_b16 a[212:213], v54 offset:51456
ds_read_b64_tr_b16 a[214:215], v54 offset:56576
v_mfma_f32_16x16x32_bf16 a[132:135], a[192:195], v[184:187], a[132:135]
v_mfma_f32_16x16x32_bf16 a[132:135], a[196:199], v[188:191], a[132:135]
s_waitcnt lgkmcnt(6)
v_mfma_f32_16x16x32_bf16 a[136:139], a[200:203], v[176:179], a[136:139]
s_waitcnt lgkmcnt(4)
ds_read_b64_tr_b16 a[216:217], v55 offset:41216
ds_read_b64_tr_b16 a[218:219], v55 offset:46336
v_mfma_f32_16x16x32_bf16 a[136:139], a[204:207], v[180:183], a[136:139]
ds_read_b64_tr_b16 a[220:221], v55 offset:51456
ds_read_b64_tr_b16 a[222:223], v55 offset:56576
v_mfma_f32_16x16x32_bf16 a[140:143], a[200:203], v[184:187], a[140:143]
v_mfma_f32_16x16x32_bf16 a[140:143], a[204:207], v[188:191], a[140:143]
s_waitcnt vmcnt(31)
s_barrier
s_waitcnt lgkmcnt(6)
v_mfma_f32_16x16x32_bf16 a[144:147], a[208:211], v[176:179], a[144:147]
s_waitcnt lgkmcnt(4)
ds_read_b64_tr_b16 a[192:193], v248 offset:0
ds_read_b64_tr_b16 a[194:195], v248 offset:5120
v_mfma_f32_16x16x32_bf16 a[144:147], a[212:215], v[180:183], a[144:147]
ds_read_b64_tr_b16 a[196:197], v248 offset:10240
ds_read_b64_tr_b16 a[198:199], v248 offset:15360
v_mfma_f32_16x16x32_bf16 a[148:151], a[208:211], v[184:187], a[148:151]
v_mfma_f32_16x16x32_bf16 a[148:151], a[212:215], v[188:191], a[148:151]
s_waitcnt lgkmcnt(6)
v_mfma_f32_16x16x32_bf16 a[152:155], a[216:219], v[176:179], a[152:155]
s_waitcnt lgkmcnt(4)
ds_read_b64_tr_b16 a[200:201], v249 offset:0
ds_read_b64_tr_b16 a[202:203], v249 offset:5120
v_mfma_f32_16x16x32_bf16 a[152:155], a[220:223], v[180:183], a[152:155]
ds_read_b64_tr_b16 a[204:205], v249 offset:10240
ds_read_b64_tr_b16 a[206:207], v249 offset:15360
v_mfma_f32_16x16x32_bf16 a[156:159], a[216:219], v[184:187], a[156:159]
v_mfma_f32_16x16x32_bf16 a[156:159], a[220:223], v[188:191], a[156:159]
s_cmp_eq_u32 s20, 32
s_cbranch_scc1 L_p2_short
s_waitcnt lgkmcnt(6)
s_waitcnt vmcnt(30)
v_mfma_f32_16x16x32_bf16 a[80:83], a[192:195], v[64:67], a[80:83]
s_waitcnt lgkmcnt(4) vmcnt(29)
ds_read_b64_tr_b16 a[208:209], v248 offset:64
ds_read_b64_tr_b16 a[210:211], v248 offset:5184
v_mfma_f32_16x16x32_bf16 a[80:83], a[196:199], v[68:71], a[80:83]
s_waitcnt vmcnt(28)
ds_read_b64_tr_b16 a[212:213], v248 offset:10304
ds_read_b64_tr_b16 a[214:215], v248 offset:15424
v_mfma_f32_16x16x32_bf16 a[84:87], a[192:195], v[72:75], a[84:87]
s_waitcnt vmcnt(27)
v_mfma_f32_16x16x32_bf16 a[84:87], a[196:199], v[76:79], a[84:87]
s_waitcnt lgkmcnt(6)
v_mfma_f32_16x16x32_bf16 a[88:91], a[200:203], v[64:67], a[88:91]
s_waitcnt lgkmcnt(4)
ds_read_b64_tr_b16 a[216:217], v249 offset:64
ds_read_b64_tr_b16 a[218:219], v249 offset:5184
v_mfma_f32_16x16x32_bf16 a[88:91], a[204:207], v[68:71], a[88:91]
ds_read_b64_tr_b16 a[220:221], v249 offset:10304
ds_read_b64_tr_b16 a[222:223], v249 offset:15424
v_mfma_f32_16x16x32_bf16 a[92:95], a[200:203], v[72:75], a[92:95]
v_mfma_f32_16x16x32_bf16 a[92:95], a[204:207], v[76:79], a[92:95]
s_waitcnt lgkmcnt(6)
v_mfma_f32_16x16x32_bf16 a[96:99], a[208:211], v[64:67], a[96:99]
s_waitcnt lgkmcnt(4)
ds_read_b64_tr_b16 a[192:193], v248 offset:128
ds_read_b64_tr_b16 a[194:195], v248 offset:5248
v_mfma_f32_16x16x32_bf16 a[96:99], a[212:215], v[68:71], a[96:99]
ds_read_b64_tr_b16 a[196:197], v248 offset:10368
ds_read_b64_tr_b16 a[198:199], v248 offset:15488
v_mfma_f32_16x16x32_bf16 a[100:103], a[208:211], v[72:75], a[100:103]
v_mfma_f32_16x16x32_bf16 a[100:103], a[212:215], v[76:79], a[100:103]
s_waitcnt lgkmcnt(6)
v_mfma_f32_16x16x32_bf16 a[104:107], a[216:219], v[64:67], a[104:107]
s_waitcnt lgkmcnt(4)
ds_read_b64_tr_b16 a[200:201], v249 offset:128
ds_read_b64_tr_b16 a[202:203], v249 offset:5248
v_mfma_f32_16x16x32_bf16 a[104:107], a[220:223], v[68:71], a[104:107]
ds_read_b64_tr_b16 a[204:205], v249 offset:10368
ds_read_b64_tr_b16 a[206:207], v249 offset:15488
v_mfma_f32_16x16x32_bf16 a[108:111], a[216:219], v[72:75], a[108:111]
v_mfma_f32_16x16x32_bf16 a[108:111], a[220:223], v[76:79], a[108:111]
s_waitcnt lgkmcnt(6)
v_mfma_f32_16x16x32_bf16 a[112:115], a[192:195], v[64:67], a[112:115]
s_waitcnt lgkmcnt(4)
ds_read_b64_tr_b16 a[208:209], v248 offset:192
ds_read_b64_tr_b16 a[210:211], v248 offset:5312
v_mfma_f32_16x16x32_bf16 a[112:115], a[196:199], v[68:71], a[112:115]
ds_read_b64_tr_b16 a[212:213], v248 offset:10432
ds_read_b64_tr_b16 a[214:215], v248 offset:15552
v_mfma_f32_16x16x32_bf16 a[116:119], a[192:195], v[72:75], a[116:119]
v_mfma_f32_16x16x32_bf16 a[116:119], a[196:199], v[76:79], a[116:119]
s_waitcnt lgkmcnt(6)
v_mfma_f32_16x16x32_bf16 a[120:123], a[200:203], v[64:67], a[120:123]
s_waitcnt lgkmcnt(4)
ds_read_b64_tr_b16 a[216:217], v249 offset:192
ds_read_b64_tr_b16 a[218:219], v249 offset:5312
v_mfma_f32_16x16x32_bf16 a[120:123], a[204:207], v[68:71], a[120:123]
ds_read_b64_tr_b16 a[220:221], v249 offset:10432
ds_read_b64_tr_b16 a[222:223], v249 offset:15552
v_mfma_f32_16x16x32_bf16 a[124:127], a[200:203], v[72:75], a[124:127]
v_mfma_f32_16x16x32_bf16 a[124:127], a[204:207], v[76:79], a[124:127]
s_waitcnt lgkmcnt(6)
v_mfma_f32_16x16x32_bf16 a[128:131], a[208:211], v[64:67], a[128:131]
s_waitcnt lgkmcnt(4)
ds_read_b64_tr_b16 a[192:193], v248 offset:256
ds_read_b64_tr_b16 a[194:195], v248 offset:5376
v_mfma_f32_16x16x32_bf16 a[128:131], a[212:215], v[68:71], a[128:131]
ds_read_b64_tr_b16 a[196:197], v248 offset:10496
ds_read_b64_tr_b16 a[198:199], v248 offset:15616
v_mfma_f32_16x16x32_bf16 a[132:135], a[208:211], v[72:75], a[132:135]
v_mfma_f32_16x16x32_bf16 a[132:135], a[212:215], v[76:79], a[132:135]
s_waitcnt lgkmcnt(6)
v_mfma_f32_16x16x32_bf16 a[136:139], a[216:219], v[64:67], a[136:139]
s_waitcnt lgkmcnt(4)
ds_read_b64_tr_b16 a[200:201], v249 offset:256
ds_read_b64_tr_b16 a[202:203], v249 offset:5376
v_mfma_f32_16x16x32_bf16 a[136:139], a[220:223], v[68:71], a[136:139]
ds_read_b64_tr_b16 a[204:205], v249 offset:10496
ds_read_b64_tr_b16 a[206:207], v249 offset:15616
v_mfma_f32_16x16x32_bf16 a[140:143], a[216:219], v[72:75], a[140:143]
v_mfma_f32_16x16x32_bf16 a[140:143], a[220:223], v[76:79], a[140:143]
s_waitcnt vmcnt(22)
s_barrier
s_waitcnt lgkmcnt(6)
v_mfma_f32_16x16x32_bf16 a[144:147], a[192:195], v[64:67], a[144:147]
s_waitcnt lgkmcnt(4)
ds_read_b64_tr_b16 a[208:209], v248 offset:20480
ds_read_b64_tr_b16 a[210:211], v248 offset:25600
v_mfma_f32_16x16x32_bf16 a[144:147], a[196:199], v[68:71], a[144:147]
ds_read_b64_tr_b16 a[212:213], v248 offset:30720
ds_read_b64_tr_b16 a[214:215], v248 offset:35840
v_mfma_f32_16x16x32_bf16 a[148:151], a[192:195], v[72:75], a[148:151]
v_mfma_f32_16x16x32_bf16 a[148:151], a[196:199], v[76:79], a[148:151]
s_waitcnt lgkmcnt(6)
v_mfma_f32_16x16x32_bf16 a[152:155], a[200:203], v[64:67], a[152:155]
s_waitcnt lgkmcnt(4)
ds_read_b64_tr_b16 a[216:217], v249 offset:20480
ds_read_b64_tr_b16 a[218:219], v249 offset:25600
v_mfma_f32_16x16x32_bf16 a[152:155], a[204:207], v[68:71], a[152:155]
ds_read_b64_tr_b16 a[220:221], v249 offset:30720
ds_read_b64_tr_b16 a[222:223], v249 offset:35840
v_mfma_f32_16x16x32_bf16 a[156:159], a[200:203], v[72:75], a[156:159]
v_mfma_f32_16x16x32_bf16 a[156:159], a[204:207], v[76:79], a[156:159]
s_cmp_eq_u32 s20, 33
s_cbranch_scc1 L_p2_short
s_waitcnt lgkmcnt(6)
s_waitcnt vmcnt(21)
v_mfma_f32_16x16x32_bf16 a[80:83], a[208:211], v[80:83], a[80:83]
s_waitcnt lgkmcnt(4) vmcnt(20)
ds_read_b64_tr_b16 a[192:193], v248 offset:20544
ds_read_b64_tr_b16 a[194:195], v248 offset:25664
v_mfma_f32_16x16x32_bf16 a[80:83], a[212:215], v[84:87], a[80:83]
s_waitcnt vmcnt(19)
ds_read_b64_tr_b16 a[196:197], v248 offset:30784
ds_read_b64_tr_b16 a[198:199], v248 offset:35904
v_mfma_f32_16x16x32_bf16 a[84:87], a[208:211], v[88:91], a[84:87]
s_waitcnt vmcnt(18)
v_mfma_f32_16x16x32_bf16 a[84:87], a[212:215], v[92:95], a[84:87]
s_waitcnt lgkmcnt(6)
v_mfma_f32_16x16x32_bf16 a[88:91], a[216:219], v[80:83], a[88:91]
s_waitcnt lgkmcnt(4)
ds_read_b64_tr_b16 a[200:201], v249 offset:20544
ds_read_b64_tr_b16 a[202:203], v249 offset:25664
v_mfma_f32_16x16x32_bf16 a[88:91], a[220:223], v[84:87], a[88:91]
ds_read_b64_tr_b16 a[204:205], v249 offset:30784
ds_read_b64_tr_b16 a[206:207], v249 offset:35904
v_mfma_f32_16x16x32_bf16 a[92:95], a[216:219], v[88:91], a[92:95]
v_mfma_f32_16x16x32_bf16 a[92:95], a[220:223], v[92:95], a[92:95]
s_waitcnt lgkmcnt(6)
v_mfma_f32_16x16x32_bf16 a[96:99], a[192:195], v[80:83], a[96:99]
s_waitcnt lgkmcnt(4)
ds_read_b64_tr_b16 a[208:209], v248 offset:20608
ds_read_b64_tr_b16 a[210:211], v248 offset:25728
v_mfma_f32_16x16x32_bf16 a[96:99], a[196:199], v[84:87], a[96:99]
ds_read_b64_tr_b16 a[212:213], v248 offset:30848
ds_read_b64_tr_b16 a[214:215], v248 offset:35968
v_mfma_f32_16x16x32_bf16 a[100:103], a[192:195], v[88:91], a[100:103]
v_mfma_f32_16x16x32_bf16 a[100:103], a[196:199], v[92:95], a[100:103]
s_waitcnt lgkmcnt(6)
v_mfma_f32_16x16x32_bf16 a[104:107], a[200:203], v[80:83], a[104:107]
s_waitcnt lgkmcnt(4)
ds_read_b64_tr_b16 a[216:217], v249 offset:20608
ds_read_b64_tr_b16 a[218:219], v249 offset:25728
v_mfma_f32_16x16x32_bf16 a[104:107], a[204:207], v[84:87], a[104:107]
ds_read_b64_tr_b16 a[220:221], v249 offset:30848
ds_read_b64_tr_b16 a[222:223], v249 offset:35968
v_mfma_f32_16x16x32_bf16 a[108:111], a[200:203], v[88:91], a[108:111]
v_mfma_f32_16x16x32_bf16 a[108:111], a[204:207], v[92:95], a[108:111]
s_waitcnt lgkmcnt(6)
v_mfma_f32_16x16x32_bf16 a[112:115], a[208:211], v[80:83], a[112:115]
s_waitcnt lgkmcnt(4)
ds_read_b64_tr_b16 a[192:193], v248 offset:20672
ds_read_b64_tr_b16 a[194:195], v248 offset:25792
v_mfma_f32_16x16x32_bf16 a[112:115], a[212:215], v[84:87], a[112:115]
ds_read_b64_tr_b16 a[196:197], v248 offset:30912
ds_read_b64_tr_b16 a[198:199], v248 offset:36032
v_mfma_f32_16x16x32_bf16 a[116:119], a[208:211], v[88:91], a[116:119]
v_mfma_f32_16x16x32_bf16 a[116:119], a[212:215], v[92:95], a[116:119]
s_waitcnt lgkmcnt(6)
v_mfma_f32_16x16x32_bf16 a[120:123], a[216:219], v[80:83], a[120:123]
s_waitcnt lgkmcnt(4)
ds_read_b64_tr_b16 a[200:201], v249 offset:20672
ds_read_b64_tr_b16 a[202:203], v249 offset:25792
v_mfma_f32_16x16x32_bf16 a[120:123], a[220:223], v[84:87], a[120:123]
ds_read_b64_tr_b16 a[204:205], v249 offset:30912
ds_read_b64_tr_b16 a[206:207], v249 offset:36032
v_mfma_f32_16x16x32_bf16 a[124:127], a[216:219], v[88:91], a[124:127]
v_mfma_f32_16x16x32_bf16 a[124:127], a[220:223], v[92:95], a[124:127]
s_waitcnt lgkmcnt(6)
v_mfma_f32_16x16x32_bf16 a[128:131], a[192:195], v[80:83], a[128:131]
s_waitcnt lgkmcnt(4)
ds_read_b64_tr_b16 a[208:209], v248 offset:20736
ds_read_b64_tr_b16 a[210:211], v248 offset:25856
v_mfma_f32_16x16x32_bf16 a[128:131], a[196:199], v[84:87], a[128:131]
ds_read_b64_tr_b16 a[212:213], v248 offset:30976
ds_read_b64_tr_b16 a[214:215], v248 offset:36096
v_mfma_f32_16x16x32_bf16 a[132:135], a[192:195], v[88:91], a[132:135]
v_mfma_f32_16x16x32_bf16 a[132:135], a[196:199], v[92:95], a[132:135]
s_waitcnt lgkmcnt(6)
v_mfma_f32_16x16x32_bf16 a[136:139], a[200:203], v[80:83], a[136:139]
s_waitcnt lgkmcnt(4)
ds_read_b64_tr_b16 a[216:217], v249 offset:20736
ds_read_b64_tr_b16 a[218:219], v249 offset:25856
v_mfma_f32_16x16x32_bf16 a[136:139], a[204:207], v[84:87], a[136:139]
ds_read_b64_tr_b16 a[220:221], v249 offset:30976
ds_read_b64_tr_b16 a[222:223], v249 offset:36096
v_mfma_f32_16x16x32_bf16 a[140:143], a[200:203], v[88:91], a[140:143]
v_mfma_f32_16x16x32_bf16 a[140:143], a[204:207], v[92:95], a[140:143]
s_waitcnt vmcnt(13)
s_barrier
s_waitcnt lgkmcnt(6)
v_mfma_f32_16x16x32_bf16 a[144:147], a[208:211], v[80:83], a[144:147]
s_waitcnt lgkmcnt(4)
ds_read_b64_tr_b16 a[192:193], v248 offset:40960
ds_read_b64_tr_b16 a[194:195], v248 offset:46080
v_mfma_f32_16x16x32_bf16 a[144:147], a[212:215], v[84:87], a[144:147]
ds_read_b64_tr_b16 a[196:197], v248 offset:51200
ds_read_b64_tr_b16 a[198:199], v248 offset:56320
v_mfma_f32_16x16x32_bf16 a[148:151], a[208:211], v[88:91], a[148:151]
v_mfma_f32_16x16x32_bf16 a[148:151], a[212:215], v[92:95], a[148:151]
s_waitcnt lgkmcnt(6)
v_mfma_f32_16x16x32_bf16 a[152:155], a[216:219], v[80:83], a[152:155]
s_waitcnt lgkmcnt(4)
ds_read_b64_tr_b16 a[200:201], v249 offset:40960
ds_read_b64_tr_b16 a[202:203], v249 offset:46080
v_mfma_f32_16x16x32_bf16 a[152:155], a[220:223], v[84:87], a[152:155]
ds_read_b64_tr_b16 a[204:205], v249 offset:51200
ds_read_b64_tr_b16 a[206:207], v249 offset:56320
v_mfma_f32_16x16x32_bf16 a[156:159], a[216:219], v[88:91], a[156:159]
v_mfma_f32_16x16x32_bf16 a[156:159], a[220:223], v[92:95], a[156:159]
s_cmp_eq_u32 s20, 34
s_cbranch_scc1 L_p2_short
s_waitcnt lgkmcnt(6)
s_waitcnt vmcnt(12)
v_mfma_f32_16x16x32_bf16 a[80:83], a[192:195], v[96:99], a[80:83]
s_waitcnt lgkmcnt(4) vmcnt(11)
ds_read_b64_tr_b16 a[208:209], v248 offset:41024
ds_read_b64_tr_b16 a[210:211], v248 offset:46144
v_mfma_f32_16x16x32_bf16 a[80:83], a[196:199], v[100:103], a[80:83]
s_waitcnt vmcnt(10)
ds_read_b64_tr_b16 a[212:213], v248 offset:51264
ds_read_b64_tr_b16 a[214:215], v248 offset:56384
v_mfma_f32_16x16x32_bf16 a[84:87], a[192:195], v[104:107], a[84:87]
s_waitcnt vmcnt(9)
v_mfma_f32_16x16x32_bf16 a[84:87], a[196:199], v[108:111], a[84:87]
s_waitcnt lgkmcnt(6)
v_mfma_f32_16x16x32_bf16 a[88:91], a[200:203], v[96:99], a[88:91]
s_waitcnt lgkmcnt(4)
ds_read_b64_tr_b16 a[216:217], v249 offset:41024
ds_read_b64_tr_b16 a[218:219], v249 offset:46144
v_mfma_f32_16x16x32_bf16 a[88:91], a[204:207], v[100:103], a[88:91]
ds_read_b64_tr_b16 a[220:221], v249 offset:51264
ds_read_b64_tr_b16 a[222:223], v249 offset:56384
v_mfma_f32_16x16x32_bf16 a[92:95], a[200:203], v[104:107], a[92:95]
v_mfma_f32_16x16x32_bf16 a[92:95], a[204:207], v[108:111], a[92:95]
s_waitcnt lgkmcnt(6)
v_mfma_f32_16x16x32_bf16 a[96:99], a[208:211], v[96:99], a[96:99]
s_waitcnt lgkmcnt(4)
ds_read_b64_tr_b16 a[192:193], v248 offset:41088
ds_read_b64_tr_b16 a[194:195], v248 offset:46208
v_mfma_f32_16x16x32_bf16 a[96:99], a[212:215], v[100:103], a[96:99]
ds_read_b64_tr_b16 a[196:197], v248 offset:51328
ds_read_b64_tr_b16 a[198:199], v248 offset:56448
v_mfma_f32_16x16x32_bf16 a[100:103], a[208:211], v[104:107], a[100:103]
v_mfma_f32_16x16x32_bf16 a[100:103], a[212:215], v[108:111], a[100:103]
s_waitcnt lgkmcnt(6)
v_mfma_f32_16x16x32_bf16 a[104:107], a[216:219], v[96:99], a[104:107]
s_waitcnt lgkmcnt(4)
ds_read_b64_tr_b16 a[200:201], v249 offset:41088
ds_read_b64_tr_b16 a[202:203], v249 offset:46208
v_mfma_f32_16x16x32_bf16 a[104:107], a[220:223], v[100:103], a[104:107]
ds_read_b64_tr_b16 a[204:205], v249 offset:51328
ds_read_b64_tr_b16 a[206:207], v249 offset:56448
v_mfma_f32_16x16x32_bf16 a[108:111], a[216:219], v[104:107], a[108:111]
v_mfma_f32_16x16x32_bf16 a[108:111], a[220:223], v[108:111], a[108:111]
s_waitcnt lgkmcnt(6)
v_mfma_f32_16x16x32_bf16 a[112:115], a[192:195], v[96:99], a[112:115]
s_waitcnt lgkmcnt(4)
ds_read_b64_tr_b16 a[208:209], v248 offset:41152
ds_read_b64_tr_b16 a[210:211], v248 offset:46272
v_mfma_f32_16x16x32_bf16 a[112:115], a[196:199], v[100:103], a[112:115]
ds_read_b64_tr_b16 a[212:213], v248 offset:51392
ds_read_b64_tr_b16 a[214:215], v248 offset:56512
v_mfma_f32_16x16x32_bf16 a[116:119], a[192:195], v[104:107], a[116:119]
v_mfma_f32_16x16x32_bf16 a[116:119], a[196:199], v[108:111], a[116:119]
s_waitcnt lgkmcnt(6)
v_mfma_f32_16x16x32_bf16 a[120:123], a[200:203], v[96:99], a[120:123]
s_waitcnt lgkmcnt(4)
ds_read_b64_tr_b16 a[216:217], v249 offset:41152
ds_read_b64_tr_b16 a[218:219], v249 offset:46272
v_mfma_f32_16x16x32_bf16 a[120:123], a[204:207], v[100:103], a[120:123]
ds_read_b64_tr_b16 a[220:221], v249 offset:51392
ds_read_b64_tr_b16 a[222:223], v249 offset:56512
v_mfma_f32_16x16x32_bf16 a[124:127], a[200:203], v[104:107], a[124:127]
v_mfma_f32_16x16x32_bf16 a[124:127], a[204:207], v[108:111], a[124:127]
s_waitcnt lgkmcnt(6)
v_mfma_f32_16x16x32_bf16 a[128:131], a[208:211], v[96:99], a[128:131]
s_waitcnt lgkmcnt(4)
ds_read_b64_tr_b16 a[192:193], v248 offset:41216
ds_read_b64_tr_b16 a[194:195], v248 offset:46336
v_mfma_f32_16x16x32_bf16 a[128:131], a[212:215], v[100:103], a[128:131]
ds_read_b64_tr_b16 a[196:197], v248 offset:51456
ds_read_b64_tr_b16 a[198:199], v248 offset:56576
v_mfma_f32_16x16x32_bf16 a[132:135], a[208:211], v[104:107], a[132:135]
v_mfma_f32_16x16x32_bf16 a[132:135], a[212:215], v[108:111], a[132:135]
s_waitcnt lgkmcnt(6)
v_mfma_f32_16x16x32_bf16 a[136:139], a[216:219], v[96:99], a[136:139]
s_waitcnt lgkmcnt(4)
ds_read_b64_tr_b16 a[200:201], v249 offset:41216
ds_read_b64_tr_b16 a[202:203], v249 offset:46336
v_mfma_f32_16x16x32_bf16 a[136:139], a[220:223], v[100:103], a[136:139]
ds_read_b64_tr_b16 a[204:205], v249 offset:51456
ds_read_b64_tr_b16 a[206:207], v249 offset:56576
v_mfma_f32_16x16x32_bf16 a[140:143], a[216:219], v[104:107], a[140:143]
v_mfma_f32_16x16x32_bf16 a[140:143], a[220:223], v[108:111], a[140:143]
s_waitcnt vmcnt(4)
s_barrier
s_waitcnt lgkmcnt(6)
v_mfma_f32_16x16x32_bf16 a[144:147], a[192:195], v[96:99], a[144:147]
s_waitcnt lgkmcnt(4)
ds_read_b64_tr_b16 a[208:209], v250 offset:0
ds_read_b64_tr_b16 a[210:211], v250 offset:5120
v_mfma_f32_16x16x32_bf16 a[144:147], a[196:199], v[100:103], a[144:147]
ds_read_b64_tr_b16 a[212:213], v250 offset:10240
ds_read_b64_tr_b16 a[214:215], v250 offset:15360
v_mfma_f32_16x16x32_bf16 a[148:151], a[192:195], v[104:107], a[148:151]
v_mfma_f32_16x16x32_bf16 a[148:151], a[196:199], v[108:111], a[148:151]
s_waitcnt lgkmcnt(6)
v_mfma_f32_16x16x32_bf16 a[152:155], a[200:203], v[96:99], a[152:155]
s_waitcnt lgkmcnt(4)
ds_read_b64_tr_b16 a[216:217], v251 offset:0
ds_read_b64_tr_b16 a[218:219], v251 offset:5120
v_mfma_f32_16x16x32_bf16 a[152:155], a[204:207], v[100:103], a[152:155]
ds_read_b64_tr_b16 a[220:221], v251 offset:10240
ds_read_b64_tr_b16 a[222:223], v251 offset:15360
v_mfma_f32_16x16x32_bf16 a[156:159], a[200:203], v[104:107], a[156:159]
v_mfma_f32_16x16x32_bf16 a[156:159], a[204:207], v[108:111], a[156:159]
s_cmp_eq_u32 s20, 35
s_cbranch_scc1 L_p2_short
s_waitcnt lgkmcnt(6)
s_waitcnt vmcnt(3)
v_mfma_f32_16x16x32_bf16 a[80:83], a[208:211], v[112:115], a[80:83]
s_waitcnt lgkmcnt(4) vmcnt(2)
ds_read_b64_tr_b16 a[192:193], v250 offset:64
ds_read_b64_tr_b16 a[194:195], v250 offset:5184
v_mfma_f32_16x16x32_bf16 a[80:83], a[212:215], v[116:119], a[80:83]
s_waitcnt vmcnt(1)
ds_read_b64_tr_b16 a[196:197], v250 offset:10304
ds_read_b64_tr_b16 a[198:199], v250 offset:15424
v_mfma_f32_16x16x32_bf16 a[84:87], a[208:211], v[120:123], a[84:87]
s_waitcnt vmcnt(0)
v_mfma_f32_16x16x32_bf16 a[84:87], a[212:215], v[124:127], a[84:87]
s_waitcnt lgkmcnt(6)
v_mfma_f32_16x16x32_bf16 a[88:91], a[216:219], v[112:115], a[88:91]
s_waitcnt lgkmcnt(4)
ds_read_b64_tr_b16 a[200:201], v251 offset:64
ds_read_b64_tr_b16 a[202:203], v251 offset:5184
v_mfma_f32_16x16x32_bf16 a[88:91], a[220:223], v[116:119], a[88:91]
ds_read_b64_tr_b16 a[204:205], v251 offset:10304
ds_read_b64_tr_b16 a[206:207], v251 offset:15424
v_mfma_f32_16x16x32_bf16 a[92:95], a[216:219], v[120:123], a[92:95]
v_mfma_f32_16x16x32_bf16 a[92:95], a[220:223], v[124:127], a[92:95]
s_waitcnt lgkmcnt(6)
v_mfma_f32_16x16x32_bf16 a[96:99], a[192:195], v[112:115], a[96:99]
s_waitcnt lgkmcnt(4)
ds_read_b64_tr_b16 a[208:209], v250 offset:128
ds_read_b64_tr_b16 a[210:211], v250 offset:5248
v_mfma_f32_16x16x32_bf16 a[96:99], a[196:199], v[116:119], a[96:99]
ds_read_b64_tr_b16 a[212:213], v250 offset:10368
ds_read_b64_tr_b16 a[214:215], v250 offset:15488
v_mfma_f32_16x16x32_bf16 a[100:103], a[192:195], v[120:123], a[100:103]
v_mfma_f32_16x16x32_bf16 a[100:103], a[196:199], v[124:127], a[100:103]
s_waitcnt lgkmcnt(6)
v_mfma_f32_16x16x32_bf16 a[104:107], a[200:203], v[112:115], a[104:107]
s_waitcnt lgkmcnt(4)
ds_read_b64_tr_b16 a[216:217], v251 offset:128
ds_read_b64_tr_b16 a[218:219], v251 offset:5248
v_mfma_f32_16x16x32_bf16 a[104:107], a[204:207], v[116:119], a[104:107]
ds_read_b64_tr_b16 a[220:221], v251 offset:10368
ds_read_b64_tr_b16 a[222:223], v251 offset:15488
v_mfma_f32_16x16x32_bf16 a[108:111], a[200:203], v[120:123], a[108:111]
v_mfma_f32_16x16x32_bf16 a[108:111], a[204:207], v[124:127], a[108:111]
s_waitcnt lgkmcnt(6)
v_mfma_f32_16x16x32_bf16 a[112:115], a[208:211], v[112:115], a[112:115]
s_waitcnt lgkmcnt(4)
ds_read_b64_tr_b16 a[192:193], v250 offset:192
ds_read_b64_tr_b16 a[194:195], v250 offset:5312
v_mfma_f32_16x16x32_bf16 a[112:115], a[212:215], v[116:119], a[112:115]
ds_read_b64_tr_b16 a[196:197], v250 offset:10432
ds_read_b64_tr_b16 a[198:199], v250 offset:15552
v_mfma_f32_16x16x32_bf16 a[116:119], a[208:211], v[120:123], a[116:119]
v_mfma_f32_16x16x32_bf16 a[116:119], a[212:215], v[124:127], a[116:119]
s_waitcnt lgkmcnt(6)
v_mfma_f32_16x16x32_bf16 a[120:123], a[216:219], v[112:115], a[120:123]
s_waitcnt lgkmcnt(4)
ds_read_b64_tr_b16 a[200:201], v251 offset:192
ds_read_b64_tr_b16 a[202:203], v251 offset:5312
v_mfma_f32_16x16x32_bf16 a[120:123], a[220:223], v[116:119], a[120:123]
ds_read_b64_tr_b16 a[204:205], v251 offset:10432
ds_read_b64_tr_b16 a[206:207], v251 offset:15552
v_mfma_f32_16x16x32_bf16 a[124:127], a[216:219], v[120:123], a[124:127]
v_mfma_f32_16x16x32_bf16 a[124:127], a[220:223], v[124:127], a[124:127]
s_waitcnt lgkmcnt(6)
v_mfma_f32_16x16x32_bf16 a[128:131], a[192:195], v[112:115], a[128:131]
s_waitcnt lgkmcnt(4)
ds_read_b64_tr_b16 a[208:209], v250 offset:256
ds_read_b64_tr_b16 a[210:211], v250 offset:5376
v_mfma_f32_16x16x32_bf16 a[128:131], a[196:199], v[116:119], a[128:131]
ds_read_b64_tr_b16 a[212:213], v250 offset:10496
ds_read_b64_tr_b16 a[214:215], v250 offset:15616
v_mfma_f32_16x16x32_bf16 a[132:135], a[192:195], v[120:123], a[132:135]
v_mfma_f32_16x16x32_bf16 a[132:135], a[196:199], v[124:127], a[132:135]
s_waitcnt lgkmcnt(6)
v_mfma_f32_16x16x32_bf16 a[136:139], a[200:203], v[112:115], a[136:139]
s_waitcnt lgkmcnt(4)
ds_read_b64_tr_b16 a[216:217], v251 offset:256
ds_read_b64_tr_b16 a[218:219], v251 offset:5376
v_mfma_f32_16x16x32_bf16 a[136:139], a[204:207], v[116:119], a[136:139]
ds_read_b64_tr_b16 a[220:221], v251 offset:10496
ds_read_b64_tr_b16 a[222:223], v251 offset:15616
v_mfma_f32_16x16x32_bf16 a[140:143], a[200:203], v[120:123], a[140:143]
v_mfma_f32_16x16x32_bf16 a[140:143], a[204:207], v[124:127], a[140:143]
s_waitcnt lgkmcnt(6)
v_mfma_f32_16x16x32_bf16 a[144:147], a[208:211], v[112:115], a[144:147]
s_waitcnt lgkmcnt(4)
v_mfma_f32_16x16x32_bf16 a[144:147], a[212:215], v[116:119], a[144:147]
v_mfma_f32_16x16x32_bf16 a[148:151], a[208:211], v[120:123], a[148:151]
v_mfma_f32_16x16x32_bf16 a[148:151], a[212:215], v[124:127], a[148:151]
s_waitcnt lgkmcnt(2)
v_mfma_f32_16x16x32_bf16 a[152:155], a[216:219], v[112:115], a[152:155]
s_waitcnt lgkmcnt(0)
v_mfma_f32_16x16x32_bf16 a[152:155], a[220:223], v[116:119], a[152:155]
v_mfma_f32_16x16x32_bf16 a[156:159], a[216:219], v[120:123], a[156:159]
v_mfma_f32_16x16x32_bf16 a[156:159], a[220:223], v[124:127], a[156:159]
L_p2_done:
s_waitcnt vmcnt(63)
v_cmp_eq_u32 vcc, 0, v63
s_nop 1
s_cbranch_vccnz L_ff
L_ff_b:
s_add_u32 s93, s84, 0
buffer_load_dwordx4 v[196:199], v57, s[76:79], s93 offen sc1
buffer_load_dwordx4 v[200:203], v57, s[76:79], s93 offen offset:1024 sc1
buffer_load_dwordx2 v[204:205], v10, s[76:79], s93 offen offset:2048 sc1
s_add_u32 s93, s85, 0
buffer_load_dwordx4 v[206:209], v57, s[76:79], s93 offen sc1
buffer_load_dwordx4 v[210:213], v57, s[76:79], s93 offen offset:1024 sc1
buffer_load_dwordx2 v[214:215], v10, s[76:79], s93 offen offset:2048 sc1
s_add_u32 s93, s86, 0
buffer_load_dwordx4 v[216:219], v57, s[76:79], s93 offen sc1
buffer_load_dwordx4 v[220:223], v57, s[76:79], s93 offen offset:1024 sc1
buffer_load_dwordx2 v[224:225], v10, s[76:79], s93 offen offset:2048 sc1
v_accvgpr_read_b32 v124, a80
v_accvgpr_read_b32 v125, a81
v_accvgpr_read_b32 v126, a82
v_accvgpr_read_b32 v127, a83
v_cvt_pk_bf16_f32 v76, v124, v125
v_cvt_pk_bf16_f32 v77, v126, v127
v_accvgpr_read_b32 v124, a88
v_accvgpr_read_b32 v125, a89
v_accvgpr_read_b32 v126, a90
v_accvgpr_read_b32 v127, a91
v_cvt_pk_bf16_f32 v78, v124, v125
v_cvt_pk_bf16_f32 v79, v126, v127
v_accvgpr_read_b32 v124, a96
v_accvgpr_read_b32 v125, a97
v_accvgpr_read_b32 v126, a98
v_accvgpr_read_b32 v127, a99
v_cvt_pk_bf16_f32 v80, v124, v125
v_cvt_pk_bf16_f32 v81, v126, v127
v_accvgpr_read_b32 v124, a104
v_accvgpr_read_b32 v125, a105
v_accvgpr_read_b32 v126, a106
v_accvgpr_read_b32 v127, a107
v_cvt_pk_bf16_f32 v82, v124, v125
v_cvt_pk_bf16_f32 v83, v126, v127
v_accvgpr_read_b32 v124, a112
v_accvgpr_read_b32 v125, a113
v_accvgpr_read_b32 v126, a114
v_accvgpr_read_b32 v127, a115
v_cvt_pk_bf16_f32 v84, v124, v125
v_cvt_pk_bf16_f32 v85, v126, v127
buffer_store_dwordx4 v[76:79], v57, s[76:79], s55 offen sc1
buffer_store_dwordx4 v[80:83], v57, s[76:79], s55 offen offset:1024 sc1
buffer_store_dwordx2 v[84:85], v10, s[76:79], s55 offen offset:2048 sc1
v_accvgpr_read_b32 v124, a84
v_accvgpr_read_b32 v125, a85
v_accvgpr_read_b32 v126, a86
v_accvgpr_read_b32 v127, a87
v_cvt_pk_bf16_f32 v88, v124, v125
v_cvt_pk_bf16_f32 v89, v126, v127
v_accvgpr_read_b32 v124, a92
v_accvgpr_read_b32 v125, a93
v_accvgpr_read_b32 v126, a94
v_accvgpr_read_b32 v127, a95
v_cvt_pk_bf16_f32 v90, v124, v125
v_cvt_pk_bf16_f32 v91, v126, v127
v_accvgpr_read_b32 v124, a100
v_accvgpr_read_b32 v125, a101
v_accvgpr_read_b32 v126, a102
v_accvgpr_read_b32 v127, a103
v_cvt_pk_bf16_f32 v92, v124, v125
v_cvt_pk_bf16_f32 v93, v126, v127
v_accvgpr_read_b32 v124, a108
v_accvgpr_read_b32 v125, a109
v_accvgpr_read_b32 v126, a110
v_accvgpr_read_b32 v127, a111
v_cvt_pk_bf16_f32 v94, v124, v125
v_cvt_pk_bf16_f32 v95, v126, v127
v_accvgpr_read_b32 v124, a116
v_accvgpr_read_b32 v125, a117
v_accvgpr_read_b32 v126, a118
v_accvgpr_read_b32 v127, a119
v_cvt_pk_bf16_f32 v96, v124, v125
v_cvt_pk_bf16_f32 v97, v126, v127
buffer_store_dwordx4 v[88:91], v57, s[76:79], s56 offen sc1
buffer_store_dwordx4 v[92:95], v57, s[76:79], s56 offen offset:1024 sc1
buffer_store_dwordx2 v[96:97], v10, s[76:79], s56 offen offset:2048 sc1
v_accvgpr_read_b32 v124, a120
v_accvgpr_read_b32 v125, a121
v_accvgpr_read_b32 v126, a122
v_accvgpr_read_b32 v127, a123
v_cvt_pk_bf16_f32 v100, v124, v125
v_cvt_pk_bf16_f32 v101, v126, v127
v_accvgpr_read_b32 v124, a128
v_accvgpr_read_b32 v125, a129
v_accvgpr_read_b32 v126, a130
v_accvgpr_read_b32 v127, a131
v_cvt_pk_bf16_f32 v102, v124, v125
v_cvt_pk_bf16_f32 v103, v126, v127
v_accvgpr_read_b32 v124, a136
v_accvgpr_read_b32 v125, a137
v_accvgpr_read_b32 v126, a138
v_accvgpr_read_b32 v127, a139
v_cvt_pk_bf16_f32 v104, v124, v125
v_cvt_pk_bf16_f32 v105, v126, v127
v_accvgpr_read_b32 v124, a144
v_accvgpr_read_b32 v125, a145
v_accvgpr_read_b32 v126, a146
v_accvgpr_read_b32 v127, a147
v_cvt_pk_bf16_f32 v106, v124, v125
v_cvt_pk_bf16_f32 v107, v126, v127
v_accvgpr_read_b32 v124, a152
v_accvgpr_read_b32 v125, a153
v_accvgpr_read_b32 v126, a154
v_accvgpr_read_b32 v127, a155
v_cvt_pk_bf16_f32 v108, v124, v125
v_cvt_pk_bf16_f32 v109, v126, v127
buffer_store_dwordx4 v[100:103], v57, s[76:79], s57 offen sc1
buffer_store_dwordx4 v[104:107], v57, s[76:79], s57 offen offset:1024 sc1
buffer_store_dwordx2 v[108:109], v10, s[76:79], s57 offen offset:2048 sc1
v_accvgpr_read_b32 v124, a124
v_accvgpr_read_b32 v125, a125
v_accvgpr_read_b32 v126, a126
v_accvgpr_read_b32 v127, a127
v_cvt_pk_bf16_f32 v112, v124, v125
v_cvt_pk_bf16_f32 v113, v126, v127
v_accvgpr_read_b32 v124, a132
v_accvgpr_read_b32 v125, a133
v_accvgpr_read_b32 v126, a134
v_accvgpr_read_b32 v127, a135
v_cvt_pk_bf16_f32 v114, v124, v125
v_cvt_pk_bf16_f32 v115, v126, v127
v_accvgpr_read_b32 v124, a140
v_accvgpr_read_b32 v125, a141
v_accvgpr_read_b32 v126, a142
v_accvgpr_read_b32 v127, a143
v_cvt_pk_bf16_f32 v116, v124, v125
v_cvt_pk_bf16_f32 v117, v126, v127
v_accvgpr_read_b32 v124, a148
v_accvgpr_read_b32 v125, a149
v_accvgpr_read_b32 v126, a150
v_accvgpr_read_b32 v127, a151
v_cvt_pk_bf16_f32 v118, v124, v125
v_cvt_pk_bf16_f32 v119, v126, v127
v_accvgpr_read_b32 v124, a156
v_accvgpr_read_b32 v125, a157
v_accvgpr_read_b32 v126, a158
v_accvgpr_read_b32 v127, a159
v_cvt_pk_bf16_f32 v120, v124, v125
v_cvt_pk_bf16_f32 v121, v126, v127
buffer_store_dwordx4 v[112:115], v57, s[76:79], s58 offen sc1
buffer_store_dwordx4 v[116:119], v57, s[76:79], s58 offen offset:1024 sc1
buffer_store_dwordx2 v[120:121], v10, s[76:79], s58 offen offset:2048 sc1
s_cmp_eq_u32 s90, 1
s_cbranch_scc1 L_xs1
s_cmp_eq_u32 s90, 2
s_cbranch_scc1 L_xs2
s_cmp_eq_u32 s90, 3
s_cbranch_scc1 L_xs3
v_accvgpr_read_b32 v128, a80
v_accvgpr_read_b32 v129, a81
v_accvgpr_read_b32 v130, a82
v_accvgpr_read_b32 v131, a83
v_accvgpr_read_b32 v132, a88
v_accvgpr_read_b32 v133, a89
v_accvgpr_read_b32 v134, a90
v_accvgpr_read_b32 v135, a91
v_accvgpr_read_b32 v136, a96
v_accvgpr_read_b32 v137, a97
v_accvgpr_read_b32 v138, a98
v_accvgpr_read_b32 v139, a99
v_accvgpr_read_b32 v140, a104
v_accvgpr_read_b32 v141, a105
v_accvgpr_read_b32 v142, a106
v_accvgpr_read_b32 v143, a107
v_accvgpr_read_b32 v144, a112
v_accvgpr_read_b32 v145, a113
v_accvgpr_read_b32 v146, a114
v_accvgpr_read_b32 v147, a115
L_xs_j:
s_add_u32 s88, s88, 16384
s_waitcnt vmcnt(12)
v_accvgpr_read_b32 v32, a160
v_accvgpr_read_b32 v33, a161
v_accvgpr_read_b32 v34, a162
v_accvgpr_read_b32 v35, a163
v_lshlrev_b32 v240, 16, v196
v_and_b32 v241, s94, v196
v_add_f32 v32, v32, v240
v_add_f32 v33, v33, v241
v_lshlrev_b32 v240, 16, v197
v_and_b32 v241, s94, v197
v_add_f32 v34, v34, v240
v_add_f32 v35, v35, v241
v_lshlrev_b32 v240, 16, v206
v_and_b32 v241, s94, v206
v_add_f32 v32, v32, v240
v_add_f32 v33, v33, v241
v_lshlrev_b32 v240, 16, v207
v_and_b32 v241, s94, v207
v_add_f32 v34, v34, v240
v_add_f32 v35, v35, v241
v_lshlrev_b32 v240, 16, v216
v_and_b32 v241, s94, v216
v_add_f32 v32, v32, v240
v_add_f32 v33, v33, v241
v_lshlrev_b32 v240, 16, v217
v_and_b32 v241, s94, v217
v_add_f32 v34, v34, v240
v_add_f32 v35, v35, v241
v_cvt_pk_bf16_f32 v236, v32, v33
v_lshlrev_b32 v32, 16, v236
v_and_b32 v33, s94, v236
v_cvt_pk_bf16_f32 v236, v34, v35
v_lshlrev_b32 v34, 16, v236
v_and_b32 v35, s94, v236
v_mul_f32 v236, s95, v32
v_mul_f32 v237, s95, v33
v_mul_f32 v238, s95, v34
v_mul_f32 v239, s95, v35
v_exp_f32 v236, v236
v_exp_f32 v237, v237
v_exp_f32 v238, v238
v_exp_f32 v239, v239
v_add_f32 v236, 1.0, v236
v_add_f32 v237, 1.0, v237
v_add_f32 v238, 1.0, v238
v_add_f32 v239, 1.0, v239
v_rcp_f32 v236, v236
v_rcp_f32 v237, v237
v_rcp_f32 v238, v238
v_rcp_f32 v239, v239
v_mul_f32 v32, v32, v236
v_mul_f32 v33, v33, v237
v_mul_f32 v34, v34, v238
v_mul_f32 v35, v35, v239
v_cvt_pk_bf16_f32 v236, v32, v33
v_lshlrev_b32 v32, 16, v236
v_and_b32 v33, s94, v236
v_cvt_pk_bf16_f32 v236, v34, v35
v_lshlrev_b32 v34, 16, v236
v_and_b32 v35, s94, v236
v_accvgpr_read_b32 v36, a164
v_accvgpr_read_b32 v37, a165
v_accvgpr_read_b32 v38, a166
v_accvgpr_read_b32 v39, a167
v_lshlrev_b32 v240, 16, v198
v_and_b32 v241, s94, v198
v_add_f32 v36, v36, v240
v_add_f32 v37, v37, v241
v_lshlrev_b32 v240, 16, v199
v_and_b32 v241, s94, v199
v_add_f32 v38, v38, v240
v_add_f32 v39, v39, v241
v_lshlrev_b32 v240, 16, v208
v_and_b32 v241, s94, v208
v_add_f32 v36, v36, v240
v_add_f32 v37, v37, v241
v_lshlrev_b32 v240, 16, v209
v_and_b32 v241, s94, v209
v_add_f32 v38, v38, v240
v_add_f32 v39, v39, v241
v_lshlrev_b32 v240, 16, v218
v_and_b32 v241, s94, v218
v_add_f32 v36, v36, v240
v_add_f32 v37, v37, v241
v_lshlrev_b32 v240, 16, v219
v_and_b32 v241, s94, v219
v_add_f32 v38, v38, v240
v_add_f32 v39, v39, v241
v_cvt_pk_bf16_f32 v236, v36, v37
v_lshlrev_b32 v36, 16, v236
v_and_b32 v37, s94, v236
v_cvt_pk_bf16_f32 v236, v38, v39
v_lshlrev_b32 v38, 16, v236
v_and_b32 v39, s94, v236
v_mul_f32 v236, s95, v36
v_mul_f32 v237, s95, v37
v_mul_f32 v238, s95, v38
v_mul_f32 v239, s95, v39
v_exp_f32 v236, v236
v_exp_f32 v237, v237
v_exp_f32 v238, v238
v_exp_f32 v239, v239
v_add_f32 v236, 1.0, v236
v_add_f32 v237, 1.0, v237
v_add_f32 v238, 1.0, v238
v_add_f32 v239, 1.0, v239
v_rcp_f32 v236, v236
v_rcp_f32 v237, v237
v_rcp_f32 v238, v238
v_rcp_f32 v239, v239
v_mul_f32 v36, v36, v236
v_mul_f32 v37, v37, v237
v_mul_f32 v38, v38, v238
v_mul_f32 v39, v39, v239
v_cvt_pk_bf16_f32 v236, v36, v37
v_lshlrev_b32 v36, 16, v236
v_and_b32 v37, s94, v236
v_cvt_pk_bf16_f32 v236, v38, v39
v_lshlrev_b32 v38, 16, v236
v_and_b32 v39, s94, v236
v_accvgpr_read_b32 v40, a168
v_accvgpr_read_b32 v41, a169
v_accvgpr_read_b32 v42, a170
v_accvgpr_read_b32 v43, a171
v_lshlrev_b32 v240, 16, v200
v_and_b32 v241, s94, v200
v_add_f32 v40, v40, v240
v_add_f32 v41, v41, v241
v_lshlrev_b32 v240, 16, v201
v_and_b32 v241, s94, v201
v_add_f32 v42, v42, v240
v_add_f32 v43, v43, v241
v_lshlrev_b32 v240, 16, v210
v_and_b32 v241, s94, v210
v_add_f32 v40, v40, v240
v_add_f32 v41, v41, v241
v_lshlrev_b32 v240, 16, v211
v_and_b32 v241, s94, v211
v_add_f32 v42, v42, v240
v_add_f32 v43, v43, v241
v_lshlrev_b32 v240, 16, v220
v_and_b32 v241, s94, v220
v_add_f32 v40, v40, v240
v_add_f32 v41, v41, v241
v_lshlrev_b32 v240, 16, v221
v_and_b32 v241, s94, v221
v_add_f32 v42, v42, v240
v_add_f32 v43, v43, v241
v_cvt_pk_bf16_f32 v236, v40, v41
v_lshlrev_b32 v40, 16, v236
v_and_b32 v41, s94, v236
v_cvt_pk_bf16_f32 v236, v42, v43
v_lshlrev_b32 v42, 16, v236
v_and_b32 v43, s94, v236
v_mul_f32 v236, s95, v40
v_mul_f32 v237, s95, v41
v_mul_f32 v238, s95, v42
v_mul_f32 v239, s95, v43
v_exp_f32 v236, v236
v_exp_f32 v237, v237
v_exp_f32 v238, v238
v_exp_f32 v239, v239
v_add_f32 v236, 1.0, v236
v_add_f32 v237, 1.0, v237
v_add_f32 v238, 1.0, v238
v_add_f32 v239, 1.0, v239
v_rcp_f32 v236, v236
v_rcp_f32 v237, v237
v_rcp_f32 v238, v238
v_rcp_f32 v239, v239
v_mul_f32 v40, v40, v236
v_mul_f32 v41, v41, v237
v_mul_f32 v42, v42, v238
v_mul_f32 v43, v43, v239
v_cvt_pk_bf16_f32 v236, v40, v41
v_lshlrev_b32 v40, 16, v236
v_and_b32 v41, s94, v236
v_cvt_pk_bf16_f32 v236, v42, v43
v_lshlrev_b32 v42, 16, v236
v_and_b32 v43, s94, v236
s_waitcnt vmcnt(0)
buffer_store_dword v16, off, s[60:63], s89 sc1
v_accvgpr_read_b32 v44, a172
v_accvgpr_read_b32 v45, a173
v_accvgpr_read_b32 v46, a174
v_accvgpr_read_b32 v47, a175
v_lshlrev_b32 v240, 16, v202
v_and_b32 v241, s94, v202
v_add_f32 v44, v44, v240
v_add_f32 v45, v45, v241
v_lshlrev_b32 v240, 16, v203
v_and_b32 v241, s94, v203
v_add_f32 v46, v46, v240
v_add_f32 v47, v47, v241
v_lshlrev_b32 v240, 16, v212
v_and_b32 v241, s94, v212
v_add_f32 v44, v44, v240
v_add_f32 v45, v45, v241
v_lshlrev_b32 v240, 16, v213
v_and_b32 v241, s94, v213
v_add_f32 v46, v46, v240
v_add_f32 v47, v47, v241
v_lshlrev_b32 v240, 16, v222
v_and_b32 v241, s94, v222
v_add_f32 v44, v44, v240
v_add_f32 v45, v45, v241
v_lshlrev_b32 v240, 16, v223
v_and_b32 v241, s94, v223
v_add_f32 v46, v46, v240
v_add_f32 v47, v47, v241
v_cvt_pk_bf16_f32 v236, v44, v45
v_lshlrev_b32 v44, 16, v236
v_and_b32 v45, s94, v236
v_cvt_pk_bf16_f32 v236, v46, v47
v_lshlrev_b32 v46, 16, v236
v_and_b32 v47, s94, v236
v_mul_f32 v236, s95, v44
v_mul_f32 v237, s95, v45
v_mul_f32 v238, s95, v46
v_mul_f32 v239, s95, v47
v_exp_f32 v236, v236
v_exp_f32 v237, v237
v_exp_f32 v238, v238
v_exp_f32 v239, v239
v_add_f32 v236, 1.0, v236
v_add_f32 v237, 1.0, v237
v_add_f32 v238, 1.0, v238
v_add_f32 v239, 1.0, v239
v_rcp_f32 v236, v236
v_rcp_f32 v237, v237
v_rcp_f32 v238, v238
v_rcp_f32 v239, v239
v_mul_f32 v44, v44, v236
v_mul_f32 v45, v45, v237
v_mul_f32 v46, v46, v238
v_mul_f32 v47, v47, v239
v_cvt_pk_bf16_f32 v236, v44, v45
v_lshlrev_b32 v44, 16, v236
v_and_b32 v45, s94, v236
v_cvt_pk_bf16_f32 v236, v46, v47
v_lshlrev_b32 v46, 16, v236
v_and_b32 v47, s94, v236
v_accvgpr_read_b32 v48, a176
v_accvgpr_read_b32 v49, a177
v_accvgpr_read_b32 v50, a178
v_accvgpr_read_b32 v51, a179
v_lshlrev_b32 v240, 16, v204
v_and_b32 v241, s94, v204
v_add_f32 v48, v48, v240
v_add_f32 v49, v49, v241
v_lshlrev_b32 v240, 16, v205
v_and_b32 v241, s94, v205
v_add_f32 v50, v50, v240
v_add_f32 v51, v51, v241
v_lshlrev_b32 v240, 16, v214
v_and_b32 v241, s94, v214
v_add_f32 v48, v48, v240
v_add_f32 v49, v49, v241
v_lshlrev_b32 v240, 16, v215
v_and_b32 v241, s94, v215
v_add_f32 v50, v50, v240
v_add_f32 v51, v51, v241
v_lshlrev_b32 v240, 16, v224
v_and_b32 v241, s94, v224
v_add_f32 v48, v48, v240
v_add_f32 v49, v49, v241
v_lshlrev_b32 v240, 16, v225
v_and_b32 v241, s94, v225
v_add_f32 v50, v50, v240
v_add_f32 v51, v51, v241
v_cvt_pk_bf16_f32 v236, v48, v49
v_lshlrev_b32 v48, 16, v236
v_and_b32 v49, s94, v236
v_cvt_pk_bf16_f32 v236, v50, v51
v_lshlrev_b32 v50, 16, v236
v_and_b32 v51, s94, v236
v_mul_f32 v236, s95, v48
v_mul_f32 v237, s95, v49
v_mul_f32 v238, s95, v50
v_mul_f32 v239, s95, v51
v_exp_f32 v236, v236
v_exp_f32 v237, v237
v_exp_f32 v238, v238
v_exp_f32 v239, v239
v_add_f32 v236, 1.0, v236
v_add_f32 v237, 1.0, v237
v_add_f32 v238, 1.0, v238
v_add_f32 v239, 1.0, v239
v_rcp_f32 v236, v236
v_rcp_f32 v237, v237
v_rcp_f32 v238, v238
v_rcp_f32 v239, v239
v_mul_f32 v48, v48, v236
v_mul_f32 v49, v49, v237
v_mul_f32 v50, v50, v238
v_mul_f32 v51, v51, v239
v_cvt_pk_bf16_f32 v236, v48, v49
v_lshlrev_b32 v48, 16, v236
v_and_b32 v49, s94, v236
v_cvt_pk_bf16_f32 v236, v50, v51
v_lshlrev_b32 v50, 16, v236
v_and_b32 v51, s94, v236
s_mov_b32 s93, 0x200000
buffer_load_dword v63, v56, s[60:63], s88 offen offset:0 sc1
s_waitcnt vmcnt(0)
v_cmp_ne_u32 vcc, 0, v63
s_nop 1
s_cmp_eq_u64 vcc, -1
s_cbranch_scc1 L_pd4
L_pl4:
s_sleep 1
buffer_load_dword v63, v56, s[60:63], s88 offen offset:0 sc1
s_waitcnt vmcnt(0)
v_cmp_ne_u32 vcc, 0, v63
s_sub_u32 s93, s93, 1
s_cmp_eq_u64 vcc, -1
s_cbranch_scc1 L_pd4
s_cmp_lg_u32 s93, 0
s_cbranch_scc1 L_pl4
L_pd4:
s_add_u32 s93, s84, 10485760
buffer_load_dwordx4 v[160:163], v57, s[76:79], s93 offen sc1
buffer_load_dwordx4 v[164:167], v57, s[76:79], s93 offen offset:1024 sc1
buffer_load_dwordx2 v[168:169], v10, s[76:79], s93 offen offset:2048 sc1
s_add_u32 s93, s85, 10485760
buffer_load_dwordx4 v[172:175], v57, s[76:79], s93 offen sc1
buffer_load_dwordx4 v[176:179], v57, s[76:79], s93 offen offset:1024 sc1
buffer_load_dwordx2 v[180:181], v10, s[76:79], s93 offen offset:2048 sc1
s_add_u32 s93, s86, 10485760
buffer_load_dwordx4 v[184:187], v57, s[76:79], s93 offen sc1
buffer_load_dwordx4 v[188:191], v57, s[76:79], s93 offen offset:1024 sc1
buffer_load_dwordx2 v[192:193], v10, s[76:79], s93 offen offset:2048 sc1
s_waitcnt vmcnt(0)
v_lshlrev_b32 v240, 16, v160
v_and_b32 v241, s94, v160
v_add_f32 v128, v128, v240
v_add_f32 v129, v129, v241
v_lshlrev_b32 v240, 16, v161
v_and_b32 v241, s94, v161
v_add_f32 v130, v130, v240
v_add_f32 v131, v131, v241
v_lshlrev_b32 v240, 16, v172
v_and_b32 v241, s94, v172
v_add_f32 v128, v128, v240
v_add_f32 v129, v129, v241
v_lshlrev_b32 v240, 16, v173
v_and_b32 v241, s94, v173
v_add_f32 v130, v130, v240
v_add_f32 v131, v131, v241
v_lshlrev_b32 v240, 16, v184
v_and_b32 v241, s94, v184
v_add_f32 v128, v128, v240
v_add_f32 v129, v129, v241
v_lshlrev_b32 v240, 16, v185
v_and_b32 v241, s94, v185
v_add_f32 v130, v130, v240
v_add_f32 v131, v131, v241
v_cvt_pk_bf16_f32 v236, v128, v129
v_lshlrev_b32 v128, 16, v236
v_and_b32 v129, s94, v236
v_mul_f32 v128, v128, v32
v_mul_f32 v129, v129, v33
v_cvt_pk_bf16_f32 v236, v128, v129
v_lshlrev_b32 v128, 16, v236
v_and_b32 v129, s94, v236
v_lshlrev_b32 v237, 16, v226
v_and_b32 v238, s94, v226
v_add_f32 v128, v128, v237
v_add_f32 v129, v129, v238
v_cvt_pk_bf16_f32 v226, v128, v129
v_cvt_pk_bf16_f32 v236, v130, v131
v_lshlrev_b32 v130, 16, v236
v_and_b32 v131, s94, v236
v_mul_f32 v130, v130, v34
v_mul_f32 v131, v131, v35
v_cvt_pk_bf16_f32 v236, v130, v131
v_lshlrev_b32 v130, 16, v236
v_and_b32 v131, s94, v236
v_lshlrev_b32 v237, 16, v227
v_and_b32 v238, s94, v227
v_add_f32 v130, v130, v237
v_add_f32 v131, v131, v238
v_cvt_pk_bf16_f32 v227, v130, v131
buffer_store_dwordx2 v[226:227], v30, s[72:75], 0 offen offset:0
v_lshlrev_b32 v240, 16, v162
v_and_b32 v241, s94, v162
v_add_f32 v132, v132, v240
v_add_f32 v133, v133, v241
v_lshlrev_b32 v240, 16, v163
v_and_b32 v241, s94, v163
v_add_f32 v134, v134, v240
v_add_f32 v135, v135, v241
v_lshlrev_b32 v240, 16, v174
v_and_b32 v241, s94, v174
v_add_f32 v132, v132, v240
v_add_f32 v133, v133, v241
v_lshlrev_b32 v240, 16, v175
v_and_b32 v241, s94, v175
v_add_f32 v134, v134, v240
v_add_f32 v135, v135, v241
v_lshlrev_b32 v240, 16, v186
v_and_b32 v241, s94, v186
v_add_f32 v132, v132, v240
v_add_f32 v133, v133, v241
v_lshlrev_b32 v240, 16, v187
v_and_b32 v241, s94, v187
v_add_f32 v134, v134, v240
v_add_f32 v135, v135, v241
v_cvt_pk_bf16_f32 v236, v132, v133
v_lshlrev_b32 v132, 16, v236
v_and_b32 v133, s94, v236
v_mul_f32 v132, v132, v36
v_mul_f32 v133, v133, v37
v_cvt_pk_bf16_f32 v236, v132, v133
v_lshlrev_b32 v132, 16, v236
v_and_b32 v133, s94, v236
v_lshlrev_b32 v237, 16, v228
v_and_b32 v238, s94, v228
v_add_f32 v132, v132, v237
v_add_f32 v133, v133, v238
v_cvt_pk_bf16_f32 v228, v132, v133
v_cvt_pk_bf16_f32 v236, v134, v135
v_lshlrev_b32 v134, 16, v236
v_and_b32 v135, s94, v236
v_mul_f32 v134, v134, v38
v_mul_f32 v135, v135, v39
v_cvt_pk_bf16_f32 v236, v134, v135
v_lshlrev_b32 v134, 16, v236
v_and_b32 v135, s94, v236
v_lshlrev_b32 v237, 16, v229
v_and_b32 v238, s94, v229
v_add_f32 v134, v134, v237
v_add_f32 v135, v135, v238
v_cvt_pk_bf16_f32 v229, v134, v135
buffer_store_dwordx2 v[228:229], v30, s[72:75], 0 offen offset:32
v_lshlrev_b32 v240, 16, v164
v_and_b32 v241, s94, v164
v_add_f32 v136, v136, v240
v_add_f32 v137, v137, v241
v_lshlrev_b32 v240, 16, v165
v_and_b32 v241, s94, v165
v_add_f32 v138, v138, v240
v_add_f32 v139, v139, v241
v_lshlrev_b32 v240, 16, v176
v_and_b32 v241, s94, v176
v_add_f32 v136, v136, v240
v_add_f32 v137, v137, v241
v_lshlrev_b32 v240, 16, v177
v_and_b32 v241, s94, v177
v_add_f32 v138, v138, v240
v_add_f32 v139, v139, v241
v_lshlrev_b32 v240, 16, v188
v_and_b32 v241, s94, v188
v_add_f32 v136, v136, v240
v_add_f32 v137, v137, v241
v_lshlrev_b32 v240, 16, v189
v_and_b32 v241, s94, v189
v_add_f32 v138, v138, v240
v_add_f32 v139, v139, v241
v_cvt_pk_bf16_f32 v236, v136, v137
v_lshlrev_b32 v136, 16, v236
v_and_b32 v137, s94, v236
v_mul_f32 v136, v136, v40
v_mul_f32 v137, v137, v41
v_cvt_pk_bf16_f32 v236, v136, v137
v_lshlrev_b32 v136, 16, v236
v_and_b32 v137, s94, v236
v_lshlrev_b32 v237, 16, v230
v_and_b32 v238, s94, v230
v_add_f32 v136, v136, v237
v_add_f32 v137, v137, v238
v_cvt_pk_bf16_f32 v230, v136, v137
v_cvt_pk_bf16_f32 v236, v138, v139
v_lshlrev_b32 v138, 16, v236
v_and_b32 v139, s94, v236
v_mul_f32 v138, v138, v42
v_mul_f32 v139, v139, v43
v_cvt_pk_bf16_f32 v236, v138, v139
v_lshlrev_b32 v138, 16, v236
v_and_b32 v139, s94, v236
v_lshlrev_b32 v237, 16, v231
v_and_b32 v238, s94, v231
v_add_f32 v138, v138, v237
v_add_f32 v139, v139, v238
v_cvt_pk_bf16_f32 v231, v138, v139
buffer_store_dwordx2 v[230:231], v30, s[72:75], 0 offen offset:64
v_lshlrev_b32 v240, 16, v166
v_and_b32 v241, s94, v166
v_add_f32 v140, v140, v240
v_add_f32 v141, v141, v241
v_lshlrev_b32 v240, 16, v167
v_and_b32 v241, s94, v167
v_add_f32 v142, v142, v240
v_add_f32 v143, v143, v241
v_lshlrev_b32 v240, 16, v178
v_and_b32 v241, s94, v178
v_add_f32 v140, v140, v240
v_add_f32 v141, v141, v241
v_lshlrev_b32 v240, 16, v179
v_and_b32 v241, s94, v179
v_add_f32 v142, v142, v240
v_add_f32 v143, v143, v241
v_lshlrev_b32 v240, 16, v190
v_and_b32 v241, s94, v190
v_add_f32 v140, v140, v240
v_add_f32 v141, v141, v241
v_lshlrev_b32 v240, 16, v191
v_and_b32 v241, s94, v191
v_add_f32 v142, v142, v240
v_add_f32 v143, v143, v241
v_cvt_pk_bf16_f32 v236, v140, v141
v_lshlrev_b32 v140, 16, v236
v_and_b32 v141, s94, v236
v_mul_f32 v140, v140, v44
v_mul_f32 v141, v141, v45
v_cvt_pk_bf16_f32 v236, v140, v141
v_lshlrev_b32 v140, 16, v236
v_and_b32 v141, s94, v236
v_lshlrev_b32 v237, 16, v232
v_and_b32 v238, s94, v232
v_add_f32 v140, v140, v237
v_add_f32 v141, v141, v238
v_cvt_pk_bf16_f32 v232, v140, v141
v_cvt_pk_bf16_f32 v236, v142, v143
v_lshlrev_b32 v142, 16, v236
v_and_b32 v143, s94, v236
v_mul_f32 v142, v142, v46
v_mul_f32 v143, v143, v47
v_cvt_pk_bf16_f32 v236, v142, v143
v_lshlrev_b32 v142, 16, v236
v_and_b32 v143, s94, v236
v_lshlrev_b32 v237, 16, v233
v_and_b32 v238, s94, v233
v_add_f32 v142, v142, v237
v_add_f32 v143, v143, v238
v_cvt_pk_bf16_f32 v233, v142, v143
buffer_store_dwordx2 v[232:233], v30, s[72:75], 0 offen offset:96
v_lshlrev_b32 v240, 16, v168
v_and_b32 v241, s94, v168
v_add_f32 v144, v144, v240
v_add_f32 v145, v145, v241
v_lshlrev_b32 v240, 16, v169
v_and_b32 v241, s94, v169
v_add_f32 v146, v146, v240
v_add_f32 v147, v147, v241
v_lshlrev_b32 v240, 16, v180
v_and_b32 v241, s94, v180
v_add_f32 v144, v144, v240
v_add_f32 v145, v145, v241
v_lshlrev_b32 v240, 16, v181
v_and_b32 v241, s94, v181
v_add_f32 v146, v146, v240
v_add_f32 v147, v147, v241
v_lshlrev_b32 v240, 16, v192
v_and_b32 v241, s94, v192
v_add_f32 v144, v144, v240
v_add_f32 v145, v145, v241
v_lshlrev_b32 v240, 16, v193
v_and_b32 v241, s94, v193
v_add_f32 v146, v146, v240
v_add_f32 v147, v147, v241
v_cvt_pk_bf16_f32 v236, v144, v145
v_lshlrev_b32 v144, 16, v236
v_and_b32 v145, s94, v236
v_mul_f32 v144, v144, v48
v_mul_f32 v145, v145, v49
v_cvt_pk_bf16_f32 v236, v144, v145
v_lshlrev_b32 v144, 16, v236
v_and_b32 v145, s94, v236
v_lshlrev_b32 v237, 16, v234
v_and_b32 v238, s94, v234
v_add_f32 v144, v144, v237
v_add_f32 v145, v145, v238
v_cvt_pk_bf16_f32 v234, v144, v145
v_cvt_pk_bf16_f32 v236, v146, v147
v_lshlrev_b32 v146, 16, v236
v_and_b32 v147, s94, v236
v_mul_f32 v146, v146, v50
v_mul_f32 v147, v147, v51
v_cvt_pk_bf16_f32 v236, v146, v147
v_lshlrev_b32 v146, 16, v236
v_and_b32 v147, s94, v236
v_lshlrev_b32 v237, 16, v235
v_and_b32 v238, s94, v235
v_add_f32 v146, v146, v237
v_add_f32 v147, v147, v238
v_cvt_pk_bf16_f32 v235, v146, v147
buffer_store_dwordx2 v[234:235], v30, s[72:75], 0 offen offset:128
L_at_end:
s_endpgm
L_stub0:
s_call_b64 s[46:47], L_rare0
s_branch L_back0
L_stub1:
s_call_b64 s[46:47], L_rare1
s_branch L_back1
L_stub2:
s_call_b64 s[46:47], L_rare0
s_branch L_back2
L_stub3:
s_call_b64 s[46:47], L_rare1
s_branch L_back3
L_stub30:
s_call_b64 s[46:47], L_rare0
s_branch L_back30
L_stub31:
s_call_b64 s[46:47], L_rare3
s_branch L_back31
L_xf1:
s_add_u32 s55, s91, 0
v_accvgpr_read_b32 v236, a0
v_accvgpr_read_b32 v237, a1
v_accvgpr_read_b32 v238, a2
v_accvgpr_read_b32 v239, a3
v_cvt_pk_bf16_f32 v196, v236, v237
v_cvt_pk_bf16_f32 v197, v238, v239
v_accvgpr_read_b32 v236, a8
v_accvgpr_read_b32 v237, a9
v_accvgpr_read_b32 v238, a10
v_accvgpr_read_b32 v239, a11
v_cvt_pk_bf16_f32 v198, v236, v237
v_cvt_pk_bf16_f32 v199, v238, v239
v_accvgpr_read_b32 v236, a16
v_accvgpr_read_b32 v237, a17
v_accvgpr_read_b32 v238, a18
v_accvgpr_read_b32 v239, a19
v_cvt_pk_bf16_f32 v200, v236, v237
v_cvt_pk_bf16_f32 v201, v238, v239
v_accvgpr_read_b32 v236, a24
v_accvgpr_read_b32 v237, a25
v_accvgpr_read_b32 v238, a26
v_accvgpr_read_b32 v239, a27
v_cvt_pk_bf16_f32 v202, v236, v237
v_cvt_pk_bf16_f32 v203, v238, v239
v_accvgpr_read_b32 v236, a32
v_accvgpr_read_b32 v237, a33
v_accvgpr_read_b32 v238, a34
v_accvgpr_read_b32 v239, a35
v_cvt_pk_bf16_f32 v204, v236, v237
v_cvt_pk_bf16_f32 v205, v238, v239
s_add_u32 s56, s91, 20480
v_accvgpr_read_b32 v236, a40
v_accvgpr_read_b32 v237, a41
v_accvgpr_read_b32 v238, a42
v_accvgpr_read_b32 v239, a43
v_cvt_pk_bf16_f32 v206, v236, v237
v_cvt_pk_bf16_f32 v207, v238, v239
v_accvgpr_read_b32 v236, a48
v_accvgpr_read_b32 v237, a49
v_accvgpr_read_b32 v238, a50
v_accvgpr_read_b32 v239, a51
v_cvt_pk_bf16_f32 v208, v236, v237
v_cvt_pk_bf16_f32 v209, v238, v239
v_accvgpr_read_b32 v236, a56
v_accvgpr_read_b32 v237, a57
v_accvgpr_read_b32 v238, a58
v_accvgpr_read_b32 v239, a59
v_cvt_pk_bf16_f32 v210, v236, v237
v_cvt_pk_bf16_f32 v211, v238, v239
v_accvgpr_read_b32 v236, a64
v_accvgpr_read_b32 v237, a65
v_accvgpr_read_b32 v238, a66
v_accvgpr_read_b32 v239, a67
v_cvt_pk_bf16_f32 v212, v236, v237
v_cvt_pk_bf16_f32 v213, v238, v239
v_accvgpr_read_b32 v236, a72
v_accvgpr_read_b32 v237, a73
v_accvgpr_read_b32 v238, a74
v_accvgpr_read_b32 v239, a75
v_cvt_pk_bf16_f32 v214, v236, v237
v_cvt_pk_bf16_f32 v215, v238, v239
s_add_u32 s57, s91, 30720
v_accvgpr_read_b32 v236, a44
v_accvgpr_read_b32 v237, a45
v_accvgpr_read_b32 v238, a46
v_accvgpr_read_b32 v239, a47
v_cvt_pk_bf16_f32 v216, v236, v237
v_cvt_pk_bf16_f32 v217, v238, v239
v_accvgpr_read_b32 v236, a52
v_accvgpr_read_b32 v237, a53
v_accvgpr_read_b32 v238, a54
v_accvgpr_read_b32 v239, a55
v_cvt_pk_bf16_f32 v218, v236, v237
v_cvt_pk_bf16_f32 v219, v238, v239
v_accvgpr_read_b32 v236, a60
v_accvgpr_read_b32 v237, a61
v_accvgpr_read_b32 v238, a62
v_accvgpr_read_b32 v239, a63
v_cvt_pk_bf16_f32 v220, v236, v237
v_cvt_pk_bf16_f32 v221, v238, v239
v_accvgpr_read_b32 v236, a68
v_accvgpr_read_b32 v237, a69
v_accvgpr_read_b32 v238, a70
v_accvgpr_read_b32 v239, a71
v_cvt_pk_bf16_f32 v222, v236, v237
v_cvt_pk_bf16_f32 v223, v238, v239
v_accvgpr_read_b32 v236, a76
v_accvgpr_read_b32 v237, a77
v_accvgpr_read_b32 v238, a78
v_accvgpr_read_b32 v239, a79
v_cvt_pk_bf16_f32 v224, v236, v237
v_cvt_pk_bf16_f32 v225, v238, v239
v_accvgpr_mov_b32 a160, a4
v_accvgpr_mov_b32 a161, a5
v_accvgpr_mov_b32 a162, a6
v_accvgpr_mov_b32 a163, a7
v_accvgpr_mov_b32 a164, a12
v_accvgpr_mov_b32 a165, a13
v_accvgpr_mov_b32 a166, a14
v_accvgpr_mov_b32 a167, a15
v_accvgpr_mov_b32 a168, a20
v_accvgpr_mov_b32 a169, a21
v_accvgpr_mov_b32 a170, a22
v_accvgpr_mov_b32 a171, a23
v_accvgpr_mov_b32 a172, a28
v_accvgpr_mov_b32 a173, a29
v_accvgpr_mov_b32 a174, a30
v_accvgpr_mov_b32 a175, a31
v_accvgpr_mov_b32 a176, a36
v_accvgpr_mov_b32 a177, a37
v_accvgpr_mov_b32 a178, a38
v_accvgpr_mov_b32 a179, a39
s_branch L_xf_j
L_xf2:
s_add_u32 s55, s91, 0
v_accvgpr_read_b32 v236, a0
v_accvgpr_read_b32 v237, a1
v_accvgpr_read_b32 v238, a2
v_accvgpr_read_b32 v239, a3
v_cvt_pk_bf16_f32 v196, v236, v237
v_cvt_pk_bf16_f32 v197, v238, v239
v_accvgpr_read_b32 v236, a8
v_accvgpr_read_b32 v237, a9
v_accvgpr_read_b32 v238, a10
v_accvgpr_read_b32 v239, a11
v_cvt_pk_bf16_f32 v198, v236, v237
v_cvt_pk_bf16_f32 v199, v238, v239
v_accvgpr_read_b32 v236, a16
v_accvgpr_read_b32 v237, a17
v_accvgpr_read_b32 v238, a18
v_accvgpr_read_b32 v239, a19
v_cvt_pk_bf16_f32 v200, v236, v237
v_cvt_pk_bf16_f32 v201, v238, v239
v_accvgpr_read_b32 v236, a24
v_accvgpr_read_b32 v237, a25
v_accvgpr_read_b32 v238, a26
v_accvgpr_read_b32 v239, a27
v_cvt_pk_bf16_f32 v202, v236, v237
v_cvt_pk_bf16_f32 v203, v238, v239
v_accvgpr_read_b32 v236, a32
v_accvgpr_read_b32 v237, a33
v_accvgpr_read_b32 v238, a34
v_accvgpr_read_b32 v239, a35
v_cvt_pk_bf16_f32 v204, v236, v237
v_cvt_pk_bf16_f32 v205, v238, v239
s_add_u32 s56, s91, 10240
v_accvgpr_read_b32 v236, a4
v_accvgpr_read_b32 v237, a5
v_accvgpr_read_b32 v238, a6
v_accvgpr_read_b32 v239, a7
v_cvt_pk_bf16_f32 v206, v236, v237
v_cvt_pk_bf16_f32 v207, v238, v239
v_accvgpr_read_b32 v236, a12
v_accvgpr_read_b32 v237, a13
v_accvgpr_read_b32 v238, a14
v_accvgpr_read_b32 v239, a15
v_cvt_pk_bf16_f32 v208, v236, v237
v_cvt_pk_bf16_f32 v209, v238, v239
v_accvgpr_read_b32 v236, a20
v_accvgpr_read_b32 v237, a21
v_accvgpr_read_b32 v238, a22
v_accvgpr_read_b32 v239, a23
v_cvt_pk_bf16_f32 v210, v236, v237
v_cvt_pk_bf16_f32 v211, v238, v239
v_accvgpr_read_b32 v236, a28
v_accvgpr_read_b32 v237, a29
v_accvgpr_read_b32 v238, a30
v_accvgpr_read_b32 v239, a31
v_cvt_pk_bf16_f32 v212, v236, v237
v_cvt_pk_bf16_f32 v213, v238, v239
v_accvgpr_read_b32 v236, a36
v_accvgpr_read_b32 v237, a37
v_accvgpr_read_b32 v238, a38
v_accvgpr_read_b32 v239, a39
v_cvt_pk_bf16_f32 v214, v236, v237
v_cvt_pk_bf16_f32 v215, v238, v239
s_add_u32 s57, s91, 30720
v_accvgpr_read_b32 v236, a44
v_accvgpr_read_b32 v237, a45
v_accvgpr_read_b32 v238, a46
v_accvgpr_read_b32 v239, a47
v_cvt_pk_bf16_f32 v216, v236, v237
v_cvt_pk_bf16_f32 v217, v238, v239
v_accvgpr_read_b32 v236, a52
v_accvgpr_read_b32 v237, a53
v_accvgpr_read_b32 v238, a54
v_accvgpr_read_b32 v239, a55
v_cvt_pk_bf16_f32 v218, v236, v237
v_cvt_pk_bf16_f32 v219, v238, v239
v_accvgpr_read_b32 v236, a60
v_accvgpr_read_b32 v237, a61
v_accvgpr_read_b32 v238, a62
v_accvgpr_read_b32 v239, a63
v_cvt_pk_bf16_f32 v220, v236, v237
v_cvt_pk_bf16_f32 v221, v238, v239
v_accvgpr_read_b32 v236, a68
v_accvgpr_read_b32 v237, a69
v_accvgpr_read_b32 v238, a70
v_accvgpr_read_b32 v239, a71
v_cvt_pk_bf16_f32 v222, v236, v237
v_cvt_pk_bf16_f32 v223, v238, v239
v_accvgpr_read_b32 v236, a76
v_accvgpr_read_b32 v237, a77
v_accvgpr_read_b32 v238, a78
v_accvgpr_read_b32 v239, a79
v_cvt_pk_bf16_f32 v224, v236, v237
v_cvt_pk_bf16_f32 v225, v238, v239
v_accvgpr_mov_b32 a160, a40
v_accvgpr_mov_b32 a161, a41
v_accvgpr_mov_b32 a162, a42
v_accvgpr_mov_b32 a163, a43
v_accvgpr_mov_b32 a164, a48
v_accvgpr_mov_b32 a165, a49
v_accvgpr_mov_b32 a166, a50
v_accvgpr_mov_b32 a167, a51
v_accvgpr_mov_b32 a168, a56
v_accvgpr_mov_b32 a169, a57
v_accvgpr_mov_b32 a170, a58
v_accvgpr_mov_b32 a171, a59
v_accvgpr_mov_b32 a172, a64
v_accvgpr_mov_b32 a173, a65
v_accvgpr_mov_b32 a174, a66
v_accvgpr_mov_b32 a175, a67
v_accvgpr_mov_b32 a176, a72
v_accvgpr_mov_b32 a177, a73
v_accvgpr_mov_b32 a178, a74
v_accvgpr_mov_b32 a179, a75
s_branch L_xf_j
L_xf3:
s_add_u32 s55, s91, 0
v_accvgpr_read_b32 v236, a0
v_accvgpr_read_b32 v237, a1
v_accvgpr_read_b32 v238, a2
v_accvgpr_read_b32 v239, a3
v_cvt_pk_bf16_f32 v196, v236, v237
v_cvt_pk_bf16_f32 v197, v238, v239
v_accvgpr_read_b32 v236, a8
v_accvgpr_read_b32 v237, a9
v_accvgpr_read_b32 v238, a10
v_accvgpr_read_b32 v239, a11
v_cvt_pk_bf16_f32 v198, v236, v237
v_cvt_pk_bf16_f32 v199, v238, v239
v_accvgpr_read_b32 v236, a16
v_accvgpr_read_b32 v237, a17
v_accvgpr_read_b32 v238, a18
v_accvgpr_read_b32 v239, a19
v_cvt_pk_bf16_f32 v200, v236, v237
v_cvt_pk_bf16_f32 v201, v238, v239
v_accvgpr_read_b32 v236, a24
v_accvgpr_read_b32 v237, a25
v_accvgpr_read_b32 v238, a26
v_accvgpr_read_b32 v239, a27
v_cvt_pk_bf16_f32 v202, v236, v237
v_cvt_pk_bf16_f32 v203, v238, v239
v_accvgpr_read_b32 v236, a32
v_accvgpr_read_b32 v237, a33
v_accvgpr_read_b32 v238, a34
v_accvgpr_read_b32 v239, a35
v_cvt_pk_bf16_f32 v204, v236, v237
v_cvt_pk_bf16_f32 v205, v238, v239
s_add_u32 s56, s91, 10240
v_accvgpr_read_b32 v236, a4
v_accvgpr_read_b32 v237, a5
v_accvgpr_read_b32 v238, a6
v_accvgpr_read_b32 v239, a7
v_cvt_pk_bf16_f32 v206, v236, v237
v_cvt_pk_bf16_f32 v207, v238, v239
v_accvgpr_read_b32 v236, a12
v_accvgpr_read_b32 v237, a13
v_accvgpr_read_b32 v238, a14
v_accvgpr_read_b32 v239, a15
v_cvt_pk_bf16_f32 v208, v236, v237
v_cvt_pk_bf16_f32 v209, v238, v239
v_accvgpr_read_b32 v236, a20
v_accvgpr_read_b32 v237, a21
v_accvgpr_read_b32 v238, a22
v_accvgpr_read_b32 v239, a23
v_cvt_pk_bf16_f32 v210, v236, v237
v_cvt_pk_bf16_f32 v211, v238, v239
v_accvgpr_read_b32 v236, a28
v_accvgpr_read_b32 v237, a29
v_accvgpr_read_b32 v238, a30
v_accvgpr_read_b32 v239, a31
v_cvt_pk_bf16_f32 v212, v236, v237
v_cvt_pk_bf16_f32 v213, v238, v239
v_accvgpr_read_b32 v236, a36
v_accvgpr_read_b32 v237, a37
v_accvgpr_read_b32 v238, a38
v_accvgpr_read_b32 v239, a39
v_cvt_pk_bf16_f32 v214, v236, v237
v_cvt_pk_bf16_f32 v215, v238, v239
s_add_u32 s57, s91, 20480
v_accvgpr_read_b32 v236, a40
v_accvgpr_read_b32 v237, a41
v_accvgpr_read_b32 v238, a42
v_accvgpr_read_b32 v239, a43
v_cvt_pk_bf16_f32 v216, v236, v237
v_cvt_pk_bf16_f32 v217, v238, v239
v_accvgpr_read_b32 v236, a48
v_accvgpr_read_b32 v237, a49
v_accvgpr_read_b32 v238, a50
v_accvgpr_read_b32 v239, a51
v_cvt_pk_bf16_f32 v218, v236, v237
v_cvt_pk_bf16_f32 v219, v238, v239
v_accvgpr_read_b32 v236, a56
v_accvgpr_read_b32 v237, a57
v_accvgpr_read_b32 v238, a58
v_accvgpr_read_b32 v239, a59
v_cvt_pk_bf16_f32 v220, v236, v237
v_cvt_pk_bf16_f32 v221, v238, v239
v_accvgpr_read_b32 v236, a64
v_accvgpr_read_b32 v237, a65
v_accvgpr_read_b32 v238, a66
v_accvgpr_read_b32 v239, a67
v_cvt_pk_bf16_f32 v222, v236, v237
v_cvt_pk_bf16_f32 v223, v238, v239
v_accvgpr_read_b32 v236, a72
v_accvgpr_read_b32 v237, a73
v_accvgpr_read_b32 v238, a74
v_accvgpr_read_b32 v239, a75
v_cvt_pk_bf16_f32 v224, v236, v237
v_cvt_pk_bf16_f32 v225, v238, v239
v_accvgpr_mov_b32 a160, a44
v_accvgpr_mov_b32 a161, a45
v_accvgpr_mov_b32 a162, a46
v_accvgpr_mov_b32 a163, a47
v_accvgpr_mov_b32 a164, a52
v_accvgpr_mov_b32 a165, a53
v_accvgpr_mov_b32 a166, a54
v_accvgpr_mov_b32 a167, a55
v_accvgpr_mov_b32 a168, a60
v_accvgpr_mov_b32 a169, a61
v_accvgpr_mov_b32 a170, a62
v_accvgpr_mov_b32 a171, a63
v_accvgpr_mov_b32 a172, a68
v_accvgpr_mov_b32 a173, a69
v_accvgpr_mov_b32 a174, a70
v_accvgpr_mov_b32 a175, a71
v_accvgpr_mov_b32 a176, a76
v_accvgpr_mov_b32 a177, a77
v_accvgpr_mov_b32 a178, a78
v_accvgpr_mov_b32 a179, a79
s_branch L_xf_j
L_of2:
s_mov_b32 s45, 0x200000
L_of2_l:
buffer_load_dword v63, v28, s[60:63], s25 offen offset:0 sc1
s_waitcnt vmcnt(0)
v_cmp_eq_u32 vcc, 0, v63
s_sleep 2
s_sub_u32 s45, s45, 1
s_cmp_eq_u32 s45, 0
s_cbranch_scc1 L_of2_b
s_cbranch_vccnz L_of2_l
s_branch L_of2_b
L_of3:
s_mov_b32 s45, 0x200000
L_of3_l:
buffer_load_dword v15, v29, s[60:63], s25 offen offset:0 sc1
s_waitcnt vmcnt(0)
v_cmp_eq_u32 vcc, 0, v15
s_sleep 2
s_sub_u32 s45, s45, 1
s_cmp_eq_u32 s45, 0
s_cbranch_scc1 L_of3_b
s_cbranch_vccnz L_of3_l
s_branch L_of3_b
L_tb:
s_mov_b32 s45, 0x200000
L_tb_l:
buffer_load_dword v14, v62, s[60:63], 0 offen offset:2048 sc1
s_waitcnt vmcnt(0)
v_cmp_eq_u32 vcc, 0, v14
s_sleep 2
s_sub_u32 s45, s45, 1
s_cmp_eq_u32 s45, 0
s_cbranch_scc1 L_tb_b
s_cbranch_vccnz L_tb_l
s_branch L_tb_b
L_p2_short:
s_waitcnt vmcnt(0)
s_branch L_p2_done
L_ff:
s_mov_b32 s45, 0x200000
L_ff_l:
buffer_load_dword v63, v56, s[60:63], s88 offen offset:0 sc1
s_waitcnt vmcnt(0)
v_cmp_eq_u32 vcc, 0, v63
s_sleep 2
s_sub_u32 s45, s45, 1
s_cmp_eq_u32 s45, 0
s_cbranch_scc1 L_ff_b
s_cbranch_vccnz L_ff_l
s_branch L_ff_b
L_xs1:
v_accvgpr_read_b32 v128, a84
v_accvgpr_read_b32 v129, a85
v_accvgpr_read_b32 v130, a86
v_accvgpr_read_b32 v131, a87
v_accvgpr_read_b32 v132, a92
v_accvgpr_read_b32 v133, a93
v_accvgpr_read_b32 v134, a94
v_accvgpr_read_b32 v135, a95
v_accvgpr_read_b32 v136, a100
v_accvgpr_read_b32 v137, a101
v_accvgpr_read_b32 v138, a102
v_accvgpr_read_b32 v139, a103
v_accvgpr_read_b32 v140, a108
v_accvgpr_read_b32 v141, a109
v_accvgpr_read_b32 v142, a110
v_accvgpr_read_b32 v143, a111
v_accvgpr_read_b32 v144, a116
v_accvgpr_read_b32 v145, a117
v_accvgpr_read_b32 v146, a118
v_accvgpr_read_b32 v147, a119
s_branch L_xs_j
L_xs2:
v_accvgpr_read_b32 v128, a120
v_accvgpr_read_b32 v129, a121
v_accvgpr_read_b32 v130, a122
v_accvgpr_read_b32 v131, a123
v_accvgpr_read_b32 v132, a128
v_accvgpr_read_b32 v133, a129
v_accvgpr_read_b32 v134, a130
v_accvgpr_read_b32 v135, a131
v_accvgpr_read_b32 v136, a136
v_accvgpr_read_b32 v137, a137
v_accvgpr_read_b32 v138, a138
v_accvgpr_read_b32 v139, a139
v_accvgpr_read_b32 v140, a144
v_accvgpr_read_b32 v141, a145
v_accvgpr_read_b32 v142, a146
v_accvgpr_read_b32 v143, a147
v_accvgpr_read_b32 v144, a152
v_accvgpr_read_b32 v145, a153
v_accvgpr_read_b32 v146, a154
v_accvgpr_read_b32 v147, a155
s_branch L_xs_j
L_xs3:
v_accvgpr_read_b32 v128, a124
v_accvgpr_read_b32 v129, a125
v_accvgpr_read_b32 v130, a126
v_accvgpr_read_b32 v131, a127
v_accvgpr_read_b32 v132, a132
v_accvgpr_read_b32 v133, a133
v_accvgpr_read_b32 v134, a134
v_accvgpr_read_b32 v135, a135
v_accvgpr_read_b32 v136, a140
v_accvgpr_read_b32 v137, a141
v_accvgpr_read_b32 v138, a142
v_accvgpr_read_b32 v139, a143
v_accvgpr_read_b32 v140, a148
v_accvgpr_read_b32 v141, a149
v_accvgpr_read_b32 v142, a150
v_accvgpr_read_b32 v143, a151
v_accvgpr_read_b32 v144, a156
v_accvgpr_read_b32 v145, a157
v_accvgpr_read_b32 v146, a158
v_accvgpr_read_b32 v147, a159
s_branch L_xs_j
L_code_end:
L_rare0:
s_nop 15
v_max3_f32 v40, v120, v121, v122
v_max3_f32 v40, v40, v123, v136
v_max3_f32 v40, v40, v137, v138
v_max3_f32 v40, v40, v139, v152
v_max3_f32 v40, v40, v153, v154
v_max3_f32 v40, v40, v155, v168
v_max3_f32 v40, v40, v169, v170
v_max_f32 v40, v40, v171
v_mov_b32 v42, v40
v_mov_b32 v43, v40
s_nop 1
v_permlane32_swap_b32 v42, v43
s_nop 1
v_max_f32 v40, v42, v43
v_mov_b32 v42, v40
v_mov_b32 v43, v40
s_nop 1
v_permlane16_swap_b32 v42, v43
s_nop 1
v_max_f32 v40, v42, v43
v_max_f32 v40, 0, v40
v_exp_f32 v41, -v40
v_sub_f32 v248, v248, v40
v_sub_f32 v249, v249, v40
v_sub_f32 v250, v250, v40
v_sub_f32 v251, v251, v40
v_sub_f32 v120, v120, v40
v_sub_f32 v121, v121, v40
v_sub_f32 v122, v122, v40
v_sub_f32 v123, v123, v40
v_sub_f32 v136, v136, v40
v_sub_f32 v137, v137, v40
v_sub_f32 v138, v138, v40
v_sub_f32 v139, v139, v40
v_sub_f32 v152, v152, v40
v_sub_f32 v153, v153, v40
v_sub_f32 v154, v154, v40
v_sub_f32 v155, v155, v40
v_sub_f32 v168, v168, v40
v_sub_f32 v169, v169, v40
v_sub_f32 v170, v170, v40
v_sub_f32 v171, v171, v40
v_mul_f32 v32, v32, v41
v_accvgpr_read_b32 v44, a0
v_accvgpr_read_b32 v45, a1
v_accvgpr_read_b32 v46, a2
v_accvgpr_read_b32 v47, a3
v_mul_f32 v44, v44, v41
v_mul_f32 v45, v45, v41
v_mul_f32 v46, v46, v41
v_mul_f32 v47, v47, v41
v_accvgpr_write_b32 a0, v44
v_accvgpr_write_b32 a1, v45
v_accvgpr_write_b32 a2, v46
v_accvgpr_write_b32 a3, v47
v_accvgpr_read_b32 v44, a16
v_accvgpr_read_b32 v45, a17
v_accvgpr_read_b32 v46, a18
v_accvgpr_read_b32 v47, a19
v_mul_f32 v44, v44, v41
v_mul_f32 v45, v45, v41
v_mul_f32 v46, v46, v41
v_mul_f32 v47, v47, v41
v_accvgpr_write_b32 a16, v44
v_accvgpr_write_b32 a17, v45
v_accvgpr_write_b32 a18, v46
v_accvgpr_write_b32 a19, v47
v_accvgpr_read_b32 v44, a32
v_accvgpr_read_b32 v45, a33
v_accvgpr_read_b32 v46, a34
v_accvgpr_read_b32 v47, a35
v_mul_f32 v44, v44, v41
v_mul_f32 v45, v45, v41
v_mul_f32 v46, v46, v41
v_mul_f32 v47, v47, v41
v_accvgpr_write_b32 a32, v44
v_accvgpr_write_b32 a33, v45
v_accvgpr_write_b32 a34, v46
v_accvgpr_write_b32 a35, v47
v_accvgpr_read_b32 v44, a48
v_accvgpr_read_b32 v45, a49
v_accvgpr_read_b32 v46, a50
v_accvgpr_read_b32 v47, a51
v_mul_f32 v44, v44, v41
v_mul_f32 v45, v45, v41
v_mul_f32 v46, v46, v41
v_mul_f32 v47, v47, v41
v_accvgpr_write_b32 a48, v44
v_accvgpr_write_b32 a49, v45
v_accvgpr_write_b32 a50, v46
v_accvgpr_write_b32 a51, v47
v_accvgpr_read_b32 v44, a64
v_accvgpr_read_b32 v45, a65
v_accvgpr_read_b32 v46, a66
v_accvgpr_read_b32 v47, a67
v_mul_f32 v44, v44, v41
v_mul_f32 v45, v45, v41
v_mul_f32 v46, v46, v41
v_mul_f32 v47, v47, v41
v_accvgpr_write_b32 a64, v44
v_accvgpr_write_b32 a65, v45
v_accvgpr_write_b32 a66, v46
v_accvgpr_write_b32 a67, v47
v_accvgpr_read_b32 v44, a80
v_accvgpr_read_b32 v45, a81
v_accvgpr_read_b32 v46, a82
v_accvgpr_read_b32 v47, a83
v_mul_f32 v44, v44, v41
v_mul_f32 v45, v45, v41
v_mul_f32 v46, v46, v41
v_mul_f32 v47, v47, v41
v_accvgpr_write_b32 a80, v44
v_accvgpr_write_b32 a81, v45
v_accvgpr_write_b32 a82, v46
v_accvgpr_write_b32 a83, v47
v_accvgpr_read_b32 v44, a96
v_accvgpr_read_b32 v45, a97
v_accvgpr_read_b32 v46, a98
v_accvgpr_read_b32 v47, a99
v_mul_f32 v44, v44, v41
v_mul_f32 v45, v45, v41
v_mul_f32 v46, v46, v41
v_mul_f32 v47, v47, v41
v_accvgpr_write_b32 a96, v44
v_accvgpr_write_b32 a97, v45
v_accvgpr_write_b32 a98, v46
v_accvgpr_write_b32 a99, v47
v_accvgpr_read_b32 v44, a112
v_accvgpr_read_b32 v45, a113
v_accvgpr_read_b32 v46, a114
v_accvgpr_read_b32 v47, a115
v_mul_f32 v44, v44, v41
v_mul_f32 v45, v45, v41
v_mul_f32 v46, v46, v41
v_mul_f32 v47, v47, v41
v_accvgpr_write_b32 a112, v44
v_accvgpr_write_b32 a113, v45
v_accvgpr_write_b32 a114, v46
v_accvgpr_write_b32 a115, v47
v_accvgpr_read_b32 v44, a128
v_accvgpr_read_b32 v45, a129
v_accvgpr_read_b32 v46, a130
v_accvgpr_read_b32 v47, a131
v_mul_f32 v44, v44, v41
v_mul_f32 v45, v45, v41
v_mul_f32 v46, v46, v41
v_mul_f32 v47, v47, v41
v_accvgpr_write_b32 a128, v44
v_accvgpr_write_b32 a129, v45
v_accvgpr_write_b32 a130, v46
v_accvgpr_write_b32 a131, v47
v_accvgpr_read_b32 v44, a144
v_accvgpr_read_b32 v45, a145
v_accvgpr_read_b32 v46, a146
v_accvgpr_read_b32 v47, a147
v_mul_f32 v44, v44, v41
v_mul_f32 v45, v45, v41
v_mul_f32 v46, v46, v41
v_mul_f32 v47, v47, v41
v_accvgpr_write_b32 a144, v44
v_accvgpr_write_b32 a145, v45
v_accvgpr_write_b32 a146, v46
v_accvgpr_write_b32 a147, v47
v_accvgpr_read_b32 v44, a160
v_accvgpr_read_b32 v45, a161
v_accvgpr_read_b32 v46, a162
v_accvgpr_read_b32 v47, a163
v_mul_f32 v44, v44, v41
v_mul_f32 v45, v45, v41
v_mul_f32 v46, v46, v41
v_mul_f32 v47, v47, v41
v_accvgpr_write_b32 a160, v44
v_accvgpr_write_b32 a161, v45
v_accvgpr_write_b32 a162, v46
v_accvgpr_write_b32 a163, v47
v_accvgpr_read_b32 v44, a176
v_accvgpr_read_b32 v45, a177
v_accvgpr_read_b32 v46, a178
v_accvgpr_read_b32 v47, a179
v_mul_f32 v44, v44, v41
v_mul_f32 v45, v45, v41
v_mul_f32 v46, v46, v41
v_mul_f32 v47, v47, v41
v_accvgpr_write_b32 a176, v44
v_accvgpr_write_b32 a177, v45
v_accvgpr_write_b32 a178, v46
v_accvgpr_write_b32 a179, v47
v_max3_f32 v40, v124, v125, v126
v_max3_f32 v40, v40, v127, v140
v_max3_f32 v40, v40, v141, v142
v_max3_f32 v40, v40, v143, v156
v_max3_f32 v40, v40, v157, v158
v_max3_f32 v40, v40, v159, v172
v_max3_f32 v40, v40, v173, v174
v_max_f32 v40, v40, v175
v_mov_b32 v42, v40
v_mov_b32 v43, v40
s_nop 1
v_permlane32_swap_b32 v42, v43
s_nop 1
v_max_f32 v40, v42, v43
v_mov_b32 v42, v40
v_mov_b32 v43, v40
s_nop 1
v_permlane16_swap_b32 v42, v43
s_nop 1
v_max_f32 v40, v42, v43
v_max_f32 v40, 0, v40
v_exp_f32 v41, -v40
v_sub_f32 v252, v252, v40
v_sub_f32 v253, v253, v40
v_sub_f32 v254, v254, v40
v_sub_f32 v255, v255, v40
v_sub_f32 v124, v124, v40
v_sub_f32 v125, v125, v40
v_sub_f32 v126, v126, v40
v_sub_f32 v127, v127, v40
v_sub_f32 v140, v140, v40
v_sub_f32 v141, v141, v40
v_sub_f32 v142, v142, v40
v_sub_f32 v143, v143, v40
v_sub_f32 v156, v156, v40
v_sub_f32 v157, v157, v40
v_sub_f32 v158, v158, v40
v_sub_f32 v159, v159, v40
v_sub_f32 v172, v172, v40
v_sub_f32 v173, v173, v40
v_sub_f32 v174, v174, v40
v_sub_f32 v175, v175, v40
v_mul_f32 v33, v33, v41
v_accvgpr_read_b32 v44, a4
v_accvgpr_read_b32 v45, a5
v_accvgpr_read_b32 v46, a6
v_accvgpr_read_b32 v47, a7
v_mul_f32 v44, v44, v41
v_mul_f32 v45, v45, v41
v_mul_f32 v46, v46, v41
v_mul_f32 v47, v47, v41
v_accvgpr_write_b32 a4, v44
v_accvgpr_write_b32 a5, v45
v_accvgpr_write_b32 a6, v46
v_accvgpr_write_b32 a7, v47
v_accvgpr_read_b32 v44, a20
v_accvgpr_read_b32 v45, a21
v_accvgpr_read_b32 v46, a22
v_accvgpr_read_b32 v47, a23
v_mul_f32 v44, v44, v41
v_mul_f32 v45, v45, v41
v_mul_f32 v46, v46, v41
v_mul_f32 v47, v47, v41
v_accvgpr_write_b32 a20, v44
v_accvgpr_write_b32 a21, v45
v_accvgpr_write_b32 a22, v46
v_accvgpr_write_b32 a23, v47
v_accvgpr_read_b32 v44, a36
v_accvgpr_read_b32 v45, a37
v_accvgpr_read_b32 v46, a38
v_accvgpr_read_b32 v47, a39
v_mul_f32 v44, v44, v41
v_mul_f32 v45, v45, v41
v_mul_f32 v46, v46, v41
v_mul_f32 v47, v47, v41
v_accvgpr_write_b32 a36, v44
v_accvgpr_write_b32 a37, v45
v_accvgpr_write_b32 a38, v46
v_accvgpr_write_b32 a39, v47
v_accvgpr_read_b32 v44, a52
v_accvgpr_read_b32 v45, a53
v_accvgpr_read_b32 v46, a54
v_accvgpr_read_b32 v47, a55
v_mul_f32 v44, v44, v41
v_mul_f32 v45, v45, v41
v_mul_f32 v46, v46, v41
v_mul_f32 v47, v47, v41
v_accvgpr_write_b32 a52, v44
v_accvgpr_write_b32 a53, v45
v_accvgpr_write_b32 a54, v46
v_accvgpr_write_b32 a55, v47
v_accvgpr_read_b32 v44, a68
v_accvgpr_read_b32 v45, a69
v_accvgpr_read_b32 v46, a70
v_accvgpr_read_b32 v47, a71
v_mul_f32 v44, v44, v41
v_mul_f32 v45, v45, v41
v_mul_f32 v46, v46, v41
v_mul_f32 v47, v47, v41
v_accvgpr_write_b32 a68, v44
v_accvgpr_write_b32 a69, v45
v_accvgpr_write_b32 a70, v46
v_accvgpr_write_b32 a71, v47
v_accvgpr_read_b32 v44, a84
v_accvgpr_read_b32 v45, a85
v_accvgpr_read_b32 v46, a86
v_accvgpr_read_b32 v47, a87
v_mul_f32 v44, v44, v41
v_mul_f32 v45, v45, v41
v_mul_f32 v46, v46, v41
v_mul_f32 v47, v47, v41
v_accvgpr_write_b32 a84, v44
v_accvgpr_write_b32 a85, v45
v_accvgpr_write_b32 a86, v46
v_accvgpr_write_b32 a87, v47
v_accvgpr_read_b32 v44, a100
v_accvgpr_read_b32 v45, a101
v_accvgpr_read_b32 v46, a102
v_accvgpr_read_b32 v47, a103
v_mul_f32 v44, v44, v41
v_mul_f32 v45, v45, v41
v_mul_f32 v46, v46, v41
v_mul_f32 v47, v47, v41
v_accvgpr_write_b32 a100, v44
v_accvgpr_write_b32 a101, v45
v_accvgpr_write_b32 a102, v46
v_accvgpr_write_b32 a103, v47
v_accvgpr_read_b32 v44, a116
v_accvgpr_read_b32 v45, a117
v_accvgpr_read_b32 v46, a118
v_accvgpr_read_b32 v47, a119
v_mul_f32 v44, v44, v41
v_mul_f32 v45, v45, v41
v_mul_f32 v46, v46, v41
v_mul_f32 v47, v47, v41
v_accvgpr_write_b32 a116, v44
v_accvgpr_write_b32 a117, v45
v_accvgpr_write_b32 a118, v46
v_accvgpr_write_b32 a119, v47
v_accvgpr_read_b32 v44, a132
v_accvgpr_read_b32 v45, a133
v_accvgpr_read_b32 v46, a134
v_accvgpr_read_b32 v47, a135
v_mul_f32 v44, v44, v41
v_mul_f32 v45, v45, v41
v_mul_f32 v46, v46, v41
v_mul_f32 v47, v47, v41
v_accvgpr_write_b32 a132, v44
v_accvgpr_write_b32 a133, v45
v_accvgpr_write_b32 a134, v46
v_accvgpr_write_b32 a135, v47
v_accvgpr_read_b32 v44, a148
v_accvgpr_read_b32 v45, a149
v_accvgpr_read_b32 v46, a150
v_accvgpr_read_b32 v47, a151
v_mul_f32 v44, v44, v41
v_mul_f32 v45, v45, v41
v_mul_f32 v46, v46, v41
v_mul_f32 v47, v47, v41
v_accvgpr_write_b32 a148, v44
v_accvgpr_write_b32 a149, v45
v_accvgpr_write_b32 a150, v46
v_accvgpr_write_b32 a151, v47
v_accvgpr_read_b32 v44, a164
v_accvgpr_read_b32 v45, a165
v_accvgpr_read_b32 v46, a166
v_accvgpr_read_b32 v47, a167
v_mul_f32 v44, v44, v41
v_mul_f32 v45, v45, v41
v_mul_f32 v46, v46, v41
v_mul_f32 v47, v47, v41
v_accvgpr_write_b32 a164, v44
v_accvgpr_write_b32 a165, v45
v_accvgpr_write_b32 a166, v46
v_accvgpr_write_b32 a167, v47
v_accvgpr_read_b32 v44, a180
v_accvgpr_read_b32 v45, a181
v_accvgpr_read_b32 v46, a182
v_accvgpr_read_b32 v47, a183
v_mul_f32 v44, v44, v41
v_mul_f32 v45, v45, v41
v_mul_f32 v46, v46, v41
v_mul_f32 v47, v47, v41
v_accvgpr_write_b32 a180, v44
v_accvgpr_write_b32 a181, v45
v_accvgpr_write_b32 a182, v46
v_accvgpr_write_b32 a183, v47
v_max3_f32 v40, v128, v129, v130
v_max3_f32 v40, v40, v131, v144
v_max3_f32 v40, v40, v145, v146
v_max3_f32 v40, v40, v147, v160
v_max3_f32 v40, v40, v161, v162
v_max3_f32 v40, v40, v163, v176
v_max3_f32 v40, v40, v177, v178
v_max_f32 v40, v40, v179
v_mov_b32 v42, v40
v_mov_b32 v43, v40
s_nop 1
v_permlane32_swap_b32 v42, v43
s_nop 1
v_max_f32 v40, v42, v43
v_mov_b32 v42, v40
v_mov_b32 v43, v40
s_nop 1
v_permlane16_swap_b32 v42, v43
s_nop 1
v_max_f32 v40, v42, v43
v_max_f32 v40, 0, v40
v_exp_f32 v41, -v40
v_sub_f32 v24, v24, v40
v_sub_f32 v25, v25, v40
v_sub_f32 v26, v26, v40
v_sub_f32 v27, v27, v40
v_sub_f32 v128, v128, v40
v_sub_f32 v129, v129, v40
v_sub_f32 v130, v130, v40
v_sub_f32 v131, v131, v40
v_sub_f32 v144, v144, v40
v_sub_f32 v145, v145, v40
v_sub_f32 v146, v146, v40
v_sub_f32 v147, v147, v40
v_sub_f32 v160, v160, v40
v_sub_f32 v161, v161, v40
v_sub_f32 v162, v162, v40
v_sub_f32 v163, v163, v40
v_sub_f32 v176, v176, v40
v_sub_f32 v177, v177, v40
v_sub_f32 v178, v178, v40
v_sub_f32 v179, v179, v40
v_mul_f32 v34, v34, v41
v_accvgpr_read_b32 v44, a8
v_accvgpr_read_b32 v45, a9
v_accvgpr_read_b32 v46, a10
v_accvgpr_read_b32 v47, a11
v_mul_f32 v44, v44, v41
v_mul_f32 v45, v45, v41
v_mul_f32 v46, v46, v41
v_mul_f32 v47, v47, v41
v_accvgpr_write_b32 a8, v44
v_accvgpr_write_b32 a9, v45
v_accvgpr_write_b32 a10, v46
v_accvgpr_write_b32 a11, v47
v_accvgpr_read_b32 v44, a24
v_accvgpr_read_b32 v45, a25
v_accvgpr_read_b32 v46, a26
v_accvgpr_read_b32 v47, a27
v_mul_f32 v44, v44, v41
v_mul_f32 v45, v45, v41
v_mul_f32 v46, v46, v41
v_mul_f32 v47, v47, v41
v_accvgpr_write_b32 a24, v44
v_accvgpr_write_b32 a25, v45
v_accvgpr_write_b32 a26, v46
v_accvgpr_write_b32 a27, v47
v_accvgpr_read_b32 v44, a40
v_accvgpr_read_b32 v45, a41
v_accvgpr_read_b32 v46, a42
v_accvgpr_read_b32 v47, a43
v_mul_f32 v44, v44, v41
v_mul_f32 v45, v45, v41
v_mul_f32 v46, v46, v41
v_mul_f32 v47, v47, v41
v_accvgpr_write_b32 a40, v44
v_accvgpr_write_b32 a41, v45
v_accvgpr_write_b32 a42, v46
v_accvgpr_write_b32 a43, v47
v_accvgpr_read_b32 v44, a56
v_accvgpr_read_b32 v45, a57
v_accvgpr_read_b32 v46, a58
v_accvgpr_read_b32 v47, a59
v_mul_f32 v44, v44, v41
v_mul_f32 v45, v45, v41
v_mul_f32 v46, v46, v41
v_mul_f32 v47, v47, v41
v_accvgpr_write_b32 a56, v44
v_accvgpr_write_b32 a57, v45
v_accvgpr_write_b32 a58, v46
v_accvgpr_write_b32 a59, v47
v_accvgpr_read_b32 v44, a72
v_accvgpr_read_b32 v45, a73
v_accvgpr_read_b32 v46, a74
v_accvgpr_read_b32 v47, a75
v_mul_f32 v44, v44, v41
v_mul_f32 v45, v45, v41
v_mul_f32 v46, v46, v41
v_mul_f32 v47, v47, v41
v_accvgpr_write_b32 a72, v44
v_accvgpr_write_b32 a73, v45
v_accvgpr_write_b32 a74, v46
v_accvgpr_write_b32 a75, v47
v_accvgpr_read_b32 v44, a88
v_accvgpr_read_b32 v45, a89
v_accvgpr_read_b32 v46, a90
v_accvgpr_read_b32 v47, a91
v_mul_f32 v44, v44, v41
v_mul_f32 v45, v45, v41
v_mul_f32 v46, v46, v41
v_mul_f32 v47, v47, v41
v_accvgpr_write_b32 a88, v44
v_accvgpr_write_b32 a89, v45
v_accvgpr_write_b32 a90, v46
v_accvgpr_write_b32 a91, v47
v_accvgpr_read_b32 v44, a104
v_accvgpr_read_b32 v45, a105
v_accvgpr_read_b32 v46, a106
v_accvgpr_read_b32 v47, a107
v_mul_f32 v44, v44, v41
v_mul_f32 v45, v45, v41
v_mul_f32 v46, v46, v41
v_mul_f32 v47, v47, v41
v_accvgpr_write_b32 a104, v44
v_accvgpr_write_b32 a105, v45
v_accvgpr_write_b32 a106, v46
v_accvgpr_write_b32 a107, v47
v_accvgpr_read_b32 v44, a120
v_accvgpr_read_b32 v45, a121
v_accvgpr_read_b32 v46, a122
v_accvgpr_read_b32 v47, a123
v_mul_f32 v44, v44, v41
v_mul_f32 v45, v45, v41
v_mul_f32 v46, v46, v41
v_mul_f32 v47, v47, v41
v_accvgpr_write_b32 a120, v44
v_accvgpr_write_b32 a121, v45
v_accvgpr_write_b32 a122, v46
v_accvgpr_write_b32 a123, v47
v_accvgpr_read_b32 v44, a136
v_accvgpr_read_b32 v45, a137
v_accvgpr_read_b32 v46, a138
v_accvgpr_read_b32 v47, a139
v_mul_f32 v44, v44, v41
v_mul_f32 v45, v45, v41
v_mul_f32 v46, v46, v41
v_mul_f32 v47, v47, v41
v_accvgpr_write_b32 a136, v44
v_accvgpr_write_b32 a137, v45
v_accvgpr_write_b32 a138, v46
v_accvgpr_write_b32 a139, v47
v_accvgpr_read_b32 v44, a152
v_accvgpr_read_b32 v45, a153
v_accvgpr_read_b32 v46, a154
v_accvgpr_read_b32 v47, a155
v_mul_f32 v44, v44, v41
v_mul_f32 v45, v45, v41
v_mul_f32 v46, v46, v41
v_mul_f32 v47, v47, v41
v_accvgpr_write_b32 a152, v44
v_accvgpr_write_b32 a153, v45
v_accvgpr_write_b32 a154, v46
v_accvgpr_write_b32 a155, v47
v_accvgpr_read_b32 v44, a168
v_accvgpr_read_b32 v45, a169
v_accvgpr_read_b32 v46, a170
v_accvgpr_read_b32 v47, a171
v_mul_f32 v44, v44, v41
v_mul_f32 v45, v45, v41
v_mul_f32 v46, v46, v41
v_mul_f32 v47, v47, v41
v_accvgpr_write_b32 a168, v44
v_accvgpr_write_b32 a169, v45
v_accvgpr_write_b32 a170, v46
v_accvgpr_write_b32 a171, v47
v_accvgpr_read_b32 v44, a184
v_accvgpr_read_b32 v45, a185
v_accvgpr_read_b32 v46, a186
v_accvgpr_read_b32 v47, a187
v_mul_f32 v44, v44, v41
v_mul_f32 v45, v45, v41
v_mul_f32 v46, v46, v41
v_mul_f32 v47, v47, v41
v_accvgpr_write_b32 a184, v44
v_accvgpr_write_b32 a185, v45
v_accvgpr_write_b32 a186, v46
v_accvgpr_write_b32 a187, v47
v_max3_f32 v40, v132, v133, v134
v_max3_f32 v40, v40, v135, v148
v_max3_f32 v40, v40, v149, v150
v_max3_f32 v40, v40, v151, v164
v_max3_f32 v40, v40, v165, v166
v_max3_f32 v40, v40, v167, v180
v_max3_f32 v40, v40, v181, v182
v_max_f32 v40, v40, v183
v_mov_b32 v42, v40
v_mov_b32 v43, v40
s_nop 1
v_permlane32_swap_b32 v42, v43
s_nop 1
v_max_f32 v40, v42, v43
v_mov_b32 v42, v40
v_mov_b32 v43, v40
s_nop 1
v_permlane16_swap_b32 v42, v43
s_nop 1
v_max_f32 v40, v42, v43
v_max_f32 v40, 0, v40
v_exp_f32 v41, -v40
v_sub_f32 v12, v12, v40
v_sub_f32 v13, v13, v40
v_sub_f32 v14, v14, v40
v_sub_f32 v15, v15, v40
v_sub_f32 v132, v132, v40
v_sub_f32 v133, v133, v40
v_sub_f32 v134, v134, v40
v_sub_f32 v135, v135, v40
v_sub_f32 v148, v148, v40
v_sub_f32 v149, v149, v40
v_sub_f32 v150, v150, v40
v_sub_f32 v151, v151, v40
v_sub_f32 v164, v164, v40
v_sub_f32 v165, v165, v40
v_sub_f32 v166, v166, v40
v_sub_f32 v167, v167, v40
v_sub_f32 v180, v180, v40
v_sub_f32 v181, v181, v40
v_sub_f32 v182, v182, v40
v_sub_f32 v183, v183, v40
v_mul_f32 v35, v35, v41
v_accvgpr_read_b32 v44, a12
v_accvgpr_read_b32 v45, a13
v_accvgpr_read_b32 v46, a14
v_accvgpr_read_b32 v47, a15
v_mul_f32 v44, v44, v41
v_mul_f32 v45, v45, v41
v_mul_f32 v46, v46, v41
v_mul_f32 v47, v47, v41
v_accvgpr_write_b32 a12, v44
v_accvgpr_write_b32 a13, v45
v_accvgpr_write_b32 a14, v46
v_accvgpr_write_b32 a15, v47
v_accvgpr_read_b32 v44, a28
v_accvgpr_read_b32 v45, a29
v_accvgpr_read_b32 v46, a30
v_accvgpr_read_b32 v47, a31
v_mul_f32 v44, v44, v41
v_mul_f32 v45, v45, v41
v_mul_f32 v46, v46, v41
v_mul_f32 v47, v47, v41
v_accvgpr_write_b32 a28, v44
v_accvgpr_write_b32 a29, v45
v_accvgpr_write_b32 a30, v46
v_accvgpr_write_b32 a31, v47
v_accvgpr_read_b32 v44, a44
v_accvgpr_read_b32 v45, a45
v_accvgpr_read_b32 v46, a46
v_accvgpr_read_b32 v47, a47
v_mul_f32 v44, v44, v41
v_mul_f32 v45, v45, v41
v_mul_f32 v46, v46, v41
v_mul_f32 v47, v47, v41
v_accvgpr_write_b32 a44, v44
v_accvgpr_write_b32 a45, v45
v_accvgpr_write_b32 a46, v46
v_accvgpr_write_b32 a47, v47
v_accvgpr_read_b32 v44, a60
v_accvgpr_read_b32 v45, a61
v_accvgpr_read_b32 v46, a62
v_accvgpr_read_b32 v47, a63
v_mul_f32 v44, v44, v41
v_mul_f32 v45, v45, v41
v_mul_f32 v46, v46, v41
v_mul_f32 v47, v47, v41
v_accvgpr_write_b32 a60, v44
v_accvgpr_write_b32 a61, v45
v_accvgpr_write_b32 a62, v46
v_accvgpr_write_b32 a63, v47
v_accvgpr_read_b32 v44, a76
v_accvgpr_read_b32 v45, a77
v_accvgpr_read_b32 v46, a78
v_accvgpr_read_b32 v47, a79
v_mul_f32 v44, v44, v41
v_mul_f32 v45, v45, v41
v_mul_f32 v46, v46, v41
v_mul_f32 v47, v47, v41
v_accvgpr_write_b32 a76, v44
v_accvgpr_write_b32 a77, v45
v_accvgpr_write_b32 a78, v46
v_accvgpr_write_b32 a79, v47
v_accvgpr_read_b32 v44, a92
v_accvgpr_read_b32 v45, a93
v_accvgpr_read_b32 v46, a94
v_accvgpr_read_b32 v47, a95
v_mul_f32 v44, v44, v41
v_mul_f32 v45, v45, v41
v_mul_f32 v46, v46, v41
v_mul_f32 v47, v47, v41
v_accvgpr_write_b32 a92, v44
v_accvgpr_write_b32 a93, v45
v_accvgpr_write_b32 a94, v46
v_accvgpr_write_b32 a95, v47
v_accvgpr_read_b32 v44, a108
v_accvgpr_read_b32 v45, a109
v_accvgpr_read_b32 v46, a110
v_accvgpr_read_b32 v47, a111
v_mul_f32 v44, v44, v41
v_mul_f32 v45, v45, v41
v_mul_f32 v46, v46, v41
v_mul_f32 v47, v47, v41
v_accvgpr_write_b32 a108, v44
v_accvgpr_write_b32 a109, v45
v_accvgpr_write_b32 a110, v46
v_accvgpr_write_b32 a111, v47
v_accvgpr_read_b32 v44, a124
v_accvgpr_read_b32 v45, a125
v_accvgpr_read_b32 v46, a126
v_accvgpr_read_b32 v47, a127
v_mul_f32 v44, v44, v41
v_mul_f32 v45, v45, v41
v_mul_f32 v46, v46, v41
v_mul_f32 v47, v47, v41
v_accvgpr_write_b32 a124, v44
v_accvgpr_write_b32 a125, v45
v_accvgpr_write_b32 a126, v46
v_accvgpr_write_b32 a127, v47
v_accvgpr_read_b32 v44, a140
v_accvgpr_read_b32 v45, a141
v_accvgpr_read_b32 v46, a142
v_accvgpr_read_b32 v47, a143
v_mul_f32 v44, v44, v41
v_mul_f32 v45, v45, v41
v_mul_f32 v46, v46, v41
v_mul_f32 v47, v47, v41
v_accvgpr_write_b32 a140, v44
v_accvgpr_write_b32 a141, v45
v_accvgpr_write_b32 a142, v46
v_accvgpr_write_b32 a143, v47
v_accvgpr_read_b32 v44, a156
v_accvgpr_read_b32 v45, a157
v_accvgpr_read_b32 v46, a158
v_accvgpr_read_b32 v47, a159
v_mul_f32 v44, v44, v41
v_mul_f32 v45, v45, v41
v_mul_f32 v46, v46, v41
v_mul_f32 v47, v47, v41
v_accvgpr_write_b32 a156, v44
v_accvgpr_write_b32 a157, v45
v_accvgpr_write_b32 a158, v46
v_accvgpr_write_b32 a159, v47
v_accvgpr_read_b32 v44, a172
v_accvgpr_read_b32 v45, a173
v_accvgpr_read_b32 v46, a174
v_accvgpr_read_b32 v47, a175
v_mul_f32 v44, v44, v41
v_mul_f32 v45, v45, v41
v_mul_f32 v46, v46, v41
v_mul_f32 v47, v47, v41
v_accvgpr_write_b32 a172, v44
v_accvgpr_write_b32 a173, v45
v_accvgpr_write_b32 a174, v46
v_accvgpr_write_b32 a175, v47
v_accvgpr_read_b32 v44, a188
v_accvgpr_read_b32 v45, a189
v_accvgpr_read_b32 v46, a190
v_accvgpr_read_b32 v47, a191
v_mul_f32 v44, v44, v41
v_mul_f32 v45, v45, v41
v_mul_f32 v46, v46, v41
v_mul_f32 v47, v47, v41
v_accvgpr_write_b32 a188, v44
v_accvgpr_write_b32 a189, v45
v_accvgpr_write_b32 a190, v46
v_accvgpr_write_b32 a191, v47
v_exp_f32 v40, v120
v_exp_f32 v41, v121
v_exp_f32 v42, v122
v_exp_f32 v43, v123
v_add_f32 v36, v40, v41
v_cvt_pk_bf16_f32 v184, v40, v41
v_add_f32 v36, v36, v42
v_add_f32 v36, v36, v43
v_cvt_pk_bf16_f32 v185, v42, v43
v_exp_f32 v44, v124
v_exp_f32 v45, v125
v_exp_f32 v46, v126
v_exp_f32 v47, v127
v_add_f32 v37, v44, v45
v_cvt_pk_bf16_f32 v188, v44, v45
v_add_f32 v37, v37, v46
v_add_f32 v37, v37, v47
v_cvt_pk_bf16_f32 v189, v46, v47
v_exp_f32 v40, v128
v_exp_f32 v41, v129
v_exp_f32 v42, v130
v_exp_f32 v43, v131
v_add_f32 v38, v40, v41
v_cvt_pk_bf16_f32 v192, v40, v41
v_add_f32 v38, v38, v42
v_add_f32 v38, v38, v43
v_cvt_pk_bf16_f32 v193, v42, v43
v_exp_f32 v44, v132
v_exp_f32 v45, v133
v_exp_f32 v46, v134
v_exp_f32 v47, v135
v_add_f32 v39, v44, v45
v_cvt_pk_bf16_f32 v196, v44, v45
v_add_f32 v39, v39, v46
v_add_f32 v39, v39, v47
v_cvt_pk_bf16_f32 v197, v46, v47
v_exp_f32 v40, v136
v_exp_f32 v41, v137
v_exp_f32 v42, v138
v_exp_f32 v43, v139
v_add_f32 v36, v36, v40
v_add_f32 v36, v36, v41
v_cvt_pk_bf16_f32 v186, v40, v41
v_add_f32 v36, v36, v42
v_add_f32 v36, v36, v43
v_cvt_pk_bf16_f32 v187, v42, v43
v_exp_f32 v44, v140
v_exp_f32 v45, v141
v_exp_f32 v46, v142
v_exp_f32 v47, v143
v_add_f32 v37, v37, v44
v_add_f32 v37, v37, v45
v_cvt_pk_bf16_f32 v190, v44, v45
v_add_f32 v37, v37, v46
v_add_f32 v37, v37, v47
v_cvt_pk_bf16_f32 v191, v46, v47
v_exp_f32 v40, v144
v_exp_f32 v41, v145
v_exp_f32 v42, v146
v_exp_f32 v43, v147
v_add_f32 v38, v38, v40
v_add_f32 v38, v38, v41
v_cvt_pk_bf16_f32 v194, v40, v41
v_add_f32 v38, v38, v42
v_add_f32 v38, v38, v43
v_cvt_pk_bf16_f32 v195, v42, v43
v_exp_f32 v44, v148
v_exp_f32 v45, v149
v_exp_f32 v46, v150
v_exp_f32 v47, v151
v_add_f32 v39, v39, v44
v_add_f32 v39, v39, v45
v_cvt_pk_bf16_f32 v198, v44, v45
v_add_f32 v39, v39, v46
v_add_f32 v39, v39, v47
v_cvt_pk_bf16_f32 v199, v46, v47
v_exp_f32 v40, v152
v_exp_f32 v41, v153
v_exp_f32 v42, v154
v_exp_f32 v43, v155
v_add_f32 v36, v36, v40
v_add_f32 v36, v36, v41
v_cvt_pk_bf16_f32 v200, v40, v41
v_add_f32 v36, v36, v42
v_add_f32 v36, v36, v43
v_cvt_pk_bf16_f32 v201, v42, v43
v_exp_f32 v44, v156
v_exp_f32 v45, v157
v_exp_f32 v46, v158
v_exp_f32 v47, v159
v_add_f32 v37, v37, v44
v_add_f32 v37, v37, v45
v_cvt_pk_bf16_f32 v204, v44, v45
v_add_f32 v37, v37, v46
v_add_f32 v37, v37, v47
v_cvt_pk_bf16_f32 v205, v46, v47
v_exp_f32 v40, v160
v_exp_f32 v41, v161
v_exp_f32 v42, v162
v_exp_f32 v43, v163
v_add_f32 v38, v38, v40
v_add_f32 v38, v38, v41
v_cvt_pk_bf16_f32 v208, v40, v41
v_add_f32 v38, v38, v42
v_add_f32 v38, v38, v43
v_cvt_pk_bf16_f32 v209, v42, v43
v_exp_f32 v44, v164
v_exp_f32 v45, v165
v_exp_f32 v46, v166
v_exp_f32 v47, v167
v_add_f32 v39, v39, v44
v_add_f32 v39, v39, v45
v_cvt_pk_bf16_f32 v212, v44, v45
v_add_f32 v39, v39, v46
v_add_f32 v39, v39, v47
v_cvt_pk_bf16_f32 v213, v46, v47
v_exp_f32 v40, v168
v_exp_f32 v41, v169
v_exp_f32 v42, v170
v_exp_f32 v43, v171
v_add_f32 v36, v36, v40
v_add_f32 v36, v36, v41
v_cvt_pk_bf16_f32 v202, v40, v41
v_add_f32 v36, v36, v42
v_add_f32 v36, v36, v43
v_cvt_pk_bf16_f32 v203, v42, v43
v_exp_f32 v44, v172
v_exp_f32 v45, v173
v_exp_f32 v46, v174
v_exp_f32 v47, v175
v_add_f32 v37, v37, v44
v_add_f32 v37, v37, v45
v_cvt_pk_bf16_f32 v206, v44, v45
v_add_f32 v37, v37, v46
v_add_f32 v37, v37, v47
v_cvt_pk_bf16_f32 v207, v46, v47
v_exp_f32 v40, v176
v_exp_f32 v41, v177
v_exp_f32 v42, v178
v_exp_f32 v43, v179
v_add_f32 v38, v38, v40
v_add_f32 v38, v38, v41
v_cvt_pk_bf16_f32 v210, v40, v41
v_add_f32 v38, v38, v42
v_add_f32 v38, v38, v43
v_cvt_pk_bf16_f32 v211, v42, v43
v_exp_f32 v44, v180
v_exp_f32 v45, v181
v_exp_f32 v46, v182
v_exp_f32 v47, v183
v_add_f32 v39, v39, v44
v_add_f32 v39, v39, v45
v_cvt_pk_bf16_f32 v214, v44, v45
v_add_f32 v39, v39, v46
v_add_f32 v39, v39, v47
v_cvt_pk_bf16_f32 v215, v46, v47
s_nop 3
s_setpc_b64 s[46:47]
L_rare1:
s_nop 15
v_max3_f32 v40, v120, v121, v122
v_max3_f32 v40, v40, v123, v136
v_max3_f32 v40, v40, v137, v138
v_max3_f32 v40, v40, v139, v152
v_max3_f32 v40, v40, v153, v154
v_max3_f32 v40, v40, v155, v168
v_max3_f32 v40, v40, v169, v170
v_max_f32 v40, v40, v171
v_mov_b32 v42, v40
v_mov_b32 v43, v40
s_nop 1
v_permlane32_swap_b32 v42, v43
s_nop 1
v_max_f32 v40, v42, v43
v_mov_b32 v42, v40
v_mov_b32 v43, v40
s_nop 1
v_permlane16_swap_b32 v42, v43
s_nop 1
v_max_f32 v40, v42, v43
v_max_f32 v40, 0, v40
v_exp_f32 v41, -v40
v_sub_f32 v248, v248, v40
v_sub_f32 v249, v249, v40
v_sub_f32 v250, v250, v40
v_sub_f32 v251, v251, v40
v_sub_f32 v120, v120, v40
v_sub_f32 v121, v121, v40
v_sub_f32 v122, v122, v40
v_sub_f32 v123, v123, v40
v_sub_f32 v136, v136, v40
v_sub_f32 v137, v137, v40
v_sub_f32 v138, v138, v40
v_sub_f32 v139, v139, v40
v_sub_f32 v152, v152, v40
v_sub_f32 v153, v153, v40
v_sub_f32 v154, v154, v40
v_sub_f32 v155, v155, v40
v_sub_f32 v168, v168, v40
v_sub_f32 v169, v169, v40
v_sub_f32 v170, v170, v40
v_sub_f32 v171, v171, v40
v_mul_f32 v32, v32, v41
v_accvgpr_read_b32 v44, a0
v_accvgpr_read_b32 v45, a1
v_accvgpr_read_b32 v46, a2
v_accvgpr_read_b32 v47, a3
v_mul_f32 v44, v44, v41
v_mul_f32 v45, v45, v41
v_mul_f32 v46, v46, v41
v_mul_f32 v47, v47, v41
v_accvgpr_write_b32 a0, v44
v_accvgpr_write_b32 a1, v45
v_accvgpr_write_b32 a2, v46
v_accvgpr_write_b32 a3, v47
v_accvgpr_read_b32 v44, a16
v_accvgpr_read_b32 v45, a17
v_accvgpr_read_b32 v46, a18
v_accvgpr_read_b32 v47, a19
v_mul_f32 v44, v44, v41
v_mul_f32 v45, v45, v41
v_mul_f32 v46, v46, v41
v_mul_f32 v47, v47, v41
v_accvgpr_write_b32 a16, v44
v_accvgpr_write_b32 a17, v45
v_accvgpr_write_b32 a18, v46
v_accvgpr_write_b32 a19, v47
v_accvgpr_read_b32 v44, a32
v_accvgpr_read_b32 v45, a33
v_accvgpr_read_b32 v46, a34
v_accvgpr_read_b32 v47, a35
v_mul_f32 v44, v44, v41
v_mul_f32 v45, v45, v41
v_mul_f32 v46, v46, v41
v_mul_f32 v47, v47, v41
v_accvgpr_write_b32 a32, v44
v_accvgpr_write_b32 a33, v45
v_accvgpr_write_b32 a34, v46
v_accvgpr_write_b32 a35, v47
v_accvgpr_read_b32 v44, a48
v_accvgpr_read_b32 v45, a49
v_accvgpr_read_b32 v46, a50
v_accvgpr_read_b32 v47, a51
v_mul_f32 v44, v44, v41
v_mul_f32 v45, v45, v41
v_mul_f32 v46, v46, v41
v_mul_f32 v47, v47, v41
v_accvgpr_write_b32 a48, v44
v_accvgpr_write_b32 a49, v45
v_accvgpr_write_b32 a50, v46
v_accvgpr_write_b32 a51, v47
v_accvgpr_read_b32 v44, a64
v_accvgpr_read_b32 v45, a65
v_accvgpr_read_b32 v46, a66
v_accvgpr_read_b32 v47, a67
v_mul_f32 v44, v44, v41
v_mul_f32 v45, v45, v41
v_mul_f32 v46, v46, v41
v_mul_f32 v47, v47, v41
v_accvgpr_write_b32 a64, v44
v_accvgpr_write_b32 a65, v45
v_accvgpr_write_b32 a66, v46
v_accvgpr_write_b32 a67, v47
v_accvgpr_read_b32 v44, a80
v_accvgpr_read_b32 v45, a81
v_accvgpr_read_b32 v46, a82
v_accvgpr_read_b32 v47, a83
v_mul_f32 v44, v44, v41
v_mul_f32 v45, v45, v41
v_mul_f32 v46, v46, v41
v_mul_f32 v47, v47, v41
v_accvgpr_write_b32 a80, v44
v_accvgpr_write_b32 a81, v45
v_accvgpr_write_b32 a82, v46
v_accvgpr_write_b32 a83, v47
v_accvgpr_read_b32 v44, a96
v_accvgpr_read_b32 v45, a97
v_accvgpr_read_b32 v46, a98
v_accvgpr_read_b32 v47, a99
v_mul_f32 v44, v44, v41
v_mul_f32 v45, v45, v41
v_mul_f32 v46, v46, v41
v_mul_f32 v47, v47, v41
v_accvgpr_write_b32 a96, v44
v_accvgpr_write_b32 a97, v45
v_accvgpr_write_b32 a98, v46
v_accvgpr_write_b32 a99, v47
v_accvgpr_read_b32 v44, a112
v_accvgpr_read_b32 v45, a113
v_accvgpr_read_b32 v46, a114
v_accvgpr_read_b32 v47, a115
v_mul_f32 v44, v44, v41
v_mul_f32 v45, v45, v41
v_mul_f32 v46, v46, v41
v_mul_f32 v47, v47, v41
v_accvgpr_write_b32 a112, v44
v_accvgpr_write_b32 a113, v45
v_accvgpr_write_b32 a114, v46
v_accvgpr_write_b32 a115, v47
v_accvgpr_read_b32 v44, a128
v_accvgpr_read_b32 v45, a129
v_accvgpr_read_b32 v46, a130
v_accvgpr_read_b32 v47, a131
v_mul_f32 v44, v44, v41
v_mul_f32 v45, v45, v41
v_mul_f32 v46, v46, v41
v_mul_f32 v47, v47, v41
v_accvgpr_write_b32 a128, v44
v_accvgpr_write_b32 a129, v45
v_accvgpr_write_b32 a130, v46
v_accvgpr_write_b32 a131, v47
v_accvgpr_read_b32 v44, a144
v_accvgpr_read_b32 v45, a145
v_accvgpr_read_b32 v46, a146
v_accvgpr_read_b32 v47, a147
v_mul_f32 v44, v44, v41
v_mul_f32 v45, v45, v41
v_mul_f32 v46, v46, v41
v_mul_f32 v47, v47, v41
v_accvgpr_write_b32 a144, v44
v_accvgpr_write_b32 a145, v45
v_accvgpr_write_b32 a146, v46
v_accvgpr_write_b32 a147, v47
v_accvgpr_read_b32 v44, a160
v_accvgpr_read_b32 v45, a161
v_accvgpr_read_b32 v46, a162
v_accvgpr_read_b32 v47, a163
v_mul_f32 v44, v44, v41
v_mul_f32 v45, v45, v41
v_mul_f32 v46, v46, v41
v_mul_f32 v47, v47, v41
v_accvgpr_write_b32 a160, v44
v_accvgpr_write_b32 a161, v45
v_accvgpr_write_b32 a162, v46
v_accvgpr_write_b32 a163, v47
v_accvgpr_read_b32 v44, a176
v_accvgpr_read_b32 v45, a177
v_accvgpr_read_b32 v46, a178
v_accvgpr_read_b32 v47, a179
v_mul_f32 v44, v44, v41
v_mul_f32 v45, v45, v41
v_mul_f32 v46, v46, v41
v_mul_f32 v47, v47, v41
v_accvgpr_write_b32 a176, v44
v_accvgpr_write_b32 a177, v45
v_accvgpr_write_b32 a178, v46
v_accvgpr_write_b32 a179, v47
v_max3_f32 v40, v124, v125, v126
v_max3_f32 v40, v40, v127, v140
v_max3_f32 v40, v40, v141, v142
v_max3_f32 v40, v40, v143, v156
v_max3_f32 v40, v40, v157, v158
v_max3_f32 v40, v40, v159, v172
v_max3_f32 v40, v40, v173, v174
v_max_f32 v40, v40, v175
v_mov_b32 v42, v40
v_mov_b32 v43, v40
s_nop 1
v_permlane32_swap_b32 v42, v43
s_nop 1
v_max_f32 v40, v42, v43
v_mov_b32 v42, v40
v_mov_b32 v43, v40
s_nop 1
v_permlane16_swap_b32 v42, v43
s_nop 1
v_max_f32 v40, v42, v43
v_max_f32 v40, 0, v40
v_exp_f32 v41, -v40
v_sub_f32 v252, v252, v40
v_sub_f32 v253, v253, v40
v_sub_f32 v254, v254, v40
v_sub_f32 v255, v255, v40
v_sub_f32 v124, v124, v40
v_sub_f32 v125, v125, v40
v_sub_f32 v126, v126, v40
v_sub_f32 v127, v127, v40
v_sub_f32 v140, v140, v40
v_sub_f32 v141, v141, v40
v_sub_f32 v142, v142, v40
v_sub_f32 v143, v143, v40
v_sub_f32 v156, v156, v40
v_sub_f32 v157, v157, v40
v_sub_f32 v158, v158, v40
v_sub_f32 v159, v159, v40
v_sub_f32 v172, v172, v40
v_sub_f32 v173, v173, v40
v_sub_f32 v174, v174, v40
v_sub_f32 v175, v175, v40
v_mul_f32 v33, v33, v41
v_accvgpr_read_b32 v44, a4
v_accvgpr_read_b32 v45, a5
v_accvgpr_read_b32 v46, a6
v_accvgpr_read_b32 v47, a7
v_mul_f32 v44, v44, v41
v_mul_f32 v45, v45, v41
v_mul_f32 v46, v46, v41
v_mul_f32 v47, v47, v41
v_accvgpr_write_b32 a4, v44
v_accvgpr_write_b32 a5, v45
v_accvgpr_write_b32 a6, v46
v_accvgpr_write_b32 a7, v47
v_accvgpr_read_b32 v44, a20
v_accvgpr_read_b32 v45, a21
v_accvgpr_read_b32 v46, a22
v_accvgpr_read_b32 v47, a23
v_mul_f32 v44, v44, v41
v_mul_f32 v45, v45, v41
v_mul_f32 v46, v46, v41
v_mul_f32 v47, v47, v41
v_accvgpr_write_b32 a20, v44
v_accvgpr_write_b32 a21, v45
v_accvgpr_write_b32 a22, v46
v_accvgpr_write_b32 a23, v47
v_accvgpr_read_b32 v44, a36
v_accvgpr_read_b32 v45, a37
v_accvgpr_read_b32 v46, a38
v_accvgpr_read_b32 v47, a39
v_mul_f32 v44, v44, v41
v_mul_f32 v45, v45, v41
v_mul_f32 v46, v46, v41
v_mul_f32 v47, v47, v41
v_accvgpr_write_b32 a36, v44
v_accvgpr_write_b32 a37, v45
v_accvgpr_write_b32 a38, v46
v_accvgpr_write_b32 a39, v47
v_accvgpr_read_b32 v44, a52
v_accvgpr_read_b32 v45, a53
v_accvgpr_read_b32 v46, a54
v_accvgpr_read_b32 v47, a55
v_mul_f32 v44, v44, v41
v_mul_f32 v45, v45, v41
v_mul_f32 v46, v46, v41
v_mul_f32 v47, v47, v41
v_accvgpr_write_b32 a52, v44
v_accvgpr_write_b32 a53, v45
v_accvgpr_write_b32 a54, v46
v_accvgpr_write_b32 a55, v47
v_accvgpr_read_b32 v44, a68
v_accvgpr_read_b32 v45, a69
v_accvgpr_read_b32 v46, a70
v_accvgpr_read_b32 v47, a71
v_mul_f32 v44, v44, v41
v_mul_f32 v45, v45, v41
v_mul_f32 v46, v46, v41
v_mul_f32 v47, v47, v41
v_accvgpr_write_b32 a68, v44
v_accvgpr_write_b32 a69, v45
v_accvgpr_write_b32 a70, v46
v_accvgpr_write_b32 a71, v47
v_accvgpr_read_b32 v44, a84
v_accvgpr_read_b32 v45, a85
v_accvgpr_read_b32 v46, a86
v_accvgpr_read_b32 v47, a87
v_mul_f32 v44, v44, v41
v_mul_f32 v45, v45, v41
v_mul_f32 v46, v46, v41
v_mul_f32 v47, v47, v41
v_accvgpr_write_b32 a84, v44
v_accvgpr_write_b32 a85, v45
v_accvgpr_write_b32 a86, v46
v_accvgpr_write_b32 a87, v47
v_accvgpr_read_b32 v44, a100
v_accvgpr_read_b32 v45, a101
v_accvgpr_read_b32 v46, a102
v_accvgpr_read_b32 v47, a103
v_mul_f32 v44, v44, v41
v_mul_f32 v45, v45, v41
v_mul_f32 v46, v46, v41
v_mul_f32 v47, v47, v41
v_accvgpr_write_b32 a100, v44
v_accvgpr_write_b32 a101, v45
v_accvgpr_write_b32 a102, v46
v_accvgpr_write_b32 a103, v47
v_accvgpr_read_b32 v44, a116
v_accvgpr_read_b32 v45, a117
v_accvgpr_read_b32 v46, a118
v_accvgpr_read_b32 v47, a119
v_mul_f32 v44, v44, v41
v_mul_f32 v45, v45, v41
v_mul_f32 v46, v46, v41
v_mul_f32 v47, v47, v41
v_accvgpr_write_b32 a116, v44
v_accvgpr_write_b32 a117, v45
v_accvgpr_write_b32 a118, v46
v_accvgpr_write_b32 a119, v47
v_accvgpr_read_b32 v44, a132
v_accvgpr_read_b32 v45, a133
v_accvgpr_read_b32 v46, a134
v_accvgpr_read_b32 v47, a135
v_mul_f32 v44, v44, v41
v_mul_f32 v45, v45, v41
v_mul_f32 v46, v46, v41
v_mul_f32 v47, v47, v41
v_accvgpr_write_b32 a132, v44
v_accvgpr_write_b32 a133, v45
v_accvgpr_write_b32 a134, v46
v_accvgpr_write_b32 a135, v47
v_accvgpr_read_b32 v44, a148
v_accvgpr_read_b32 v45, a149
v_accvgpr_read_b32 v46, a150
v_accvgpr_read_b32 v47, a151
v_mul_f32 v44, v44, v41
v_mul_f32 v45, v45, v41
v_mul_f32 v46, v46, v41
v_mul_f32 v47, v47, v41
v_accvgpr_write_b32 a148, v44
v_accvgpr_write_b32 a149, v45
v_accvgpr_write_b32 a150, v46
v_accvgpr_write_b32 a151, v47
v_accvgpr_read_b32 v44, a164
v_accvgpr_read_b32 v45, a165
v_accvgpr_read_b32 v46, a166
v_accvgpr_read_b32 v47, a167
v_mul_f32 v44, v44, v41
v_mul_f32 v45, v45, v41
v_mul_f32 v46, v46, v41
v_mul_f32 v47, v47, v41
v_accvgpr_write_b32 a164, v44
v_accvgpr_write_b32 a165, v45
v_accvgpr_write_b32 a166, v46
v_accvgpr_write_b32 a167, v47
v_accvgpr_read_b32 v44, a180
v_accvgpr_read_b32 v45, a181
v_accvgpr_read_b32 v46, a182
v_accvgpr_read_b32 v47, a183
v_mul_f32 v44, v44, v41
v_mul_f32 v45, v45, v41
v_mul_f32 v46, v46, v41
v_mul_f32 v47, v47, v41
v_accvgpr_write_b32 a180, v44
v_accvgpr_write_b32 a181, v45
v_accvgpr_write_b32 a182, v46
v_accvgpr_write_b32 a183, v47
v_max3_f32 v40, v128, v129, v130
v_max3_f32 v40, v40, v131, v144
v_max3_f32 v40, v40, v145, v146
v_max3_f32 v40, v40, v147, v160
v_max3_f32 v40, v40, v161, v162
v_max3_f32 v40, v40, v163, v176
v_max3_f32 v40, v40, v177, v178
v_max_f32 v40, v40, v179
v_mov_b32 v42, v40
v_mov_b32 v43, v40
s_nop 1
v_permlane32_swap_b32 v42, v43
s_nop 1
v_max_f32 v40, v42, v43
v_mov_b32 v42, v40
v_mov_b32 v43, v40
s_nop 1
v_permlane16_swap_b32 v42, v43
s_nop 1
v_max_f32 v40, v42, v43
v_max_f32 v40, 0, v40
v_exp_f32 v41, -v40
v_sub_f32 v24, v24, v40
v_sub_f32 v25, v25, v40
v_sub_f32 v26, v26, v40
v_sub_f32 v27, v27, v40
v_sub_f32 v128, v128, v40
v_sub_f32 v129, v129, v40
v_sub_f32 v130, v130, v40
v_sub_f32 v131, v131, v40
v_sub_f32 v144, v144, v40
v_sub_f32 v145, v145, v40
v_sub_f32 v146, v146, v40
v_sub_f32 v147, v147, v40
v_sub_f32 v160, v160, v40
v_sub_f32 v161, v161, v40
v_sub_f32 v162, v162, v40
v_sub_f32 v163, v163, v40
v_sub_f32 v176, v176, v40
v_sub_f32 v177, v177, v40
v_sub_f32 v178, v178, v40
v_sub_f32 v179, v179, v40
v_mul_f32 v34, v34, v41
v_accvgpr_read_b32 v44, a8
v_accvgpr_read_b32 v45, a9
v_accvgpr_read_b32 v46, a10
v_accvgpr_read_b32 v47, a11
v_mul_f32 v44, v44, v41
v_mul_f32 v45, v45, v41
v_mul_f32 v46, v46, v41
v_mul_f32 v47, v47, v41
v_accvgpr_write_b32 a8, v44
v_accvgpr_write_b32 a9, v45
v_accvgpr_write_b32 a10, v46
v_accvgpr_write_b32 a11, v47
v_accvgpr_read_b32 v44, a24
v_accvgpr_read_b32 v45, a25
v_accvgpr_read_b32 v46, a26
v_accvgpr_read_b32 v47, a27
v_mul_f32 v44, v44, v41
v_mul_f32 v45, v45, v41
v_mul_f32 v46, v46, v41
v_mul_f32 v47, v47, v41
v_accvgpr_write_b32 a24, v44
v_accvgpr_write_b32 a25, v45
v_accvgpr_write_b32 a26, v46
v_accvgpr_write_b32 a27, v47
v_accvgpr_read_b32 v44, a40
v_accvgpr_read_b32 v45, a41
v_accvgpr_read_b32 v46, a42
v_accvgpr_read_b32 v47, a43
v_mul_f32 v44, v44, v41
v_mul_f32 v45, v45, v41
v_mul_f32 v46, v46, v41
v_mul_f32 v47, v47, v41
v_accvgpr_write_b32 a40, v44
v_accvgpr_write_b32 a41, v45
v_accvgpr_write_b32 a42, v46
v_accvgpr_write_b32 a43, v47
v_accvgpr_read_b32 v44, a56
v_accvgpr_read_b32 v45, a57
v_accvgpr_read_b32 v46, a58
v_accvgpr_read_b32 v47, a59
v_mul_f32 v44, v44, v41
v_mul_f32 v45, v45, v41
v_mul_f32 v46, v46, v41
v_mul_f32 v47, v47, v41
v_accvgpr_write_b32 a56, v44
v_accvgpr_write_b32 a57, v45
v_accvgpr_write_b32 a58, v46
v_accvgpr_write_b32 a59, v47
v_accvgpr_read_b32 v44, a72
v_accvgpr_read_b32 v45, a73
v_accvgpr_read_b32 v46, a74
v_accvgpr_read_b32 v47, a75
v_mul_f32 v44, v44, v41
v_mul_f32 v45, v45, v41
v_mul_f32 v46, v46, v41
v_mul_f32 v47, v47, v41
v_accvgpr_write_b32 a72, v44
v_accvgpr_write_b32 a73, v45
v_accvgpr_write_b32 a74, v46
v_accvgpr_write_b32 a75, v47
v_accvgpr_read_b32 v44, a88
v_accvgpr_read_b32 v45, a89
v_accvgpr_read_b32 v46, a90
v_accvgpr_read_b32 v47, a91
v_mul_f32 v44, v44, v41
v_mul_f32 v45, v45, v41
v_mul_f32 v46, v46, v41
v_mul_f32 v47, v47, v41
v_accvgpr_write_b32 a88, v44
v_accvgpr_write_b32 a89, v45
v_accvgpr_write_b32 a90, v46
v_accvgpr_write_b32 a91, v47
v_accvgpr_read_b32 v44, a104
v_accvgpr_read_b32 v45, a105
v_accvgpr_read_b32 v46, a106
v_accvgpr_read_b32 v47, a107
v_mul_f32 v44, v44, v41
v_mul_f32 v45, v45, v41
v_mul_f32 v46, v46, v41
v_mul_f32 v47, v47, v41
v_accvgpr_write_b32 a104, v44
v_accvgpr_write_b32 a105, v45
v_accvgpr_write_b32 a106, v46
v_accvgpr_write_b32 a107, v47
v_accvgpr_read_b32 v44, a120
v_accvgpr_read_b32 v45, a121
v_accvgpr_read_b32 v46, a122
v_accvgpr_read_b32 v47, a123
v_mul_f32 v44, v44, v41
v_mul_f32 v45, v45, v41
v_mul_f32 v46, v46, v41
v_mul_f32 v47, v47, v41
v_accvgpr_write_b32 a120, v44
v_accvgpr_write_b32 a121, v45
v_accvgpr_write_b32 a122, v46
v_accvgpr_write_b32 a123, v47
v_accvgpr_read_b32 v44, a136
v_accvgpr_read_b32 v45, a137
v_accvgpr_read_b32 v46, a138
v_accvgpr_read_b32 v47, a139
v_mul_f32 v44, v44, v41
v_mul_f32 v45, v45, v41
v_mul_f32 v46, v46, v41
v_mul_f32 v47, v47, v41
v_accvgpr_write_b32 a136, v44
v_accvgpr_write_b32 a137, v45
v_accvgpr_write_b32 a138, v46
v_accvgpr_write_b32 a139, v47
v_accvgpr_read_b32 v44, a152
v_accvgpr_read_b32 v45, a153
v_accvgpr_read_b32 v46, a154
v_accvgpr_read_b32 v47, a155
v_mul_f32 v44, v44, v41
v_mul_f32 v45, v45, v41
v_mul_f32 v46, v46, v41
v_mul_f32 v47, v47, v41
v_accvgpr_write_b32 a152, v44
v_accvgpr_write_b32 a153, v45
v_accvgpr_write_b32 a154, v46
v_accvgpr_write_b32 a155, v47
v_accvgpr_read_b32 v44, a168
v_accvgpr_read_b32 v45, a169
v_accvgpr_read_b32 v46, a170
v_accvgpr_read_b32 v47, a171
v_mul_f32 v44, v44, v41
v_mul_f32 v45, v45, v41
v_mul_f32 v46, v46, v41
v_mul_f32 v47, v47, v41
v_accvgpr_write_b32 a168, v44
v_accvgpr_write_b32 a169, v45
v_accvgpr_write_b32 a170, v46
v_accvgpr_write_b32 a171, v47
v_accvgpr_read_b32 v44, a184
v_accvgpr_read_b32 v45, a185
v_accvgpr_read_b32 v46, a186
v_accvgpr_read_b32 v47, a187
v_mul_f32 v44, v44, v41
v_mul_f32 v45, v45, v41
v_mul_f32 v46, v46, v41
v_mul_f32 v47, v47, v41
v_accvgpr_write_b32 a184, v44
v_accvgpr_write_b32 a185, v45
v_accvgpr_write_b32 a186, v46
v_accvgpr_write_b32 a187, v47
v_max3_f32 v40, v132, v133, v134
v_max3_f32 v40, v40, v135, v148
v_max3_f32 v40, v40, v149, v150
v_max3_f32 v40, v40, v151, v164
v_max3_f32 v40, v40, v165, v166
v_max3_f32 v40, v40, v167, v180
v_max3_f32 v40, v40, v181, v182
v_max_f32 v40, v40, v183
v_mov_b32 v42, v40
v_mov_b32 v43, v40
s_nop 1
v_permlane32_swap_b32 v42, v43
s_nop 1
v_max_f32 v40, v42, v43
v_mov_b32 v42, v40
v_mov_b32 v43, v40
s_nop 1
v_permlane16_swap_b32 v42, v43
s_nop 1
v_max_f32 v40, v42, v43
v_max_f32 v40, 0, v40
v_exp_f32 v41, -v40
v_sub_f32 v12, v12, v40
v_sub_f32 v13, v13, v40
v_sub_f32 v14, v14, v40
v_sub_f32 v15, v15, v40
v_sub_f32 v132, v132, v40
v_sub_f32 v133, v133, v40
v_sub_f32 v134, v134, v40
v_sub_f32 v135, v135, v40
v_sub_f32 v148, v148, v40
v_sub_f32 v149, v149, v40
v_sub_f32 v150, v150, v40
v_sub_f32 v151, v151, v40
v_sub_f32 v164, v164, v40
v_sub_f32 v165, v165, v40
v_sub_f32 v166, v166, v40
v_sub_f32 v167, v167, v40
v_sub_f32 v180, v180, v40
v_sub_f32 v181, v181, v40
v_sub_f32 v182, v182, v40
v_sub_f32 v183, v183, v40
v_mul_f32 v35, v35, v41
v_accvgpr_read_b32 v44, a12
v_accvgpr_read_b32 v45, a13
v_accvgpr_read_b32 v46, a14
v_accvgpr_read_b32 v47, a15
v_mul_f32 v44, v44, v41
v_mul_f32 v45, v45, v41
v_mul_f32 v46, v46, v41
v_mul_f32 v47, v47, v41
v_accvgpr_write_b32 a12, v44
v_accvgpr_write_b32 a13, v45
v_accvgpr_write_b32 a14, v46
v_accvgpr_write_b32 a15, v47
v_accvgpr_read_b32 v44, a28
v_accvgpr_read_b32 v45, a29
v_accvgpr_read_b32 v46, a30
v_accvgpr_read_b32 v47, a31
v_mul_f32 v44, v44, v41
v_mul_f32 v45, v45, v41
v_mul_f32 v46, v46, v41
v_mul_f32 v47, v47, v41
v_accvgpr_write_b32 a28, v44
v_accvgpr_write_b32 a29, v45
v_accvgpr_write_b32 a30, v46
v_accvgpr_write_b32 a31, v47
v_accvgpr_read_b32 v44, a44
v_accvgpr_read_b32 v45, a45
v_accvgpr_read_b32 v46, a46
v_accvgpr_read_b32 v47, a47
v_mul_f32 v44, v44, v41
v_mul_f32 v45, v45, v41
v_mul_f32 v46, v46, v41
v_mul_f32 v47, v47, v41
v_accvgpr_write_b32 a44, v44
v_accvgpr_write_b32 a45, v45
v_accvgpr_write_b32 a46, v46
v_accvgpr_write_b32 a47, v47
v_accvgpr_read_b32 v44, a60
v_accvgpr_read_b32 v45, a61
v_accvgpr_read_b32 v46, a62
v_accvgpr_read_b32 v47, a63
v_mul_f32 v44, v44, v41
v_mul_f32 v45, v45, v41
v_mul_f32 v46, v46, v41
v_mul_f32 v47, v47, v41
v_accvgpr_write_b32 a60, v44
v_accvgpr_write_b32 a61, v45
v_accvgpr_write_b32 a62, v46
v_accvgpr_write_b32 a63, v47
v_accvgpr_read_b32 v44, a76
v_accvgpr_read_b32 v45, a77
v_accvgpr_read_b32 v46, a78
v_accvgpr_read_b32 v47, a79
v_mul_f32 v44, v44, v41
v_mul_f32 v45, v45, v41
v_mul_f32 v46, v46, v41
v_mul_f32 v47, v47, v41
v_accvgpr_write_b32 a76, v44
v_accvgpr_write_b32 a77, v45
v_accvgpr_write_b32 a78, v46
v_accvgpr_write_b32 a79, v47
v_accvgpr_read_b32 v44, a92
v_accvgpr_read_b32 v45, a93
v_accvgpr_read_b32 v46, a94
v_accvgpr_read_b32 v47, a95
v_mul_f32 v44, v44, v41
v_mul_f32 v45, v45, v41
v_mul_f32 v46, v46, v41
v_mul_f32 v47, v47, v41
v_accvgpr_write_b32 a92, v44
v_accvgpr_write_b32 a93, v45
v_accvgpr_write_b32 a94, v46
v_accvgpr_write_b32 a95, v47
v_accvgpr_read_b32 v44, a108
v_accvgpr_read_b32 v45, a109
v_accvgpr_read_b32 v46, a110
v_accvgpr_read_b32 v47, a111
v_mul_f32 v44, v44, v41
v_mul_f32 v45, v45, v41
v_mul_f32 v46, v46, v41
v_mul_f32 v47, v47, v41
v_accvgpr_write_b32 a108, v44
v_accvgpr_write_b32 a109, v45
v_accvgpr_write_b32 a110, v46
v_accvgpr_write_b32 a111, v47
v_accvgpr_read_b32 v44, a124
v_accvgpr_read_b32 v45, a125
v_accvgpr_read_b32 v46, a126
v_accvgpr_read_b32 v47, a127
v_mul_f32 v44, v44, v41
v_mul_f32 v45, v45, v41
v_mul_f32 v46, v46, v41
v_mul_f32 v47, v47, v41
v_accvgpr_write_b32 a124, v44
v_accvgpr_write_b32 a125, v45
v_accvgpr_write_b32 a126, v46
v_accvgpr_write_b32 a127, v47
v_accvgpr_read_b32 v44, a140
v_accvgpr_read_b32 v45, a141
v_accvgpr_read_b32 v46, a142
v_accvgpr_read_b32 v47, a143
v_mul_f32 v44, v44, v41
v_mul_f32 v45, v45, v41
v_mul_f32 v46, v46, v41
v_mul_f32 v47, v47, v41
v_accvgpr_write_b32 a140, v44
v_accvgpr_write_b32 a141, v45
v_accvgpr_write_b32 a142, v46
v_accvgpr_write_b32 a143, v47
v_accvgpr_read_b32 v44, a156
v_accvgpr_read_b32 v45, a157
v_accvgpr_read_b32 v46, a158
v_accvgpr_read_b32 v47, a159
v_mul_f32 v44, v44, v41
v_mul_f32 v45, v45, v41
v_mul_f32 v46, v46, v41
v_mul_f32 v47, v47, v41
v_accvgpr_write_b32 a156, v44
v_accvgpr_write_b32 a157, v45
v_accvgpr_write_b32 a158, v46
v_accvgpr_write_b32 a159, v47
v_accvgpr_read_b32 v44, a172
v_accvgpr_read_b32 v45, a173
v_accvgpr_read_b32 v46, a174
v_accvgpr_read_b32 v47, a175
v_mul_f32 v44, v44, v41
v_mul_f32 v45, v45, v41
v_mul_f32 v46, v46, v41
v_mul_f32 v47, v47, v41
v_accvgpr_write_b32 a172, v44
v_accvgpr_write_b32 a173, v45
v_accvgpr_write_b32 a174, v46
v_accvgpr_write_b32 a175, v47
v_accvgpr_read_b32 v44, a188
v_accvgpr_read_b32 v45, a189
v_accvgpr_read_b32 v46, a190
v_accvgpr_read_b32 v47, a191
v_mul_f32 v44, v44, v41
v_mul_f32 v45, v45, v41
v_mul_f32 v46, v46, v41
v_mul_f32 v47, v47, v41
v_accvgpr_write_b32 a188, v44
v_accvgpr_write_b32 a189, v45
v_accvgpr_write_b32 a190, v46
v_accvgpr_write_b32 a191, v47
v_exp_f32 v40, v120
v_exp_f32 v41, v121
v_exp_f32 v42, v122
v_exp_f32 v43, v123
v_add_f32 v36, v40, v41
v_cvt_pk_bf16_f32 v216, v40, v41
v_add_f32 v36, v36, v42
v_add_f32 v36, v36, v43
v_cvt_pk_bf16_f32 v217, v42, v43
v_exp_f32 v44, v124
v_exp_f32 v45, v125
v_exp_f32 v46, v126
v_exp_f32 v47, v127
v_add_f32 v37, v44, v45
v_cvt_pk_bf16_f32 v220, v44, v45
v_add_f32 v37, v37, v46
v_add_f32 v37, v37, v47
v_cvt_pk_bf16_f32 v221, v46, v47
v_exp_f32 v40, v128
v_exp_f32 v41, v129
v_exp_f32 v42, v130
v_exp_f32 v43, v131
v_add_f32 v38, v40, v41
v_cvt_pk_bf16_f32 v224, v40, v41
v_add_f32 v38, v38, v42
v_add_f32 v38, v38, v43
v_cvt_pk_bf16_f32 v225, v42, v43
v_exp_f32 v44, v132
v_exp_f32 v45, v133
v_exp_f32 v46, v134
v_exp_f32 v47, v135
v_add_f32 v39, v44, v45
v_cvt_pk_bf16_f32 v228, v44, v45
v_add_f32 v39, v39, v46
v_add_f32 v39, v39, v47
v_cvt_pk_bf16_f32 v229, v46, v47
v_exp_f32 v40, v136
v_exp_f32 v41, v137
v_exp_f32 v42, v138
v_exp_f32 v43, v139
v_add_f32 v36, v36, v40
v_add_f32 v36, v36, v41
v_cvt_pk_bf16_f32 v218, v40, v41
v_add_f32 v36, v36, v42
v_add_f32 v36, v36, v43
v_cvt_pk_bf16_f32 v219, v42, v43
v_exp_f32 v44, v140
v_exp_f32 v45, v141
v_exp_f32 v46, v142
v_exp_f32 v47, v143
v_add_f32 v37, v37, v44
v_add_f32 v37, v37, v45
v_cvt_pk_bf16_f32 v222, v44, v45
v_add_f32 v37, v37, v46
v_add_f32 v37, v37, v47
v_cvt_pk_bf16_f32 v223, v46, v47
v_exp_f32 v40, v144
v_exp_f32 v41, v145
v_exp_f32 v42, v146
v_exp_f32 v43, v147
v_add_f32 v38, v38, v40
v_add_f32 v38, v38, v41
v_cvt_pk_bf16_f32 v226, v40, v41
v_add_f32 v38, v38, v42
v_add_f32 v38, v38, v43
v_cvt_pk_bf16_f32 v227, v42, v43
v_exp_f32 v44, v148
v_exp_f32 v45, v149
v_exp_f32 v46, v150
v_exp_f32 v47, v151
v_add_f32 v39, v39, v44
v_add_f32 v39, v39, v45
v_cvt_pk_bf16_f32 v230, v44, v45
v_add_f32 v39, v39, v46
v_add_f32 v39, v39, v47
v_cvt_pk_bf16_f32 v231, v46, v47
v_exp_f32 v40, v152
v_exp_f32 v41, v153
v_exp_f32 v42, v154
v_exp_f32 v43, v155
v_add_f32 v36, v36, v40
v_add_f32 v36, v36, v41
v_cvt_pk_bf16_f32 v232, v40, v41
v_add_f32 v36, v36, v42
v_add_f32 v36, v36, v43
v_cvt_pk_bf16_f32 v233, v42, v43
v_exp_f32 v44, v156
v_exp_f32 v45, v157
v_exp_f32 v46, v158
v_exp_f32 v47, v159
v_add_f32 v37, v37, v44
v_add_f32 v37, v37, v45
v_cvt_pk_bf16_f32 v236, v44, v45
v_add_f32 v37, v37, v46
v_add_f32 v37, v37, v47
v_cvt_pk_bf16_f32 v237, v46, v47
v_exp_f32 v40, v160
v_exp_f32 v41, v161
v_exp_f32 v42, v162
v_exp_f32 v43, v163
v_add_f32 v38, v38, v40
v_add_f32 v38, v38, v41
v_cvt_pk_bf16_f32 v240, v40, v41
v_add_f32 v38, v38, v42
v_add_f32 v38, v38, v43
v_cvt_pk_bf16_f32 v241, v42, v43
v_exp_f32 v44, v164
v_exp_f32 v45, v165
v_exp_f32 v46, v166
v_exp_f32 v47, v167
v_add_f32 v39, v39, v44
v_add_f32 v39, v39, v45
v_cvt_pk_bf16_f32 v244, v44, v45
v_add_f32 v39, v39, v46
v_add_f32 v39, v39, v47
v_cvt_pk_bf16_f32 v245, v46, v47
v_exp_f32 v40, v168
v_exp_f32 v41, v169
v_exp_f32 v42, v170
v_exp_f32 v43, v171
v_add_f32 v36, v36, v40
v_add_f32 v36, v36, v41
v_cvt_pk_bf16_f32 v234, v40, v41
v_add_f32 v36, v36, v42
v_add_f32 v36, v36, v43
v_cvt_pk_bf16_f32 v235, v42, v43
v_exp_f32 v44, v172
v_exp_f32 v45, v173
v_exp_f32 v46, v174
v_exp_f32 v47, v175
v_add_f32 v37, v37, v44
v_add_f32 v37, v37, v45
v_cvt_pk_bf16_f32 v238, v44, v45
v_add_f32 v37, v37, v46
v_add_f32 v37, v37, v47
v_cvt_pk_bf16_f32 v239, v46, v47
v_exp_f32 v40, v176
v_exp_f32 v41, v177
v_exp_f32 v42, v178
v_exp_f32 v43, v179
v_add_f32 v38, v38, v40
v_add_f32 v38, v38, v41
v_cvt_pk_bf16_f32 v242, v40, v41
v_add_f32 v38, v38, v42
v_add_f32 v38, v38, v43
v_cvt_pk_bf16_f32 v243, v42, v43
v_exp_f32 v44, v180
v_exp_f32 v45, v181
v_exp_f32 v46, v182
v_exp_f32 v47, v183
v_add_f32 v39, v39, v44
v_add_f32 v39, v39, v45
v_cvt_pk_bf16_f32 v246, v44, v45
v_add_f32 v39, v39, v46
v_add_f32 v39, v39, v47
v_cvt_pk_bf16_f32 v247, v46, v47
s_nop 3
s_setpc_b64 s[46:47]
L_rare3:
s_nop 15
v_max3_f32 v40, v120, v121, v122
v_max3_f32 v40, v40, v123, v136
v_max3_f32 v40, v40, v137, v138
v_max3_f32 v40, v40, v139, v152
v_max3_f32 v40, v40, v153, v154
v_max3_f32 v40, v40, v155, v168
v_max3_f32 v40, v40, v169, v170
v_max_f32 v40, v40, v171
v_mov_b32 v42, v40
v_mov_b32 v43, v40
s_nop 1
v_permlane32_swap_b32 v42, v43
s_nop 1
v_max_f32 v40, v42, v43
v_mov_b32 v42, v40
v_mov_b32 v43, v40
s_nop 1
v_permlane16_swap_b32 v42, v43
s_nop 1
v_max_f32 v40, v42, v43
v_max_f32 v40, 0, v40
v_exp_f32 v41, -v40
v_sub_f32 v120, v120, v40
v_sub_f32 v121, v121, v40
v_sub_f32 v122, v122, v40
v_sub_f32 v123, v123, v40
v_sub_f32 v136, v136, v40
v_sub_f32 v137, v137, v40
v_sub_f32 v138, v138, v40
v_sub_f32 v139, v139, v40
v_sub_f32 v152, v152, v40
v_sub_f32 v153, v153, v40
v_sub_f32 v154, v154, v40
v_sub_f32 v155, v155, v40
v_sub_f32 v168, v168, v40
v_sub_f32 v169, v169, v40
v_sub_f32 v170, v170, v40
v_sub_f32 v171, v171, v40
v_mul_f32 v32, v32, v41
v_accvgpr_read_b32 v44, a0
v_accvgpr_read_b32 v45, a1
v_accvgpr_read_b32 v46, a2
v_accvgpr_read_b32 v47, a3
v_mul_f32 v44, v44, v41
v_mul_f32 v45, v45, v41
v_mul_f32 v46, v46, v41
v_mul_f32 v47, v47, v41
v_accvgpr_write_b32 a0, v44
v_accvgpr_write_b32 a1, v45
v_accvgpr_write_b32 a2, v46
v_accvgpr_write_b32 a3, v47
v_accvgpr_read_b32 v44, a16
v_accvgpr_read_b32 v45, a17
v_accvgpr_read_b32 v46, a18
v_accvgpr_read_b32 v47, a19
v_mul_f32 v44, v44, v41
v_mul_f32 v45, v45, v41
v_mul_f32 v46, v46, v41
v_mul_f32 v47, v47, v41
v_accvgpr_write_b32 a16, v44
v_accvgpr_write_b32 a17, v45
v_accvgpr_write_b32 a18, v46
v_accvgpr_write_b32 a19, v47
v_accvgpr_read_b32 v44, a32
v_accvgpr_read_b32 v45, a33
v_accvgpr_read_b32 v46, a34
v_accvgpr_read_b32 v47, a35
v_mul_f32 v44, v44, v41
v_mul_f32 v45, v45, v41
v_mul_f32 v46, v46, v41
v_mul_f32 v47, v47, v41
v_accvgpr_write_b32 a32, v44
v_accvgpr_write_b32 a33, v45
v_accvgpr_write_b32 a34, v46
v_accvgpr_write_b32 a35, v47
v_accvgpr_read_b32 v44, a48
v_accvgpr_read_b32 v45, a49
v_accvgpr_read_b32 v46, a50
v_accvgpr_read_b32 v47, a51
v_mul_f32 v44, v44, v41
v_mul_f32 v45, v45, v41
v_mul_f32 v46, v46, v41
v_mul_f32 v47, v47, v41
v_accvgpr_write_b32 a48, v44
v_accvgpr_write_b32 a49, v45
v_accvgpr_write_b32 a50, v46
v_accvgpr_write_b32 a51, v47
v_accvgpr_read_b32 v44, a64
v_accvgpr_read_b32 v45, a65
v_accvgpr_read_b32 v46, a66
v_accvgpr_read_b32 v47, a67
v_mul_f32 v44, v44, v41
v_mul_f32 v45, v45, v41
v_mul_f32 v46, v46, v41
v_mul_f32 v47, v47, v41
v_accvgpr_write_b32 a64, v44
v_accvgpr_write_b32 a65, v45
v_accvgpr_write_b32 a66, v46
v_accvgpr_write_b32 a67, v47
v_accvgpr_read_b32 v44, a80
v_accvgpr_read_b32 v45, a81
v_accvgpr_read_b32 v46, a82
v_accvgpr_read_b32 v47, a83
v_mul_f32 v44, v44, v41
v_mul_f32 v45, v45, v41
v_mul_f32 v46, v46, v41
v_mul_f32 v47, v47, v41
v_accvgpr_write_b32 a80, v44
v_accvgpr_write_b32 a81, v45
v_accvgpr_write_b32 a82, v46
v_accvgpr_write_b32 a83, v47
v_accvgpr_read_b32 v44, a96
v_accvgpr_read_b32 v45, a97
v_accvgpr_read_b32 v46, a98
v_accvgpr_read_b32 v47, a99
v_mul_f32 v44, v44, v41
v_mul_f32 v45, v45, v41
v_mul_f32 v46, v46, v41
v_mul_f32 v47, v47, v41
v_accvgpr_write_b32 a96, v44
v_accvgpr_write_b32 a97, v45
v_accvgpr_write_b32 a98, v46
v_accvgpr_write_b32 a99, v47
v_accvgpr_read_b32 v44, a112
v_accvgpr_read_b32 v45, a113
v_accvgpr_read_b32 v46, a114
v_accvgpr_read_b32 v47, a115
v_mul_f32 v44, v44, v41
v_mul_f32 v45, v45, v41
v_mul_f32 v46, v46, v41
v_mul_f32 v47, v47, v41
v_accvgpr_write_b32 a112, v44
v_accvgpr_write_b32 a113, v45
v_accvgpr_write_b32 a114, v46
v_accvgpr_write_b32 a115, v47
v_accvgpr_read_b32 v44, a128
v_accvgpr_read_b32 v45, a129
v_accvgpr_read_b32 v46, a130
v_accvgpr_read_b32 v47, a131
v_mul_f32 v44, v44, v41
v_mul_f32 v45, v45, v41
v_mul_f32 v46, v46, v41
v_mul_f32 v47, v47, v41
v_accvgpr_write_b32 a128, v44
v_accvgpr_write_b32 a129, v45
v_accvgpr_write_b32 a130, v46
v_accvgpr_write_b32 a131, v47
v_accvgpr_read_b32 v44, a144
v_accvgpr_read_b32 v45, a145
v_accvgpr_read_b32 v46, a146
v_accvgpr_read_b32 v47, a147
v_mul_f32 v44, v44, v41
v_mul_f32 v45, v45, v41
v_mul_f32 v46, v46, v41
v_mul_f32 v47, v47, v41
v_accvgpr_write_b32 a144, v44
v_accvgpr_write_b32 a145, v45
v_accvgpr_write_b32 a146, v46
v_accvgpr_write_b32 a147, v47
v_accvgpr_read_b32 v44, a160
v_accvgpr_read_b32 v45, a161
v_accvgpr_read_b32 v46, a162
v_accvgpr_read_b32 v47, a163
v_mul_f32 v44, v44, v41
v_mul_f32 v45, v45, v41
v_mul_f32 v46, v46, v41
v_mul_f32 v47, v47, v41
v_accvgpr_write_b32 a160, v44
v_accvgpr_write_b32 a161, v45
v_accvgpr_write_b32 a162, v46
v_accvgpr_write_b32 a163, v47
v_accvgpr_read_b32 v44, a176
v_accvgpr_read_b32 v45, a177
v_accvgpr_read_b32 v46, a178
v_accvgpr_read_b32 v47, a179
v_mul_f32 v44, v44, v41
v_mul_f32 v45, v45, v41
v_mul_f32 v46, v46, v41
v_mul_f32 v47, v47, v41
v_accvgpr_write_b32 a176, v44
v_accvgpr_write_b32 a177, v45
v_accvgpr_write_b32 a178, v46
v_accvgpr_write_b32 a179, v47
v_max3_f32 v40, v124, v125, v126
v_max3_f32 v40, v40, v127, v140
v_max3_f32 v40, v40, v141, v142
v_max3_f32 v40, v40, v143, v156
v_max3_f32 v40, v40, v157, v158
v_max3_f32 v40, v40, v159, v172
v_max3_f32 v40, v40, v173, v174
v_max_f32 v40, v40, v175
v_mov_b32 v42, v40
v_mov_b32 v43, v40
s_nop 1
v_permlane32_swap_b32 v42, v43
s_nop 1
v_max_f32 v40, v42, v43
v_mov_b32 v42, v40
v_mov_b32 v43, v40
s_nop 1
v_permlane16_swap_b32 v42, v43
s_nop 1
v_max_f32 v40, v42, v43
v_max_f32 v40, 0, v40
v_exp_f32 v41, -v40
v_sub_f32 v124, v124, v40
v_sub_f32 v125, v125, v40
v_sub_f32 v126, v126, v40
v_sub_f32 v127, v127, v40
v_sub_f32 v140, v140, v40
v_sub_f32 v141, v141, v40
v_sub_f32 v142, v142, v40
v_sub_f32 v143, v143, v40
v_sub_f32 v156, v156, v40
v_sub_f32 v157, v157, v40
v_sub_f32 v158, v158, v40
v_sub_f32 v159, v159, v40
v_sub_f32 v172, v172, v40
v_sub_f32 v173, v173, v40
v_sub_f32 v174, v174, v40
v_sub_f32 v175, v175, v40
v_mul_f32 v33, v33, v41
v_accvgpr_read_b32 v44, a4
v_accvgpr_read_b32 v45, a5
v_accvgpr_read_b32 v46, a6
v_accvgpr_read_b32 v47, a7
v_mul_f32 v44, v44, v41
v_mul_f32 v45, v45, v41
v_mul_f32 v46, v46, v41
v_mul_f32 v47, v47, v41
v_accvgpr_write_b32 a4, v44
v_accvgpr_write_b32 a5, v45
v_accvgpr_write_b32 a6, v46
v_accvgpr_write_b32 a7, v47
v_accvgpr_read_b32 v44, a20
v_accvgpr_read_b32 v45, a21
v_accvgpr_read_b32 v46, a22
v_accvgpr_read_b32 v47, a23
v_mul_f32 v44, v44, v41
v_mul_f32 v45, v45, v41
v_mul_f32 v46, v46, v41
v_mul_f32 v47, v47, v41
v_accvgpr_write_b32 a20, v44
v_accvgpr_write_b32 a21, v45
v_accvgpr_write_b32 a22, v46
v_accvgpr_write_b32 a23, v47
v_accvgpr_read_b32 v44, a36
v_accvgpr_read_b32 v45, a37
v_accvgpr_read_b32 v46, a38
v_accvgpr_read_b32 v47, a39
v_mul_f32 v44, v44, v41
v_mul_f32 v45, v45, v41
v_mul_f32 v46, v46, v41
v_mul_f32 v47, v47, v41
v_accvgpr_write_b32 a36, v44
v_accvgpr_write_b32 a37, v45
v_accvgpr_write_b32 a38, v46
v_accvgpr_write_b32 a39, v47
v_accvgpr_read_b32 v44, a52
v_accvgpr_read_b32 v45, a53
v_accvgpr_read_b32 v46, a54
v_accvgpr_read_b32 v47, a55
v_mul_f32 v44, v44, v41
v_mul_f32 v45, v45, v41
v_mul_f32 v46, v46, v41
v_mul_f32 v47, v47, v41
v_accvgpr_write_b32 a52, v44
v_accvgpr_write_b32 a53, v45
v_accvgpr_write_b32 a54, v46
v_accvgpr_write_b32 a55, v47
v_accvgpr_read_b32 v44, a68
v_accvgpr_read_b32 v45, a69
v_accvgpr_read_b32 v46, a70
v_accvgpr_read_b32 v47, a71
v_mul_f32 v44, v44, v41
v_mul_f32 v45, v45, v41
v_mul_f32 v46, v46, v41
v_mul_f32 v47, v47, v41
v_accvgpr_write_b32 a68, v44
v_accvgpr_write_b32 a69, v45
v_accvgpr_write_b32 a70, v46
v_accvgpr_write_b32 a71, v47
v_accvgpr_read_b32 v44, a84
v_accvgpr_read_b32 v45, a85
v_accvgpr_read_b32 v46, a86
v_accvgpr_read_b32 v47, a87
v_mul_f32 v44, v44, v41
v_mul_f32 v45, v45, v41
v_mul_f32 v46, v46, v41
v_mul_f32 v47, v47, v41
v_accvgpr_write_b32 a84, v44
v_accvgpr_write_b32 a85, v45
v_accvgpr_write_b32 a86, v46
v_accvgpr_write_b32 a87, v47
v_accvgpr_read_b32 v44, a100
v_accvgpr_read_b32 v45, a101
v_accvgpr_read_b32 v46, a102
v_accvgpr_read_b32 v47, a103
v_mul_f32 v44, v44, v41
v_mul_f32 v45, v45, v41
v_mul_f32 v46, v46, v41
v_mul_f32 v47, v47, v41
v_accvgpr_write_b32 a100, v44
v_accvgpr_write_b32 a101, v45
v_accvgpr_write_b32 a102, v46
v_accvgpr_write_b32 a103, v47
v_accvgpr_read_b32 v44, a116
v_accvgpr_read_b32 v45, a117
v_accvgpr_read_b32 v46, a118
v_accvgpr_read_b32 v47, a119
v_mul_f32 v44, v44, v41
v_mul_f32 v45, v45, v41
v_mul_f32 v46, v46, v41
v_mul_f32 v47, v47, v41
v_accvgpr_write_b32 a116, v44
v_accvgpr_write_b32 a117, v45
v_accvgpr_write_b32 a118, v46
v_accvgpr_write_b32 a119, v47
v_accvgpr_read_b32 v44, a132
v_accvgpr_read_b32 v45, a133
v_accvgpr_read_b32 v46, a134
v_accvgpr_read_b32 v47, a135
v_mul_f32 v44, v44, v41
v_mul_f32 v45, v45, v41
v_mul_f32 v46, v46, v41
v_mul_f32 v47, v47, v41
v_accvgpr_write_b32 a132, v44
v_accvgpr_write_b32 a133, v45
v_accvgpr_write_b32 a134, v46
v_accvgpr_write_b32 a135, v47
v_accvgpr_read_b32 v44, a148
v_accvgpr_read_b32 v45, a149
v_accvgpr_read_b32 v46, a150
v_accvgpr_read_b32 v47, a151
v_mul_f32 v44, v44, v41
v_mul_f32 v45, v45, v41
v_mul_f32 v46, v46, v41
v_mul_f32 v47, v47, v41
v_accvgpr_write_b32 a148, v44
v_accvgpr_write_b32 a149, v45
v_accvgpr_write_b32 a150, v46
v_accvgpr_write_b32 a151, v47
v_accvgpr_read_b32 v44, a164
v_accvgpr_read_b32 v45, a165
v_accvgpr_read_b32 v46, a166
v_accvgpr_read_b32 v47, a167
v_mul_f32 v44, v44, v41
v_mul_f32 v45, v45, v41
v_mul_f32 v46, v46, v41
v_mul_f32 v47, v47, v41
v_accvgpr_write_b32 a164, v44
v_accvgpr_write_b32 a165, v45
v_accvgpr_write_b32 a166, v46
v_accvgpr_write_b32 a167, v47
v_accvgpr_read_b32 v44, a180
v_accvgpr_read_b32 v45, a181
v_accvgpr_read_b32 v46, a182
v_accvgpr_read_b32 v47, a183
v_mul_f32 v44, v44, v41
v_mul_f32 v45, v45, v41
v_mul_f32 v46, v46, v41
v_mul_f32 v47, v47, v41
v_accvgpr_write_b32 a180, v44
v_accvgpr_write_b32 a181, v45
v_accvgpr_write_b32 a182, v46
v_accvgpr_write_b32 a183, v47
v_max3_f32 v40, v128, v129, v130
v_max3_f32 v40, v40, v131, v144
v_max3_f32 v40, v40, v145, v146
v_max3_f32 v40, v40, v147, v160
v_max3_f32 v40, v40, v161, v162
v_max3_f32 v40, v40, v163, v176
v_max3_f32 v40, v40, v177, v178
v_max_f32 v40, v40, v179
v_mov_b32 v42, v40
v_mov_b32 v43, v40
s_nop 1
v_permlane32_swap_b32 v42, v43
s_nop 1
v_max_f32 v40, v42, v43
v_mov_b32 v42, v40
v_mov_b32 v43, v40
s_nop 1
v_permlane16_swap_b32 v42, v43
s_nop 1
v_max_f32 v40, v42, v43
v_max_f32 v40, 0, v40
v_exp_f32 v41, -v40
v_sub_f32 v128, v128, v40
v_sub_f32 v129, v129, v40
v_sub_f32 v130, v130, v40
v_sub_f32 v131, v131, v40
v_sub_f32 v144, v144, v40
v_sub_f32 v145, v145, v40
v_sub_f32 v146, v146, v40
v_sub_f32 v147, v147, v40
v_sub_f32 v160, v160, v40
v_sub_f32 v161, v161, v40
v_sub_f32 v162, v162, v40
v_sub_f32 v163, v163, v40
v_sub_f32 v176, v176, v40
v_sub_f32 v177, v177, v40
v_sub_f32 v178, v178, v40
v_sub_f32 v179, v179, v40
v_mul_f32 v34, v34, v41
v_accvgpr_read_b32 v44, a8
v_accvgpr_read_b32 v45, a9
v_accvgpr_read_b32 v46, a10
v_accvgpr_read_b32 v47, a11
v_mul_f32 v44, v44, v41
v_mul_f32 v45, v45, v41
v_mul_f32 v46, v46, v41
v_mul_f32 v47, v47, v41
v_accvgpr_write_b32 a8, v44
v_accvgpr_write_b32 a9, v45
v_accvgpr_write_b32 a10, v46
v_accvgpr_write_b32 a11, v47
v_accvgpr_read_b32 v44, a24
v_accvgpr_read_b32 v45, a25
v_accvgpr_read_b32 v46, a26
v_accvgpr_read_b32 v47, a27
v_mul_f32 v44, v44, v41
v_mul_f32 v45, v45, v41
v_mul_f32 v46, v46, v41
v_mul_f32 v47, v47, v41
v_accvgpr_write_b32 a24, v44
v_accvgpr_write_b32 a25, v45
v_accvgpr_write_b32 a26, v46
v_accvgpr_write_b32 a27, v47
v_accvgpr_read_b32 v44, a40
v_accvgpr_read_b32 v45, a41
v_accvgpr_read_b32 v46, a42
v_accvgpr_read_b32 v47, a43
v_mul_f32 v44, v44, v41
v_mul_f32 v45, v45, v41
v_mul_f32 v46, v46, v41
v_mul_f32 v47, v47, v41
v_accvgpr_write_b32 a40, v44
v_accvgpr_write_b32 a41, v45
v_accvgpr_write_b32 a42, v46
v_accvgpr_write_b32 a43, v47
v_accvgpr_read_b32 v44, a56
v_accvgpr_read_b32 v45, a57
v_accvgpr_read_b32 v46, a58
v_accvgpr_read_b32 v47, a59
v_mul_f32 v44, v44, v41
v_mul_f32 v45, v45, v41
v_mul_f32 v46, v46, v41
v_mul_f32 v47, v47, v41
v_accvgpr_write_b32 a56, v44
v_accvgpr_write_b32 a57, v45
v_accvgpr_write_b32 a58, v46
v_accvgpr_write_b32 a59, v47
v_accvgpr_read_b32 v44, a72
v_accvgpr_read_b32 v45, a73
v_accvgpr_read_b32 v46, a74
v_accvgpr_read_b32 v47, a75
v_mul_f32 v44, v44, v41
v_mul_f32 v45, v45, v41
v_mul_f32 v46, v46, v41
v_mul_f32 v47, v47, v41
v_accvgpr_write_b32 a72, v44
v_accvgpr_write_b32 a73, v45
v_accvgpr_write_b32 a74, v46
v_accvgpr_write_b32 a75, v47
v_accvgpr_read_b32 v44, a88
v_accvgpr_read_b32 v45, a89
v_accvgpr_read_b32 v46, a90
v_accvgpr_read_b32 v47, a91
v_mul_f32 v44, v44, v41
v_mul_f32 v45, v45, v41
v_mul_f32 v46, v46, v41
v_mul_f32 v47, v47, v41
v_accvgpr_write_b32 a88, v44
v_accvgpr_write_b32 a89, v45
v_accvgpr_write_b32 a90, v46
v_accvgpr_write_b32 a91, v47
v_accvgpr_read_b32 v44, a104
v_accvgpr_read_b32 v45, a105
v_accvgpr_read_b32 v46, a106
v_accvgpr_read_b32 v47, a107
v_mul_f32 v44, v44, v41
v_mul_f32 v45, v45, v41
v_mul_f32 v46, v46, v41
v_mul_f32 v47, v47, v41
v_accvgpr_write_b32 a104, v44
v_accvgpr_write_b32 a105, v45
v_accvgpr_write_b32 a106, v46
v_accvgpr_write_b32 a107, v47
v_accvgpr_read_b32 v44, a120
v_accvgpr_read_b32 v45, a121
v_accvgpr_read_b32 v46, a122
v_accvgpr_read_b32 v47, a123
v_mul_f32 v44, v44, v41
v_mul_f32 v45, v45, v41
v_mul_f32 v46, v46, v41
v_mul_f32 v47, v47, v41
v_accvgpr_write_b32 a120, v44
v_accvgpr_write_b32 a121, v45
v_accvgpr_write_b32 a122, v46
v_accvgpr_write_b32 a123, v47
v_accvgpr_read_b32 v44, a136
v_accvgpr_read_b32 v45, a137
v_accvgpr_read_b32 v46, a138
v_accvgpr_read_b32 v47, a139
v_mul_f32 v44, v44, v41
v_mul_f32 v45, v45, v41
v_mul_f32 v46, v46, v41
v_mul_f32 v47, v47, v41
v_accvgpr_write_b32 a136, v44
v_accvgpr_write_b32 a137, v45
v_accvgpr_write_b32 a138, v46
v_accvgpr_write_b32 a139, v47
v_accvgpr_read_b32 v44, a152
v_accvgpr_read_b32 v45, a153
v_accvgpr_read_b32 v46, a154
v_accvgpr_read_b32 v47, a155
v_mul_f32 v44, v44, v41
v_mul_f32 v45, v45, v41
v_mul_f32 v46, v46, v41
v_mul_f32 v47, v47, v41
v_accvgpr_write_b32 a152, v44
v_accvgpr_write_b32 a153, v45
v_accvgpr_write_b32 a154, v46
v_accvgpr_write_b32 a155, v47
v_accvgpr_read_b32 v44, a168
v_accvgpr_read_b32 v45, a169
v_accvgpr_read_b32 v46, a170
v_accvgpr_read_b32 v47, a171
v_mul_f32 v44, v44, v41
v_mul_f32 v45, v45, v41
v_mul_f32 v46, v46, v41
v_mul_f32 v47, v47, v41
v_accvgpr_write_b32 a168, v44
v_accvgpr_write_b32 a169, v45
v_accvgpr_write_b32 a170, v46
v_accvgpr_write_b32 a171, v47
v_accvgpr_read_b32 v44, a184
v_accvgpr_read_b32 v45, a185
v_accvgpr_read_b32 v46, a186
v_accvgpr_read_b32 v47, a187
v_mul_f32 v44, v44, v41
v_mul_f32 v45, v45, v41
v_mul_f32 v46, v46, v41
v_mul_f32 v47, v47, v41
v_accvgpr_write_b32 a184, v44
v_accvgpr_write_b32 a185, v45
v_accvgpr_write_b32 a186, v46
v_accvgpr_write_b32 a187, v47
v_max3_f32 v40, v132, v133, v134
v_max3_f32 v40, v40, v135, v148
v_max3_f32 v40, v40, v149, v150
v_max3_f32 v40, v40, v151, v164
v_max3_f32 v40, v40, v165, v166
v_max3_f32 v40, v40, v167, v180
v_max3_f32 v40, v40, v181, v182
v_max_f32 v40, v40, v183
v_mov_b32 v42, v40
v_mov_b32 v43, v40
s_nop 1
v_permlane32_swap_b32 v42, v43
s_nop 1
v_max_f32 v40, v42, v43
v_mov_b32 v42, v40
v_mov_b32 v43, v40
s_nop 1
v_permlane16_swap_b32 v42, v43
s_nop 1
v_max_f32 v40, v42, v43
v_max_f32 v40, 0, v40
v_exp_f32 v41, -v40
v_sub_f32 v132, v132, v40
v_sub_f32 v133, v133, v40
v_sub_f32 v134, v134, v40
v_sub_f32 v135, v135, v40
v_sub_f32 v148, v148, v40
v_sub_f32 v149, v149, v40
v_sub_f32 v150, v150, v40
v_sub_f32 v151, v151, v40
v_sub_f32 v164, v164, v40
v_sub_f32 v165, v165, v40
v_sub_f32 v166, v166, v40
v_sub_f32 v167, v167, v40
v_sub_f32 v180, v180, v40
v_sub_f32 v181, v181, v40
v_sub_f32 v182, v182, v40
v_sub_f32 v183, v183, v40
v_mul_f32 v35, v35, v41
v_accvgpr_read_b32 v44, a12
v_accvgpr_read_b32 v45, a13
v_accvgpr_read_b32 v46, a14
v_accvgpr_read_b32 v47, a15
v_mul_f32 v44, v44, v41
v_mul_f32 v45, v45, v41
v_mul_f32 v46, v46, v41
v_mul_f32 v47, v47, v41
v_accvgpr_write_b32 a12, v44
v_accvgpr_write_b32 a13, v45
v_accvgpr_write_b32 a14, v46
v_accvgpr_write_b32 a15, v47
v_accvgpr_read_b32 v44, a28
v_accvgpr_read_b32 v45, a29
v_accvgpr_read_b32 v46, a30
v_accvgpr_read_b32 v47, a31
v_mul_f32 v44, v44, v41
v_mul_f32 v45, v45, v41
v_mul_f32 v46, v46, v41
v_mul_f32 v47, v47, v41
v_accvgpr_write_b32 a28, v44
v_accvgpr_write_b32 a29, v45
v_accvgpr_write_b32 a30, v46
v_accvgpr_write_b32 a31, v47
v_accvgpr_read_b32 v44, a44
v_accvgpr_read_b32 v45, a45
v_accvgpr_read_b32 v46, a46
v_accvgpr_read_b32 v47, a47
v_mul_f32 v44, v44, v41
v_mul_f32 v45, v45, v41
v_mul_f32 v46, v46, v41
v_mul_f32 v47, v47, v41
v_accvgpr_write_b32 a44, v44
v_accvgpr_write_b32 a45, v45
v_accvgpr_write_b32 a46, v46
v_accvgpr_write_b32 a47, v47
v_accvgpr_read_b32 v44, a60
v_accvgpr_read_b32 v45, a61
v_accvgpr_read_b32 v46, a62
v_accvgpr_read_b32 v47, a63
v_mul_f32 v44, v44, v41
v_mul_f32 v45, v45, v41
v_mul_f32 v46, v46, v41
v_mul_f32 v47, v47, v41
v_accvgpr_write_b32 a60, v44
v_accvgpr_write_b32 a61, v45
v_accvgpr_write_b32 a62, v46
v_accvgpr_write_b32 a63, v47
v_accvgpr_read_b32 v44, a76
v_accvgpr_read_b32 v45, a77
v_accvgpr_read_b32 v46, a78
v_accvgpr_read_b32 v47, a79
v_mul_f32 v44, v44, v41
v_mul_f32 v45, v45, v41
v_mul_f32 v46, v46, v41
v_mul_f32 v47, v47, v41
v_accvgpr_write_b32 a76, v44
v_accvgpr_write_b32 a77, v45
v_accvgpr_write_b32 a78, v46
v_accvgpr_write_b32 a79, v47
v_accvgpr_read_b32 v44, a92
v_accvgpr_read_b32 v45, a93
v_accvgpr_read_b32 v46, a94
v_accvgpr_read_b32 v47, a95
v_mul_f32 v44, v44, v41
v_mul_f32 v45, v45, v41
v_mul_f32 v46, v46, v41
v_mul_f32 v47, v47, v41
v_accvgpr_write_b32 a92, v44
v_accvgpr_write_b32 a93, v45
v_accvgpr_write_b32 a94, v46
v_accvgpr_write_b32 a95, v47
v_accvgpr_read_b32 v44, a108
v_accvgpr_read_b32 v45, a109
v_accvgpr_read_b32 v46, a110
v_accvgpr_read_b32 v47, a111
v_mul_f32 v44, v44, v41
v_mul_f32 v45, v45, v41
v_mul_f32 v46, v46, v41
v_mul_f32 v47, v47, v41
v_accvgpr_write_b32 a108, v44
v_accvgpr_write_b32 a109, v45
v_accvgpr_write_b32 a110, v46
v_accvgpr_write_b32 a111, v47
v_accvgpr_read_b32 v44, a124
v_accvgpr_read_b32 v45, a125
v_accvgpr_read_b32 v46, a126
v_accvgpr_read_b32 v47, a127
v_mul_f32 v44, v44, v41
v_mul_f32 v45, v45, v41
v_mul_f32 v46, v46, v41
v_mul_f32 v47, v47, v41
v_accvgpr_write_b32 a124, v44
v_accvgpr_write_b32 a125, v45
v_accvgpr_write_b32 a126, v46
v_accvgpr_write_b32 a127, v47
v_accvgpr_read_b32 v44, a140
v_accvgpr_read_b32 v45, a141
v_accvgpr_read_b32 v46, a142
v_accvgpr_read_b32 v47, a143
v_mul_f32 v44, v44, v41
v_mul_f32 v45, v45, v41
v_mul_f32 v46, v46, v41
v_mul_f32 v47, v47, v41
v_accvgpr_write_b32 a140, v44
v_accvgpr_write_b32 a141, v45
v_accvgpr_write_b32 a142, v46
v_accvgpr_write_b32 a143, v47
v_accvgpr_read_b32 v44, a156
v_accvgpr_read_b32 v45, a157
v_accvgpr_read_b32 v46, a158
v_accvgpr_read_b32 v47, a159
v_mul_f32 v44, v44, v41
v_mul_f32 v45, v45, v41
v_mul_f32 v46, v46, v41
v_mul_f32 v47, v47, v41
v_accvgpr_write_b32 a156, v44
v_accvgpr_write_b32 a157, v45
v_accvgpr_write_b32 a158, v46
v_accvgpr_write_b32 a159, v47
v_accvgpr_read_b32 v44, a172
v_accvgpr_read_b32 v45, a173
v_accvgpr_read_b32 v46, a174
v_accvgpr_read_b32 v47, a175
v_mul_f32 v44, v44, v41
v_mul_f32 v45, v45, v41
v_mul_f32 v46, v46, v41
v_mul_f32 v47, v47, v41
v_accvgpr_write_b32 a172, v44
v_accvgpr_write_b32 a173, v45
v_accvgpr_write_b32 a174, v46
v_accvgpr_write_b32 a175, v47
v_accvgpr_read_b32 v44, a188
v_accvgpr_read_b32 v45, a189
v_accvgpr_read_b32 v46, a190
v_accvgpr_read_b32 v47, a191
v_mul_f32 v44, v44, v41
v_mul_f32 v45, v45, v41
v_mul_f32 v46, v46, v41
v_mul_f32 v47, v47, v41
v_accvgpr_write_b32 a188, v44
v_accvgpr_write_b32 a189, v45
v_accvgpr_write_b32 a190, v46
v_accvgpr_write_b32 a191, v47
v_exp_f32 v40, v120
v_exp_f32 v41, v121
v_exp_f32 v42, v122
v_exp_f32 v43, v123
v_add_f32 v36, v40, v41
v_cvt_pk_bf16_f32 v216, v40, v41
v_add_f32 v36, v36, v42
v_add_f32 v36, v36, v43
v_cvt_pk_bf16_f32 v217, v42, v43
v_exp_f32 v44, v124
v_exp_f32 v45, v125
v_exp_f32 v46, v126
v_exp_f32 v47, v127
v_add_f32 v37, v44, v45
v_cvt_pk_bf16_f32 v220, v44, v45
v_add_f32 v37, v37, v46
v_add_f32 v37, v37, v47
v_cvt_pk_bf16_f32 v221, v46, v47
v_exp_f32 v40, v128
v_exp_f32 v41, v129
v_exp_f32 v42, v130
v_exp_f32 v43, v131
v_add_f32 v38, v40, v41
v_cvt_pk_bf16_f32 v224, v40, v41
v_add_f32 v38, v38, v42
v_add_f32 v38, v38, v43
v_cvt_pk_bf16_f32 v225, v42, v43
v_exp_f32 v44, v132
v_exp_f32 v45, v133
v_exp_f32 v46, v134
v_exp_f32 v47, v135
v_add_f32 v39, v44, v45
v_cvt_pk_bf16_f32 v228, v44, v45
v_add_f32 v39, v39, v46
v_add_f32 v39, v39, v47
v_cvt_pk_bf16_f32 v229, v46, v47
v_exp_f32 v40, v136
v_exp_f32 v41, v137
v_exp_f32 v42, v138
v_exp_f32 v43, v139
v_add_f32 v36, v36, v40
v_add_f32 v36, v36, v41
v_cvt_pk_bf16_f32 v218, v40, v41
v_add_f32 v36, v36, v42
v_add_f32 v36, v36, v43
v_cvt_pk_bf16_f32 v219, v42, v43
v_exp_f32 v44, v140
v_exp_f32 v45, v141
v_exp_f32 v46, v142
v_exp_f32 v47, v143
v_add_f32 v37, v37, v44
v_add_f32 v37, v37, v45
v_cvt_pk_bf16_f32 v222, v44, v45
v_add_f32 v37, v37, v46
v_add_f32 v37, v37, v47
v_cvt_pk_bf16_f32 v223, v46, v47
v_exp_f32 v40, v144
v_exp_f32 v41, v145
v_exp_f32 v42, v146
v_exp_f32 v43, v147
v_add_f32 v38, v38, v40
v_add_f32 v38, v38, v41
v_cvt_pk_bf16_f32 v226, v40, v41
v_add_f32 v38, v38, v42
v_add_f32 v38, v38, v43
v_cvt_pk_bf16_f32 v227, v42, v43
v_exp_f32 v44, v148
v_exp_f32 v45, v149
v_exp_f32 v46, v150
v_exp_f32 v47, v151
v_add_f32 v39, v39, v44
v_add_f32 v39, v39, v45
v_cvt_pk_bf16_f32 v230, v44, v45
v_add_f32 v39, v39, v46
v_add_f32 v39, v39, v47
v_cvt_pk_bf16_f32 v231, v46, v47
v_exp_f32 v40, v152
v_exp_f32 v41, v153
v_exp_f32 v42, v154
v_exp_f32 v43, v155
v_add_f32 v36, v36, v40
v_add_f32 v36, v36, v41
v_cvt_pk_bf16_f32 v232, v40, v41
v_add_f32 v36, v36, v42
v_add_f32 v36, v36, v43
v_cvt_pk_bf16_f32 v233, v42, v43
v_exp_f32 v44, v156
v_exp_f32 v45, v157
v_exp_f32 v46, v158
v_exp_f32 v47, v159
v_add_f32 v37, v37, v44
v_add_f32 v37, v37, v45
v_cvt_pk_bf16_f32 v236, v44, v45
v_add_f32 v37, v37, v46
v_add_f32 v37, v37, v47
v_cvt_pk_bf16_f32 v237, v46, v47
v_exp_f32 v40, v160
v_exp_f32 v41, v161
v_exp_f32 v42, v162
v_exp_f32 v43, v163
v_add_f32 v38, v38, v40
v_add_f32 v38, v38, v41
v_cvt_pk_bf16_f32 v240, v40, v41
v_add_f32 v38, v38, v42
v_add_f32 v38, v38, v43
v_cvt_pk_bf16_f32 v241, v42, v43
v_exp_f32 v44, v164
v_exp_f32 v45, v165
v_exp_f32 v46, v166
v_exp_f32 v47, v167
v_add_f32 v39, v39, v44
v_add_f32 v39, v39, v45
v_cvt_pk_bf16_f32 v244, v44, v45
v_add_f32 v39, v39, v46
v_add_f32 v39, v39, v47
v_cvt_pk_bf16_f32 v245, v46, v47
v_exp_f32 v40, v168
v_exp_f32 v41, v169
v_exp_f32 v42, v170
v_exp_f32 v43, v171
v_add_f32 v36, v36, v40
v_add_f32 v36, v36, v41
v_cvt_pk_bf16_f32 v234, v40, v41
v_add_f32 v36, v36, v42
v_add_f32 v36, v36, v43
v_cvt_pk_bf16_f32 v235, v42, v43
v_exp_f32 v44, v172
v_exp_f32 v45, v173
v_exp_f32 v46, v174
v_exp_f32 v47, v175
v_add_f32 v37, v37, v44
v_add_f32 v37, v37, v45
v_cvt_pk_bf16_f32 v238, v44, v45
v_add_f32 v37, v37, v46
v_add_f32 v37, v37, v47
v_cvt_pk_bf16_f32 v239, v46, v47
v_exp_f32 v40, v176
v_exp_f32 v41, v177
v_exp_f32 v42, v178
v_exp_f32 v43, v179
v_add_f32 v38, v38, v40
v_add_f32 v38, v38, v41
v_cvt_pk_bf16_f32 v242, v40, v41
v_add_f32 v38, v38, v42
v_add_f32 v38, v38, v43
v_cvt_pk_bf16_f32 v243, v42, v43
v_exp_f32 v44, v180
v_exp_f32 v45, v181
v_exp_f32 v46, v182
v_exp_f32 v47, v183
v_add_f32 v39, v39, v44
v_add_f32 v39, v39, v45
v_cvt_pk_bf16_f32 v246, v44, v45
v_add_f32 v39, v39, v46
v_add_f32 v39, v39, v47
v_cvt_pk_bf16_f32 v247, v46, v47
s_nop 3
s_setpc_b64 s[46:47]
.section .rodata,"a"
.p2align 6
.amdhsa_kernel recurrent_scan__mha_block_cached__glu_gated_swiglu__prompt_kernel
  .amdhsa_next_free_vgpr 512
  .amdhsa_next_free_sgpr 102
  .amdhsa_accum_offset 256
  .amdhsa_group_segment_fixed_size 0
  .amdhsa_kernarg_size 96
  .amdhsa_user_sgpr_count 2
  .amdhsa_user_sgpr_kernarg_segment_ptr 1
  .amdhsa_system_sgpr_workgroup_id_x 1
  .amdhsa_float_denorm_mode_32 3
  .amdhsa_float_denorm_mode_16_64 3
.end_amdhsa_kernel
```
